```python
import torch

def _softmax(x, axis=-1):
    return torch.softmax(x, dim=axis)
def _gelu(x):
    return torch.nn.functional.gelu(x, approximate="tanh")
def _silu(x):
    return torch.nn.functional.silu(x)
def _sigmoid(x):
    return torch.sigmoid(x)
def _layernorm(x, axis=-1, eps=1e-5):
    m = x.mean(dim=axis, keepdim=True)
    v = x.var(dim=axis, keepdim=True, unbiased=False)
    return (x - m) / torch.sqrt(v + eps)
def _scatter_add(tgt, idx, src, axis=0):
    return tgt.clone().index_add_(axis, idx, src)
def _segment_sum(src, seg, n):
    out = torch.zeros((n,) + src.shape[1:], dtype=src.dtype)
    return out.index_add_(0, seg, src)
def _pad(x, pw):
    flat = tuple(v for pair in reversed(pw) for v in pair)
    return torch.nn.functional.pad(x, flat)

kernel_name = 'interleave_layers__ssm_conv_h3__mixer_channel_mlp__prompt'

def setup_inputs():

    _w = (lambda a: (lambda t: t.to(torch.bfloat16) if t.is_floating_point() else t)(torch.as_tensor(a)))
    def _A_setup():
        B, S, D = 1, 2048, 512
        ks = 4
        return {
            "q": _w((lambda *s: torch.randn(*s, dtype=torch.bfloat16) * 0.05)(B, S, D)),
            "k": _w((lambda *s: torch.randn(*s, dtype=torch.bfloat16) * 0.4)(B, S, D)),
            "v": _w((lambda *s: torch.randn(*s, dtype=torch.bfloat16) * 0.4)(B, S, D)),
            "shift_k": _w((lambda *s: torch.randn(*s, dtype=torch.bfloat16) * 0.4)(D, ks) * 0.5),
            "ssm_k": _w((lambda *s: torch.randn(*s, dtype=torch.bfloat16) * 0.4)(D, S) * (1.0 / S ** 0.5)),
            "ssm_D": _w((lambda *s: torch.randn(*s, dtype=torch.bfloat16) * 0.4)(D)),
        }
    _A_in = _A_setup()

    def _B_setup():
        B, S, D, F = 1, 2048, 512, 1792
        return {
            "x": _w((lambda *s: torch.randn(*s, dtype=torch.bfloat16) * 0.05)(B, S, D)),
            "w1": _w((lambda *s: torch.randn(*s, dtype=torch.bfloat16) * 0.8)(D, F) * (D ** -0.5)),
            "b1": _w((lambda *s: torch.randn(*s, dtype=torch.bfloat16) * 0.8)(F)),
            "w2": _w((lambda *s: torch.randn(*s, dtype=torch.bfloat16) * 0.8)(F, D) * (F ** -0.5)),
            "b2": _w((lambda *s: torch.randn(*s, dtype=torch.bfloat16) * 0.2)(D)),
        }
    _B_in = _B_setup()

    return {
        "A_q": _A_in["q"],
        "A_k": _A_in["k"],
        "A_v": _A_in["v"],
        "A_shift_k": _A_in["shift_k"],
        "A_ssm_k": _A_in["ssm_k"],
        "A_ssm_D": _A_in["ssm_D"],
        "B_x": _B_in["x"],
        "B_w1": _B_in["w1"],
        "B_b1": _B_in["b1"],
        "B_w2": _B_in["w2"],
        "B_b2": _B_in["b2"],
    }

def reference(A_q, A_k, A_v, A_shift_k, A_ssm_k, A_ssm_D, B_x, B_w1, B_b1, B_w2, B_b2):
    def _A_ref(q, k, v, shift_k, ssm_k, ssm_D):
        B, S, D = q.shape
        ks = shift_k.shape[-1]
        k_pad = _pad(k, ((0, 0), (ks - 1, 0), (0, 0)))
        k_shift = torch.zeros_like(k)
        for t in range(ks):
            k_shift = k_shift + k_pad[:, t:t + S, :] * shift_k[:, ks - 1 - t][None, None, :]
        kv = k_shift * v
        L = 2 * S
        kv_pad = _pad(kv, ((0, 0), (0, S), (0, 0)))
        kf_pad = _pad(ssm_k, ((0, 0), (0, S)))
        kv_f = (lambda x, axes=(-2,-1): torch.fft.rfft2(x.float(), dim=axes))(kv_pad[:, None, :, :], axes=(1, 2))
        kf_f = (lambda x, axes=(-2,-1): torch.fft.rfft2(x.float(), dim=axes))(kf_pad[:, None, :], axes=(1, 2))
        kf_f = (lambda x, *d: x.permute(*d))(kf_f, 1, 2, 0)
        y_f = kv_f * kf_f[None, :, :, :]
        y = (lambda x, s, axes=(-2,-1): torch.fft.irfft2(x, s=s, dim=axes).to(torch.bfloat16))(y_f, (1, L), axes=(1, 2))[:, 0, :S, :]
        y = y + kv * ssm_D[None, None, :]
        return q * y

    def _B_ref(x, w1, b1, w2, b2):
        y = _layernorm(x, axis=-1)
        h = _gelu(torch.einsum("bsd,df->bsf", y, w1) + b1)
        return torch.einsum("bsf,fd->bsd", h, w2) + b2

    x = A_q
    x = x + _A_ref(_layernorm(x, axis=-1), A_k, A_v, A_shift_k, A_ssm_k, A_ssm_D)
    x = x + _B_ref(_layernorm(x, axis=-1), B_w1, B_b1, B_w2, B_b2)
    x = x + _A_ref(_layernorm(x, axis=-1), A_k, A_v, A_shift_k, A_ssm_k, A_ssm_D)
    x = x + _B_ref(_layernorm(x, axis=-1), B_w1, B_b1, B_w2, B_b2)
    return x
```

```asm
; @launch grid=(256,1,1) block=(256,1,1) lds=163840
.amdgcn_target "amdgcn-amd-amdhsa--gfx950"
.text
.globl interleave_layers__ssm_conv_h3__mixer_channel_mlp__prompt_kernel
.p2align 8
.type interleave_layers__ssm_conv_h3__mixer_channel_mlp__prompt_kernel,@function
interleave_layers__ssm_conv_h3__mixer_channel_mlp__prompt_kernel:
.set CODE_BYTES, L_slow - interleave_layers__ssm_conv_h3__mixer_channel_mlp__prompt_kernel
    s_cmp_ge_u32 s2, 256
    s_cbranch_scc1 L_end
    s_load_dwordx16 s[16:31], s[0:1], 0
    s_load_dwordx8 s[32:39], s[0:1], 64
    s_load_dwordx4 s[40:43], s[0:1], 96
    s_getpc_b64 s[68:69]
    s_and_b32 s48, s2, 7
    s_lshr_b32 s49, s2, 3
    s_mov_b32 s52, 0
    s_getreg_b32 s101, hwreg(HW_REG_XCC_ID)
    s_min_u32 s101, s101, 8
    v_lshrrev_b32 v4, 6, v0
    v_and_b32 v1, 63, v0
    v_readfirstlane_b32 s50, v4
    v_lshlrev_b32 v2, 4, v1
    s_and_b32 s68, s68, 0xffffff00
    s_and_b32 s69, s69, 0xffff
    s_mov_b32 s72, s68
    s_mov_b32 s73, s69
    s_mov_b32 s74, CODE_BYTES
    s_mov_b32 s75, 0x00020000
    v_lshlrev_b32 v87, 7, v0
    buffer_load_dword v254, v87, s[72:75], 0 offen
    v_add_u32 v87, 0x8000, v87
    buffer_load_dword v254, v87, s[72:75], 0 offen
    s_waitcnt lgkmcnt(0)
    s_mov_b32 s44, s42
    s_and_b32 s45, s43, 0xffff
    s_mov_b32 s46, 268435456
    s_mov_b32 s47, 0x00020000
    buffer_load_dword v3, off, s[44:47], 0 sc1
    v_lshrrev_b32 v8, 3, v0
    v_and_b32 v9, 7, v0
    v_lshlrev_b32 v8, 15, v8
    v_lshl_add_u32 v8, v9, 4, v8
    s_lshl_b32 s53, s48, 5
    s_add_u32 s53, s53, s49
    s_lshl_b32 s53, s53, 7
    s_add_u32 s53, s53, 7340032
    v_mov_b32 v160, -1
    v_mov_b32 v161, -1
    v_mov_b32 v162, -1
    v_mov_b32 v163, -1
    v_lshrrev_b32 v4, 5, v0
    v_and_b32 v5, 31, v0
    s_lshl_b32 s53, s49, 16
    s_lshl_b32 s54, s48, 7
    s_add_u32 s53, s53, s54
    v_lshlrev_b32 v6, 13, v4
    v_lshl_add_u32 v6, v5, 2, v6
    v_add_u32 v6, s53, v6
    v_subrev_u32 v7, 3072, v6
    v_add_u32 v8, 4096, v6
    s_mov_b32 s4, s18
    s_and_b32 s5, s19, 0xffff
    s_mov_b32 s6, 2097152
    s_mov_b32 s7, 0x00020000
    s_mov_b32 s8, s20
    s_and_b32 s9, s21, 0xffff
    s_mov_b32 s10, 2097152
    s_mov_b32 s11, 0x00020000
    s_mov_b32 s12, s22
    s_and_b32 s13, s23, 0xffff
    s_mov_b32 s14, 4096
    s_mov_b32 s15, 0x00020000
    buffer_load_dword v10, v7, s[4:7], 0 offen
    buffer_load_dword v11, v7, s[4:7], 0 offen offset:1024
    buffer_load_dword v12, v7, s[4:7], 0 offen offset:2048
    buffer_load_dword v13, v6, s[4:7], 0 offen
    buffer_load_dword v14, v6, s[4:7], 0 offen offset:1024
    buffer_load_dword v15, v6, s[4:7], 0 offen offset:2048
    buffer_load_dword v16, v6, s[4:7], 0 offen offset:3072
    buffer_load_dword v17, v8, s[4:7], 0 offen
    buffer_load_dword v18, v8, s[4:7], 0 offen offset:1024
    buffer_load_dword v19, v8, s[4:7], 0 offen offset:2048
    buffer_load_dword v20, v8, s[4:7], 0 offen offset:3072
    buffer_load_dword v21, v6, s[8:11], 0 offen
    buffer_load_dword v22, v6, s[8:11], 0 offen offset:1024
    buffer_load_dword v23, v6, s[8:11], 0 offen offset:2048
    buffer_load_dword v24, v6, s[8:11], 0 offen offset:3072
    buffer_load_dword v25, v8, s[8:11], 0 offen
    buffer_load_dword v26, v8, s[8:11], 0 offen offset:1024
    buffer_load_dword v27, v8, s[8:11], 0 offen offset:2048
    buffer_load_dword v28, v8, s[8:11], 0 offen offset:3072
    s_lshl_b32 s53, s48, 9
    v_lshlrev_b32 v9, 4, v5
    v_add_u32 v9, s53, v9
    buffer_load_dwordx4 v[30:33], v9, s[12:15], 0 offen
    s_lshl_b32 s53, s48, 5
    s_add_u32 s53, s53, s49
    s_lshl_b32 s53, s53, 1
    s_lshr_b32 s54, s50, 1
    s_add_u32 s53, s53, s54
    s_lshl_b32 s53, s53, 12
    s_add_u32 s12, s24, s53
    s_addc_u32 s13, s25, 0
    s_and_b32 s13, s13, 0xffff
    s_mov_b32 s14, 4096
    s_mov_b32 s15, 0x00020000
    v_and_b32 v54, 127, v0
    v_lshlrev_b32 v51, 4, v54
    v_subrev_u32 v52, 64, v51
    v_subrev_u32 v53, 48, v51
    buffer_load_dwordx4 v[56:59], v52, s[12:15], 0 offen
    buffer_load_dwordx4 v[60:63], v53, s[12:15], 0 offen
    v_add_u32 v52, 2048, v52
    v_add_u32 v53, 2048, v53
    buffer_load_dwordx4 v[64:67], v52, s[12:15], 0 offen
    buffer_load_dwordx4 v[68:71], v53, s[12:15], 0 offen
    v_add_u32 v52, 2048, v52
    v_add_u32 v53, 2048, v53
    buffer_load_dwordx4 v[72:75], v52, s[12:15], 0 offen
    buffer_load_dwordx4 v[76:79], v53, s[12:15], 0 offen
    s_lshl_b32 s53, s48, 5
    s_add_u32 s53, s53, s49
    s_lshl_b32 s53, s53, 7
    s_add_u32 s53, s53, 7340032
    v_lshrrev_b32 v85, 3, v0
    v_and_b32 v86, 7, v0
    v_lshlrev_b32 v85, 15, v85
    v_lshl_add_u32 v85, v86, 4, v85
    buffer_store_dwordx4 v[160:163], v85, s[44:47], s53 offen sc1
    s_add_u32 s53, s53, 1048576
    buffer_store_dwordx4 v[160:163], v85, s[44:47], s53 offen sc1
    s_lshl_b32 s53, s48, 5
    s_add_u32 s53, s53, s49
    s_lshl_b32 s53, s53, 2
    s_add_u32 s54, s26, s53
    s_addc_u32 s55, s27, 0
    s_load_dword s60, s[54:55], 0
    s_min_u32 s58, s101, 7
    s_lshl_b32 s53, s58, 18
    s_lshl_b32 s54, s49, 13
    s_add_u32 s53, s53, s54
    v_lshlrev_b32 v88, 7, v1
    s_cmp_lg_u32 s50, 3
    s_cbranch_scc1 L_pt_1
    s_mov_b32 s72, s16
    s_and_b32 s73, s17, 0xffff
    s_mov_b32 s74, 2097152
    s_mov_b32 s75, 0x00020000
    buffer_load_dword v255, v88, s[72:75], s53 offen
    s_mov_b32 s72, s32
    s_and_b32 s73, s33, 0xffff
    s_mov_b32 s74, 3584
    s_mov_b32 s75, 0x00020000
    buffer_load_dword v255, v88, s[72:75], 0 offen
    s_mov_b32 s72, s36
    s_and_b32 s73, s37, 0xffff
    s_mov_b32 s74, 1024
    s_mov_b32 s75, 0x00020000
    buffer_load_dword v255, v88, s[72:75], 0 offen
    s_mov_b32 s72, s38
    s_and_b32 s73, s39, 0xffff
    s_mov_b32 s74, 2097152
    s_mov_b32 s75, 0x00020000
    buffer_load_dword v255, off, s[72:75], s53
    v_lshlrev_b32 v87, 21, v1
    v_min_u32 v87, 0x1c00000, v87
    buffer_load_dword v255, v87, s[44:47], 0 offen
L_pt_1:
    v_mov_b32 v80, 0
    v_mov_b32 v81, 0
    v_mov_b32 v82, 0
    v_mov_b32 v83, 0
    v_lshlrev_b32 v84, 4, v0
    v_cmp_gt_u32 vcc, 90, v0
    s_and_saveexec_b64 s[56:57], vcc
    ds_write_b128 v84, v[80:83] offset:31744
    ds_write_b128 v84, v[80:83] offset:39328
    s_mov_b64 exec, s[56:57]
    s_waitcnt vmcnt(8)
    v_add_u32 v3, 16, v3
    v_lshlrev_b32 v90, 16, v30
    v_lshlrev_b32 v91, 16, v32
    v_readfirstlane_b32 s51, v3
    v_and_b32 v92, 0xffff0000, v30
    v_and_b32 v93, 0xffff0000, v32
    v_lshlrev_b32 v94, 16, v31
    v_lshlrev_b32 v95, 16, v33
    v_and_b32 v96, 0xffff0000, v31
    v_and_b32 v97, 0xffff0000, v33
    s_cmp_lg_u32 s50, 0
    s_cbranch_scc1 L_noxc_2
    s_lshl_b32 s53, s2, 2
    s_add_u32 s53, s53, 14336
    v_add_u32 v85, s101, v3
    buffer_store_dword v85, off, s[44:47], s53 sc1
L_noxc_2:
    v_lshlrev_b32 v100, 16, v10
    v_and_b32 v101, 0xffff0000, v10
    v_lshlrev_b32 v102, 16, v11
    v_and_b32 v103, 0xffff0000, v11
    v_lshlrev_b32 v104, 16, v12
    v_and_b32 v105, 0xffff0000, v12
    v_lshlrev_b32 v106, 16, v13
    v_and_b32 v107, 0xffff0000, v13
    v_lshlrev_b32 v108, 16, v14
    v_and_b32 v109, 0xffff0000, v14
    v_lshlrev_b32 v110, 16, v15
    v_and_b32 v111, 0xffff0000, v15
    v_lshlrev_b32 v112, 16, v16
    v_and_b32 v113, 0xffff0000, v16
    v_lshlrev_b32 v114, 16, v17
    v_and_b32 v115, 0xffff0000, v17
    v_lshlrev_b32 v116, 16, v18
    v_and_b32 v117, 0xffff0000, v18
    v_lshlrev_b32 v118, 16, v19
    v_and_b32 v119, 0xffff0000, v19
    v_lshlrev_b32 v120, 16, v20
    v_and_b32 v121, 0xffff0000, v20
    v_lshlrev_b32 v122, 16, v21
    v_and_b32 v123, 0xffff0000, v21
    v_lshlrev_b32 v124, 16, v22
    v_and_b32 v125, 0xffff0000, v22
    v_lshlrev_b32 v126, 16, v23
    v_and_b32 v127, 0xffff0000, v23
    v_lshlrev_b32 v128, 16, v24
    v_and_b32 v129, 0xffff0000, v24
    v_lshlrev_b32 v130, 16, v25
    v_and_b32 v131, 0xffff0000, v25
    v_lshlrev_b32 v132, 16, v26
    v_and_b32 v133, 0xffff0000, v26
    v_lshlrev_b32 v134, 16, v27
    v_and_b32 v135, 0xffff0000, v27
    v_lshlrev_b32 v136, 16, v28
    v_and_b32 v137, 0xffff0000, v28
    v_pk_mul_f32 v[140:141], v[100:101], v[96:97]
    v_pk_mul_f32 v[142:143], v[102:103], v[96:97]
    v_pk_mul_f32 v[144:145], v[104:105], v[96:97]
    v_pk_mul_f32 v[146:147], v[106:107], v[96:97]
    v_pk_mul_f32 v[148:149], v[108:109], v[96:97]
    v_pk_mul_f32 v[150:151], v[110:111], v[96:97]
    v_pk_mul_f32 v[152:153], v[112:113], v[96:97]
    v_pk_mul_f32 v[154:155], v[114:115], v[96:97]
    v_pk_fma_f32 v[140:141], v[102:103], v[94:95], v[140:141]
    v_pk_fma_f32 v[142:143], v[104:105], v[94:95], v[142:143]
    v_pk_fma_f32 v[144:145], v[106:107], v[94:95], v[144:145]
    v_pk_fma_f32 v[146:147], v[108:109], v[94:95], v[146:147]
    v_pk_fma_f32 v[148:149], v[110:111], v[94:95], v[148:149]
    v_pk_fma_f32 v[150:151], v[112:113], v[94:95], v[150:151]
    v_pk_fma_f32 v[152:153], v[114:115], v[94:95], v[152:153]
    v_pk_fma_f32 v[154:155], v[116:117], v[94:95], v[154:155]
    v_pk_fma_f32 v[140:141], v[104:105], v[92:93], v[140:141]
    v_pk_fma_f32 v[142:143], v[106:107], v[92:93], v[142:143]
    v_pk_fma_f32 v[144:145], v[108:109], v[92:93], v[144:145]
    v_pk_fma_f32 v[146:147], v[110:111], v[92:93], v[146:147]
    v_pk_fma_f32 v[148:149], v[112:113], v[92:93], v[148:149]
    v_pk_fma_f32 v[150:151], v[114:115], v[92:93], v[150:151]
    v_pk_fma_f32 v[152:153], v[116:117], v[92:93], v[152:153]
    v_pk_fma_f32 v[154:155], v[118:119], v[92:93], v[154:155]
    v_pk_fma_f32 v[140:141], v[106:107], v[90:91], v[140:141]
    v_pk_fma_f32 v[142:143], v[108:109], v[90:91], v[142:143]
    v_pk_fma_f32 v[144:145], v[110:111], v[90:91], v[144:145]
    v_pk_fma_f32 v[146:147], v[112:113], v[90:91], v[146:147]
    v_pk_fma_f32 v[148:149], v[114:115], v[90:91], v[148:149]
    v_pk_fma_f32 v[150:151], v[116:117], v[90:91], v[150:151]
    v_pk_fma_f32 v[152:153], v[118:119], v[90:91], v[152:153]
    v_pk_fma_f32 v[154:155], v[120:121], v[90:91], v[154:155]
    v_pk_mul_f32 v[140:141], v[140:141], v[122:123]
    v_pk_mul_f32 v[142:143], v[142:143], v[124:125]
    v_pk_mul_f32 v[144:145], v[144:145], v[126:127]
    v_pk_mul_f32 v[146:147], v[146:147], v[128:129]
    v_pk_mul_f32 v[148:149], v[148:149], v[130:131]
    v_pk_mul_f32 v[150:151], v[150:151], v[132:133]
    v_pk_mul_f32 v[152:153], v[152:153], v[134:135]
    v_pk_mul_f32 v[154:155], v[154:155], v[136:137]
    v_cvt_pk_bf16_f32 v160, v154, v152
    v_cvt_pk_bf16_f32 v164, v155, v153
    v_cvt_pk_bf16_f32 v161, v150, v148
    v_cvt_pk_bf16_f32 v165, v151, v149
    v_cvt_pk_bf16_f32 v162, v146, v144
    v_cvt_pk_bf16_f32 v166, v147, v145
    v_cvt_pk_bf16_f32 v163, v142, v140
    v_cvt_pk_bf16_f32 v167, v143, v141
    v_sub_u32 v85, 7, v4
    v_and_b32 v9, 7, v5
    v_xor_b32 v85, v85, v9
    v_lshlrev_b32 v85, 4, v85
    v_lshl_add_u32 v85, v5, 8, v85
    ds_write_b128 v85, v[160:163] offset:0
    ds_write_b128 v85, v[164:167] offset:128
    v_lshrrev_b32 v85, 3, v0
    v_and_b32 v9, 7, v0
    v_bfe_u32 v29, v85, 1, 3
    v_xor_b32 v29, v29, v9
    v_lshlrev_b32 v29, 4, v29
    v_lshl_add_u32 v29, v85, 7, v29
    s_lshl_b32 s53, s48, 18
    s_lshl_b32 s54, s49, 7
    s_sub_u32 s53, s53, s54
    s_add_u32 s53, s53, 1052544
    v_lshlrev_b32 v50, 12, v85
    v_lshl_add_u32 v50, v9, 4, v50
    v_add_u32 v51, 0x20000, v50
    s_waitcnt lgkmcnt(0)
    s_barrier
    ds_read_b128 v[160:163], v29 offset:0
    ds_read_b128 v[164:167], v29 offset:4096
    s_waitcnt lgkmcnt(1)
    buffer_store_dwordx4 v[160:163], v50, s[44:47], s53 offen sc1
    s_waitcnt lgkmcnt(0)
    buffer_store_dwordx4 v[164:167], v51, s[44:47], s53 offen sc1
    s_mov_b32 s4, s30
    s_and_b32 s5, s31, 0xffff
    s_mov_b32 s6, 1835008
    s_mov_b32 s7, 0x00020000
    s_mov_b32 s8, s34
    s_and_b32 s9, s35, 0xffff
    s_mov_b32 s10, 1835008
    s_mov_b32 s11, 0x00020000
    s_lshl_b32 s53, s49, 4
    s_lshl_b32 s54, s50, 2
    s_add_u32 s53, s53, s54
    s_mul_i32 s53, s53, 3584
    s_mul_i32 s54, s48, 448
    s_add_u32 s53, s53, s54
    v_lshrrev_b32 v34, 4, v1
    v_and_b32 v9, 15, v1
    v_mul_u32_u24 v29, 3584, v34
    v_lshl_add_u32 v29, v9, 4, v29
    v_add_u32 v29, s53, v29
    buffer_load_dwordx4 v[196:199], v29, s[4:7], 0 offen
    buffer_load_dwordx4 v[200:203], v29, s[4:7], 0 offen offset:256
    s_lshr_b32 s53, s2, 1
    s_lshl_b32 s53, s53, 14
    s_and_b32 s54, s2, 1
    s_lshl_b32 s54, s54, 9
    s_add_u32 s53, s53, s54
    v_lshrrev_b32 v42, 4, v0
    v_lshlrev_b32 v50, 10, v42
    v_lshl_add_u32 v50, v9, 4, v50
    v_add_u32 v50, s53, v50
    buffer_load_dwordx4 v[204:207], v50, s[8:11], 0 offen
    buffer_load_dwordx4 v[208:211], v50, s[8:11], 0 offen offset:256
    s_waitcnt vmcnt(4)
    s_barrier
    s_cmp_lg_u32 s50, 0
    s_cbranch_scc1 L_noflag_3
    s_lshl_b32 s53, s48, 5
    s_add_u32 s53, s53, s49
    s_lshl_b32 s53, s53, 2
    s_add_u32 s53, s53, 4096
    buffer_store_dword v3, off, s[44:47], s53 sc1
L_noflag_3:
    v_and_b32 v54, 127, v0
    v_lshlrev_b32 v50, 4, v54
    s_lshr_b32 s53, s50, 1
    s_mul_i32 s53, s53, 33280
    s_add_u32 s53, s53, 40960
    v_add_u32 v50, s53, v50
    v_alignbit_b32 v100, v57, v56, 16
    v_alignbit_b32 v101, v58, v57, 16
    v_alignbit_b32 v102, v59, v58, 16
    v_alignbit_b32 v103, v60, v59, 16
    v_alignbit_b32 v104, v61, v60, 16
    v_alignbit_b32 v105, v62, v61, 16
    v_alignbit_b32 v106, v63, v62, 16
    v_alignbit_b32 v110, v58, v57, 16
    v_alignbit_b32 v111, v59, v58, 16
    v_alignbit_b32 v112, v60, v59, 16
    v_alignbit_b32 v113, v61, v60, 16
    v_alignbit_b32 v114, v62, v61, 16
    v_alignbit_b32 v115, v63, v62, 16
    v_mov_b32 v120, v57
    v_mov_b32 v121, v58
    v_mov_b32 v122, v59
    v_mov_b32 v123, v60
    v_mov_b32 v124, v61
    v_mov_b32 v125, v62
    ds_write_b128 v50, v[100:103] offset:0
    ds_write_b128 v50, v[120:123] offset:4160
    ds_write_b128 v50, v[110:113] offset:8320
    ds_write_b128 v50, v[58:61] offset:12480
    ds_write_b128 v50, v[102:105] offset:16640
    ds_write_b128 v50, v[122:125] offset:20800
    ds_write_b128 v50, v[112:115] offset:24960
    ds_write_b128 v50, v[60:63] offset:29120
    s_nop 0
    v_alignbit_b32 v100, v65, v64, 16
    v_alignbit_b32 v101, v66, v65, 16
    v_alignbit_b32 v102, v67, v66, 16
    v_alignbit_b32 v103, v68, v67, 16
    v_alignbit_b32 v104, v69, v68, 16
    v_alignbit_b32 v105, v70, v69, 16
    v_alignbit_b32 v106, v71, v70, 16
    v_alignbit_b32 v110, v66, v65, 16
    v_alignbit_b32 v111, v67, v66, 16
    v_alignbit_b32 v112, v68, v67, 16
    v_alignbit_b32 v113, v69, v68, 16
    v_alignbit_b32 v114, v70, v69, 16
    v_alignbit_b32 v115, v71, v70, 16
    v_mov_b32 v120, v65
    v_mov_b32 v121, v66
    v_mov_b32 v122, v67
    v_mov_b32 v123, v68
    v_mov_b32 v124, v69
    v_mov_b32 v125, v70
    ds_write_b128 v50, v[100:103] offset:2048
    ds_write_b128 v50, v[120:123] offset:6208
    ds_write_b128 v50, v[110:113] offset:10368
    ds_write_b128 v50, v[66:69] offset:14528
    ds_write_b128 v50, v[102:105] offset:18688
    ds_write_b128 v50, v[122:125] offset:22848
    ds_write_b128 v50, v[112:115] offset:27008
    ds_write_b128 v50, v[68:71] offset:31168
    s_nop 0
    v_cmp_gt_u32 vcc, 3, v54
    s_and_saveexec_b64 s[56:57], vcc
    v_alignbit_b32 v100, v73, v72, 16
    v_alignbit_b32 v101, v74, v73, 16
    v_alignbit_b32 v102, v75, v74, 16
    v_alignbit_b32 v103, v76, v75, 16
    v_alignbit_b32 v104, v77, v76, 16
    v_alignbit_b32 v105, v78, v77, 16
    v_alignbit_b32 v106, v79, v78, 16
    v_alignbit_b32 v110, v74, v73, 16
    v_alignbit_b32 v111, v75, v74, 16
    v_alignbit_b32 v112, v76, v75, 16
    v_alignbit_b32 v113, v77, v76, 16
    v_alignbit_b32 v114, v78, v77, 16
    v_alignbit_b32 v115, v79, v78, 16
    v_mov_b32 v120, v73
    v_mov_b32 v121, v74
    v_mov_b32 v122, v75
    v_mov_b32 v123, v76
    v_mov_b32 v124, v77
    v_mov_b32 v125, v78
    ds_write_b128 v50, v[100:103] offset:4096
    ds_write_b128 v50, v[120:123] offset:8256
    ds_write_b128 v50, v[110:113] offset:12416
    ds_write_b128 v50, v[74:77] offset:16576
    ds_write_b128 v50, v[102:105] offset:20736
    ds_write_b128 v50, v[122:125] offset:24896
    ds_write_b128 v50, v[112:115] offset:29056
    ds_write_b128 v50, v[76:79] offset:33216
    s_mov_b64 exec, s[56:57]
    s_lshl_b32 s53, s48, 7
    s_add_u32 s53, s53, 4096
    v_and_b32 v5, 31, v1
    v_lshlrev_b32 v5, 2, v5
    v_add_u32 v5, s53, v5
    s_cmp_lg_u32 s50, 0
    s_cbranch_scc1 L_np_4
    s_mov_b32 s53, 0
L_poll_5:
    buffer_load_dword v8, v5, s[44:47], 0 offen sc1
    s_waitcnt vmcnt(0)
    v_cmp_ne_u32 vcc, s51, v8
    s_cbranch_vccz L_polld_6
    s_add_u32 s53, s53, 1
    s_cmp_lg_u32 s52, 0
    s_cbranch_scc1 L_polld_6
    s_cmp_lt_u32 s53, 0x8000
    s_cbranch_scc1 L_poll_5
    s_mov_b32 s52, 1
L_polld_6:
L_np_4:
    s_waitcnt vmcnt(0)
    s_barrier
    s_lshl_b32 s53, s48, 5
    s_add_u32 s53, s53, s49
    s_lshl_b32 s61, s53, 7
    s_lshl_b32 s53, s53, 13
    s_add_u32 s53, s53, 1048576
    v_lshlrev_b32 v5, 4, v0
    buffer_load_dwordx4 v[184:187], v5, s[44:47], s53 offen sc1
    s_add_u32 s53, s53, 4096
    buffer_load_dwordx4 v[188:191], v5, s[44:47], s53 offen sc1
    v_add_u32 v132, 14336, v2
    buffer_load_dwordx4 v[128:131], v132, s[44:47], 0 offen sc1
    v_lshrrev_b32 v212, 4, v0
    v_and_b32 v213, 15, v0
    v_mul_u32_u24 v214, 448, v212
    v_lshl_add_u32 v214, v213, 4, v214
    ds_write_b128 v214, v[196:199] offset:8192
    v_cmp_gt_u32 vcc, 12, v213
    s_and_saveexec_b64 s[56:57], vcc
    ds_write_b128 v214, v[200:203] offset:8448
    s_mov_b64 exec, s[56:57]
    v_mul_u32_u24 v214, 576, v212
    v_lshl_add_u32 v214, v213, 4, v214
    ds_write_b128 v214, v[204:207] offset:16384
    ds_write_b128 v214, v[208:211] offset:16640
    v_lshrrev_b32 v212, 5, v1
    v_bfe_u32 v213, v1, 2, 2
    v_bfe_u32 v214, v1, 4, 1
    v_and_b32 v215, 3, v1
    v_lshlrev_b32 v215, 3, v215
    v_lshl_add_u32 v215, v214, 5, v215
    v_lshl_add_u32 v216, v212, 3, v213
    v_mul_u32_u24 v216, 448, v216
    v_add_u32 v216, v216, v215
    s_lshl_b32 s54, s50, 6
    v_add_u32 v216, s54, v216
    v_lshl_add_u32 v217, v212, 2, v213
    v_mul_u32_u24 v217, 576, v217
    v_add_u32 v217, v217, v215
    v_add_u32 v217, s54, v217
    s_waitcnt lgkmcnt(0)
    s_barrier
    ds_read_b64_tr_b16 v[168:169], v216 offset:8192
    ds_read_b64_tr_b16 v[170:171], v216 offset:9984
    ds_read_b64_tr_b16 v[172:173], v216 offset:8448
    ds_read_b64_tr_b16 v[174:175], v216 offset:10240
    ds_read_b64_tr_b16 v[176:177], v217 offset:16384
    ds_read_b64_tr_b16 v[178:179], v217 offset:20992
    ds_read_b64_tr_b16 v[180:181], v217 offset:16640
    ds_read_b64_tr_b16 v[182:183], v217 offset:21248
    s_mul_i32 s53, s48, 7
    s_add_u32 s53, s53, s50
    s_mul_i32 s54, s49, 56
    s_add_u32 s53, s53, s54
    s_lshl_b32 s53, s53, 10
    s_add_u32 s53, s53, 3145728
    s_add_u32 s55, s53, 4096
    s_lshl_b32 s57, s2, 12
    s_add_u32 s57, s57, 47185920
    s_cmp_eq_u32 s50, 3
    s_cselect_b32 s55, s57, s55
    s_waitcnt lgkmcnt(4)
    buffer_store_dwordx4 v[168:171], v2, s[44:47], s53 offen sc1
    buffer_store_dwordx4 v[172:175], v2, s[44:47], s55 offen sc1
    s_mov_b32 s4, s53
    s_mov_b32 s5, s55
    s_lshr_b32 s54, s2, 1
    s_mul_i32 s55, s54, 9363
    s_lshr_b32 s55, s55, 18
    s_mul_i32 s56, s55, 28
    s_sub_u32 s54, s54, s56
    s_lshl_b32 s54, s54, 2
    s_add_u32 s54, s54, s55
    s_lshl_b32 s54, s54, 4
    s_and_b32 s53, s2, 1
    s_lshl_b32 s53, s53, 3
    s_add_u32 s53, s53, s50
    s_add_u32 s53, s53, s54
    s_lshl_b32 s53, s53, 10
    s_add_u32 s53, s53, 5242880
    s_cmp_ge_u32 s2, 224
    s_cselect_b32 s53, s57, s53
    s_waitcnt lgkmcnt(0)
    buffer_store_dwordx4 v[176:179], v2, s[44:47], s53 offen sc1
    s_mov_b32 s6, s53
    s_add_u32 s54, s53, 4096
    s_cmp_ge_u32 s2, 224
    s_cselect_b32 s53, s57, s54
    buffer_store_dwordx4 v[180:183], v2, s[44:47], s53 offen sc1
    s_mov_b32 s7, s53
    v_lshrrev_b32 v4, 2, v0
    v_mul_u32_u24 v4, 96, v4
    v_and_b32 v5, 3, v0
    v_lshl_add_u32 v4, v5, 4, v4
    s_waitcnt vmcnt(6)
    ds_write_b128 v4, v[184:187] offset:25600
    s_waitcnt vmcnt(5)
    ds_write_b128 v4, v[188:191] offset:33184
    s_lshr_b32 s67, s50, 1
    s_and_b32 s59, s50, 1
    v_and_b32 v4, 15, v1
    v_lshrrev_b32 v5, 4, v1
    v_and_b32 v6, 7, v4
    v_mul_u32_u24 v6, 4160, v6
    v_and_b32 v7, 8, v4
    v_lshl_add_u32 v7, v5, 3, v7
    v_lshl_add_u32 v6, v7, 1, v6
    s_mul_i32 s55, s67, 33280
    s_lshl_b32 s56, s59, 5
    s_add_u32 s55, s55, s56
    s_add_u32 s55, s55, 40960
    v_add_u32 v6, s55, v6
    v_sub_u32 v7, 15, v4
    v_mul_u32_u24 v7, 96, v7
    v_lshl_add_u32 v7, v5, 4, v7
    s_mul_i32 s55, s67, 7584
    s_add_u32 s55, s55, 25600
    v_add_u32 v7, s55, v7
    s_waitcnt lgkmcnt(0)
    s_barrier
    v_mov_b32 v16, 0
    v_mov_b32 v17, 0
    v_mov_b32 v18, 0
    v_mov_b32 v19, 0
    v_mov_b32 v20, 0
    v_mov_b32 v21, 0
    v_mov_b32 v22, 0
    v_mov_b32 v23, 0
    v_mov_b32 v24, 0
    v_mov_b32 v25, 0
    v_mov_b32 v26, 0
    v_mov_b32 v27, 0
    v_mov_b32 v28, 0
    v_mov_b32 v29, 0
    v_mov_b32 v30, 0
    v_mov_b32 v31, 0
    ds_read_b128 v[48:51], v6 offset:0
    ds_read_b128 v[32:35], v7 offset:4608
    ds_read_b128 v[52:55], v6 offset:1024
    ds_read_b128 v[36:39], v7 offset:3072
    ds_read_b128 v[56:59], v6 offset:2048
    ds_read_b128 v[40:43], v7 offset:1536
    ds_read_b128 v[60:63], v6 offset:3072
    ds_read_b128 v[44:47], v7 offset:0
    ds_read_b128 v[80:83], v6 offset:64
    ds_read_b128 v[64:67], v7 offset:4704
    ds_read_b128 v[84:87], v6 offset:1088
    ds_read_b128 v[68:71], v7 offset:3168
    ds_read_b128 v[88:91], v6 offset:2112
    ds_read_b128 v[72:75], v7 offset:1632
    ds_read_b128 v[92:95], v6 offset:3136
    s_waitcnt lgkmcnt(7)
    v_mfma_f32_16x16x32_bf16 v[16:19], v[48:51], v[32:35], v[16:19]
    ds_read_b128 v[76:79], v7 offset:96
    v_mfma_f32_16x16x32_bf16 v[20:23], v[48:51], v[36:39], v[20:23]
    ds_read_b128 v[112:115], v6 offset:128
    v_mfma_f32_16x16x32_bf16 v[24:27], v[48:51], v[40:43], v[24:27]
    ds_read_b128 v[96:99], v7 offset:4800
    v_mfma_f32_16x16x32_bf16 v[28:31], v[48:51], v[44:47], v[28:31]
    ds_read_b128 v[116:119], v6 offset:1152
    v_mfma_f32_16x16x32_bf16 v[20:23], v[52:55], v[32:35], v[20:23]
    ds_read_b128 v[100:103], v7 offset:3264
    v_mfma_f32_16x16x32_bf16 v[24:27], v[52:55], v[36:39], v[24:27]
    ds_read_b128 v[120:123], v6 offset:2176
    v_mfma_f32_16x16x32_bf16 v[28:31], v[52:55], v[40:43], v[28:31]
    ds_read_b128 v[104:107], v7 offset:1728
    v_mfma_f32_16x16x32_bf16 v[24:27], v[56:59], v[32:35], v[24:27]
    ds_read_b128 v[124:127], v6 offset:3200
    v_mfma_f32_16x16x32_bf16 v[28:31], v[56:59], v[36:39], v[28:31]
    ds_read_b128 v[108:111], v7 offset:192
    v_mfma_f32_16x16x32_bf16 v[28:31], v[60:63], v[32:35], v[28:31]
    s_waitcnt vmcnt(4)
    s_mov_b32 s53, 0
L_fw_7:
    v_subrev_u32 v128, s51, v128
    v_subrev_u32 v129, s51, v129
    v_subrev_u32 v130, s51, v130
    v_subrev_u32 v131, s51, v131
    v_or_b32 v133, v128, v129
    v_or3_b32 v133, v133, v130, v131
    v_cmp_lt_u32 vcc, 15, v133
    s_cbranch_vccz L_fwd_8
    s_add_u32 s53, s53, 1
    s_cmp_lg_u32 s52, 0
    s_cbranch_scc1 L_fwd_8
    s_cmp_lt_u32 s53, 0x8000
    s_cbranch_scc0 L_fwd_8_ab
    buffer_load_dwordx4 v[128:131], v132, s[44:47], 0 offen sc1
    s_waitcnt vmcnt(0)
    s_branch L_fw_7
L_fwd_8_ab:
    s_mov_b32 s52, 1
L_fwd_8:
    s_waitcnt lgkmcnt(8)
    v_mfma_f32_16x16x32_bf16 v[16:19], v[80:83], v[64:67], v[16:19]
    ds_read_b128 v[48:51], v6 offset:192
    v_mov_b32 v137, 1
    v_mov_b32 v133, 0
    v_mfma_f32_16x16x32_bf16 v[20:23], v[80:83], v[68:71], v[20:23]
    ds_read_b128 v[32:35], v7 offset:4896
    v_mov_b32 v134, 0
    v_and_b32 v135, 3, v128
    v_mfma_f32_16x16x32_bf16 v[24:27], v[80:83], v[72:75], v[24:27]
    ds_read_b128 v[52:55], v6 offset:1216
    v_lshlrev_b32 v135, 3, v135
    v_lshlrev_b32 v135, v135, v137
    v_mfma_f32_16x16x32_bf16 v[28:31], v[80:83], v[76:79], v[28:31]
    ds_read_b128 v[36:39], v7 offset:3360
    v_lshrrev_b32 v136, 2, v128
    v_cmp_eq_u32 vcc, 0, v136
    v_mfma_f32_16x16x32_bf16 v[20:23], v[84:87], v[64:67], v[20:23]
    ds_read_b128 v[56:59], v6 offset:2240
    s_nop 1
    v_cndmask_b32 v138, 0, v135, vcc
    v_mfma_f32_16x16x32_bf16 v[24:27], v[84:87], v[68:71], v[24:27]
    ds_read_b128 v[40:43], v7 offset:1824
    v_cmp_eq_u32 vcc, 1, v136
    v_add_u32 v133, v133, v138
    v_mfma_f32_16x16x32_bf16 v[28:31], v[84:87], v[72:75], v[28:31]
    ds_read_b128 v[60:63], v6 offset:3264
    s_nop 0
    v_cndmask_b32 v138, 0, v135, vcc
    v_mfma_f32_16x16x32_bf16 v[24:27], v[88:91], v[64:67], v[24:27]
    ds_read_b128 v[44:47], v7 offset:288
    v_add_u32 v134, v134, v138
    v_and_b32 v135, 3, v129
    v_mfma_f32_16x16x32_bf16 v[28:31], v[88:91], v[68:71], v[28:31]
    v_lshlrev_b32 v135, 3, v135
    v_lshlrev_b32 v135, v135, v137
    v_mfma_f32_16x16x32_bf16 v[28:31], v[92:95], v[64:67], v[28:31]
    v_lshrrev_b32 v136, 2, v129
    v_cmp_eq_u32 vcc, 0, v136
    s_waitcnt lgkmcnt(8)
    v_mfma_f32_16x16x32_bf16 v[16:19], v[112:115], v[96:99], v[16:19]
    ds_read_b128 v[80:83], v6 offset:256
    s_nop 1
    v_cndmask_b32 v138, 0, v135, vcc
    v_mfma_f32_16x16x32_bf16 v[20:23], v[112:115], v[100:103], v[20:23]
    ds_read_b128 v[64:67], v7 offset:4992
    v_cmp_eq_u32 vcc, 1, v136
    v_add_u32 v133, v133, v138
    v_mfma_f32_16x16x32_bf16 v[24:27], v[112:115], v[104:107], v[24:27]
    ds_read_b128 v[84:87], v6 offset:1280
    s_nop 0
    v_cndmask_b32 v138, 0, v135, vcc
    v_mfma_f32_16x16x32_bf16 v[28:31], v[112:115], v[108:111], v[28:31]
    ds_read_b128 v[68:71], v7 offset:3456
    v_add_u32 v134, v134, v138
    v_and_b32 v135, 3, v130
    v_mfma_f32_16x16x32_bf16 v[20:23], v[116:119], v[96:99], v[20:23]
    ds_read_b128 v[88:91], v6 offset:2304
    v_lshlrev_b32 v135, 3, v135
    v_lshlrev_b32 v135, v135, v137
    v_mfma_f32_16x16x32_bf16 v[24:27], v[116:119], v[100:103], v[24:27]
    ds_read_b128 v[72:75], v7 offset:1920
    v_lshrrev_b32 v136, 2, v130
    v_cmp_eq_u32 vcc, 0, v136
    v_mfma_f32_16x16x32_bf16 v[28:31], v[116:119], v[104:107], v[28:31]
    ds_read_b128 v[92:95], v6 offset:3328
    s_nop 1
    v_cndmask_b32 v138, 0, v135, vcc
    v_mfma_f32_16x16x32_bf16 v[24:27], v[120:123], v[96:99], v[24:27]
    ds_read_b128 v[76:79], v7 offset:384
    v_cmp_eq_u32 vcc, 1, v136
    v_add_u32 v133, v133, v138
    v_mfma_f32_16x16x32_bf16 v[28:31], v[120:123], v[100:103], v[28:31]
    s_nop 0
    v_cndmask_b32 v138, 0, v135, vcc
    v_mfma_f32_16x16x32_bf16 v[28:31], v[124:127], v[96:99], v[28:31]
    v_add_u32 v134, v134, v138
    v_and_b32 v135, 3, v131
    s_waitcnt lgkmcnt(8)
    v_mfma_f32_16x16x32_bf16 v[16:19], v[48:51], v[32:35], v[16:19]
    ds_read_b128 v[112:115], v6 offset:320
    v_lshlrev_b32 v135, 3, v135
    v_lshlrev_b32 v135, v135, v137
    v_mfma_f32_16x16x32_bf16 v[20:23], v[48:51], v[36:39], v[20:23]
    ds_read_b128 v[96:99], v7 offset:5088
    v_lshrrev_b32 v136, 2, v131
    v_cmp_eq_u32 vcc, 0, v136
    v_mfma_f32_16x16x32_bf16 v[24:27], v[48:51], v[40:43], v[24:27]
    ds_read_b128 v[116:119], v6 offset:1344
    s_nop 1
    v_cndmask_b32 v138, 0, v135, vcc
    v_mfma_f32_16x16x32_bf16 v[28:31], v[48:51], v[44:47], v[28:31]
    ds_read_b128 v[100:103], v7 offset:3552
    v_cmp_eq_u32 vcc, 1, v136
    v_add_u32 v133, v133, v138
    v_mfma_f32_16x16x32_bf16 v[20:23], v[52:55], v[32:35], v[20:23]
    ds_read_b128 v[120:123], v6 offset:2368
    s_nop 0
    v_cndmask_b32 v138, 0, v135, vcc
    v_mfma_f32_16x16x32_bf16 v[24:27], v[52:55], v[36:39], v[24:27]
    ds_read_b128 v[104:107], v7 offset:2016
    v_add_u32 v134, v134, v138
    s_nop 1
    v_mfma_f32_16x16x32_bf16 v[28:31], v[52:55], v[40:43], v[28:31]
    ds_read_b128 v[124:127], v6 offset:3392
    v_add_u32_dpp v133, v133, v133 quad_perm:[1,0,3,2] row_mask:0xf bank_mask:0xf
    v_add_u32_dpp v134, v134, v134 quad_perm:[1,0,3,2] row_mask:0xf bank_mask:0xf
    v_mfma_f32_16x16x32_bf16 v[24:27], v[56:59], v[32:35], v[24:27]
    ds_read_b128 v[108:111], v7 offset:480
    s_nop 0
    v_add_u32_dpp v133, v133, v133 quad_perm:[2,3,0,1] row_mask:0xf bank_mask:0xf
    v_mfma_f32_16x16x32_bf16 v[28:31], v[56:59], v[36:39], v[28:31]
    v_add_u32_dpp v134, v134, v134 quad_perm:[2,3,0,1] row_mask:0xf bank_mask:0xf
    s_nop 0
    v_mfma_f32_16x16x32_bf16 v[28:31], v[60:63], v[32:35], v[28:31]
    v_add_u32_dpp v133, v133, v133 row_half_mirror row_mask:0xf bank_mask:0xf
    v_add_u32_dpp v134, v134, v134 row_half_mirror row_mask:0xf bank_mask:0xf
    s_waitcnt lgkmcnt(8)
    s_waitcnt vmcnt(0)
    s_barrier
    s_cmp_lg_u32 s50, 0
    s_cbranch_scc1 L_noflag_9
    s_lshl_b32 s53, s2, 2
    s_add_u32 s53, s53, 12288
    buffer_store_dword v3, off, s[44:47], s53 sc1
L_noflag_9:
    v_mfma_f32_16x16x32_bf16 v[16:19], v[80:83], v[64:67], v[16:19]
    ds_read_b128 v[48:51], v6 offset:384
    s_nop 0
    v_add_u32_dpp v133, v133, v133 row_mirror row_mask:0xf bank_mask:0xf
    v_mfma_f32_16x16x32_bf16 v[20:23], v[80:83], v[68:71], v[20:23]
    ds_read_b128 v[32:35], v7 offset:5184
    v_add_u32_dpp v134, v134, v134 row_mirror row_mask:0xf bank_mask:0xf
    s_nop 0
    v_mfma_f32_16x16x32_bf16 v[24:27], v[80:83], v[72:75], v[24:27]
    ds_read_b128 v[52:55], v6 offset:1408
    v_add_u32_dpp v133, v133, v133 row_bcast:15 row_mask:0xa bank_mask:0xf
    v_add_u32_dpp v134, v134, v134 row_bcast:15 row_mask:0xa bank_mask:0xf
    v_mfma_f32_16x16x32_bf16 v[28:31], v[80:83], v[76:79], v[28:31]
    ds_read_b128 v[36:39], v7 offset:3648
    s_nop 0
    v_add_u32_dpp v133, v133, v133 row_bcast:31 row_mask:0xc bank_mask:0xf
    v_mfma_f32_16x16x32_bf16 v[20:23], v[84:87], v[64:67], v[20:23]
    ds_read_b128 v[56:59], v6 offset:2432
    v_add_u32_dpp v134, v134, v134 row_bcast:31 row_mask:0xc bank_mask:0xf
    s_nop 0
    v_mfma_f32_16x16x32_bf16 v[24:27], v[84:87], v[68:71], v[24:27]
    ds_read_b128 v[40:43], v7 offset:2112
    v_readlane_b32 s56, v133, 63
    v_readlane_b32 s57, v134, 63
    v_mfma_f32_16x16x32_bf16 v[28:31], v[84:87], v[72:75], v[28:31]
    ds_read_b128 v[60:63], v6 offset:3456
    v_lshlrev_b32 v135, 2, v1
    s_mov_b32 s58, 0
    v_mfma_f32_16x16x32_bf16 v[24:27], v[88:91], v[64:67], v[24:27]
    ds_read_b128 v[44:47], v7 offset:576
    v_cmp_eq_u32 vcc, s101, v128
    v_add_u32 v136, 0, v135
    v_mfma_f32_16x16x32_bf16 v[28:31], v[88:91], v[68:71], v[28:31]
    v_cmp_gt_u32 s[54:55], s2, v136
    s_nop 0
    v_mfma_f32_16x16x32_bf16 v[28:31], v[92:95], v[64:67], v[28:31]
    s_and_b64 s[54:55], s[54:55], vcc
    s_bcnt1_i32_b64 s55, s[54:55]
    s_waitcnt lgkmcnt(8)
    v_mfma_f32_16x16x32_bf16 v[16:19], v[112:115], v[96:99], v[16:19]
    ds_read_b128 v[80:83], v6 offset:448
    s_add_u32 s58, s58, s55
    v_cmp_eq_u32 vcc, s101, v129
    v_mfma_f32_16x16x32_bf16 v[20:23], v[112:115], v[100:103], v[20:23]
    ds_read_b128 v[64:67], v7 offset:5280
    v_add_u32 v136, 1, v135
    v_cmp_gt_u32 s[54:55], s2, v136
    v_mfma_f32_16x16x32_bf16 v[24:27], v[112:115], v[104:107], v[24:27]
    ds_read_b128 v[84:87], v6 offset:1472
    s_nop 0
    s_and_b64 s[54:55], s[54:55], vcc
    v_mfma_f32_16x16x32_bf16 v[28:31], v[112:115], v[108:111], v[28:31]
    ds_read_b128 v[68:71], v7 offset:3744
    s_bcnt1_i32_b64 s55, s[54:55]
    s_add_u32 s58, s58, s55
    v_mfma_f32_16x16x32_bf16 v[20:23], v[116:119], v[96:99], v[20:23]
    ds_read_b128 v[88:91], v6 offset:2496
    v_cmp_eq_u32 vcc, s101, v130
    v_add_u32 v136, 2, v135
    v_mfma_f32_16x16x32_bf16 v[24:27], v[116:119], v[100:103], v[24:27]
    ds_read_b128 v[72:75], v7 offset:2208
    v_cmp_gt_u32 s[54:55], s2, v136
    s_nop 0
    v_mfma_f32_16x16x32_bf16 v[28:31], v[116:119], v[104:107], v[28:31]
    ds_read_b128 v[92:95], v6 offset:3520
    s_and_b64 s[54:55], s[54:55], vcc
    s_bcnt1_i32_b64 s55, s[54:55]
    v_mfma_f32_16x16x32_bf16 v[24:27], v[120:123], v[96:99], v[24:27]
    ds_read_b128 v[76:79], v7 offset:672
    s_add_u32 s58, s58, s55
    v_cmp_eq_u32 vcc, s101, v131
    v_mfma_f32_16x16x32_bf16 v[28:31], v[120:123], v[100:103], v[28:31]
    v_add_u32 v136, 3, v135
    v_cmp_gt_u32 s[54:55], s2, v136
    v_mfma_f32_16x16x32_bf16 v[28:31], v[124:127], v[96:99], v[28:31]
    s_nop 0
    s_and_b64 s[54:55], s[54:55], vcc
    s_waitcnt lgkmcnt(8)
    v_mfma_f32_16x16x32_bf16 v[16:19], v[48:51], v[32:35], v[16:19]
    ds_read_b128 v[112:115], v6 offset:512
    s_bcnt1_i32_b64 s55, s[54:55]
    s_add_u32 s58, s58, s55
    v_mfma_f32_16x16x32_bf16 v[20:23], v[48:51], v[36:39], v[20:23]
    ds_read_b128 v[96:99], v7 offset:5376
    s_cmp_eq_u32 s56, 0x20202020
    s_cselect_b32 s3, 1, 0
    s_cmp_eq_u32 s57, 0x20202020
    s_cselect_b32 s3, s3, 0
    v_mfma_f32_16x16x32_bf16 v[24:27], v[48:51], v[40:43], v[24:27]
    ds_read_b128 v[116:119], v6 offset:1536
    s_cmp_eq_u32 s52, 0
    s_cselect_b32 s3, s3, 0
    s_cmp_eq_u32 s3, 1
    s_cselect_b32 s48, s101, s48
    s_cselect_b32 s49, s58, s49
    v_mfma_f32_16x16x32_bf16 v[28:31], v[48:51], v[44:47], v[28:31]
    ds_read_b128 v[100:103], v7 offset:3840
    s_cmp_ge_u32 s49, 14
    s_cselect_b32 s65, 1, 0
    s_mul_i32 s53, s65, 14
    v_mfma_f32_16x16x32_bf16 v[20:23], v[52:55], v[32:35], v[20:23]
    ds_read_b128 v[120:123], v6 offset:2560
    s_sub_u32 s66, s49, s53
    s_lshl_b32 s14, s66, 2
    v_mfma_f32_16x16x32_bf16 v[24:27], v[52:55], v[36:39], v[24:27]
    ds_read_b128 v[104:107], v7 offset:2304
    s_add_u32 s14, s14, s50
    s_min_u32 s14, s14, 55
    v_mfma_f32_16x16x32_bf16 v[28:31], v[52:55], v[40:43], v[28:31]
    ds_read_b128 v[124:127], v6 offset:3584
    s_lshl_b32 s14, s14, 10
    s_add_u32 s14, s14, 3145728
    v_mfma_f32_16x16x32_bf16 v[24:27], v[56:59], v[32:35], v[24:27]
    ds_read_b128 v[108:111], v7 offset:768
    s_and_b32 s15, s49, 7
    s_lshl_b32 s15, s15, 1
    v_mfma_f32_16x16x32_bf16 v[28:31], v[56:59], v[36:39], v[28:31]
    s_lshl_b32 s53, s50, 4
    s_add_u32 s15, s15, s53
    v_mfma_f32_16x16x32_bf16 v[28:31], v[60:63], v[32:35], v[28:31]
    s_lshl_b32 s15, s15, 10
    s_add_u32 s15, s15, 5242880
    s_waitcnt lgkmcnt(8)
    v_mfma_f32_16x16x32_bf16 v[16:19], v[80:83], v[64:67], v[16:19]
    ds_read_b128 v[48:51], v6 offset:576
    v_sub_u32 v140, 15, v4
    v_mul_u32_u24 v140, 96, v140
    v_mfma_f32_16x16x32_bf16 v[20:23], v[80:83], v[68:71], v[20:23]
    ds_read_b128 v[32:35], v7 offset:5472
    v_lshlrev_b32 v141, 3, v5
    v_sub_u32 v140, v140, v141
    v_mfma_f32_16x16x32_bf16 v[24:27], v[80:83], v[72:75], v[24:27]
    ds_read_b128 v[52:55], v6 offset:1600
    s_mul_i32 s55, s67, 7584
    s_add_u32 s55, s55, 25656
    v_mfma_f32_16x16x32_bf16 v[28:31], v[80:83], v[76:79], v[28:31]
    ds_read_b128 v[36:39], v7 offset:3936
    s_lshl_b32 s56, s59, 5
    s_sub_u32 s55, s55, s56
    v_mfma_f32_16x16x32_bf16 v[20:23], v[84:87], v[64:67], v[20:23]
    ds_read_b128 v[56:59], v6 offset:2624
    v_add_u32 v140, s55, v140
    ds_read_b64 v[160:161], v140 offset:4608
    v_mfma_f32_16x16x32_bf16 v[24:27], v[84:87], v[68:71], v[24:27]
    ds_read_b128 v[40:43], v7 offset:2400
    ds_read_b64 v[162:163], v140 offset:3072
    ds_read_b64 v[164:165], v140 offset:1536
    v_mfma_f32_16x16x32_bf16 v[28:31], v[84:87], v[72:75], v[28:31]
    ds_read_b128 v[60:63], v6 offset:3648
    ds_read_b64 v[166:167], v140 offset:0
    v_lshrrev_b32 v141, 1, v5
    v_mfma_f32_16x16x32_bf16 v[24:27], v[88:91], v[64:67], v[24:27]
    ds_read_b128 v[44:47], v7 offset:864
    v_lshlrev_b32 v141, 1, v141
    s_lshl_b32 s56, s59, 2
    v_mfma_f32_16x16x32_bf16 v[28:31], v[88:91], v[68:71], v[28:31]
    s_add_u32 s56, s56, s67
    v_add_u32 v141, s56, v141
    v_mfma_f32_16x16x32_bf16 v[28:31], v[92:95], v[64:67], v[28:31]
    v_and_b32 v142, 7, v4
    v_xor_b32 v141, v141, v142
    s_waitcnt lgkmcnt(8)
    v_mfma_f32_16x16x32_bf16 v[16:19], v[112:115], v[96:99], v[16:19]
    ds_read_b128 v[80:83], v6 offset:640
    v_lshlrev_b32 v141, 4, v141
    v_lshl_add_u32 v141, v4, 7, v141
    v_mfma_f32_16x16x32_bf16 v[20:23], v[112:115], v[100:103], v[20:23]
    ds_read_b128 v[64:67], v7 offset:5568
    v_and_b32 v142, 1, v5
    v_lshl_add_u32 v141, v142, 3, v141
    v_mfma_f32_16x16x32_bf16 v[24:27], v[112:115], v[104:107], v[24:27]
    ds_read_b128 v[84:87], v6 offset:1664
    v_lshrrev_b32 v140, 3, v0
    v_and_b32 v143, 7, v0
    v_mfma_f32_16x16x32_bf16 v[28:31], v[112:115], v[108:111], v[28:31]
    ds_read_b128 v[68:71], v7 offset:4032
    v_and_b32 v142, 7, v140
    v_xor_b32 v142, v142, v143
    v_mfma_f32_16x16x32_bf16 v[20:23], v[116:119], v[96:99], v[20:23]
    ds_read_b128 v[88:91], v6 offset:2688
    v_lshlrev_b32 v142, 4, v142
    v_lshl_add_u32 v142, v140, 7, v142
    v_mfma_f32_16x16x32_bf16 v[24:27], v[116:119], v[100:103], v[24:27]
    ds_read_b128 v[72:75], v7 offset:2496
    v_lshlrev_b32 v140, 15, v140
    v_lshl_add_u32 v143, v143, 4, v140
    v_mfma_f32_16x16x32_bf16 v[28:31], v[116:119], v[104:107], v[28:31]
    ds_read_b128 v[92:95], v6 offset:3712
    s_lshl_b32 s55, s60, 16
    s_and_b32 s56, s60, 0xffff0000
    v_mfma_f32_16x16x32_bf16 v[24:27], v[120:123], v[96:99], v[24:27]
    ds_read_b128 v[76:79], v7 offset:960
    s_cmp_eq_u32 s67, 0
    s_cselect_b32 s60, s55, s56
    v_mfma_f32_16x16x32_bf16 v[28:31], v[120:123], v[100:103], v[28:31]
    v_mfma_f32_16x16x32_bf16 v[28:31], v[124:127], v[96:99], v[28:31]
    s_waitcnt lgkmcnt(8)
    v_mfma_f32_16x16x32_bf16 v[16:19], v[48:51], v[32:35], v[16:19]
    ds_read_b128 v[112:115], v6 offset:704
    v_mfma_f32_16x16x32_bf16 v[20:23], v[48:51], v[36:39], v[20:23]
    ds_read_b128 v[96:99], v7 offset:5664
    v_mfma_f32_16x16x32_bf16 v[24:27], v[48:51], v[40:43], v[24:27]
    ds_read_b128 v[116:119], v6 offset:1728
    v_mfma_f32_16x16x32_bf16 v[28:31], v[48:51], v[44:47], v[28:31]
    ds_read_b128 v[100:103], v7 offset:4128
    v_mfma_f32_16x16x32_bf16 v[20:23], v[52:55], v[32:35], v[20:23]
    ds_read_b128 v[120:123], v6 offset:2752
    v_mfma_f32_16x16x32_bf16 v[24:27], v[52:55], v[36:39], v[24:27]
    ds_read_b128 v[104:107], v7 offset:2592
    v_mfma_f32_16x16x32_bf16 v[28:31], v[52:55], v[40:43], v[28:31]
    ds_read_b128 v[124:127], v6 offset:3776
    v_mfma_f32_16x16x32_bf16 v[24:27], v[56:59], v[32:35], v[24:27]
    ds_read_b128 v[108:111], v7 offset:1056
    v_mfma_f32_16x16x32_bf16 v[28:31], v[56:59], v[36:39], v[28:31]
    v_mfma_f32_16x16x32_bf16 v[28:31], v[60:63], v[32:35], v[28:31]
    v_and_b32 v144, 0xffff0000, v161
    s_waitcnt lgkmcnt(8)
    s_cmp_eq_u32 s3, 0
    s_cbranch_scc1 L_nods_10
    s_lshl_b32 s53, s48, 8
    s_lshl_b32 s54, s49, 3
    s_add_u32 s53, s53, s54
    s_add_u32 s53, s53, s50
    s_lshl_b32 s53, s53, 10
    s_add_u32 s53, s53, 9437184
    buffer_store_dwordx4 v[192:195], v2, s[44:47], s53 offen
    s_add_u32 s53, s53, 4096
    buffer_store_dwordx4 v[192:195], v2, s[44:47], s53 offen
L_nods_10:
    v_mfma_f32_16x16x32_bf16 v[16:19], v[80:83], v[64:67], v[16:19]
    ds_read_b128 v[48:51], v6 offset:768
    v_lshlrev_b32 v145, 16, v161
    v_and_b32 v146, 0xffff0000, v160
    v_mfma_f32_16x16x32_bf16 v[20:23], v[80:83], v[68:71], v[20:23]
    ds_read_b128 v[32:35], v7 offset:5760
    v_lshlrev_b32 v147, 16, v160
    v_mul_f32 v144, s60, v144
    v_mfma_f32_16x16x32_bf16 v[24:27], v[80:83], v[72:75], v[24:27]
    ds_read_b128 v[52:55], v6 offset:1792
    v_mul_f32 v145, s60, v145
    v_mul_f32 v146, s60, v146
    v_mfma_f32_16x16x32_bf16 v[28:31], v[80:83], v[76:79], v[28:31]
    ds_read_b128 v[36:39], v7 offset:4224
    v_mul_f32 v147, s60, v147
    v_and_b32 v148, 0xffff0000, v163
    v_mfma_f32_16x16x32_bf16 v[20:23], v[84:87], v[64:67], v[20:23]
    ds_read_b128 v[56:59], v6 offset:2816
    v_lshlrev_b32 v149, 16, v163
    v_and_b32 v150, 0xffff0000, v162
    v_mfma_f32_16x16x32_bf16 v[24:27], v[84:87], v[68:71], v[24:27]
    ds_read_b128 v[40:43], v7 offset:2688
    v_lshlrev_b32 v151, 16, v162
    v_mul_f32 v148, s60, v148
    v_mfma_f32_16x16x32_bf16 v[28:31], v[84:87], v[72:75], v[28:31]
    ds_read_b128 v[60:63], v6 offset:3840
    v_mul_f32 v149, s60, v149
    v_mul_f32 v150, s60, v150
    v_mfma_f32_16x16x32_bf16 v[24:27], v[88:91], v[64:67], v[24:27]
    ds_read_b128 v[44:47], v7 offset:1152
    v_mul_f32 v151, s60, v151
    v_and_b32 v152, 0xffff0000, v165
    v_mfma_f32_16x16x32_bf16 v[28:31], v[88:91], v[68:71], v[28:31]
    v_lshlrev_b32 v153, 16, v165
    v_and_b32 v154, 0xffff0000, v164
    v_mfma_f32_16x16x32_bf16 v[28:31], v[92:95], v[64:67], v[28:31]
    v_lshlrev_b32 v155, 16, v164
    v_mul_f32 v152, s60, v152
    s_waitcnt lgkmcnt(8)
    v_mfma_f32_16x16x32_bf16 v[16:19], v[112:115], v[96:99], v[16:19]
    ds_read_b128 v[80:83], v6 offset:832
    v_mul_f32 v153, s60, v153
    v_mul_f32 v154, s60, v154
    v_mfma_f32_16x16x32_bf16 v[20:23], v[112:115], v[100:103], v[20:23]
    ds_read_b128 v[64:67], v7 offset:5856
    v_mul_f32 v155, s60, v155
    v_and_b32 v156, 0xffff0000, v167
    v_mfma_f32_16x16x32_bf16 v[24:27], v[112:115], v[104:107], v[24:27]
    ds_read_b128 v[84:87], v6 offset:1856
    v_lshlrev_b32 v157, 16, v167
    v_and_b32 v158, 0xffff0000, v166
    v_mfma_f32_16x16x32_bf16 v[28:31], v[112:115], v[108:111], v[28:31]
    ds_read_b128 v[68:71], v7 offset:4320
    v_lshlrev_b32 v159, 16, v166
    v_mul_f32 v156, s60, v156
    v_mfma_f32_16x16x32_bf16 v[20:23], v[116:119], v[96:99], v[20:23]
    ds_read_b128 v[88:91], v6 offset:2880
    v_mul_f32 v157, s60, v157
    v_mul_f32 v158, s60, v158
    v_mfma_f32_16x16x32_bf16 v[24:27], v[116:119], v[100:103], v[24:27]
    ds_read_b128 v[72:75], v7 offset:2784
    v_mul_f32 v159, s60, v159
    v_mfma_f32_16x16x32_bf16 v[28:31], v[116:119], v[104:107], v[28:31]
    ds_read_b128 v[92:95], v6 offset:3904
    v_mfma_f32_16x16x32_bf16 v[24:27], v[120:123], v[96:99], v[24:27]
    ds_read_b128 v[76:79], v7 offset:1248
    v_mfma_f32_16x16x32_bf16 v[28:31], v[120:123], v[100:103], v[28:31]
    v_mfma_f32_16x16x32_bf16 v[28:31], v[124:127], v[96:99], v[28:31]
    s_waitcnt lgkmcnt(8)
    v_mfma_f32_16x16x32_bf16 v[16:19], v[48:51], v[32:35], v[16:19]
    ds_read_b128 v[112:115], v6 offset:896
    v_mfma_f32_16x16x32_bf16 v[20:23], v[48:51], v[36:39], v[20:23]
    ds_read_b128 v[96:99], v7 offset:5952
    v_mfma_f32_16x16x32_bf16 v[24:27], v[48:51], v[40:43], v[24:27]
    ds_read_b128 v[116:119], v6 offset:1920
    v_mfma_f32_16x16x32_bf16 v[28:31], v[48:51], v[44:47], v[28:31]
    ds_read_b128 v[100:103], v7 offset:4416
    v_mfma_f32_16x16x32_bf16 v[20:23], v[52:55], v[32:35], v[20:23]
    ds_read_b128 v[120:123], v6 offset:2944
    v_mfma_f32_16x16x32_bf16 v[24:27], v[52:55], v[36:39], v[24:27]
    ds_read_b128 v[104:107], v7 offset:2880
    v_mfma_f32_16x16x32_bf16 v[28:31], v[52:55], v[40:43], v[28:31]
    ds_read_b128 v[124:127], v6 offset:3968
    v_mfma_f32_16x16x32_bf16 v[24:27], v[56:59], v[32:35], v[24:27]
    ds_read_b128 v[108:111], v7 offset:1344
    v_mfma_f32_16x16x32_bf16 v[28:31], v[56:59], v[36:39], v[28:31]
    v_mfma_f32_16x16x32_bf16 v[28:31], v[60:63], v[32:35], v[28:31]
    s_waitcnt lgkmcnt(8)
    v_add_u32 v132, 12288, v2
    buffer_load_dwordx4 v[128:131], v132, s[44:47], 0 offen sc1
    v_mfma_f32_16x16x32_bf16 v[16:19], v[80:83], v[64:67], v[16:19]
    ds_read_b128 v[48:51], v6 offset:960
    v_mfma_f32_16x16x32_bf16 v[20:23], v[80:83], v[68:71], v[20:23]
    ds_read_b128 v[32:35], v7 offset:6048
    v_mfma_f32_16x16x32_bf16 v[24:27], v[80:83], v[72:75], v[24:27]
    ds_read_b128 v[52:55], v6 offset:1984
    v_mfma_f32_16x16x32_bf16 v[28:31], v[80:83], v[76:79], v[28:31]
    ds_read_b128 v[36:39], v7 offset:4512
    v_mfma_f32_16x16x32_bf16 v[20:23], v[84:87], v[64:67], v[20:23]
    ds_read_b128 v[56:59], v6 offset:3008
    v_mfma_f32_16x16x32_bf16 v[24:27], v[84:87], v[68:71], v[24:27]
    ds_read_b128 v[40:43], v7 offset:2976
    v_mfma_f32_16x16x32_bf16 v[28:31], v[84:87], v[72:75], v[28:31]
    ds_read_b128 v[60:63], v6 offset:4032
    v_mfma_f32_16x16x32_bf16 v[24:27], v[88:91], v[64:67], v[24:27]
    ds_read_b128 v[44:47], v7 offset:1440
    v_mfma_f32_16x16x32_bf16 v[28:31], v[88:91], v[68:71], v[28:31]
    v_mfma_f32_16x16x32_bf16 v[28:31], v[92:95], v[64:67], v[28:31]
    s_waitcnt lgkmcnt(8)
    v_mfma_f32_16x16x32_bf16 v[16:19], v[112:115], v[96:99], v[16:19]
    v_mfma_f32_16x16x32_bf16 v[20:23], v[112:115], v[100:103], v[20:23]
    v_mfma_f32_16x16x32_bf16 v[24:27], v[112:115], v[104:107], v[24:27]
    v_mfma_f32_16x16x32_bf16 v[28:31], v[112:115], v[108:111], v[28:31]
    v_mfma_f32_16x16x32_bf16 v[20:23], v[116:119], v[96:99], v[20:23]
    v_mfma_f32_16x16x32_bf16 v[24:27], v[116:119], v[100:103], v[24:27]
    v_mfma_f32_16x16x32_bf16 v[28:31], v[116:119], v[104:107], v[28:31]
    v_mfma_f32_16x16x32_bf16 v[24:27], v[120:123], v[96:99], v[24:27]
    v_mfma_f32_16x16x32_bf16 v[28:31], v[120:123], v[100:103], v[28:31]
    v_mfma_f32_16x16x32_bf16 v[28:31], v[124:127], v[96:99], v[28:31]
    s_waitcnt lgkmcnt(0)
    v_mfma_f32_16x16x32_bf16 v[16:19], v[48:51], v[32:35], v[16:19]
    v_mfma_f32_16x16x32_bf16 v[20:23], v[48:51], v[36:39], v[20:23]
    v_mfma_f32_16x16x32_bf16 v[24:27], v[48:51], v[40:43], v[24:27]
    v_mfma_f32_16x16x32_bf16 v[28:31], v[48:51], v[44:47], v[28:31]
    v_mfma_f32_16x16x32_bf16 v[20:23], v[52:55], v[32:35], v[20:23]
    v_mfma_f32_16x16x32_bf16 v[24:27], v[52:55], v[36:39], v[24:27]
    v_mfma_f32_16x16x32_bf16 v[28:31], v[52:55], v[40:43], v[28:31]
    v_mfma_f32_16x16x32_bf16 v[24:27], v[56:59], v[32:35], v[24:27]
    v_mfma_f32_16x16x32_bf16 v[28:31], v[56:59], v[36:39], v[28:31]
    v_mfma_f32_16x16x32_bf16 v[28:31], v[60:63], v[32:35], v[28:31]
    s_nop 5
    v_add_f32 v16, v16, v144
    v_add_f32 v17, v17, v145
    v_add_f32 v18, v18, v146
    v_add_f32 v19, v19, v147
    v_cvt_pk_bf16_f32 v64, v16, v17
    v_cvt_pk_bf16_f32 v65, v18, v19
    ds_write_b64 v141, v[64:65] offset:0
    v_add_f32 v20, v20, v148
    v_add_f32 v21, v21, v149
    v_add_f32 v22, v22, v150
    v_add_f32 v23, v23, v151
    v_cvt_pk_bf16_f32 v66, v20, v21
    v_cvt_pk_bf16_f32 v67, v22, v23
    ds_write_b64 v141, v[66:67] offset:2048
    v_add_f32 v24, v24, v152
    v_add_f32 v25, v25, v153
    v_add_f32 v26, v26, v154
    v_add_f32 v27, v27, v155
    v_cvt_pk_bf16_f32 v68, v24, v25
    v_cvt_pk_bf16_f32 v69, v26, v27
    ds_write_b64 v141, v[68:69] offset:4096
    v_add_f32 v28, v28, v156
    v_add_f32 v29, v29, v157
    v_add_f32 v30, v30, v158
    v_add_f32 v31, v31, v159
    v_cvt_pk_bf16_f32 v70, v28, v29
    v_cvt_pk_bf16_f32 v71, v30, v31
    ds_write_b64 v141, v[70:71] offset:6144
    s_waitcnt lgkmcnt(0)
    s_barrier
    ds_read_b128 v[48:51], v142 offset:0
    ds_read_b128 v[52:55], v142 offset:4096
    s_add_u32 s53, s61, 7340032
    s_waitcnt lgkmcnt(1)
    buffer_store_dwordx4 v[48:51], v143, s[44:47], s53 offen sc1
    s_add_u32 s53, s53, 1048576
    s_waitcnt lgkmcnt(0)
    buffer_store_dwordx4 v[52:55], v143, s[44:47], s53 offen sc1
    s_mov_b32 s4, s16
    s_and_b32 s5, s17, 0xffff
    s_mov_b32 s6, 2097152
    s_mov_b32 s7, 0x00020000
    s_lshl_b32 s53, s48, 8
    s_lshl_b32 s54, s49, 3
    s_add_u32 s53, s53, s54
    s_add_u32 s53, s53, s50
    s_lshl_b32 s53, s53, 10
    buffer_load_dwordx4 v[8:11], v2, s[4:7], s53 offen
    s_add_u32 s53, s53, 4096
    buffer_load_dwordx4 v[12:15], v2, s[4:7], s53 offen
    s_waitcnt vmcnt(4)
    s_mov_b32 s53, 0
L_fw_11:
    v_xor_b32 v128, s51, v128
    v_xor_b32 v129, s51, v129
    v_xor_b32 v130, s51, v130
    v_xor_b32 v131, s51, v131
    v_or_b32 v128, v128, v129
    v_or3_b32 v128, v128, v130, v131
    v_cmp_ne_u32 vcc, 0, v128
    s_cbranch_vccz L_fwd_12
    s_add_u32 s53, s53, 1
    s_cmp_lg_u32 s52, 0
    s_cbranch_scc1 L_fwd_12
    s_cmp_lt_u32 s53, 0x8000
    s_cbranch_scc0 L_fwd_12_ab
    buffer_load_dwordx4 v[128:131], v132, s[44:47], 0 offen sc1
    s_waitcnt vmcnt(0)
    s_branch L_fw_11
L_fwd_12_ab:
    s_mov_b32 s52, 1
L_fwd_12:
    s_barrier
    s_add_u32 s13, s14, 0
    buffer_load_dwordx4 v[128:131], v2, s[44:47], s13 offen sc1
    s_add_u32 s13, s14, 57344
    buffer_load_dwordx4 v[132:135], v2, s[44:47], s13 offen sc1
    s_add_u32 s13, s14, 114688
    buffer_load_dwordx4 v[136:139], v2, s[44:47], s13 offen sc1
    s_add_u32 s13, s14, 172032
    buffer_load_dwordx4 v[140:143], v2, s[44:47], s13 offen sc1
    s_add_u32 s13, s14, 229376
    buffer_load_dwordx4 v[144:147], v2, s[44:47], s13 offen sc1
    s_add_u32 s13, s14, 286720
    buffer_load_dwordx4 v[148:151], v2, s[44:47], s13 offen sc1
    s_add_u32 s13, s14, 344064
    buffer_load_dwordx4 v[152:155], v2, s[44:47], s13 offen sc1
    s_add_u32 s13, s14, 401408
    buffer_load_dwordx4 v[156:159], v2, s[44:47], s13 offen sc1
    s_add_u32 s13, s14, 458752
    buffer_load_dwordx4 v[160:163], v2, s[44:47], s13 offen sc1
    s_add_u32 s13, s14, 516096
    buffer_load_dwordx4 v[164:167], v2, s[44:47], s13 offen sc1
    s_add_u32 s13, s14, 573440
    buffer_load_dwordx4 v[168:171], v2, s[44:47], s13 offen sc1
    s_add_u32 s13, s14, 630784
    buffer_load_dwordx4 v[172:175], v2, s[44:47], s13 offen sc1
    s_add_u32 s13, s14, 688128
    buffer_load_dwordx4 v[176:179], v2, s[44:47], s13 offen sc1
    s_add_u32 s13, s14, 745472
    buffer_load_dwordx4 v[180:183], v2, s[44:47], s13 offen sc1
    s_add_u32 s13, s14, 802816
    buffer_load_dwordx4 v[184:187], v2, s[44:47], s13 offen sc1
    s_add_u32 s13, s14, 860160
    buffer_load_dwordx4 v[188:191], v2, s[44:47], s13 offen sc1
    s_add_u32 s13, s14, 917504
    buffer_load_dwordx4 v[192:195], v2, s[44:47], s13 offen sc1
    s_add_u32 s13, s14, 974848
    buffer_load_dwordx4 v[196:199], v2, s[44:47], s13 offen sc1
    s_add_u32 s13, s14, 1032192
    buffer_load_dwordx4 v[200:203], v2, s[44:47], s13 offen sc1
    s_add_u32 s13, s14, 1089536
    buffer_load_dwordx4 v[204:207], v2, s[44:47], s13 offen sc1
    s_add_u32 s13, s14, 1146880
    buffer_load_dwordx4 v[208:211], v2, s[44:47], s13 offen sc1
    s_add_u32 s13, s14, 1204224
    buffer_load_dwordx4 v[212:215], v2, s[44:47], s13 offen sc1
    s_add_u32 s13, s14, 1261568
    buffer_load_dwordx4 v[216:219], v2, s[44:47], s13 offen sc1
    s_add_u32 s13, s14, 1318912
    buffer_load_dwordx4 v[220:223], v2, s[44:47], s13 offen sc1
    v_mov_b32 v108, 0x3b000000
    s_waitcnt vmcnt(24)
    v_lshlrev_b32 v16, 16, v8
    v_and_b32 v17, 0xffff0000, v8
    v_lshlrev_b32 v18, 16, v9
    v_and_b32 v19, 0xffff0000, v9
    v_lshlrev_b32 v20, 16, v10
    v_and_b32 v21, 0xffff0000, v10
    v_lshlrev_b32 v22, 16, v11
    v_and_b32 v23, 0xffff0000, v11
    v_lshlrev_b32 v64, 16, v12
    v_and_b32 v65, 0xffff0000, v12
    v_lshlrev_b32 v66, 16, v13
    v_and_b32 v67, 0xffff0000, v13
    v_lshlrev_b32 v68, 16, v14
    v_and_b32 v69, 0xffff0000, v14
    v_lshlrev_b32 v70, 16, v15
    v_and_b32 v71, 0xffff0000, v15
    v_pk_add_f32 v[52:53], v[16:17], v[18:19]
    v_pk_mul_f32 v[54:55], v[16:17], v[16:17]
    v_pk_add_f32 v[100:101], v[64:65], v[66:67]
    v_pk_mul_f32 v[102:103], v[64:65], v[64:65]
    v_pk_add_f32 v[56:57], v[20:21], v[22:23]
    v_pk_fma_f32 v[54:55], v[18:19], v[18:19], v[54:55]
    v_pk_add_f32 v[104:105], v[68:69], v[70:71]
    v_pk_fma_f32 v[102:103], v[66:67], v[66:67], v[102:103]
    v_pk_add_f32 v[52:53], v[52:53], v[56:57]
    v_pk_fma_f32 v[54:55], v[20:21], v[20:21], v[54:55]
    v_pk_add_f32 v[100:101], v[100:101], v[104:105]
    v_pk_fma_f32 v[102:103], v[68:69], v[68:69], v[102:103]
    v_add_f32 v52, v52, v53
    v_pk_fma_f32 v[54:55], v[22:23], v[22:23], v[54:55]
    v_add_f32 v100, v100, v101
    v_pk_fma_f32 v[102:103], v[70:71], v[70:71], v[102:103]
    v_add_f32 v54, v54, v55
    v_add_f32 v102, v102, v103
    v_add_f32_dpp v52, v52, v52 quad_perm:[1,0,3,2] row_mask:0xf bank_mask:0xf
    v_add_f32_dpp v54, v54, v54 quad_perm:[1,0,3,2] row_mask:0xf bank_mask:0xf
    v_add_f32_dpp v100, v100, v100 quad_perm:[1,0,3,2] row_mask:0xf bank_mask:0xf
    v_add_f32_dpp v102, v102, v102 quad_perm:[1,0,3,2] row_mask:0xf bank_mask:0xf
    v_add_f32_dpp v52, v52, v52 quad_perm:[2,3,0,1] row_mask:0xf bank_mask:0xf
    v_add_f32_dpp v54, v54, v54 quad_perm:[2,3,0,1] row_mask:0xf bank_mask:0xf
    v_add_f32_dpp v100, v100, v100 quad_perm:[2,3,0,1] row_mask:0xf bank_mask:0xf
    v_add_f32_dpp v102, v102, v102 quad_perm:[2,3,0,1] row_mask:0xf bank_mask:0xf
    v_add_f32_dpp v52, v52, v52 row_half_mirror row_mask:0xf bank_mask:0xf
    v_add_f32_dpp v54, v54, v54 row_half_mirror row_mask:0xf bank_mask:0xf
    v_add_f32_dpp v100, v100, v100 row_half_mirror row_mask:0xf bank_mask:0xf
    v_add_f32_dpp v102, v102, v102 row_half_mirror row_mask:0xf bank_mask:0xf
    v_add_f32_dpp v52, v52, v52 row_mirror row_mask:0xf bank_mask:0xf
    v_add_f32_dpp v54, v54, v54 row_mirror row_mask:0xf bank_mask:0xf
    v_add_f32_dpp v100, v100, v100 row_mirror row_mask:0xf bank_mask:0xf
    v_add_f32_dpp v102, v102, v102 row_mirror row_mask:0xf bank_mask:0xf
    v_add_f32_dpp v52, v52, v52 row_bcast:15 row_mask:0xa bank_mask:0xf
    v_add_f32_dpp v54, v54, v54 row_bcast:15 row_mask:0xa bank_mask:0xf
    v_add_f32_dpp v100, v100, v100 row_bcast:15 row_mask:0xa bank_mask:0xf
    v_add_f32_dpp v102, v102, v102 row_bcast:15 row_mask:0xa bank_mask:0xf
    v_add_f32_dpp v52, v52, v52 row_bcast:31 row_mask:0xc bank_mask:0xf
    v_add_f32_dpp v54, v54, v54 row_bcast:31 row_mask:0xc bank_mask:0xf
    v_add_f32_dpp v100, v100, v100 row_bcast:31 row_mask:0xc bank_mask:0xf
    v_add_f32_dpp v102, v102, v102 row_bcast:31 row_mask:0xc bank_mask:0xf
    v_readlane_b32 s58, v52, 63
    v_readlane_b32 s59, v54, 63
    v_readlane_b32 s56, v100, 63
    v_readlane_b32 s57, v102, 63
    s_nop 1
    v_mul_f32 v56, s58, v108
    v_mul_f32 v54, s59, v108
    v_mul_f32 v104, s56, v108
    v_mul_f32 v102, s57, v108
    v_fma_f32 v54, -v56, v56, v54
    v_fma_f32 v102, -v104, v104, v102
    v_max_f32 v54, 0, v54
    v_max_f32 v102, 0, v102
    v_add_f32 v54, 0x3727c5ac, v54
    v_add_f32 v102, 0x3727c5ac, v102
    v_rsq_f32 v54, v54
    v_rsq_f32 v102, v102
    v_mul_f32 v56, v56, v54
    v_mul_f32 v104, v104, v102
    v_pk_fma_f32 v[24:25], v[16:17], v[54:55], v[56:57] op_sel_hi:[1,0,0] neg_lo:[0,0,1] neg_hi:[0,0,1]
    v_pk_fma_f32 v[26:27], v[18:19], v[54:55], v[56:57] op_sel_hi:[1,0,0] neg_lo:[0,0,1] neg_hi:[0,0,1]
    v_pk_fma_f32 v[28:29], v[20:21], v[54:55], v[56:57] op_sel_hi:[1,0,0] neg_lo:[0,0,1] neg_hi:[0,0,1]
    v_pk_fma_f32 v[30:31], v[22:23], v[54:55], v[56:57] op_sel_hi:[1,0,0] neg_lo:[0,0,1] neg_hi:[0,0,1]
    v_pk_fma_f32 v[72:73], v[64:65], v[102:103], v[104:105] op_sel_hi:[1,0,0] neg_lo:[0,0,1] neg_hi:[0,0,1]
    v_pk_fma_f32 v[74:75], v[66:67], v[102:103], v[104:105] op_sel_hi:[1,0,0] neg_lo:[0,0,1] neg_hi:[0,0,1]
    v_pk_fma_f32 v[76:77], v[68:69], v[102:103], v[104:105] op_sel_hi:[1,0,0] neg_lo:[0,0,1] neg_hi:[0,0,1]
    v_pk_fma_f32 v[78:79], v[70:71], v[102:103], v[104:105] op_sel_hi:[1,0,0] neg_lo:[0,0,1] neg_hi:[0,0,1]
    s_lshl_b32 s75, s48, 8
    s_lshl_b32 s54, s49, 3
    s_add_u32 s75, s75, s54
    s_add_u32 s75, s75, s50
    s_lshl_b32 s75, s75, 10
    s_lshl_b32 s61, s48, 7
    s_lshl_b32 s54, s49, 2
    s_add_u32 s61, s61, s54
    s_add_u32 s61, s61, s50
    s_lshl_b32 s61, s61, 2
    s_add_u32 s61, s61, 16384
    s_lshl_b32 s53, s48, 7
    s_lshl_b32 s54, s65, 6
    s_add_u32 s53, s53, s54
    s_lshl_b32 s54, s50, 3
    s_add_u32 s53, s53, s54
    s_lshl_b32 s53, s53, 2
    s_add_u32 s53, s53, 16384
    v_and_b32 v120, 7, v1
    v_bfe_u32 v12, v1, 3, 1
    v_lshl_add_u32 v120, v12, 5, v120
    v_lshlrev_b32 v120, 2, v120
    v_add_u32 v120, s53, v120
    v_lshrrev_b32 v14, 5, v1
    v_and_b32 v15, 31, v1
    v_and_b32 v12, 15, v1
    v_add_u32 v4, 0, v14
    v_xor_b32 v4, v4, v12
    v_lshlrev_b32 v4, 4, v4
    v_lshl_add_u32 v4, v15, 10, v4
    v_add_u32 v5, 2, v14
    v_xor_b32 v5, v5, v12
    v_lshlrev_b32 v5, 4, v5
    v_lshl_add_u32 v5, v15, 10, v5
    v_add_u32 v6, 4, v14
    v_xor_b32 v6, v6, v12
    v_lshlrev_b32 v6, 4, v6
    v_lshl_add_u32 v6, v15, 10, v6
    v_add_u32 v7, 6, v14
    v_xor_b32 v7, v7, v12
    v_lshlrev_b32 v7, 4, v7
    v_lshl_add_u32 v7, v15, 10, v7
    v_add_u32 v8, 8, v14
    v_xor_b32 v8, v8, v12
    v_lshlrev_b32 v8, 4, v8
    v_lshl_add_u32 v8, v15, 10, v8
    v_add_u32 v9, 10, v14
    v_xor_b32 v9, v9, v12
    v_lshlrev_b32 v9, 4, v9
    v_lshl_add_u32 v9, v15, 10, v9
    v_add_u32 v10, 12, v14
    v_xor_b32 v10, v10, v12
    v_lshlrev_b32 v10, 4, v10
    v_lshl_add_u32 v10, v15, 10, v10
    v_add_u32 v11, 14, v14
    v_xor_b32 v11, v11, v12
    v_lshlrev_b32 v11, 4, v11
    v_lshl_add_u32 v11, v15, 10, v11
    s_and_b32 s54, s50, 1
    s_lshl_b32 s54, s54, 7
    v_xor_b32 v121, s54, v2
    s_lshl_b32 s68, s66, 2
    s_add_u32 s68, s68, s50
    s_lshl_b32 s53, s48, 1
    s_add_u32 s53, s53, s65
    s_lshl_b32 s53, s53, 2
    s_mul_i32 s71, s53, 112
    s_lshl_b32 s55, s68, 1
    s_add_u32 s71, s71, s55
    s_lshl_b32 s71, s71, 10
    s_add_u32 s71, s71, 20971520
    s_lshl_b32 s70, s53, 8
    s_lshl_b32 s55, s68, 2
    s_add_u32 s70, s70, s55
    s_add_u32 s70, s70, 32768
    s_lshl_b32 s55, s2, 13
    s_add_u32 s55, s55, 38797312
    s_cmp_ge_u32 s49, 28
    s_cselect_b32 s71, s55, s71
    s_cselect_b32 s70, s55, s70
    s_lshl_b32 s53, s48, 8
    s_lshl_b32 s54, s65, 7
    s_add_u32 s53, s53, s54
    s_lshl_b32 s54, s50, 4
    s_add_u32 s53, s53, s54
    s_lshl_b32 s53, s53, 10
    s_add_u32 s72, s53, 9437184
    s_lshl_b32 s73, s50, 13
    s_lshr_b32 s54, s49, 4
    s_lshl_b32 s53, s48, 1
    s_add_u32 s53, s53, s54
    s_lshl_b32 s53, s53, 2
    s_lshr_b32 s54, s49, 3
    s_and_b32 s54, s54, 1
    s_add_u32 s55, s53, s54
    s_lshl_b32 s53, s55, 8
    s_mul_i32 s54, s50, 56
    s_add_u32 s53, s53, s54
    s_add_u32 s53, s53, 32768
    v_min_u32 v119, 13, v1
    v_lshlrev_b32 v119, 2, v119
    v_add_u32 v119, s53, v119
    s_mul_i32 s69, s55, 112
    s_mul_i32 s54, s50, 28
    s_add_u32 s69, s69, s54
    s_lshl_b32 s69, s69, 10
    s_add_u32 s69, s69, 20971520
    v_and_b32 v15, 7, v0
    v_lshrrev_b32 v112, 3, v0
    v_and_b32 v12, 7, v112
    v_and_b32 v113, 3, v15
    v_lshlrev_b32 v113, 1, v113
    v_or_b32 v114, 1, v113
    v_xor_b32 v113, v113, v12
    v_xor_b32 v114, v114, v12
    v_lshrrev_b32 v12, 2, v15
    v_lshlrev_b32 v12, 7, v12
    v_lshl_add_u32 v12, v112, 8, v12
    v_lshl_add_u32 v113, v113, 4, v12
    v_lshl_add_u32 v114, v114, 4, v12
    s_lshr_b32 s53, s49, 3
    s_lshl_b32 s53, s53, 5
    v_add_u32 v12, s53, v112
    v_lshrrev_b32 v112, 2, v12
    v_lshlrev_b32 v112, 3, v112
    v_and_b32 v12, 3, v12
    v_add_u32 v112, v112, v12
    s_lshl_b32 s53, s48, 8
    v_add_u32 v112, s53, v112
    v_lshlrev_b32 v112, 10, v112
    s_and_b32 s53, s49, 7
    s_lshl_b32 s53, s53, 7
    v_lshl_add_u32 v112, v15, 4, v112
    v_add_u32 v112, s53, v112
    v_lshlrev_b32 v123, 4, v15
    v_add_u32 v123, s53, v123
    v_and_b32 v12, 31, v1
    v_lshrrev_b32 v13, 5, v1
    v_and_b32 v14, 7, v1
    s_lshl_b32 s53, s50, 13
    v_add_u32 v115, 0, v13
    v_xor_b32 v115, v115, v14
    v_lshlrev_b32 v115, 4, v115
    v_lshl_add_u32 v115, v12, 8, v115
    v_add_u32 v115, s53, v115
    v_add_u32 v116, 2, v13
    v_xor_b32 v116, v116, v14
    v_lshlrev_b32 v116, 4, v116
    v_lshl_add_u32 v116, v12, 8, v116
    v_add_u32 v116, s53, v116
    v_add_u32 v117, 4, v13
    v_xor_b32 v117, v117, v14
    v_lshlrev_b32 v117, 4, v117
    v_lshl_add_u32 v117, v12, 8, v117
    v_add_u32 v117, s53, v117
    v_add_u32 v118, 6, v13
    v_xor_b32 v118, v118, v14
    v_lshlrev_b32 v118, 4, v118
    v_lshl_add_u32 v118, v12, 8, v118
    v_add_u32 v118, s53, v118
    s_lshl_b32 s67, s48, 3
    s_lshr_b32 s54, s49, 3
    s_add_u32 s67, s67, s54
    s_lshl_b32 s67, s67, 2
    s_add_u32 s67, s67, s50
    s_lshl_b32 s67, s67, 3
    s_and_b32 s54, s49, 7
    s_add_u32 s67, s67, s54
    s_lshl_b32 s67, s67, 2
    s_add_u32 s67, s67, 65536
    s_lshl_b32 s53, s48, 3
    s_lshr_b32 s54, s49, 3
    s_add_u32 s53, s53, s54
    s_lshl_b32 s53, s53, 2
    s_and_b32 s54, s49, 7
    s_lshr_b32 s54, s54, 1
    s_add_u32 s53, s53, s54
    s_lshl_b32 s53, s53, 5
    s_add_u32 s53, s53, 65536
    v_and_b32 v122, 7, v1
    v_lshlrev_b32 v122, 2, v122
    v_add_u32 v122, s53, v122
    s_lshl_b32 s53, s48, 3
    s_lshr_b32 s54, s49, 2
    s_add_u32 s53, s53, s54
    s_lshl_b32 s53, s53, 15
    s_and_b32 s54, s49, 3
    s_lshl_b32 s54, s54, 5
    s_add_u32 s53, s53, s54
    s_add_u32 s55, s53, 7340032
    v_lshlrev_b32 v111, 7, v0
    s_mov_b32 s53, 0
    s_mov_b64 s[56:57], exec
L_gp_13:
    buffer_load_dwordx4 v[60:63], v111, s[44:47], s55 offen sc1
    buffer_load_dwordx4 v[124:127], v111, s[44:47], s55 offen offset:16 sc1
    s_waitcnt vmcnt(0)
    v_max3_u32 v109, v60, v61, v62
    v_max3_u32 v110, v63, v124, v125
    v_max3_u32 v109, v109, v126, v127
    v_max_u32 v109, v109, v110
    v_cmp_eq_u32 vcc, -1, v109
    s_cbranch_vccz L_gpd_14
    s_and_b64 exec, exec, vcc
    s_add_u32 s53, s53, 1
    s_cmp_lg_u32 s52, 0
    s_cbranch_scc1 L_gpd_14
    s_cmp_lt_u32 s53, 0x8000
    s_cbranch_scc1 L_gp_13
    s_mov_b32 s52, 1
L_gpd_14:
    s_mov_b64 exec, s[56:57]
    s_mov_b32 s56, 0x05040100
    s_mov_b32 s57, 0x07060302
    v_lshlrev_b32 v109, 2, v0
    v_add_u32 v109, 155648, v109
    v_perm_b32 v12, v124, v60, s56
    v_perm_b32 v13, v124, v60, s57
    v_perm_b32 v14, v125, v61, s56
    v_perm_b32 v15, v125, v61, s57
    ds_write_b32 v109, v12 offset:0
    ds_write_b32 v109, v13 offset:1024
    ds_write_b32 v109, v14 offset:2048
    ds_write_b32 v109, v15 offset:3072
    v_perm_b32 v12, v126, v62, s56
    v_perm_b32 v13, v126, v62, s57
    v_perm_b32 v14, v127, v63, s56
    v_perm_b32 v15, v127, v63, s57
    ds_write_b32 v109, v12 offset:4096
    ds_write_b32 v109, v13 offset:5120
    ds_write_b32 v109, v14 offset:6144
    ds_write_b32 v109, v15 offset:7168
    s_waitcnt lgkmcnt(0)
    s_barrier
    s_cmp_eq_u32 s3, 0
    s_cbranch_scc1 L_slow
    s_lshl_b32 s53, s50, 10
    s_add_u32 s53, s53, 155648
    v_add_u32 v44, s53, v2
    ds_read_b128 v[32:35], v44
    s_waitcnt lgkmcnt(0)
    v_lshlrev_b32 v36, 16, v32
    v_and_b32 v37, 0xffff0000, v32
    v_lshlrev_b32 v38, 16, v33
    v_and_b32 v39, 0xffff0000, v33
    v_lshlrev_b32 v40, 16, v34
    v_and_b32 v41, 0xffff0000, v34
    v_lshlrev_b32 v42, 16, v35
    v_and_b32 v43, 0xffff0000, v35
    v_pk_fma_f32 v[16:17], v[24:25], v[36:37], v[16:17]
    v_pk_fma_f32 v[18:19], v[26:27], v[38:39], v[18:19]
    v_pk_fma_f32 v[20:21], v[28:29], v[40:41], v[20:21]
    v_pk_fma_f32 v[22:23], v[30:31], v[42:43], v[22:23]
    v_cvt_pk_bf16_f32 v48, v16, v17
    v_cvt_pk_bf16_f32 v49, v18, v19
    v_cvt_pk_bf16_f32 v50, v20, v21
    v_cvt_pk_bf16_f32 v51, v22, v23
    v_lshlrev_b32 v16, 16, v48
    v_and_b32 v17, 0xffff0000, v48
    v_lshlrev_b32 v18, 16, v49
    v_and_b32 v19, 0xffff0000, v49
    v_lshlrev_b32 v20, 16, v50
    v_and_b32 v21, 0xffff0000, v50
    v_lshlrev_b32 v22, 16, v51
    v_and_b32 v23, 0xffff0000, v51
    s_add_u32 s54, s75, 13631488
    buffer_store_dwordx4 v[48:51], v2, s[44:47], s54 offen sc1
    v_pk_add_f32 v[52:53], v[16:17], v[18:19]
    v_pk_mul_f32 v[54:55], v[16:17], v[16:17]
    v_pk_add_f32 v[56:57], v[20:21], v[22:23]
    v_pk_fma_f32 v[54:55], v[18:19], v[18:19], v[54:55]
    v_pk_add_f32 v[52:53], v[52:53], v[56:57]
    v_pk_fma_f32 v[54:55], v[20:21], v[20:21], v[54:55]
    v_add_f32 v52, v52, v53
    v_pk_fma_f32 v[54:55], v[22:23], v[22:23], v[54:55]
    v_add_f32 v54, v54, v55
    s_nop 0
    v_add_f32_dpp v52, v52, v52 quad_perm:[1,0,3,2] row_mask:0xf bank_mask:0xf
    v_add_f32_dpp v54, v54, v54 quad_perm:[1,0,3,2] row_mask:0xf bank_mask:0xf
    s_nop 0
    v_add_f32_dpp v52, v52, v52 quad_perm:[2,3,0,1] row_mask:0xf bank_mask:0xf
    v_add_f32_dpp v54, v54, v54 quad_perm:[2,3,0,1] row_mask:0xf bank_mask:0xf
    s_nop 0
    v_add_f32_dpp v52, v52, v52 row_half_mirror row_mask:0xf bank_mask:0xf
    v_add_f32_dpp v54, v54, v54 row_half_mirror row_mask:0xf bank_mask:0xf
    s_nop 0
    v_add_f32_dpp v52, v52, v52 row_mirror row_mask:0xf bank_mask:0xf
    v_add_f32_dpp v54, v54, v54 row_mirror row_mask:0xf bank_mask:0xf
    s_nop 0
    v_add_f32_dpp v52, v52, v52 row_bcast:15 row_mask:0xa bank_mask:0xf
    v_add_f32_dpp v54, v54, v54 row_bcast:15 row_mask:0xa bank_mask:0xf
    s_nop 0
    v_add_f32_dpp v52, v52, v52 row_bcast:31 row_mask:0xc bank_mask:0xf
    v_add_f32_dpp v54, v54, v54 row_bcast:31 row_mask:0xc bank_mask:0xf
    s_nop 0
    v_readlane_b32 s58, v52, 63
    v_readlane_b32 s59, v54, 63
    s_nop 1
    v_mul_f32 v56, s58, v108
    v_mul_f32 v54, s59, v108
    v_fma_f32 v54, -v56, v56, v54
    v_max_f32 v54, 0, v54
    v_add_f32 v52, 0x3727c5ac, v54
    v_rsq_f32 v52, v52
    s_nop 0
    v_mul_f32 v54, v54, v52
    v_fmaak_f32 v54, v54, v52, 0x3727c5ac
    v_rsq_f32 v54, v54
    s_nop 0
    v_mul_f32 v54, v54, v52
    v_mul_f32 v56, v56, v54
    v_pk_fma_f32 v[24:25], v[16:17], v[54:55], v[56:57] op_sel_hi:[1,0,0] neg_lo:[0,0,1] neg_hi:[0,0,1]
    v_pk_fma_f32 v[26:27], v[18:19], v[54:55], v[56:57] op_sel_hi:[1,0,0] neg_lo:[0,0,1] neg_hi:[0,0,1]
    v_pk_fma_f32 v[28:29], v[20:21], v[54:55], v[56:57] op_sel_hi:[1,0,0] neg_lo:[0,0,1] neg_hi:[0,0,1]
    v_pk_fma_f32 v[30:31], v[22:23], v[54:55], v[56:57] op_sel_hi:[1,0,0] neg_lo:[0,0,1] neg_hi:[0,0,1]
    v_cvt_pk_bf16_f32 v32, v24, v25
    v_cvt_pk_bf16_f32 v33, v26, v27
    v_cvt_pk_bf16_f32 v34, v28, v29
    v_cvt_pk_bf16_f32 v35, v30, v31
    s_add_u32 s54, s75, 9437184
    buffer_store_dwordx4 v[32:35], v2, s[44:47], s54 offen
    s_add_u32 s13, s14, 1376256
    buffer_load_dwordx4 v[224:227], v2, s[44:47], s13 offen sc1
    s_add_u32 s13, s14, 1433600
    buffer_load_dwordx4 v[228:231], v2, s[44:47], s13 offen sc1
    s_add_u32 s13, s14, 1490944
    buffer_load_dwordx4 v[232:235], v2, s[44:47], s13 offen sc1
    s_lshl_b32 s53, s50, 10
    s_add_u32 s53, s53, 159744
    v_add_u32 v92, s53, v2
    ds_read_b128 v[80:83], v92
    s_waitcnt lgkmcnt(0)
    v_lshlrev_b32 v84, 16, v80
    v_and_b32 v85, 0xffff0000, v80
    v_lshlrev_b32 v86, 16, v81
    v_and_b32 v87, 0xffff0000, v81
    v_lshlrev_b32 v88, 16, v82
    v_and_b32 v89, 0xffff0000, v82
    v_lshlrev_b32 v90, 16, v83
    v_and_b32 v91, 0xffff0000, v83
    v_pk_fma_f32 v[64:65], v[72:73], v[84:85], v[64:65]
    v_pk_fma_f32 v[66:67], v[74:75], v[86:87], v[66:67]
    v_pk_fma_f32 v[68:69], v[76:77], v[88:89], v[68:69]
    v_pk_fma_f32 v[70:71], v[78:79], v[90:91], v[70:71]
    v_cvt_pk_bf16_f32 v96, v64, v65
    v_cvt_pk_bf16_f32 v97, v66, v67
    v_cvt_pk_bf16_f32 v98, v68, v69
    v_cvt_pk_bf16_f32 v99, v70, v71
    v_lshlrev_b32 v64, 16, v96
    v_and_b32 v65, 0xffff0000, v96
    v_lshlrev_b32 v66, 16, v97
    v_and_b32 v67, 0xffff0000, v97
    v_lshlrev_b32 v68, 16, v98
    v_and_b32 v69, 0xffff0000, v98
    v_lshlrev_b32 v70, 16, v99
    v_and_b32 v71, 0xffff0000, v99
    s_add_u32 s54, s75, 13635584
    buffer_store_dwordx4 v[96:99], v2, s[44:47], s54 offen sc1
    s_waitcnt vmcnt(4)
    s_add_u32 s53, s61, 0
    buffer_store_dword v3, off, s[44:47], s53
    s_add_u32 s13, s14, 1548288
    buffer_load_dwordx4 v[236:239], v2, s[44:47], s13 offen sc1
    s_add_u32 s13, s14, 1605632
    buffer_load_dwordx4 v[240:243], v2, s[44:47], s13 offen sc1
    s_add_u32 s13, s14, 1662976
    buffer_load_dwordx4 v[244:247], v2, s[44:47], s13 offen sc1
    s_add_u32 s13, s14, 1720320
    buffer_load_dwordx4 v[248:251], v2, s[44:47], s13 offen sc1
    s_add_u32 s13, s14, 1777664
    buffer_load_dwordx4 v[252:255], v2, s[44:47], s13 offen sc1
    s_add_u32 s13, s15, 0
    buffer_load_dwordx4 a[0:3], v2, s[44:47], s13 offen sc1
    s_add_u32 s13, s15, 0
    buffer_load_dwordx4 a[112:115], v2, s[44:47], s13 offen offset:1024 sc1
    s_add_u32 s13, s15, 65536
    buffer_load_dwordx4 a[4:7], v2, s[44:47], s13 offen sc1
    v_pk_add_f32 v[100:101], v[64:65], v[66:67]
    v_pk_mul_f32 v[102:103], v[64:65], v[64:65]
    v_pk_add_f32 v[104:105], v[68:69], v[70:71]
    v_pk_fma_f32 v[102:103], v[66:67], v[66:67], v[102:103]
    v_pk_add_f32 v[100:101], v[100:101], v[104:105]
    v_pk_fma_f32 v[102:103], v[68:69], v[68:69], v[102:103]
    v_add_f32 v100, v100, v101
    v_pk_fma_f32 v[102:103], v[70:71], v[70:71], v[102:103]
    v_add_f32 v102, v102, v103
    s_nop 0
    v_add_f32_dpp v100, v100, v100 quad_perm:[1,0,3,2] row_mask:0xf bank_mask:0xf
    v_add_f32_dpp v102, v102, v102 quad_perm:[1,0,3,2] row_mask:0xf bank_mask:0xf
    s_nop 0
    v_add_f32_dpp v100, v100, v100 quad_perm:[2,3,0,1] row_mask:0xf bank_mask:0xf
    v_add_f32_dpp v102, v102, v102 quad_perm:[2,3,0,1] row_mask:0xf bank_mask:0xf
    s_nop 0
    v_add_f32_dpp v100, v100, v100 row_half_mirror row_mask:0xf bank_mask:0xf
    v_add_f32_dpp v102, v102, v102 row_half_mirror row_mask:0xf bank_mask:0xf
    s_nop 0
    v_add_f32_dpp v100, v100, v100 row_mirror row_mask:0xf bank_mask:0xf
    v_add_f32_dpp v102, v102, v102 row_mirror row_mask:0xf bank_mask:0xf
    s_nop 0
    v_add_f32_dpp v100, v100, v100 row_bcast:15 row_mask:0xa bank_mask:0xf
    v_add_f32_dpp v102, v102, v102 row_bcast:15 row_mask:0xa bank_mask:0xf
    s_nop 0
    v_add_f32_dpp v100, v100, v100 row_bcast:31 row_mask:0xc bank_mask:0xf
    v_add_f32_dpp v102, v102, v102 row_bcast:31 row_mask:0xc bank_mask:0xf
    s_nop 0
    v_readlane_b32 s58, v100, 63
    v_readlane_b32 s59, v102, 63
    s_nop 1
    v_mul_f32 v104, s58, v108
    v_mul_f32 v102, s59, v108
    v_fma_f32 v102, -v104, v104, v102
    v_max_f32 v102, 0, v102
    v_add_f32 v100, 0x3727c5ac, v102
    v_rsq_f32 v100, v100
    s_nop 0
    v_mul_f32 v102, v102, v100
    v_fmaak_f32 v102, v102, v100, 0x3727c5ac
    v_rsq_f32 v102, v102
    s_nop 0
    v_mul_f32 v102, v102, v100
    v_mul_f32 v104, v104, v102
    v_pk_fma_f32 v[72:73], v[64:65], v[102:103], v[104:105] op_sel_hi:[1,0,0] neg_lo:[0,0,1] neg_hi:[0,0,1]
    v_pk_fma_f32 v[74:75], v[66:67], v[102:103], v[104:105] op_sel_hi:[1,0,0] neg_lo:[0,0,1] neg_hi:[0,0,1]
    v_pk_fma_f32 v[76:77], v[68:69], v[102:103], v[104:105] op_sel_hi:[1,0,0] neg_lo:[0,0,1] neg_hi:[0,0,1]
    v_pk_fma_f32 v[78:79], v[70:71], v[102:103], v[104:105] op_sel_hi:[1,0,0] neg_lo:[0,0,1] neg_hi:[0,0,1]
    v_cvt_pk_bf16_f32 v80, v72, v73
    v_cvt_pk_bf16_f32 v81, v74, v75
    v_cvt_pk_bf16_f32 v82, v76, v77
    v_cvt_pk_bf16_f32 v83, v78, v79
    s_add_u32 s54, s75, 9441280
    buffer_store_dwordx4 v[80:83], v2, s[44:47], s54 offen
    s_add_u32 s13, s15, 65536
    buffer_load_dwordx4 a[116:119], v2, s[44:47], s13 offen offset:1024 sc1
    s_add_u32 s13, s15, 131072
    buffer_load_dwordx4 a[8:11], v2, s[44:47], s13 offen sc1
    s_add_u32 s13, s15, 131072
    buffer_load_dwordx4 a[120:123], v2, s[44:47], s13 offen offset:1024 sc1
    s_add_u32 s13, s15, 196608
    buffer_load_dwordx4 a[12:15], v2, s[44:47], s13 offen sc1
    s_add_u32 s13, s15, 196608
    buffer_load_dwordx4 a[124:127], v2, s[44:47], s13 offen offset:1024 sc1
    s_waitcnt vmcnt(5)
    s_add_u32 s53, s61, 4096
    buffer_store_dword v3, off, s[44:47], s53
    s_mov_b32 s64, 0
    s_cmp_ge_u32 s49, 28
    s_cbranch_scc1 L_idle_15
    v_add_u32 v100, 0, v120
    v_add_u32 v101, 4096, v120
    buffer_load_dword v102, v100, s[44:47], 0 offen sc1
    s_barrier
    s_mov_b32 s4, s32
    s_and_b32 s5, s33, 0xffff
    s_mov_b32 s6, 3584
    s_mov_b32 s7, 0x00020000
    v_lshrrev_b32 v14, 5, v1
    v_lshlrev_b32 v15, 3, v14
    s_lshl_b32 s53, s68, 6
    buffer_load_dwordx2 v[104:105], v15, s[4:7], s53 offen
    buffer_load_dwordx2 v[106:107], v15, s[4:7], s53 offen offset:16
    buffer_load_dwordx2 v[108:109], v15, s[4:7], s53 offen offset:32
    buffer_load_dwordx2 v[110:111], v15, s[4:7], s53 offen offset:48
    v_mov_b32 v12, 0xbdd2d3e8
    v_mov_b32 v13, 0xc0135761
    v_mov_b32 v14, 1.0
    v_mov_b32 v15, 1.0
    s_waitcnt vmcnt(4)
    v_cmp_ne_u32 vcc, s51, v102
    s_cbranch_vccz L_pcd_18
    s_mov_b32 s53, 0
L_pc_17:
    buffer_load_dword v102, v100, s[44:47], 0 offen sc1
    s_waitcnt vmcnt(0)
    v_cmp_ne_u32 vcc, s51, v102
    s_cbranch_vccz L_pcd_18
    s_add_u32 s53, s53, 1
    s_cmp_lg_u32 s52, 0
    s_cbranch_scc1 L_pcd_18
    s_cmp_lt_u32 s53, 0x8000
    s_cbranch_scc1 L_pc_17
    s_mov_b32 s52, 1
L_pcd_18:
    s_add_u32 m0, s73, 0
    s_add_u32 s57, s72, 0
    v_xor_b32 v103, 0, v121
    buffer_load_dwordx4 v103, s[44:47], s57 offen sc1 lds
    v_xor_b32 v103, 16, v121
    buffer_load_dwordx4 v103, s[44:47], s57 offen offset:1024 sc1 lds
    v_xor_b32 v103, 32, v121
    buffer_load_dwordx4 v103, s[44:47], s57 offen offset:2048 sc1 lds
    v_xor_b32 v103, 48, v121
    buffer_load_dwordx4 v103, s[44:47], s57 offen offset:3072 sc1 lds
    s_add_u32 m0, s73, 4096
    s_add_u32 s57, s72, 8192
    v_xor_b32 v103, 64, v121
    buffer_load_dwordx4 v103, s[44:47], s57 offen sc1 lds
    v_xor_b32 v103, 80, v121
    buffer_load_dwordx4 v103, s[44:47], s57 offen offset:1024 sc1 lds
    v_xor_b32 v103, 96, v121
    buffer_load_dwordx4 v103, s[44:47], s57 offen offset:2048 sc1 lds
    v_xor_b32 v103, 112, v121
    buffer_load_dwordx4 v103, s[44:47], s57 offen offset:3072 sc1 lds
    buffer_load_dword v102, v101, s[44:47], 0 offen sc1
    s_waitcnt vmcnt(9)
    v_lshlrev_b32 v48, 16, v104
    v_and_b32 v49, 0xffff0000, v104
    v_lshlrev_b32 v50, 16, v105
    v_and_b32 v51, 0xffff0000, v105
    v_lshlrev_b32 v52, 16, v106
    v_and_b32 v53, 0xffff0000, v106
    v_lshlrev_b32 v54, 16, v107
    v_and_b32 v55, 0xffff0000, v107
    v_lshlrev_b32 v56, 16, v108
    v_and_b32 v57, 0xffff0000, v108
    v_lshlrev_b32 v58, 16, v109
    v_and_b32 v59, 0xffff0000, v109
    v_lshlrev_b32 v60, 16, v110
    v_and_b32 v61, 0xffff0000, v110
    v_lshlrev_b32 v62, 16, v111
    v_and_b32 v63, 0xffff0000, v111
    s_waitcnt vmcnt(1)
    s_barrier
    ds_read_b128 v[64:67], v4 offset:0
    ds_read_b128 v[68:71], v5 offset:0
    ds_read_b128 v[72:75], v6 offset:0
    ds_read_b128 v[76:79], v7 offset:0
    ds_read_b128 v[80:83], v8 offset:0
    ds_read_b128 v[84:87], v9 offset:0
    ds_read_b128 v[88:91], v10 offset:0
    s_waitcnt lgkmcnt(3)
    v_mfma_f32_32x32x16_bf16 v[16:31], v[128:131], v[64:67], v[48:63]
    ds_read_b128 v[92:95], v11 offset:0
    s_add_u32 m0, s73, 32768
    s_add_u32 s57, s72, 65536
    v_xor_b32 v103, 0, v121
    buffer_load_dwordx4 v103, s[44:47], s57 offen sc1 lds
    v_mfma_f32_32x32x16_bf16 v[16:31], v[132:135], v[68:71], v[16:31]
    ds_read_b128 v[64:67], v4 offset:256
    v_xor_b32 v103, 16, v121
    buffer_load_dwordx4 v103, s[44:47], s57 offen offset:1024 sc1 lds
    v_mfma_f32_32x32x16_bf16 v[16:31], v[136:139], v[72:75], v[16:31]
    ds_read_b128 v[68:71], v5 offset:256
    v_xor_b32 v103, 32, v121
    buffer_load_dwordx4 v103, s[44:47], s57 offen offset:2048 sc1 lds
    v_mfma_f32_32x32x16_bf16 v[16:31], v[140:143], v[76:79], v[16:31]
    ds_read_b128 v[72:75], v6 offset:256
    v_xor_b32 v103, 48, v121
    buffer_load_dwordx4 v103, s[44:47], s57 offen offset:3072 sc1 lds
    s_waitcnt lgkmcnt(3)
    v_mfma_f32_32x32x16_bf16 v[16:31], v[144:147], v[80:83], v[16:31]
    ds_read_b128 v[76:79], v7 offset:256
    s_add_u32 m0, s73, 36864
    s_add_u32 s57, s72, 73728
    v_xor_b32 v103, 64, v121
    buffer_load_dwordx4 v103, s[44:47], s57 offen sc1 lds
    v_mfma_f32_32x32x16_bf16 v[16:31], v[148:151], v[84:87], v[16:31]
    ds_read_b128 v[80:83], v8 offset:256
    v_xor_b32 v103, 80, v121
    buffer_load_dwordx4 v103, s[44:47], s57 offen offset:1024 sc1 lds
    v_mfma_f32_32x32x16_bf16 v[16:31], v[152:155], v[88:91], v[16:31]
    ds_read_b128 v[84:87], v9 offset:256
    v_xor_b32 v103, 96, v121
    buffer_load_dwordx4 v103, s[44:47], s57 offen offset:2048 sc1 lds
    v_mfma_f32_32x32x16_bf16 v[16:31], v[156:159], v[92:95], v[16:31]
    ds_read_b128 v[88:91], v10 offset:256
    v_xor_b32 v103, 112, v121
    buffer_load_dwordx4 v103, s[44:47], s57 offen offset:3072 sc1 lds
    s_waitcnt lgkmcnt(3)
    v_mfma_f32_32x32x16_bf16 v[16:31], v[160:163], v[64:67], v[16:31]
    ds_read_b128 v[92:95], v11 offset:256
    s_waitcnt vmcnt(8)
    v_cmp_ne_u32 vcc, s51, v102
    s_cbranch_vccz L_pcd_20
    s_mov_b32 s53, 0
L_pc_19:
    buffer_load_dword v102, v101, s[44:47], 0 offen sc1
    s_waitcnt vmcnt(0)
    v_cmp_ne_u32 vcc, s51, v102
    s_cbranch_vccz L_pcd_20
    s_add_u32 s53, s53, 1
    s_cmp_lg_u32 s52, 0
    s_cbranch_scc1 L_pcd_20
    s_cmp_lt_u32 s53, 0x8000
    s_cbranch_scc1 L_pc_19
    s_mov_b32 s52, 1
L_pcd_20:
    v_mfma_f32_32x32x16_bf16 v[16:31], v[164:167], v[68:71], v[16:31]
    ds_read_b128 v[64:67], v4 offset:512
    s_add_u32 m0, s73, 65536
    s_add_u32 s57, s72, 4096
    v_xor_b32 v103, 0, v121
    buffer_load_dwordx4 v103, s[44:47], s57 offen sc1 lds
    v_mfma_f32_32x32x16_bf16 v[16:31], v[168:171], v[72:75], v[16:31]
    ds_read_b128 v[68:71], v5 offset:512
    v_xor_b32 v103, 16, v121
    buffer_load_dwordx4 v103, s[44:47], s57 offen offset:1024 sc1 lds
    v_mfma_f32_32x32x16_bf16 v[16:31], v[172:175], v[76:79], v[16:31]
    ds_read_b128 v[72:75], v6 offset:512
    v_xor_b32 v103, 32, v121
    buffer_load_dwordx4 v103, s[44:47], s57 offen offset:2048 sc1 lds
    s_waitcnt lgkmcnt(3)
    v_mfma_f32_32x32x16_bf16 v[16:31], v[176:179], v[80:83], v[16:31]
    ds_read_b128 v[76:79], v7 offset:512
    v_mfma_f32_32x32x16_bf16 v[16:31], v[180:183], v[84:87], v[16:31]
    ds_read_b128 v[80:83], v8 offset:512
    v_xor_b32 v103, 48, v121
    buffer_load_dwordx4 v103, s[44:47], s57 offen offset:3072 sc1 lds
    v_mfma_f32_32x32x16_bf16 v[16:31], v[184:187], v[88:91], v[16:31]
    ds_read_b128 v[84:87], v9 offset:512
    s_add_u32 m0, s73, 69632
    s_add_u32 s57, s72, 12288
    v_xor_b32 v103, 64, v121
    buffer_load_dwordx4 v103, s[44:47], s57 offen sc1 lds
    v_mfma_f32_32x32x16_bf16 v[16:31], v[188:191], v[92:95], v[16:31]
    ds_read_b128 v[88:91], v10 offset:512
    v_xor_b32 v103, 80, v121
    buffer_load_dwordx4 v103, s[44:47], s57 offen offset:1024 sc1 lds
    s_waitcnt lgkmcnt(3)
    v_mfma_f32_32x32x16_bf16 v[16:31], v[192:195], v[64:67], v[16:31]
    ds_read_b128 v[92:95], v11 offset:512
    v_mfma_f32_32x32x16_bf16 v[16:31], v[196:199], v[68:71], v[16:31]
    ds_read_b128 v[64:67], v4 offset:768
    v_xor_b32 v103, 96, v121
    buffer_load_dwordx4 v103, s[44:47], s57 offen offset:2048 sc1 lds
    v_mfma_f32_32x32x16_bf16 v[16:31], v[200:203], v[72:75], v[16:31]
    ds_read_b128 v[68:71], v5 offset:768
    v_xor_b32 v103, 112, v121
    buffer_load_dwordx4 v103, s[44:47], s57 offen offset:3072 sc1 lds
    v_mfma_f32_32x32x16_bf16 v[16:31], v[204:207], v[76:79], v[16:31]
    ds_read_b128 v[72:75], v6 offset:768
    s_waitcnt lgkmcnt(3)
    v_mfma_f32_32x32x16_bf16 v[16:31], v[208:211], v[80:83], v[16:31]
    ds_read_b128 v[76:79], v7 offset:768
    s_add_u32 m0, s73, 98304
    s_add_u32 s57, s72, 69632
    v_xor_b32 v103, 0, v121
    buffer_load_dwordx4 v103, s[44:47], s57 offen sc1 lds
    v_mfma_f32_32x32x16_bf16 v[16:31], v[212:215], v[84:87], v[16:31]
    ds_read_b128 v[80:83], v8 offset:768
    v_xor_b32 v103, 16, v121
    buffer_load_dwordx4 v103, s[44:47], s57 offen offset:1024 sc1 lds
    v_mfma_f32_32x32x16_bf16 v[16:31], v[216:219], v[88:91], v[16:31]
    ds_read_b128 v[84:87], v9 offset:768
    v_xor_b32 v103, 32, v121
    buffer_load_dwordx4 v103, s[44:47], s57 offen offset:2048 sc1 lds
    v_mfma_f32_32x32x16_bf16 v[16:31], v[220:223], v[92:95], v[16:31]
    ds_read_b128 v[88:91], v10 offset:768
    s_waitcnt lgkmcnt(3)
    v_mfma_f32_32x32x16_bf16 v[16:31], v[224:227], v[64:67], v[16:31]
    ds_read_b128 v[92:95], v11 offset:768
    v_xor_b32 v103, 48, v121
    buffer_load_dwordx4 v103, s[44:47], s57 offen offset:3072 sc1 lds
    v_mfma_f32_32x32x16_bf16 v[16:31], v[228:231], v[68:71], v[16:31]
    s_waitcnt vmcnt(12)
    s_barrier
    s_add_u32 m0, s73, 102400
    s_add_u32 s57, s72, 77824
    v_xor_b32 v103, 64, v121
    buffer_load_dwordx4 v103, s[44:47], s57 offen sc1 lds
    ds_read_b128 v[64:67], v4 offset:32768
    v_mfma_f32_32x32x16_bf16 v[16:31], v[232:235], v[72:75], v[16:31]
    v_xor_b32 v103, 80, v121
    buffer_load_dwordx4 v103, s[44:47], s57 offen offset:1024 sc1 lds
    ds_read_b128 v[68:71], v5 offset:32768
    v_mfma_f32_32x32x16_bf16 v[16:31], v[236:239], v[76:79], v[16:31]
    ds_read_b128 v[72:75], v6 offset:32768
    s_waitcnt lgkmcnt(3)
    v_mfma_f32_32x32x16_bf16 v[16:31], v[240:243], v[80:83], v[16:31]
    v_xor_b32 v103, 96, v121
    buffer_load_dwordx4 v103, s[44:47], s57 offen offset:2048 sc1 lds
    ds_read_b128 v[76:79], v7 offset:32768
    v_mfma_f32_32x32x16_bf16 v[16:31], v[244:247], v[84:87], v[16:31]
    v_xor_b32 v103, 112, v121
    buffer_load_dwordx4 v103, s[44:47], s57 offen offset:3072 sc1 lds
    ds_read_b128 v[80:83], v8 offset:32768
    v_mfma_f32_32x32x16_bf16 v[16:31], v[248:251], v[88:91], v[16:31]
    ds_read_b128 v[84:87], v9 offset:32768
    v_mfma_f32_32x32x16_bf16 v[16:31], v[252:255], v[92:95], v[16:31]
    ds_read_b128 v[88:91], v10 offset:32768
    s_waitcnt lgkmcnt(3)
    v_mfma_f32_32x32x16_bf16 v[32:47], v[128:131], v[64:67], v[48:63]
    ds_read_b128 v[92:95], v11 offset:32768
    v_mfma_f32_32x32x16_bf16 v[32:47], v[132:135], v[68:71], v[32:47]
    ds_read_b128 v[64:67], v4 offset:33024
    s_add_u32 s13, s15, 262144
    buffer_load_dwordx4 a[16:19], v2, s[44:47], s13 offen sc1
    v_mfma_f32_32x32x16_bf16 v[32:47], v[136:139], v[72:75], v[32:47]
    ds_read_b128 v[68:71], v5 offset:33024
    s_add_u32 s13, s15, 262144
    buffer_load_dwordx4 a[128:131], v2, s[44:47], s13 offen offset:1024 sc1
    v_mfma_f32_32x32x16_bf16 v[32:47], v[140:143], v[76:79], v[32:47]
    ds_read_b128 v[72:75], v6 offset:33024
    s_add_u32 s13, s15, 327680
    buffer_load_dwordx4 a[20:23], v2, s[44:47], s13 offen sc1
    s_waitcnt lgkmcnt(3)
    v_mfma_f32_32x32x16_bf16 v[32:47], v[144:147], v[80:83], v[32:47]
    ds_read_b128 v[76:79], v7 offset:33024
    s_add_u32 s74, s71, 0
    v_mul_f32 v96, v16, v16
    v_mul_f32 v97, v17, v17
    v_fma_f32 v96, v96, v12, v13
    v_fma_f32 v97, v97, v12, v13
    v_mul_f32 v96, v96, v16
    v_mfma_f32_32x32x16_bf16 v[32:47], v[148:151], v[84:87], v[32:47]
    ds_read_b128 v[80:83], v8 offset:33024
    v_mul_f32 v97, v97, v17
    v_exp_f32 v96, v96
    v_exp_f32 v97, v97
    v_add_f32 v96, 1.0, v96
    v_add_f32 v97, 1.0, v97
    s_add_u32 s13, s15, 327680
    buffer_load_dwordx4 a[132:135], v2, s[44:47], s13 offen offset:1024 sc1
    v_mfma_f32_32x32x16_bf16 v[32:47], v[152:155], v[88:91], v[32:47]
    ds_read_b128 v[84:87], v9 offset:33024
    v_rcp_f32 v96, v96
    v_rcp_f32 v97, v97
    v_mul_f32 v16, v16, v96
    v_mul_f32 v17, v17, v97
    v_cvt_pk_bf16_f32 v104, v16, v17
    s_add_u32 s13, s15, 393216
    buffer_load_dwordx4 a[24:27], v2, s[44:47], s13 offen sc1
    v_mfma_f32_32x32x16_bf16 v[32:47], v[156:159], v[92:95], v[32:47]
    ds_read_b128 v[88:91], v10 offset:33024
    v_mul_f32 v98, v18, v18
    v_mul_f32 v99, v19, v19
    v_fma_f32 v98, v98, v12, v13
    v_fma_f32 v99, v99, v12, v13
    v_mul_f32 v98, v98, v18
    s_waitcnt lgkmcnt(3)
    v_mfma_f32_32x32x16_bf16 v[32:47], v[160:163], v[64:67], v[32:47]
    ds_read_b128 v[92:95], v11 offset:33024
    v_mul_f32 v99, v99, v19
    v_exp_f32 v98, v98
    v_exp_f32 v99, v99
    v_add_f32 v98, 1.0, v98
    v_add_f32 v99, 1.0, v99
    s_add_u32 s13, s15, 393216
    buffer_load_dwordx4 a[136:139], v2, s[44:47], s13 offen offset:1024 sc1
    v_mfma_f32_32x32x16_bf16 v[32:47], v[164:167], v[68:71], v[32:47]
    ds_read_b128 v[64:67], v4 offset:33280
    v_rcp_f32 v98, v98
    v_rcp_f32 v99, v99
    v_mul_f32 v18, v18, v98
    v_mul_f32 v19, v19, v99
    v_cvt_pk_bf16_f32 v105, v18, v19
    s_add_u32 s13, s15, 458752
    buffer_load_dwordx4 a[28:31], v2, s[44:47], s13 offen sc1
    v_mfma_f32_32x32x16_bf16 v[32:47], v[168:171], v[72:75], v[32:47]
    ds_read_b128 v[68:71], v5 offset:33280
    v_mul_f32 v96, v20, v20
    v_mul_f32 v97, v21, v21
    v_fma_f32 v96, v96, v12, v13
    v_fma_f32 v97, v97, v12, v13
    v_mul_f32 v96, v96, v20
    v_mfma_f32_32x32x16_bf16 v[32:47], v[172:175], v[76:79], v[32:47]
    ds_read_b128 v[72:75], v6 offset:33280
    v_mul_f32 v97, v97, v21
    v_exp_f32 v96, v96
    v_exp_f32 v97, v97
    v_add_f32 v96, 1.0, v96
    v_add_f32 v97, 1.0, v97
    s_add_u32 s13, s15, 458752
    buffer_load_dwordx4 a[140:143], v2, s[44:47], s13 offen offset:1024 sc1
    s_waitcnt lgkmcnt(3)
    v_mfma_f32_32x32x16_bf16 v[32:47], v[176:179], v[80:83], v[32:47]
    ds_read_b128 v[76:79], v7 offset:33280
    v_rcp_f32 v96, v96
    v_rcp_f32 v97, v97
    v_mul_f32 v20, v20, v96
    v_mul_f32 v21, v21, v97
    v_cvt_pk_bf16_f32 v106, v20, v21
    v_mul_f32 v98, v22, v22
    s_add_u32 s13, s15, 524288
    buffer_load_dwordx4 a[32:35], v2, s[44:47], s13 offen sc1
    v_mfma_f32_32x32x16_bf16 v[32:47], v[180:183], v[84:87], v[32:47]
    ds_read_b128 v[80:83], v8 offset:33280
    v_mul_f32 v99, v23, v23
    v_fma_f32 v98, v98, v12, v13
    v_fma_f32 v99, v99, v12, v13
    v_mul_f32 v98, v98, v22
    v_mul_f32 v99, v99, v23
    s_add_u32 s13, s15, 524288
    buffer_load_dwordx4 a[144:147], v2, s[44:47], s13 offen offset:1024 sc1
    v_mfma_f32_32x32x16_bf16 v[32:47], v[184:187], v[88:91], v[32:47]
    ds_read_b128 v[84:87], v9 offset:33280
    v_exp_f32 v98, v98
    v_exp_f32 v99, v99
    v_add_f32 v98, 1.0, v98
    v_add_f32 v99, 1.0, v99
    v_rcp_f32 v98, v98
    v_mfma_f32_32x32x16_bf16 v[32:47], v[188:191], v[92:95], v[32:47]
    ds_read_b128 v[88:91], v10 offset:33280
    v_rcp_f32 v99, v99
    v_mul_f32 v22, v22, v98
    v_mul_f32 v23, v23, v99
    v_cvt_pk_bf16_f32 v107, v22, v23
    buffer_store_dwordx4 v[104:107], v2, s[44:47], s74 offen sc1
    s_add_u32 s13, s15, 589824
    buffer_load_dwordx4 a[36:39], v2, s[44:47], s13 offen sc1
    s_waitcnt lgkmcnt(3)
    v_mfma_f32_32x32x16_bf16 v[32:47], v[192:195], v[64:67], v[32:47]
    ds_read_b128 v[92:95], v11 offset:33280
    v_mul_f32 v96, v24, v24
    v_mul_f32 v97, v25, v25
    v_fma_f32 v96, v96, v12, v13
    v_fma_f32 v97, v97, v12, v13
    v_mul_f32 v96, v96, v24
    s_add_u32 s13, s15, 589824
    buffer_load_dwordx4 a[148:151], v2, s[44:47], s13 offen offset:1024 sc1
    v_mfma_f32_32x32x16_bf16 v[32:47], v[196:199], v[68:71], v[32:47]
    ds_read_b128 v[64:67], v4 offset:33536
    v_mul_f32 v97, v97, v25
    v_exp_f32 v96, v96
    v_exp_f32 v97, v97
    v_add_f32 v96, 1.0, v96
    v_add_f32 v97, 1.0, v97
    v_mfma_f32_32x32x16_bf16 v[32:47], v[200:203], v[72:75], v[32:47]
    ds_read_b128 v[68:71], v5 offset:33536
    v_rcp_f32 v96, v96
    v_rcp_f32 v97, v97
    v_mul_f32 v24, v24, v96
    v_mul_f32 v25, v25, v97
    v_cvt_pk_bf16_f32 v108, v24, v25
    s_add_u32 s13, s15, 655360
    buffer_load_dwordx4 a[40:43], v2, s[44:47], s13 offen sc1
    v_mfma_f32_32x32x16_bf16 v[32:47], v[204:207], v[76:79], v[32:47]
    ds_read_b128 v[72:75], v6 offset:33536
    v_mul_f32 v98, v26, v26
    v_mul_f32 v99, v27, v27
    v_fma_f32 v98, v98, v12, v13
    v_fma_f32 v99, v99, v12, v13
    v_mul_f32 v98, v98, v26
    s_add_u32 s13, s15, 655360
    buffer_load_dwordx4 a[152:155], v2, s[44:47], s13 offen offset:1024 sc1
    s_waitcnt lgkmcnt(3)
    v_mfma_f32_32x32x16_bf16 v[32:47], v[208:211], v[80:83], v[32:47]
    ds_read_b128 v[76:79], v7 offset:33536
    v_mul_f32 v99, v99, v27
    v_exp_f32 v98, v98
    v_exp_f32 v99, v99
    v_add_f32 v98, 1.0, v98
    v_add_f32 v99, 1.0, v99
    v_rcp_f32 v98, v98
    v_mfma_f32_32x32x16_bf16 v[32:47], v[212:215], v[84:87], v[32:47]
    ds_read_b128 v[80:83], v8 offset:33536
    v_rcp_f32 v99, v99
    v_mul_f32 v26, v26, v98
    v_mul_f32 v27, v27, v99
    v_cvt_pk_bf16_f32 v109, v26, v27
    v_mul_f32 v96, v28, v28
    s_add_u32 s13, s15, 720896
    buffer_load_dwordx4 a[44:47], v2, s[44:47], s13 offen sc1
    v_mfma_f32_32x32x16_bf16 v[32:47], v[216:219], v[88:91], v[32:47]
    ds_read_b128 v[84:87], v9 offset:33536
    v_mul_f32 v97, v29, v29
    v_fma_f32 v96, v96, v12, v13
    v_fma_f32 v97, v97, v12, v13
    v_mul_f32 v96, v96, v28
    v_mul_f32 v97, v97, v29
    s_add_u32 s13, s15, 720896
    buffer_load_dwordx4 a[156:159], v2, s[44:47], s13 offen offset:1024 sc1
    v_mfma_f32_32x32x16_bf16 v[32:47], v[220:223], v[92:95], v[32:47]
    ds_read_b128 v[88:91], v10 offset:33536
    v_exp_f32 v96, v96
    v_exp_f32 v97, v97
    v_add_f32 v96, 1.0, v96
    v_add_f32 v97, 1.0, v97
    v_rcp_f32 v96, v96
    s_waitcnt lgkmcnt(3)
    v_mfma_f32_32x32x16_bf16 v[32:47], v[224:227], v[64:67], v[32:47]
    ds_read_b128 v[92:95], v11 offset:33536
    v_rcp_f32 v97, v97
    v_mul_f32 v28, v28, v96
    v_mul_f32 v29, v29, v97
    v_cvt_pk_bf16_f32 v110, v28, v29
    v_mul_f32 v98, v30, v30
    v_mfma_f32_32x32x16_bf16 v[32:47], v[228:231], v[68:71], v[32:47]
    v_mul_f32 v99, v31, v31
    v_fma_f32 v98, v98, v12, v13
    v_fma_f32 v99, v99, v12, v13
    v_mul_f32 v98, v98, v30
    v_mul_f32 v99, v99, v31
    s_waitcnt vmcnt(25)
    s_barrier
    v_add_u32 v4, 0x10000, v4
    v_add_u32 v5, 0x10000, v5
    v_add_u32 v6, 0x10000, v6
    v_add_u32 v7, 0x10000, v7
    v_add_u32 v8, 0x10000, v8
    v_add_u32 v9, 0x10000, v9
    v_add_u32 v10, 0x10000, v10
    v_add_u32 v11, 0x10000, v11
    ds_read_b128 v[64:67], v4 offset:0
    v_mfma_f32_32x32x16_bf16 v[32:47], v[232:235], v[72:75], v[32:47]
    v_exp_f32 v98, v98
    v_exp_f32 v99, v99
    v_add_f32 v98, 1.0, v98
    v_add_f32 v99, 1.0, v99
    v_rcp_f32 v98, v98
    ds_read_b128 v[68:71], v5 offset:0
    v_mfma_f32_32x32x16_bf16 v[32:47], v[236:239], v[76:79], v[32:47]
    v_rcp_f32 v99, v99
    v_mul_f32 v30, v30, v98
    v_mul_f32 v31, v31, v99
    v_cvt_pk_bf16_f32 v111, v30, v31
    buffer_store_dwordx4 v[108:111], v2, s[44:47], s74 offen offset:1024 sc1
    ds_read_b128 v[72:75], v6 offset:0
    s_waitcnt lgkmcnt(3)
    v_mfma_f32_32x32x16_bf16 v[32:47], v[240:243], v[80:83], v[32:47]
    ds_read_b128 v[76:79], v7 offset:0
    v_mfma_f32_32x32x16_bf16 v[32:47], v[244:247], v[84:87], v[32:47]
    ds_read_b128 v[80:83], v8 offset:0
    v_mfma_f32_32x32x16_bf16 v[32:47], v[248:251], v[88:91], v[32:47]
    ds_read_b128 v[84:87], v9 offset:0
    v_mfma_f32_32x32x16_bf16 v[32:47], v[252:255], v[92:95], v[32:47]
    ds_read_b128 v[88:91], v10 offset:0
    s_waitcnt lgkmcnt(3)
    v_mfma_f32_32x32x16_bf16 v[16:31], v[128:131], v[64:67], v[48:63]
    ds_read_b128 v[92:95], v11 offset:0
    v_mfma_f32_32x32x16_bf16 v[16:31], v[132:135], v[68:71], v[16:31]
    ds_read_b128 v[64:67], v4 offset:256
    s_add_u32 s13, s15, 786432
    buffer_load_dwordx4 a[48:51], v2, s[44:47], s13 offen sc1
    v_mfma_f32_32x32x16_bf16 v[16:31], v[136:139], v[72:75], v[16:31]
    ds_read_b128 v[68:71], v5 offset:256
    s_add_u32 s13, s15, 786432
    buffer_load_dwordx4 a[160:163], v2, s[44:47], s13 offen offset:1024 sc1
    v_mfma_f32_32x32x16_bf16 v[16:31], v[140:143], v[76:79], v[16:31]
    ds_read_b128 v[72:75], v6 offset:256
    s_add_u32 s13, s15, 851968
    buffer_load_dwordx4 a[52:55], v2, s[44:47], s13 offen sc1
    s_waitcnt lgkmcnt(3)
    v_mfma_f32_32x32x16_bf16 v[16:31], v[144:147], v[80:83], v[16:31]
    ds_read_b128 v[76:79], v7 offset:256
    s_add_u32 s74, s71, 114688
    v_mul_f32 v96, v32, v32
    v_mul_f32 v97, v33, v33
    v_fma_f32 v96, v96, v12, v13
    v_fma_f32 v97, v97, v12, v13
    v_mul_f32 v96, v96, v32
    v_mfma_f32_32x32x16_bf16 v[16:31], v[148:151], v[84:87], v[16:31]
    ds_read_b128 v[80:83], v8 offset:256
    v_mul_f32 v97, v97, v33
    v_exp_f32 v96, v96
    v_exp_f32 v97, v97
    v_add_f32 v96, 1.0, v96
    v_add_f32 v97, 1.0, v97
    s_add_u32 s13, s15, 851968
    buffer_load_dwordx4 a[164:167], v2, s[44:47], s13 offen offset:1024 sc1
    v_mfma_f32_32x32x16_bf16 v[16:31], v[152:155], v[88:91], v[16:31]
    ds_read_b128 v[84:87], v9 offset:256
    v_rcp_f32 v96, v96
    v_rcp_f32 v97, v97
    v_mul_f32 v32, v32, v96
    v_mul_f32 v33, v33, v97
    v_cvt_pk_bf16_f32 v104, v32, v33
    s_add_u32 s13, s15, 917504
    buffer_load_dwordx4 a[56:59], v2, s[44:47], s13 offen sc1
    v_mfma_f32_32x32x16_bf16 v[16:31], v[156:159], v[92:95], v[16:31]
    ds_read_b128 v[88:91], v10 offset:256
    v_mul_f32 v98, v34, v34
    v_mul_f32 v99, v35, v35
    v_fma_f32 v98, v98, v12, v13
    v_fma_f32 v99, v99, v12, v13
    v_mul_f32 v98, v98, v34
    s_waitcnt lgkmcnt(3)
    v_mfma_f32_32x32x16_bf16 v[16:31], v[160:163], v[64:67], v[16:31]
    ds_read_b128 v[92:95], v11 offset:256
    v_mul_f32 v99, v99, v35
    v_exp_f32 v98, v98
    v_exp_f32 v99, v99
    v_add_f32 v98, 1.0, v98
    v_add_f32 v99, 1.0, v99
    s_add_u32 s13, s15, 917504
    buffer_load_dwordx4 a[168:171], v2, s[44:47], s13 offen offset:1024 sc1
    v_mfma_f32_32x32x16_bf16 v[16:31], v[164:167], v[68:71], v[16:31]
    ds_read_b128 v[64:67], v4 offset:512
    v_rcp_f32 v98, v98
    v_rcp_f32 v99, v99
    v_mul_f32 v34, v34, v98
    v_mul_f32 v35, v35, v99
    v_cvt_pk_bf16_f32 v105, v34, v35
    s_add_u32 s13, s15, 983040
    buffer_load_dwordx4 a[60:63], v2, s[44:47], s13 offen sc1
    v_mfma_f32_32x32x16_bf16 v[16:31], v[168:171], v[72:75], v[16:31]
    ds_read_b128 v[68:71], v5 offset:512
    v_mul_f32 v96, v36, v36
    v_mul_f32 v97, v37, v37
    v_fma_f32 v96, v96, v12, v13
    v_fma_f32 v97, v97, v12, v13
    v_mul_f32 v96, v96, v36
    v_mfma_f32_32x32x16_bf16 v[16:31], v[172:175], v[76:79], v[16:31]
    ds_read_b128 v[72:75], v6 offset:512
    v_mul_f32 v97, v97, v37
    v_exp_f32 v96, v96
    v_exp_f32 v97, v97
    v_add_f32 v96, 1.0, v96
    v_add_f32 v97, 1.0, v97
    s_add_u32 s13, s15, 983040
    buffer_load_dwordx4 a[172:175], v2, s[44:47], s13 offen offset:1024 sc1
    s_waitcnt lgkmcnt(3)
    v_mfma_f32_32x32x16_bf16 v[16:31], v[176:179], v[80:83], v[16:31]
    ds_read_b128 v[76:79], v7 offset:512
    v_rcp_f32 v96, v96
    v_rcp_f32 v97, v97
    v_mul_f32 v36, v36, v96
    v_mul_f32 v37, v37, v97
    v_cvt_pk_bf16_f32 v106, v36, v37
    v_mul_f32 v98, v38, v38
    s_add_u32 s13, s15, 1048576
    buffer_load_dwordx4 a[64:67], v2, s[44:47], s13 offen sc1
    v_mfma_f32_32x32x16_bf16 v[16:31], v[180:183], v[84:87], v[16:31]
    ds_read_b128 v[80:83], v8 offset:512
    v_mul_f32 v99, v39, v39
    v_fma_f32 v98, v98, v12, v13
    v_fma_f32 v99, v99, v12, v13
    v_mul_f32 v98, v98, v38
    v_mul_f32 v99, v99, v39
    s_add_u32 s13, s15, 1048576
    buffer_load_dwordx4 a[176:179], v2, s[44:47], s13 offen offset:1024 sc1
    v_mfma_f32_32x32x16_bf16 v[16:31], v[184:187], v[88:91], v[16:31]
    ds_read_b128 v[84:87], v9 offset:512
    v_exp_f32 v98, v98
    v_exp_f32 v99, v99
    v_add_f32 v98, 1.0, v98
    v_add_f32 v99, 1.0, v99
    v_rcp_f32 v98, v98
    v_mfma_f32_32x32x16_bf16 v[16:31], v[188:191], v[92:95], v[16:31]
    ds_read_b128 v[88:91], v10 offset:512
    v_rcp_f32 v99, v99
    v_mul_f32 v38, v38, v98
    v_mul_f32 v39, v39, v99
    v_cvt_pk_bf16_f32 v107, v38, v39
    buffer_store_dwordx4 v[104:107], v2, s[44:47], s74 offen sc1
    s_add_u32 s13, s15, 1114112
    buffer_load_dwordx4 a[68:71], v2, s[44:47], s13 offen sc1
    s_waitcnt lgkmcnt(3)
    v_mfma_f32_32x32x16_bf16 v[16:31], v[192:195], v[64:67], v[16:31]
    ds_read_b128 v[92:95], v11 offset:512
    v_mul_f32 v96, v40, v40
    v_mul_f32 v97, v41, v41
    v_fma_f32 v96, v96, v12, v13
    v_fma_f32 v97, v97, v12, v13
    v_mul_f32 v96, v96, v40
    s_add_u32 s13, s15, 1114112
    buffer_load_dwordx4 a[180:183], v2, s[44:47], s13 offen offset:1024 sc1
    v_mfma_f32_32x32x16_bf16 v[16:31], v[196:199], v[68:71], v[16:31]
    ds_read_b128 v[64:67], v4 offset:768
    v_mul_f32 v97, v97, v41
    v_exp_f32 v96, v96
    v_exp_f32 v97, v97
    v_add_f32 v96, 1.0, v96
    v_add_f32 v97, 1.0, v97
    v_mfma_f32_32x32x16_bf16 v[16:31], v[200:203], v[72:75], v[16:31]
    ds_read_b128 v[68:71], v5 offset:768
    v_rcp_f32 v96, v96
    v_rcp_f32 v97, v97
    v_mul_f32 v40, v40, v96
    v_mul_f32 v41, v41, v97
    v_cvt_pk_bf16_f32 v108, v40, v41
    s_add_u32 s13, s15, 1179648
    buffer_load_dwordx4 a[72:75], v2, s[44:47], s13 offen sc1
    v_mfma_f32_32x32x16_bf16 v[16:31], v[204:207], v[76:79], v[16:31]
    ds_read_b128 v[72:75], v6 offset:768
    v_mul_f32 v98, v42, v42
    v_mul_f32 v99, v43, v43
    v_fma_f32 v98, v98, v12, v13
    v_fma_f32 v99, v99, v12, v13
    v_mul_f32 v98, v98, v42
    s_add_u32 s13, s15, 1179648
    buffer_load_dwordx4 a[184:187], v2, s[44:47], s13 offen offset:1024 sc1
    s_waitcnt lgkmcnt(3)
    v_mfma_f32_32x32x16_bf16 v[16:31], v[208:211], v[80:83], v[16:31]
    ds_read_b128 v[76:79], v7 offset:768
    v_mul_f32 v99, v99, v43
    v_exp_f32 v98, v98
    v_exp_f32 v99, v99
    v_add_f32 v98, 1.0, v98
    v_add_f32 v99, 1.0, v99
    v_rcp_f32 v98, v98
    v_mfma_f32_32x32x16_bf16 v[16:31], v[212:215], v[84:87], v[16:31]
    ds_read_b128 v[80:83], v8 offset:768
    v_rcp_f32 v99, v99
    v_mul_f32 v42, v42, v98
    v_mul_f32 v43, v43, v99
    v_cvt_pk_bf16_f32 v109, v42, v43
    v_mul_f32 v96, v44, v44
    s_add_u32 s13, s15, 1245184
    buffer_load_dwordx4 a[76:79], v2, s[44:47], s13 offen sc1
    v_mfma_f32_32x32x16_bf16 v[16:31], v[216:219], v[88:91], v[16:31]
    ds_read_b128 v[84:87], v9 offset:768
    v_mul_f32 v97, v45, v45
    v_fma_f32 v96, v96, v12, v13
    v_fma_f32 v97, v97, v12, v13
    v_mul_f32 v96, v96, v44
    v_mul_f32 v97, v97, v45
    s_add_u32 s13, s15, 1245184
    buffer_load_dwordx4 a[188:191], v2, s[44:47], s13 offen offset:1024 sc1
    v_mfma_f32_32x32x16_bf16 v[16:31], v[220:223], v[92:95], v[16:31]
    ds_read_b128 v[88:91], v10 offset:768
    v_exp_f32 v96, v96
    v_exp_f32 v97, v97
    v_add_f32 v96, 1.0, v96
    v_add_f32 v97, 1.0, v97
    v_rcp_f32 v96, v96
    s_waitcnt lgkmcnt(3)
    v_mfma_f32_32x32x16_bf16 v[16:31], v[224:227], v[64:67], v[16:31]
    ds_read_b128 v[92:95], v11 offset:768
    v_rcp_f32 v97, v97
    v_mul_f32 v44, v44, v96
    v_mul_f32 v45, v45, v97
    v_cvt_pk_bf16_f32 v110, v44, v45
    v_mul_f32 v98, v46, v46
    v_mfma_f32_32x32x16_bf16 v[16:31], v[228:231], v[68:71], v[16:31]
    v_mul_f32 v99, v47, v47
    v_fma_f32 v98, v98, v12, v13
    v_fma_f32 v99, v99, v12, v13
    v_mul_f32 v98, v98, v46
    v_mul_f32 v99, v99, v47
    s_waitcnt vmcnt(35)
    s_barrier
    ds_read_b128 v[64:67], v4 offset:32768
    v_mfma_f32_32x32x16_bf16 v[16:31], v[232:235], v[72:75], v[16:31]
    v_exp_f32 v98, v98
    v_exp_f32 v99, v99
    v_add_f32 v98, 1.0, v98
    v_add_f32 v99, 1.0, v99
    v_rcp_f32 v98, v98
    ds_read_b128 v[68:71], v5 offset:32768
    v_mfma_f32_32x32x16_bf16 v[16:31], v[236:239], v[76:79], v[16:31]
    v_rcp_f32 v99, v99
    v_mul_f32 v46, v46, v98
    v_mul_f32 v47, v47, v99
    v_cvt_pk_bf16_f32 v111, v46, v47
    buffer_store_dwordx4 v[108:111], v2, s[44:47], s74 offen offset:1024 sc1
    ds_read_b128 v[72:75], v6 offset:32768
    s_waitcnt lgkmcnt(3)
    v_mfma_f32_32x32x16_bf16 v[16:31], v[240:243], v[80:83], v[16:31]
    ds_read_b128 v[76:79], v7 offset:32768
    v_mfma_f32_32x32x16_bf16 v[16:31], v[244:247], v[84:87], v[16:31]
    ds_read_b128 v[80:83], v8 offset:32768
    v_mfma_f32_32x32x16_bf16 v[16:31], v[248:251], v[88:91], v[16:31]
    ds_read_b128 v[84:87], v9 offset:32768
    v_mfma_f32_32x32x16_bf16 v[16:31], v[252:255], v[92:95], v[16:31]
    ds_read_b128 v[88:91], v10 offset:32768
    s_waitcnt lgkmcnt(3)
    v_mfma_f32_32x32x16_bf16 v[32:47], v[128:131], v[64:67], v[48:63]
    ds_read_b128 v[92:95], v11 offset:32768
    v_mfma_f32_32x32x16_bf16 v[32:47], v[132:135], v[68:71], v[32:47]
    ds_read_b128 v[64:67], v4 offset:33024
    s_add_u32 s13, s15, 1310720
    buffer_load_dwordx4 a[80:83], v2, s[44:47], s13 offen sc1
    v_mfma_f32_32x32x16_bf16 v[32:47], v[136:139], v[72:75], v[32:47]
    ds_read_b128 v[68:71], v5 offset:33024
    s_waitcnt vmcnt(19)
    s_add_u32 s56, s70, 0
    buffer_store_dword v3, off, s[44:47], s56
    s_add_u32 s13, s15, 1310720
    buffer_load_dwordx4 a[192:195], v2, s[44:47], s13 offen offset:1024 sc1
    v_mfma_f32_32x32x16_bf16 v[32:47], v[140:143], v[76:79], v[32:47]
    ds_read_b128 v[72:75], v6 offset:33024
    s_add_u32 s13, s15, 1376256
    buffer_load_dwordx4 a[84:87], v2, s[44:47], s13 offen sc1
    s_waitcnt lgkmcnt(3)
    v_mfma_f32_32x32x16_bf16 v[32:47], v[144:147], v[80:83], v[32:47]
    ds_read_b128 v[76:79], v7 offset:33024
    s_add_u32 s74, s71, 229376
    v_mul_f32 v96, v16, v16
    v_mul_f32 v97, v17, v17
    v_fma_f32 v96, v96, v12, v13
    v_fma_f32 v97, v97, v12, v13
    v_mul_f32 v96, v96, v16
    v_mfma_f32_32x32x16_bf16 v[32:47], v[148:151], v[84:87], v[32:47]
    ds_read_b128 v[80:83], v8 offset:33024
    v_mul_f32 v97, v97, v17
    v_exp_f32 v96, v96
    v_exp_f32 v97, v97
    v_add_f32 v96, 1.0, v96
    v_add_f32 v97, 1.0, v97
    s_add_u32 s13, s15, 1376256
    buffer_load_dwordx4 a[196:199], v2, s[44:47], s13 offen offset:1024 sc1
    v_mfma_f32_32x32x16_bf16 v[32:47], v[152:155], v[88:91], v[32:47]
    ds_read_b128 v[84:87], v9 offset:33024
    v_rcp_f32 v96, v96
    v_rcp_f32 v97, v97
    v_mul_f32 v16, v16, v96
    v_mul_f32 v17, v17, v97
    v_cvt_pk_bf16_f32 v104, v16, v17
    s_add_u32 s13, s15, 1441792
    buffer_load_dwordx4 a[88:91], v2, s[44:47], s13 offen sc1
    v_mfma_f32_32x32x16_bf16 v[32:47], v[156:159], v[92:95], v[32:47]
    ds_read_b128 v[88:91], v10 offset:33024
    v_mul_f32 v98, v18, v18
    v_mul_f32 v99, v19, v19
    v_fma_f32 v98, v98, v12, v13
    v_fma_f32 v99, v99, v12, v13
    v_mul_f32 v98, v98, v18
    s_waitcnt lgkmcnt(3)
    v_mfma_f32_32x32x16_bf16 v[32:47], v[160:163], v[64:67], v[32:47]
    ds_read_b128 v[92:95], v11 offset:33024
    v_mul_f32 v99, v99, v19
    v_exp_f32 v98, v98
    v_exp_f32 v99, v99
    v_add_f32 v98, 1.0, v98
    v_add_f32 v99, 1.0, v99
    s_add_u32 s13, s15, 1441792
    buffer_load_dwordx4 a[200:203], v2, s[44:47], s13 offen offset:1024 sc1
    v_mfma_f32_32x32x16_bf16 v[32:47], v[164:167], v[68:71], v[32:47]
    ds_read_b128 v[64:67], v4 offset:33280
    v_rcp_f32 v98, v98
    v_rcp_f32 v99, v99
    v_mul_f32 v18, v18, v98
    v_mul_f32 v19, v19, v99
    v_cvt_pk_bf16_f32 v105, v18, v19
    s_add_u32 s13, s15, 1507328
    buffer_load_dwordx4 a[92:95], v2, s[44:47], s13 offen sc1
    v_mfma_f32_32x32x16_bf16 v[32:47], v[168:171], v[72:75], v[32:47]
    ds_read_b128 v[68:71], v5 offset:33280
    v_mul_f32 v96, v20, v20
    v_mul_f32 v97, v21, v21
    v_fma_f32 v96, v96, v12, v13
    v_fma_f32 v97, v97, v12, v13
    v_mul_f32 v96, v96, v20
    v_mfma_f32_32x32x16_bf16 v[32:47], v[172:175], v[76:79], v[32:47]
    ds_read_b128 v[72:75], v6 offset:33280
    v_mul_f32 v97, v97, v21
    v_exp_f32 v96, v96
    v_exp_f32 v97, v97
    v_add_f32 v96, 1.0, v96
    v_add_f32 v97, 1.0, v97
    s_add_u32 s13, s15, 1507328
    buffer_load_dwordx4 a[204:207], v2, s[44:47], s13 offen offset:1024 sc1
    s_waitcnt lgkmcnt(3)
    v_mfma_f32_32x32x16_bf16 v[32:47], v[176:179], v[80:83], v[32:47]
    ds_read_b128 v[76:79], v7 offset:33280
    v_rcp_f32 v96, v96
    v_rcp_f32 v97, v97
    v_mul_f32 v20, v20, v96
    v_mul_f32 v21, v21, v97
    v_cvt_pk_bf16_f32 v106, v20, v21
    v_mul_f32 v98, v22, v22
    s_add_u32 s13, s15, 1572864
    buffer_load_dwordx4 a[96:99], v2, s[44:47], s13 offen sc1
    v_mfma_f32_32x32x16_bf16 v[32:47], v[180:183], v[84:87], v[32:47]
    ds_read_b128 v[80:83], v8 offset:33280
    v_mul_f32 v99, v23, v23
    v_fma_f32 v98, v98, v12, v13
    v_fma_f32 v99, v99, v12, v13
    v_mul_f32 v98, v98, v22
    v_mul_f32 v99, v99, v23
    s_add_u32 s13, s15, 1572864
    buffer_load_dwordx4 a[208:211], v2, s[44:47], s13 offen offset:1024 sc1
    v_mfma_f32_32x32x16_bf16 v[32:47], v[184:187], v[88:91], v[32:47]
    ds_read_b128 v[84:87], v9 offset:33280
    v_exp_f32 v98, v98
    v_exp_f32 v99, v99
    v_add_f32 v98, 1.0, v98
    v_add_f32 v99, 1.0, v99
    v_rcp_f32 v98, v98
    v_mfma_f32_32x32x16_bf16 v[32:47], v[188:191], v[92:95], v[32:47]
    ds_read_b128 v[88:91], v10 offset:33280
    v_rcp_f32 v99, v99
    v_mul_f32 v22, v22, v98
    v_mul_f32 v23, v23, v99
    v_cvt_pk_bf16_f32 v107, v22, v23
    buffer_store_dwordx4 v[104:107], v2, s[44:47], s74 offen sc1
    s_add_u32 s13, s15, 1638400
    buffer_load_dwordx4 a[100:103], v2, s[44:47], s13 offen sc1
    s_waitcnt lgkmcnt(3)
    v_mfma_f32_32x32x16_bf16 v[32:47], v[192:195], v[64:67], v[32:47]
    ds_read_b128 v[92:95], v11 offset:33280
    v_mul_f32 v96, v24, v24
    v_mul_f32 v97, v25, v25
    v_fma_f32 v96, v96, v12, v13
    v_fma_f32 v97, v97, v12, v13
    v_mul_f32 v96, v96, v24
    s_add_u32 s13, s15, 1638400
    buffer_load_dwordx4 a[212:215], v2, s[44:47], s13 offen offset:1024 sc1
    v_mfma_f32_32x32x16_bf16 v[32:47], v[196:199], v[68:71], v[32:47]
    ds_read_b128 v[64:67], v4 offset:33536
    v_mul_f32 v97, v97, v25
    v_exp_f32 v96, v96
    v_exp_f32 v97, v97
    v_add_f32 v96, 1.0, v96
    v_add_f32 v97, 1.0, v97
    v_mfma_f32_32x32x16_bf16 v[32:47], v[200:203], v[72:75], v[32:47]
    ds_read_b128 v[68:71], v5 offset:33536
    v_rcp_f32 v96, v96
    v_rcp_f32 v97, v97
    v_mul_f32 v24, v24, v96
    v_mul_f32 v25, v25, v97
    v_cvt_pk_bf16_f32 v108, v24, v25
    s_add_u32 s13, s15, 1703936
    buffer_load_dwordx4 a[104:107], v2, s[44:47], s13 offen sc1
    v_mfma_f32_32x32x16_bf16 v[32:47], v[204:207], v[76:79], v[32:47]
    ds_read_b128 v[72:75], v6 offset:33536
    v_mul_f32 v98, v26, v26
    v_mul_f32 v99, v27, v27
    v_fma_f32 v98, v98, v12, v13
    v_fma_f32 v99, v99, v12, v13
    v_mul_f32 v98, v98, v26
    s_add_u32 s13, s15, 1703936
    buffer_load_dwordx4 a[216:219], v2, s[44:47], s13 offen offset:1024 sc1
    s_waitcnt lgkmcnt(3)
    v_mfma_f32_32x32x16_bf16 v[32:47], v[208:211], v[80:83], v[32:47]
    ds_read_b128 v[76:79], v7 offset:33536
    v_mul_f32 v99, v99, v27
    v_exp_f32 v98, v98
    v_exp_f32 v99, v99
    v_add_f32 v98, 1.0, v98
    v_add_f32 v99, 1.0, v99
    v_rcp_f32 v98, v98
    v_mfma_f32_32x32x16_bf16 v[32:47], v[212:215], v[84:87], v[32:47]
    ds_read_b128 v[80:83], v8 offset:33536
    v_rcp_f32 v99, v99
    v_mul_f32 v26, v26, v98
    v_mul_f32 v27, v27, v99
    v_cvt_pk_bf16_f32 v109, v26, v27
    v_mul_f32 v96, v28, v28
    s_add_u32 s13, s15, 1769472
    buffer_load_dwordx4 a[108:111], v2, s[44:47], s13 offen sc1
    v_mfma_f32_32x32x16_bf16 v[32:47], v[216:219], v[88:91], v[32:47]
    ds_read_b128 v[84:87], v9 offset:33536
    v_mul_f32 v97, v29, v29
    v_fma_f32 v96, v96, v12, v13
    v_fma_f32 v97, v97, v12, v13
    v_mul_f32 v96, v96, v28
    v_mul_f32 v97, v97, v29
    s_add_u32 s13, s15, 1769472
    buffer_load_dwordx4 a[220:223], v2, s[44:47], s13 offen offset:1024 sc1
    v_mfma_f32_32x32x16_bf16 v[32:47], v[220:223], v[92:95], v[32:47]
    ds_read_b128 v[88:91], v10 offset:33536
    v_exp_f32 v96, v96
    v_exp_f32 v97, v97
    v_add_f32 v96, 1.0, v96
    v_add_f32 v97, 1.0, v97
    v_rcp_f32 v96, v96
    s_waitcnt lgkmcnt(3)
    v_mfma_f32_32x32x16_bf16 v[32:47], v[224:227], v[64:67], v[32:47]
    ds_read_b128 v[92:95], v11 offset:33536
    v_rcp_f32 v97, v97
    v_mul_f32 v28, v28, v96
    v_mul_f32 v29, v29, v97
    v_cvt_pk_bf16_f32 v110, v28, v29
    v_mul_f32 v98, v30, v30
    v_mfma_f32_32x32x16_bf16 v[32:47], v[228:231], v[68:71], v[32:47]
    v_mul_f32 v99, v31, v31
    v_fma_f32 v98, v98, v12, v13
    v_fma_f32 v99, v99, v12, v13
    v_mul_f32 v98, v98, v30
    v_mul_f32 v99, v99, v31
    v_mfma_f32_32x32x16_bf16 v[32:47], v[232:235], v[72:75], v[32:47]
    v_exp_f32 v98, v98
    v_exp_f32 v99, v99
    v_add_f32 v98, 1.0, v98
    v_add_f32 v99, 1.0, v99
    v_rcp_f32 v98, v98
    v_mfma_f32_32x32x16_bf16 v[32:47], v[236:239], v[76:79], v[32:47]
    v_rcp_f32 v99, v99
    v_mul_f32 v30, v30, v98
    v_mul_f32 v31, v31, v99
    v_cvt_pk_bf16_f32 v111, v30, v31
    buffer_store_dwordx4 v[108:111], v2, s[44:47], s74 offen offset:1024 sc1
    s_waitcnt lgkmcnt(0)
    v_mfma_f32_32x32x16_bf16 v[32:47], v[240:243], v[80:83], v[32:47]
    s_waitcnt vmcnt(19)
    s_add_u32 s56, s70, 256
    buffer_store_dword v3, off, s[44:47], s56
    v_mfma_f32_32x32x16_bf16 v[32:47], v[244:247], v[84:87], v[32:47]
    v_add_u32 v100, 0, v119
    v_add_u32 v101, 512, v100
    buffer_load_dword v102, v100, s[44:47], 0 offen sc1
    v_mfma_f32_32x32x16_bf16 v[32:47], v[248:251], v[88:91], v[32:47]
    v_mfma_f32_32x32x16_bf16 v[32:47], v[252:255], v[92:95], v[32:47]
    v_subrev_u32 v4, 0x10000, v4
    v_subrev_u32 v5, 0x10000, v5
    v_subrev_u32 v6, 0x10000, v6
    v_subrev_u32 v7, 0x10000, v7
    v_subrev_u32 v8, 0x10000, v8
    v_subrev_u32 v9, 0x10000, v9
    v_subrev_u32 v10, 0x10000, v10
    v_subrev_u32 v11, 0x10000, v11
    v_mov_b32 v124, v100
    v_mov_b32 v125, v101
    s_waitcnt vmcnt(0)
    v_cmp_ne_u32 vcc, s51, v102
    s_cbranch_vccz L_pcd_22
    s_mov_b32 s53, 0
L_pc_21:
    buffer_load_dword v102, v100, s[44:47], 0 offen sc1
    s_waitcnt vmcnt(0)
    v_cmp_ne_u32 vcc, s51, v102
    s_cbranch_vccz L_pcd_22
    s_add_u32 s53, s53, 1
    s_cmp_lg_u32 s52, 0
    s_cbranch_scc1 L_pcd_22
    s_cmp_lt_u32 s53, 0x8000
    s_cbranch_scc1 L_pc_21
    s_mov_b32 s52, 1
L_pcd_22:
    s_add_u32 s54, s69, 0
    buffer_load_dwordx4 v[64:67], v2, s[44:47], s54 offen sc1
    s_add_u32 s54, s69, 0
    buffer_load_dwordx4 v[68:71], v2, s[44:47], s54 offen offset:1024 sc1
    s_add_u32 s54, s69, 0
    buffer_load_dwordx4 v[72:75], v2, s[44:47], s54 offen offset:2048 sc1
    s_add_u32 s54, s69, 0
    buffer_load_dwordx4 v[76:79], v2, s[44:47], s54 offen offset:3072 sc1
    s_add_u32 s54, s69, 4096
    buffer_load_dwordx4 v[80:83], v2, s[44:47], s54 offen sc1
    s_add_u32 s54, s69, 4096
    buffer_load_dwordx4 v[84:87], v2, s[44:47], s54 offen offset:1024 sc1
    s_add_u32 s54, s69, 4096
    buffer_load_dwordx4 v[88:91], v2, s[44:47], s54 offen offset:2048 sc1
    s_add_u32 s54, s69, 4096
    buffer_load_dwordx4 v[92:95], v2, s[44:47], s54 offen offset:3072 sc1
    s_add_u32 s54, s69, 8192
    buffer_load_dwordx4 v[96:99], v2, s[44:47], s54 offen sc1
    s_add_u32 s54, s69, 8192
    buffer_load_dwordx4 v[100:103], v2, s[44:47], s54 offen offset:1024 sc1
    s_add_u32 s54, s69, 8192
    buffer_load_dwordx4 v[104:107], v2, s[44:47], s54 offen offset:2048 sc1
    s_add_u32 s54, s69, 8192
    buffer_load_dwordx4 v[108:111], v2, s[44:47], s54 offen offset:3072 sc1
    s_nop 1
    s_add_u32 s74, s71, 344064
    v_pk_mul_f32 v[60:61], v[32:33], v[32:33]
    v_pk_mul_f32 v[62:63], v[34:35], v[34:35]
    v_pk_fma_f32 v[60:61], v[60:61], v[12:13], v[12:13] op_sel:[0,0,1] op_sel_hi:[1,0,1]
    v_pk_fma_f32 v[62:63], v[62:63], v[12:13], v[12:13] op_sel:[0,0,1] op_sel_hi:[1,0,1]
    v_pk_mul_f32 v[60:61], v[60:61], v[32:33]
    v_pk_mul_f32 v[62:63], v[62:63], v[34:35]
    v_exp_f32 v60, v60
    v_exp_f32 v62, v62
    v_exp_f32 v61, v61
    v_exp_f32 v63, v63
    v_pk_add_f32 v[60:61], v[60:61], v[14:15]
    v_pk_add_f32 v[62:63], v[62:63], v[14:15]
    v_rcp_f32 v60, v60
    v_rcp_f32 v62, v62
    v_rcp_f32 v61, v61
    v_rcp_f32 v63, v63
    v_pk_mul_f32 v[32:33], v[32:33], v[60:61]
    v_pk_mul_f32 v[34:35], v[34:35], v[62:63]
    v_cvt_pk_bf16_f32 v48, v32, v33
    v_cvt_pk_bf16_f32 v49, v34, v35
    v_pk_mul_f32 v[60:61], v[36:37], v[36:37]
    v_pk_mul_f32 v[62:63], v[38:39], v[38:39]
    v_pk_fma_f32 v[60:61], v[60:61], v[12:13], v[12:13] op_sel:[0,0,1] op_sel_hi:[1,0,1]
    v_pk_fma_f32 v[62:63], v[62:63], v[12:13], v[12:13] op_sel:[0,0,1] op_sel_hi:[1,0,1]
    v_pk_mul_f32 v[60:61], v[60:61], v[36:37]
    v_pk_mul_f32 v[62:63], v[62:63], v[38:39]
    v_exp_f32 v60, v60
    v_exp_f32 v62, v62
    v_exp_f32 v61, v61
    v_exp_f32 v63, v63
    v_pk_add_f32 v[60:61], v[60:61], v[14:15]
    v_pk_add_f32 v[62:63], v[62:63], v[14:15]
    v_rcp_f32 v60, v60
    v_rcp_f32 v62, v62
    v_rcp_f32 v61, v61
    v_rcp_f32 v63, v63
    v_pk_mul_f32 v[36:37], v[36:37], v[60:61]
    v_pk_mul_f32 v[38:39], v[38:39], v[62:63]
    v_cvt_pk_bf16_f32 v50, v36, v37
    v_cvt_pk_bf16_f32 v51, v38, v39
    s_add_u32 s56, s70, 512
    buffer_store_dword v3, off, s[44:47], s56
    buffer_store_dwordx4 v[48:51], v2, s[44:47], s74 offen sc1
    v_pk_mul_f32 v[60:61], v[40:41], v[40:41]
    v_pk_mul_f32 v[62:63], v[42:43], v[42:43]
    v_pk_fma_f32 v[60:61], v[60:61], v[12:13], v[12:13] op_sel:[0,0,1] op_sel_hi:[1,0,1]
    v_pk_fma_f32 v[62:63], v[62:63], v[12:13], v[12:13] op_sel:[0,0,1] op_sel_hi:[1,0,1]
    v_pk_mul_f32 v[60:61], v[60:61], v[40:41]
    v_pk_mul_f32 v[62:63], v[62:63], v[42:43]
    v_exp_f32 v60, v60
    v_exp_f32 v62, v62
    v_exp_f32 v61, v61
    v_exp_f32 v63, v63
    v_pk_add_f32 v[60:61], v[60:61], v[14:15]
    v_pk_add_f32 v[62:63], v[62:63], v[14:15]
    v_rcp_f32 v60, v60
    v_rcp_f32 v62, v62
    v_rcp_f32 v61, v61
    v_rcp_f32 v63, v63
    v_pk_mul_f32 v[40:41], v[40:41], v[60:61]
    v_pk_mul_f32 v[42:43], v[42:43], v[62:63]
    v_cvt_pk_bf16_f32 v52, v40, v41
    v_cvt_pk_bf16_f32 v53, v42, v43
    v_pk_mul_f32 v[60:61], v[44:45], v[44:45]
    v_pk_mul_f32 v[62:63], v[46:47], v[46:47]
    v_pk_fma_f32 v[60:61], v[60:61], v[12:13], v[12:13] op_sel:[0,0,1] op_sel_hi:[1,0,1]
    v_pk_fma_f32 v[62:63], v[62:63], v[12:13], v[12:13] op_sel:[0,0,1] op_sel_hi:[1,0,1]
    v_pk_mul_f32 v[60:61], v[60:61], v[44:45]
    v_pk_mul_f32 v[62:63], v[62:63], v[46:47]
    v_exp_f32 v60, v60
    v_exp_f32 v62, v62
    v_exp_f32 v61, v61
    v_exp_f32 v63, v63
    v_pk_add_f32 v[60:61], v[60:61], v[14:15]
    v_pk_add_f32 v[62:63], v[62:63], v[14:15]
    v_rcp_f32 v60, v60
    v_rcp_f32 v62, v62
    v_rcp_f32 v61, v61
    v_rcp_f32 v63, v63
    v_pk_mul_f32 v[44:45], v[44:45], v[60:61]
    v_pk_mul_f32 v[46:47], v[46:47], v[62:63]
    v_cvt_pk_bf16_f32 v54, v44, v45
    v_cvt_pk_bf16_f32 v55, v46, v47
    buffer_store_dwordx4 v[52:55], v2, s[44:47], s74 offen offset:1024 sc1
    s_mov_b32 s4, s36
    s_and_b32 s5, s37, 0xffff
    s_mov_b32 s6, 1024
    s_mov_b32 s7, 0x00020000
    buffer_load_dwordx4 v[56:59], v123, s[4:7], 0 offen
    s_mov_b32 s53, 13631488
    buffer_load_dwordx4 v[60:63], v112, s[44:47], s53 offen sc1
    s_waitcnt vmcnt(16)
    v_mfma_f32_32x32x16_bf16 a[224:239], a[0:3], v[64:67], 0
    v_mfma_f32_32x32x16_bf16 a[240:255], a[112:115], v[64:67], 0
    s_waitcnt vmcnt(15)
    v_mfma_f32_32x32x16_bf16 a[224:239], a[4:7], v[68:71], a[224:239]
    s_add_u32 s54, s69, 12288
    buffer_load_dwordx4 v[64:67], v2, s[44:47], s54 offen sc1
    v_mfma_f32_32x32x16_bf16 a[240:255], a[116:119], v[68:71], a[240:255]
    s_waitcnt vmcnt(15)
    v_mfma_f32_32x32x16_bf16 a[224:239], a[8:11], v[72:75], a[224:239]
    s_add_u32 s54, s69, 12288
    buffer_load_dwordx4 v[68:71], v2, s[44:47], s54 offen offset:1024 sc1
    v_mfma_f32_32x32x16_bf16 a[240:255], a[120:123], v[72:75], a[240:255]
    s_waitcnt vmcnt(15)
    v_mfma_f32_32x32x16_bf16 a[224:239], a[12:15], v[76:79], a[224:239]
    s_add_u32 s54, s69, 12288
    buffer_load_dwordx4 v[72:75], v2, s[44:47], s54 offen offset:2048 sc1
    v_mfma_f32_32x32x16_bf16 a[240:255], a[124:127], v[76:79], a[240:255]
    s_waitcnt vmcnt(5)
    s_add_u32 s56, s70, 768
    buffer_store_dword v3, off, s[44:47], s56
    v_mfma_f32_32x32x16_bf16 a[224:239], a[16:19], v[80:83], a[224:239]
    s_add_u32 s54, s69, 12288
    buffer_load_dwordx4 v[76:79], v2, s[44:47], s54 offen offset:3072 sc1
    v_mfma_f32_32x32x16_bf16 a[240:255], a[128:131], v[80:83], a[240:255]
    v_mfma_f32_32x32x16_bf16 a[224:239], a[20:23], v[84:87], a[224:239]
    s_add_u32 s54, s69, 16384
    buffer_load_dwordx4 v[80:83], v2, s[44:47], s54 offen sc1
    v_mfma_f32_32x32x16_bf16 a[240:255], a[132:135], v[84:87], a[240:255]
    v_mfma_f32_32x32x16_bf16 a[224:239], a[24:27], v[88:91], a[224:239]
    s_add_u32 s54, s69, 16384
    buffer_load_dwordx4 v[84:87], v2, s[44:47], s54 offen offset:1024 sc1
    v_mfma_f32_32x32x16_bf16 a[240:255], a[136:139], v[88:91], a[240:255]
    v_mfma_f32_32x32x16_bf16 a[224:239], a[28:31], v[92:95], a[224:239]
    s_add_u32 s54, s69, 16384
    buffer_load_dwordx4 v[88:91], v2, s[44:47], s54 offen offset:2048 sc1
    v_mfma_f32_32x32x16_bf16 a[240:255], a[140:143], v[92:95], a[240:255]
    v_mfma_f32_32x32x16_bf16 a[224:239], a[32:35], v[96:99], a[224:239]
    s_add_u32 s54, s69, 16384
    buffer_load_dwordx4 v[92:95], v2, s[44:47], s54 offen offset:3072 sc1
    v_mfma_f32_32x32x16_bf16 a[240:255], a[144:147], v[96:99], a[240:255]
    v_mfma_f32_32x32x16_bf16 a[224:239], a[36:39], v[100:103], a[224:239]
    s_add_u32 s54, s69, 20480
    buffer_load_dwordx4 v[96:99], v2, s[44:47], s54 offen sc1
    v_mfma_f32_32x32x16_bf16 a[240:255], a[148:151], v[100:103], a[240:255]
    v_mfma_f32_32x32x16_bf16 a[224:239], a[40:43], v[104:107], a[224:239]
    s_add_u32 s54, s69, 20480
    buffer_load_dwordx4 v[100:103], v2, s[44:47], s54 offen offset:1024 sc1
    v_mfma_f32_32x32x16_bf16 a[240:255], a[152:155], v[104:107], a[240:255]
    buffer_load_dword v126, v125, s[44:47], 0 offen sc1
    v_mfma_f32_32x32x16_bf16 a[224:239], a[44:47], v[108:111], a[224:239]
    s_add_u32 s54, s69, 20480
    buffer_load_dwordx4 v[104:107], v2, s[44:47], s54 offen offset:2048 sc1
    v_mfma_f32_32x32x16_bf16 a[240:255], a[156:159], v[108:111], a[240:255]
    s_waitcnt vmcnt(12)
    v_mfma_f32_32x32x16_bf16 a[224:239], a[48:51], v[64:67], a[224:239]
    s_add_u32 s54, s69, 20480
    buffer_load_dwordx4 v[108:111], v2, s[44:47], s54 offen offset:3072 sc1
    v_mfma_f32_32x32x16_bf16 a[240:255], a[160:163], v[64:67], a[240:255]
    s_waitcnt vmcnt(12)
    v_mfma_f32_32x32x16_bf16 a[224:239], a[52:55], v[68:71], a[224:239]
    s_add_u32 s54, s69, 24576
    buffer_load_dwordx4 v[64:67], v2, s[44:47], s54 offen sc1
    v_mfma_f32_32x32x16_bf16 a[240:255], a[164:167], v[68:71], a[240:255]
    s_waitcnt vmcnt(12)
    v_mfma_f32_32x32x16_bf16 a[224:239], a[56:59], v[72:75], a[224:239]
    s_add_u32 s54, s69, 24576
    buffer_load_dwordx4 v[68:71], v2, s[44:47], s54 offen offset:1024 sc1
    v_mfma_f32_32x32x16_bf16 a[240:255], a[168:171], v[72:75], a[240:255]
    s_waitcnt vmcnt(11)
    v_mfma_f32_32x32x16_bf16 a[224:239], a[60:63], v[76:79], a[224:239]
    s_add_u32 s54, s69, 24576
    buffer_load_dwordx4 v[72:75], v2, s[44:47], s54 offen offset:2048 sc1
    v_mfma_f32_32x32x16_bf16 a[240:255], a[172:175], v[76:79], a[240:255]
    s_waitcnt vmcnt(5)
    v_cmp_ne_u32 vcc, s51, v126
    s_cbranch_vccz L_pcd_24
    s_mov_b32 s53, 0
L_pc_23:
    buffer_load_dword v126, v125, s[44:47], 0 offen sc1
    s_waitcnt vmcnt(0)
    v_cmp_ne_u32 vcc, s51, v126
    s_cbranch_vccz L_pcd_24
    s_add_u32 s53, s53, 1
    s_cmp_lg_u32 s52, 0
    s_cbranch_scc1 L_pcd_24
    s_cmp_lt_u32 s53, 0x8000
    s_cbranch_scc1 L_pc_23
    s_mov_b32 s52, 1
L_pcd_24:
    v_mfma_f32_32x32x16_bf16 a[224:239], a[64:67], v[80:83], a[224:239]
    s_add_u32 s54, s69, 24576
    buffer_load_dwordx4 v[76:79], v2, s[44:47], s54 offen offset:3072 sc1
    v_mfma_f32_32x32x16_bf16 a[240:255], a[176:179], v[80:83], a[240:255]
    v_mfma_f32_32x32x16_bf16 a[224:239], a[68:71], v[84:87], a[224:239]
    s_add_u32 s54, s69, 229376
    buffer_load_dwordx4 v[80:83], v2, s[44:47], s54 offen sc1
    v_mfma_f32_32x32x16_bf16 a[240:255], a[180:183], v[84:87], a[240:255]
    v_mfma_f32_32x32x16_bf16 a[224:239], a[72:75], v[88:91], a[224:239]
    s_add_u32 s54, s69, 229376
    buffer_load_dwordx4 v[84:87], v2, s[44:47], s54 offen offset:1024 sc1
    v_mfma_f32_32x32x16_bf16 a[240:255], a[184:187], v[88:91], a[240:255]
    v_mfma_f32_32x32x16_bf16 a[224:239], a[76:79], v[92:95], a[224:239]
    s_add_u32 s54, s69, 229376
    buffer_load_dwordx4 v[88:91], v2, s[44:47], s54 offen offset:2048 sc1
    v_mfma_f32_32x32x16_bf16 a[240:255], a[188:191], v[92:95], a[240:255]
    v_mfma_f32_32x32x16_bf16 a[224:239], a[80:83], v[96:99], a[224:239]
    s_add_u32 s54, s69, 229376
    buffer_load_dwordx4 v[92:95], v2, s[44:47], s54 offen offset:3072 sc1
    v_mfma_f32_32x32x16_bf16 a[240:255], a[192:195], v[96:99], a[240:255]
    v_mfma_f32_32x32x16_bf16 a[224:239], a[84:87], v[100:103], a[224:239]
    s_add_u32 s54, s69, 233472
    buffer_load_dwordx4 v[96:99], v2, s[44:47], s54 offen sc1
    v_mfma_f32_32x32x16_bf16 a[240:255], a[196:199], v[100:103], a[240:255]
    s_waitcnt vmcnt(10)
    v_mfma_f32_32x32x16_bf16 a[224:239], a[88:91], v[104:107], a[224:239]
    s_add_u32 s54, s69, 233472
    buffer_load_dwordx4 v[100:103], v2, s[44:47], s54 offen offset:1024 sc1
    v_mfma_f32_32x32x16_bf16 a[240:255], a[200:203], v[104:107], a[240:255]
    s_waitcnt vmcnt(10)
    v_mfma_f32_32x32x16_bf16 a[224:239], a[92:95], v[108:111], a[224:239]
    s_add_u32 s54, s69, 233472
    buffer_load_dwordx4 v[104:107], v2, s[44:47], s54 offen offset:2048 sc1
    v_mfma_f32_32x32x16_bf16 a[240:255], a[204:207], v[108:111], a[240:255]
    s_waitcnt vmcnt(10)
    v_mfma_f32_32x32x16_bf16 a[224:239], a[96:99], v[64:67], a[224:239]
    s_add_u32 s54, s69, 233472
    buffer_load_dwordx4 v[108:111], v2, s[44:47], s54 offen offset:3072 sc1
    v_mfma_f32_32x32x16_bf16 a[240:255], a[208:211], v[64:67], a[240:255]
    s_waitcnt vmcnt(10)
    v_mfma_f32_32x32x16_bf16 a[224:239], a[100:103], v[68:71], a[224:239]
    s_add_u32 s54, s69, 237568
    buffer_load_dwordx4 v[64:67], v2, s[44:47], s54 offen sc1
    v_mfma_f32_32x32x16_bf16 a[240:255], a[212:215], v[68:71], a[240:255]
    s_waitcnt vmcnt(10)
    v_mfma_f32_32x32x16_bf16 a[224:239], a[104:107], v[72:75], a[224:239]
    s_add_u32 s54, s69, 237568
    buffer_load_dwordx4 v[68:71], v2, s[44:47], s54 offen offset:1024 sc1
    v_mfma_f32_32x32x16_bf16 a[240:255], a[216:219], v[72:75], a[240:255]
    s_waitcnt vmcnt(10)
    v_mfma_f32_32x32x16_bf16 a[224:239], a[108:111], v[76:79], a[224:239]
    s_add_u32 s54, s69, 237568
    buffer_load_dwordx4 v[72:75], v2, s[44:47], s54 offen offset:2048 sc1
    v_mfma_f32_32x32x16_bf16 a[240:255], a[220:223], v[76:79], a[240:255]
    s_waitcnt vmcnt(10)
    v_mfma_f32_32x32x16_bf16 v[16:31], a[0:3], v[80:83], 0
    s_add_u32 s54, s69, 237568
    buffer_load_dwordx4 v[76:79], v2, s[44:47], s54 offen offset:3072 sc1
    v_mfma_f32_32x32x16_bf16 v[32:47], a[112:115], v[80:83], 0
    s_waitcnt vmcnt(10)
    v_mfma_f32_32x32x16_bf16 v[16:31], a[4:7], v[84:87], v[16:31]
    s_add_u32 s54, s69, 241664
    buffer_load_dwordx4 v[80:83], v2, s[44:47], s54 offen sc1
    v_mfma_f32_32x32x16_bf16 v[32:47], a[116:119], v[84:87], v[32:47]
    s_waitcnt vmcnt(10)
    v_mfma_f32_32x32x16_bf16 v[16:31], a[8:11], v[88:91], v[16:31]
    s_add_u32 s54, s69, 241664
    buffer_load_dwordx4 v[84:87], v2, s[44:47], s54 offen offset:1024 sc1
    v_mfma_f32_32x32x16_bf16 v[32:47], a[120:123], v[88:91], v[32:47]
    ds_write_b128 v115, a[224:227] offset:0
    ds_write_b128 v116, a[228:231] offset:0
    s_waitcnt vmcnt(10)
    v_mfma_f32_32x32x16_bf16 v[16:31], a[12:15], v[92:95], v[16:31]
    s_add_u32 s54, s69, 241664
    buffer_load_dwordx4 v[88:91], v2, s[44:47], s54 offen offset:2048 sc1
    v_mfma_f32_32x32x16_bf16 v[32:47], a[124:127], v[92:95], v[32:47]
    ds_write_b128 v117, a[232:235] offset:0
    ds_write_b128 v118, a[236:239] offset:0
    s_waitcnt vmcnt(10)
    v_mfma_f32_32x32x16_bf16 v[16:31], a[16:19], v[96:99], v[16:31]
    s_add_u32 s54, s69, 241664
    buffer_load_dwordx4 v[92:95], v2, s[44:47], s54 offen offset:3072 sc1
    v_mfma_f32_32x32x16_bf16 v[32:47], a[128:131], v[96:99], v[32:47]
    ds_write_b128 v115, a[240:243] offset:128
    ds_write_b128 v116, a[244:247] offset:128
    s_waitcnt vmcnt(10)
    v_mfma_f32_32x32x16_bf16 v[16:31], a[20:23], v[100:103], v[16:31]
    s_add_u32 s54, s69, 245760
    buffer_load_dwordx4 v[96:99], v2, s[44:47], s54 offen sc1
    v_mfma_f32_32x32x16_bf16 v[32:47], a[132:135], v[100:103], v[32:47]
    ds_write_b128 v117, a[248:251] offset:128
    ds_write_b128 v118, a[252:255] offset:128
    s_waitcnt vmcnt(10)
    v_mfma_f32_32x32x16_bf16 v[16:31], a[24:27], v[104:107], v[16:31]
    s_add_u32 s54, s69, 245760
    buffer_load_dwordx4 v[100:103], v2, s[44:47], s54 offen offset:1024 sc1
    v_mfma_f32_32x32x16_bf16 v[32:47], a[136:139], v[104:107], v[32:47]
    s_waitcnt vmcnt(10)
    v_mfma_f32_32x32x16_bf16 v[16:31], a[28:31], v[108:111], v[16:31]
    s_add_u32 s54, s69, 245760
    buffer_load_dwordx4 v[104:107], v2, s[44:47], s54 offen offset:2048 sc1
    v_mfma_f32_32x32x16_bf16 v[32:47], a[140:143], v[108:111], v[32:47]
    s_waitcnt lgkmcnt(0)
    s_barrier
    s_waitcnt vmcnt(10)
    v_mfma_f32_32x32x16_bf16 v[16:31], a[32:35], v[64:67], v[16:31]
    s_add_u32 s54, s69, 245760
    buffer_load_dwordx4 v[108:111], v2, s[44:47], s54 offen offset:3072 sc1
    v_mfma_f32_32x32x16_bf16 v[32:47], a[144:147], v[64:67], v[32:47]
    ds_read_b128 v[48:51], v113 offset:0
    ds_read_b128 v[52:55], v113 offset:8192
    s_waitcnt lgkmcnt(0)
    v_add_f32 v48, v48, v52
    v_add_f32 v49, v49, v53
    v_add_f32 v50, v50, v54
    v_add_f32 v51, v51, v55
    ds_read_b128 v[52:55], v113 offset:16384
    s_waitcnt vmcnt(10)
    v_mfma_f32_32x32x16_bf16 v[16:31], a[36:39], v[68:71], v[16:31]
    s_add_u32 s54, s69, 249856
    buffer_load_dwordx4 v[64:67], v2, s[44:47], s54 offen sc1
    v_mfma_f32_32x32x16_bf16 v[32:47], a[148:151], v[68:71], v[32:47]
    s_waitcnt lgkmcnt(0)
    v_add_f32 v48, v48, v52
    v_add_f32 v49, v49, v53
    v_add_f32 v50, v50, v54
    v_add_f32 v51, v51, v55
    ds_read_b128 v[52:55], v113 offset:24576
    s_waitcnt vmcnt(10)
    v_mfma_f32_32x32x16_bf16 v[16:31], a[40:43], v[72:75], v[16:31]
    s_add_u32 s54, s69, 249856
    buffer_load_dwordx4 v[68:71], v2, s[44:47], s54 offen offset:1024 sc1
    v_mfma_f32_32x32x16_bf16 v[32:47], a[152:155], v[72:75], v[32:47]
    s_waitcnt lgkmcnt(0)
    v_add_f32 v48, v48, v52
    v_add_f32 v49, v49, v53
    v_add_f32 v50, v50, v54
    v_add_f32 v51, v51, v55
    v_lshlrev_b32 v52, 16, v56
    v_and_b32 v53, 0xffff0000, v56
    v_lshlrev_b32 v54, 16, v57
    v_and_b32 v55, 0xffff0000, v57
    v_add_f32 v48, v48, v52
    v_add_f32 v49, v49, v53
    v_add_f32 v50, v50, v54
    v_add_f32 v51, v51, v55
    s_waitcnt vmcnt(10)
    v_mfma_f32_32x32x16_bf16 v[16:31], a[44:47], v[76:79], v[16:31]
    s_add_u32 s54, s69, 249856
    buffer_load_dwordx4 v[72:75], v2, s[44:47], s54 offen offset:2048 sc1
    v_mfma_f32_32x32x16_bf16 v[32:47], a[156:159], v[76:79], v[32:47]
    v_cvt_pk_bf16_f32 v52, v48, v49
    v_cvt_pk_bf16_f32 v53, v50, v51
    v_lshlrev_b32 v48, 16, v52
    v_and_b32 v49, 0xffff0000, v52
    v_lshlrev_b32 v50, 16, v53
    v_and_b32 v51, 0xffff0000, v53
    s_waitcnt vmcnt(10)
    v_mfma_f32_32x32x16_bf16 v[16:31], a[48:51], v[80:83], v[16:31]
    s_add_u32 s54, s69, 249856
    buffer_load_dwordx4 v[76:79], v2, s[44:47], s54 offen offset:3072 sc1
    v_mfma_f32_32x32x16_bf16 v[32:47], a[160:163], v[80:83], v[32:47]
    v_lshlrev_b32 v52, 16, v60
    v_and_b32 v53, 0xffff0000, v60
    v_lshlrev_b32 v54, 16, v61
    v_and_b32 v55, 0xffff0000, v61
    v_add_f32 v48, v48, v52
    v_add_f32 v49, v49, v53
    v_add_f32 v50, v50, v54
    v_add_f32 v51, v51, v55
    v_cvt_pk_bf16_f32 v12, v48, v49
    v_cvt_pk_bf16_f32 v13, v50, v51
    s_waitcnt vmcnt(10)
    v_mfma_f32_32x32x16_bf16 v[16:31], a[52:55], v[84:87], v[16:31]
    s_add_u32 s54, s69, 253952
    buffer_load_dwordx4 v[80:83], v2, s[44:47], s54 offen sc1
    v_mfma_f32_32x32x16_bf16 v[32:47], a[164:167], v[84:87], v[32:47]
    ds_read_b128 v[48:51], v114 offset:0
    ds_read_b128 v[52:55], v114 offset:8192
    s_waitcnt vmcnt(10)
    v_mfma_f32_32x32x16_bf16 v[16:31], a[56:59], v[88:91], v[16:31]
    s_add_u32 s54, s69, 253952
    buffer_load_dwordx4 v[84:87], v2, s[44:47], s54 offen offset:1024 sc1
    v_mfma_f32_32x32x16_bf16 v[32:47], a[168:171], v[88:91], v[32:47]
    s_waitcnt lgkmcnt(0)
    v_add_f32 v48, v48, v52
    v_add_f32 v49, v49, v53
    v_add_f32 v50, v50, v54
    v_add_f32 v51, v51, v55
    ds_read_b128 v[52:55], v114 offset:16384
    s_waitcnt lgkmcnt(0)
    v_add_f32 v48, v48, v52
    v_add_f32 v49, v49, v53
    v_add_f32 v50, v50, v54
    v_add_f32 v51, v51, v55
    ds_read_b128 v[52:55], v114 offset:24576
    s_waitcnt vmcnt(10)
    v_mfma_f32_32x32x16_bf16 v[16:31], a[60:63], v[92:95], v[16:31]
    s_add_u32 s54, s69, 253952
    buffer_load_dwordx4 v[88:91], v2, s[44:47], s54 offen offset:2048 sc1
    v_mfma_f32_32x32x16_bf16 v[32:47], a[172:175], v[92:95], v[32:47]
    s_waitcnt lgkmcnt(0)
    v_add_f32 v48, v48, v52
    v_add_f32 v49, v49, v53
    v_add_f32 v50, v50, v54
    v_add_f32 v51, v51, v55
    s_waitcnt vmcnt(10)
    v_mfma_f32_32x32x16_bf16 v[16:31], a[64:67], v[96:99], v[16:31]
    s_add_u32 s54, s69, 253952
    buffer_load_dwordx4 v[92:95], v2, s[44:47], s54 offen offset:3072 sc1
    v_mfma_f32_32x32x16_bf16 v[32:47], a[176:179], v[96:99], v[32:47]
    v_lshlrev_b32 v52, 16, v58
    v_and_b32 v53, 0xffff0000, v58
    v_lshlrev_b32 v54, 16, v59
    v_and_b32 v55, 0xffff0000, v59
    v_add_f32 v48, v48, v52
    v_add_f32 v49, v49, v53
    v_add_f32 v50, v50, v54
    v_add_f32 v51, v51, v55
    v_cvt_pk_bf16_f32 v52, v48, v49
    v_cvt_pk_bf16_f32 v53, v50, v51
    v_lshlrev_b32 v48, 16, v52
    v_and_b32 v49, 0xffff0000, v52
    v_lshlrev_b32 v50, 16, v53
    v_and_b32 v51, 0xffff0000, v53
    s_waitcnt vmcnt(10)
    v_mfma_f32_32x32x16_bf16 v[16:31], a[68:71], v[100:103], v[16:31]
    v_mfma_f32_32x32x16_bf16 v[32:47], a[180:183], v[100:103], v[32:47]
    v_lshlrev_b32 v52, 16, v62
    v_and_b32 v53, 0xffff0000, v62
    v_lshlrev_b32 v54, 16, v63
    v_and_b32 v55, 0xffff0000, v63
    v_add_f32 v48, v48, v52
    v_add_f32 v49, v49, v53
    v_add_f32 v50, v50, v54
    v_add_f32 v51, v51, v55
    s_waitcnt vmcnt(9)
    v_mfma_f32_32x32x16_bf16 v[16:31], a[72:75], v[104:107], v[16:31]
    v_mfma_f32_32x32x16_bf16 v[32:47], a[184:187], v[104:107], v[32:47]
    v_cvt_pk_bf16_f32 v14, v48, v49
    v_cvt_pk_bf16_f32 v15, v50, v51
    s_mov_b32 s53, 15728640
    buffer_store_dwordx4 v[12:15], v112, s[44:47], s53 offen sc1
    s_waitcnt vmcnt(9)
    v_mfma_f32_32x32x16_bf16 v[16:31], a[76:79], v[108:111], v[16:31]
    v_mfma_f32_32x32x16_bf16 v[32:47], a[188:191], v[108:111], v[32:47]
    s_waitcnt vmcnt(8)
    v_mfma_f32_32x32x16_bf16 v[16:31], a[80:83], v[64:67], v[16:31]
    v_mfma_f32_32x32x16_bf16 v[32:47], a[192:195], v[64:67], v[32:47]
    s_waitcnt vmcnt(7)
    v_mfma_f32_32x32x16_bf16 v[16:31], a[84:87], v[68:71], v[16:31]
    v_mfma_f32_32x32x16_bf16 v[32:47], a[196:199], v[68:71], v[32:47]
    s_waitcnt vmcnt(6)
    v_mfma_f32_32x32x16_bf16 v[16:31], a[88:91], v[72:75], v[16:31]
    v_mfma_f32_32x32x16_bf16 v[32:47], a[200:203], v[72:75], v[32:47]
    s_mov_b32 s53, 13635584
    buffer_load_dwordx4 v[60:63], v112, s[44:47], s53 offen sc1
    s_waitcnt vmcnt(6)
    v_mfma_f32_32x32x16_bf16 v[16:31], a[92:95], v[76:79], v[16:31]
    v_mfma_f32_32x32x16_bf16 v[32:47], a[204:207], v[76:79], v[32:47]
    s_waitcnt vmcnt(5)
    v_mfma_f32_32x32x16_bf16 v[16:31], a[96:99], v[80:83], v[16:31]
    v_mfma_f32_32x32x16_bf16 v[32:47], a[208:211], v[80:83], v[32:47]
    s_waitcnt vmcnt(4)
    v_mfma_f32_32x32x16_bf16 v[16:31], a[100:103], v[84:87], v[16:31]
    v_mfma_f32_32x32x16_bf16 v[32:47], a[212:215], v[84:87], v[32:47]
    s_waitcnt vmcnt(3)
    v_mfma_f32_32x32x16_bf16 v[16:31], a[104:107], v[88:91], v[16:31]
    v_mfma_f32_32x32x16_bf16 v[32:47], a[216:219], v[88:91], v[32:47]
    s_waitcnt vmcnt(2)
    v_mfma_f32_32x32x16_bf16 v[16:31], a[108:111], v[92:95], v[16:31]
    v_mfma_f32_32x32x16_bf16 v[32:47], a[220:223], v[92:95], v[32:47]
    s_branch L_ldone_16
L_idle_15:
    s_barrier
    s_add_u32 s13, s15, 262144
    buffer_load_dwordx4 a[16:19], v2, s[44:47], s13 offen sc1
    s_add_u32 s13, s15, 262144
    buffer_load_dwordx4 a[128:131], v2, s[44:47], s13 offen offset:1024 sc1
    s_add_u32 s13, s15, 327680
    buffer_load_dwordx4 a[20:23], v2, s[44:47], s13 offen sc1
    s_add_u32 s13, s15, 327680
    buffer_load_dwordx4 a[132:135], v2, s[44:47], s13 offen offset:1024 sc1
    s_add_u32 s13, s15, 393216
    buffer_load_dwordx4 a[24:27], v2, s[44:47], s13 offen sc1
    s_add_u32 s13, s15, 393216
    buffer_load_dwordx4 a[136:139], v2, s[44:47], s13 offen offset:1024 sc1
    s_add_u32 s13, s15, 458752
    buffer_load_dwordx4 a[28:31], v2, s[44:47], s13 offen sc1
    s_add_u32 s13, s15, 458752
    buffer_load_dwordx4 a[140:143], v2, s[44:47], s13 offen offset:1024 sc1
    s_add_u32 s13, s15, 524288
    buffer_load_dwordx4 a[32:35], v2, s[44:47], s13 offen sc1
    s_add_u32 s13, s15, 524288
    buffer_load_dwordx4 a[144:147], v2, s[44:47], s13 offen offset:1024 sc1
    s_add_u32 s13, s15, 589824
    buffer_load_dwordx4 a[36:39], v2, s[44:47], s13 offen sc1
    s_add_u32 s13, s15, 589824
    buffer_load_dwordx4 a[148:151], v2, s[44:47], s13 offen offset:1024 sc1
    s_add_u32 s13, s15, 655360
    buffer_load_dwordx4 a[40:43], v2, s[44:47], s13 offen sc1
    s_add_u32 s13, s15, 655360
    buffer_load_dwordx4 a[152:155], v2, s[44:47], s13 offen offset:1024 sc1
    s_add_u32 s13, s15, 720896
    buffer_load_dwordx4 a[44:47], v2, s[44:47], s13 offen sc1
    s_add_u32 s13, s15, 720896
    buffer_load_dwordx4 a[156:159], v2, s[44:47], s13 offen offset:1024 sc1
    s_add_u32 s13, s15, 786432
    buffer_load_dwordx4 a[48:51], v2, s[44:47], s13 offen sc1
    s_add_u32 s13, s15, 786432
    buffer_load_dwordx4 a[160:163], v2, s[44:47], s13 offen offset:1024 sc1
    s_add_u32 s13, s15, 851968
    buffer_load_dwordx4 a[52:55], v2, s[44:47], s13 offen sc1
    s_add_u32 s13, s15, 851968
    buffer_load_dwordx4 a[164:167], v2, s[44:47], s13 offen offset:1024 sc1
    s_add_u32 s13, s15, 917504
    buffer_load_dwordx4 a[56:59], v2, s[44:47], s13 offen sc1
    s_add_u32 s13, s15, 917504
    buffer_load_dwordx4 a[168:171], v2, s[44:47], s13 offen offset:1024 sc1
    s_add_u32 s13, s15, 983040
    buffer_load_dwordx4 a[60:63], v2, s[44:47], s13 offen sc1
    s_add_u32 s13, s15, 983040
    buffer_load_dwordx4 a[172:175], v2, s[44:47], s13 offen offset:1024 sc1
    s_add_u32 s13, s15, 1048576
    buffer_load_dwordx4 a[64:67], v2, s[44:47], s13 offen sc1
    s_add_u32 s13, s15, 1048576
    buffer_load_dwordx4 a[176:179], v2, s[44:47], s13 offen offset:1024 sc1
    s_add_u32 s13, s15, 1114112
    buffer_load_dwordx4 a[68:71], v2, s[44:47], s13 offen sc1
    s_add_u32 s13, s15, 1114112
    buffer_load_dwordx4 a[180:183], v2, s[44:47], s13 offen offset:1024 sc1
    s_add_u32 s13, s15, 1179648
    buffer_load_dwordx4 a[72:75], v2, s[44:47], s13 offen sc1
    s_add_u32 s13, s15, 1179648
    buffer_load_dwordx4 a[184:187], v2, s[44:47], s13 offen offset:1024 sc1
    s_add_u32 s13, s15, 1245184
    buffer_load_dwordx4 a[76:79], v2, s[44:47], s13 offen sc1
    s_add_u32 s13, s15, 1245184
    buffer_load_dwordx4 a[188:191], v2, s[44:47], s13 offen offset:1024 sc1
    s_add_u32 s13, s15, 1310720
    buffer_load_dwordx4 a[80:83], v2, s[44:47], s13 offen sc1
    s_add_u32 s13, s15, 1310720
    buffer_load_dwordx4 a[192:195], v2, s[44:47], s13 offen offset:1024 sc1
    s_add_u32 s13, s15, 1376256
    buffer_load_dwordx4 a[84:87], v2, s[44:47], s13 offen sc1
    s_add_u32 s13, s15, 1376256
    buffer_load_dwordx4 a[196:199], v2, s[44:47], s13 offen offset:1024 sc1
    s_add_u32 s13, s15, 1441792
    buffer_load_dwordx4 a[88:91], v2, s[44:47], s13 offen sc1
    s_add_u32 s13, s15, 1441792
    buffer_load_dwordx4 a[200:203], v2, s[44:47], s13 offen offset:1024 sc1
    s_add_u32 s13, s15, 1507328
    buffer_load_dwordx4 a[92:95], v2, s[44:47], s13 offen sc1
    s_add_u32 s13, s15, 1507328
    buffer_load_dwordx4 a[204:207], v2, s[44:47], s13 offen offset:1024 sc1
    s_add_u32 s13, s15, 1572864
    buffer_load_dwordx4 a[96:99], v2, s[44:47], s13 offen sc1
    s_add_u32 s13, s15, 1572864
    buffer_load_dwordx4 a[208:211], v2, s[44:47], s13 offen offset:1024 sc1
    s_add_u32 s13, s15, 1638400
    buffer_load_dwordx4 a[100:103], v2, s[44:47], s13 offen sc1
    s_add_u32 s13, s15, 1638400
    buffer_load_dwordx4 a[212:215], v2, s[44:47], s13 offen offset:1024 sc1
    s_add_u32 s13, s15, 1703936
    buffer_load_dwordx4 a[104:107], v2, s[44:47], s13 offen sc1
    s_add_u32 s13, s15, 1703936
    buffer_load_dwordx4 a[216:219], v2, s[44:47], s13 offen offset:1024 sc1
    s_add_u32 s13, s15, 1769472
    buffer_load_dwordx4 a[108:111], v2, s[44:47], s13 offen sc1
    s_add_u32 s13, s15, 1769472
    buffer_load_dwordx4 a[220:223], v2, s[44:47], s13 offen offset:1024 sc1
    v_add_u32 v100, 0, v119
    v_add_u32 v101, 512, v100
    buffer_load_dword v102, v100, s[44:47], 0 offen sc1
    v_mov_b32 v124, v100
    v_mov_b32 v125, v101
    s_waitcnt vmcnt(0)
    v_cmp_ne_u32 vcc, s51, v102
    s_cbranch_vccz L_pcd_26
    s_mov_b32 s53, 0
L_pc_25:
    buffer_load_dword v102, v100, s[44:47], 0 offen sc1
    s_waitcnt vmcnt(0)
    v_cmp_ne_u32 vcc, s51, v102
    s_cbranch_vccz L_pcd_26
    s_add_u32 s53, s53, 1
    s_cmp_lg_u32 s52, 0
    s_cbranch_scc1 L_pcd_26
    s_cmp_lt_u32 s53, 0x8000
    s_cbranch_scc1 L_pc_25
    s_mov_b32 s52, 1
L_pcd_26:
    s_add_u32 s54, s69, 0
    buffer_load_dwordx4 v[64:67], v2, s[44:47], s54 offen sc1
    s_add_u32 s54, s69, 0
    buffer_load_dwordx4 v[68:71], v2, s[44:47], s54 offen offset:1024 sc1
    s_add_u32 s54, s69, 0
    buffer_load_dwordx4 v[72:75], v2, s[44:47], s54 offen offset:2048 sc1
    s_add_u32 s54, s69, 0
    buffer_load_dwordx4 v[76:79], v2, s[44:47], s54 offen offset:3072 sc1
    s_add_u32 s54, s69, 4096
    buffer_load_dwordx4 v[80:83], v2, s[44:47], s54 offen sc1
    s_add_u32 s54, s69, 4096
    buffer_load_dwordx4 v[84:87], v2, s[44:47], s54 offen offset:1024 sc1
    s_add_u32 s54, s69, 4096
    buffer_load_dwordx4 v[88:91], v2, s[44:47], s54 offen offset:2048 sc1
    s_add_u32 s54, s69, 4096
    buffer_load_dwordx4 v[92:95], v2, s[44:47], s54 offen offset:3072 sc1
    s_add_u32 s54, s69, 8192
    buffer_load_dwordx4 v[96:99], v2, s[44:47], s54 offen sc1
    s_add_u32 s54, s69, 8192
    buffer_load_dwordx4 v[100:103], v2, s[44:47], s54 offen offset:1024 sc1
    s_add_u32 s54, s69, 8192
    buffer_load_dwordx4 v[104:107], v2, s[44:47], s54 offen offset:2048 sc1
    s_add_u32 s54, s69, 8192
    buffer_load_dwordx4 v[108:111], v2, s[44:47], s54 offen offset:3072 sc1
    s_mov_b32 s4, s36
    s_and_b32 s5, s37, 0xffff
    s_mov_b32 s6, 1024
    s_mov_b32 s7, 0x00020000
    buffer_load_dwordx4 v[56:59], v123, s[4:7], 0 offen
    s_mov_b32 s53, 13631488
    buffer_load_dwordx4 v[60:63], v112, s[44:47], s53 offen sc1
    s_waitcnt vmcnt(13)
    v_mfma_f32_32x32x16_bf16 a[224:239], a[0:3], v[64:67], 0
    v_mfma_f32_32x32x16_bf16 a[240:255], a[112:115], v[64:67], 0
    s_waitcnt vmcnt(12)
    v_mfma_f32_32x32x16_bf16 a[224:239], a[4:7], v[68:71], a[224:239]
    s_add_u32 s54, s69, 12288
    buffer_load_dwordx4 v[64:67], v2, s[44:47], s54 offen sc1
    v_mfma_f32_32x32x16_bf16 a[240:255], a[116:119], v[68:71], a[240:255]
    s_waitcnt vmcnt(12)
    v_mfma_f32_32x32x16_bf16 a[224:239], a[8:11], v[72:75], a[224:239]
    s_add_u32 s54, s69, 12288
    buffer_load_dwordx4 v[68:71], v2, s[44:47], s54 offen offset:1024 sc1
    v_mfma_f32_32x32x16_bf16 a[240:255], a[120:123], v[72:75], a[240:255]
    s_waitcnt vmcnt(12)
    v_mfma_f32_32x32x16_bf16 a[224:239], a[12:15], v[76:79], a[224:239]
    s_add_u32 s54, s69, 12288
    buffer_load_dwordx4 v[72:75], v2, s[44:47], s54 offen offset:2048 sc1
    v_mfma_f32_32x32x16_bf16 a[240:255], a[124:127], v[76:79], a[240:255]
    s_waitcnt vmcnt(12)
    v_mfma_f32_32x32x16_bf16 a[224:239], a[16:19], v[80:83], a[224:239]
    s_add_u32 s54, s69, 12288
    buffer_load_dwordx4 v[76:79], v2, s[44:47], s54 offen offset:3072 sc1
    v_mfma_f32_32x32x16_bf16 a[240:255], a[128:131], v[80:83], a[240:255]
    s_waitcnt vmcnt(12)
    v_mfma_f32_32x32x16_bf16 a[224:239], a[20:23], v[84:87], a[224:239]
    s_add_u32 s54, s69, 16384
    buffer_load_dwordx4 v[80:83], v2, s[44:47], s54 offen sc1
    v_mfma_f32_32x32x16_bf16 a[240:255], a[132:135], v[84:87], a[240:255]
    s_waitcnt vmcnt(12)
    v_mfma_f32_32x32x16_bf16 a[224:239], a[24:27], v[88:91], a[224:239]
    s_add_u32 s54, s69, 16384
    buffer_load_dwordx4 v[84:87], v2, s[44:47], s54 offen offset:1024 sc1
    v_mfma_f32_32x32x16_bf16 a[240:255], a[136:139], v[88:91], a[240:255]
    s_waitcnt vmcnt(12)
    v_mfma_f32_32x32x16_bf16 a[224:239], a[28:31], v[92:95], a[224:239]
    s_add_u32 s54, s69, 16384
    buffer_load_dwordx4 v[88:91], v2, s[44:47], s54 offen offset:2048 sc1
    v_mfma_f32_32x32x16_bf16 a[240:255], a[140:143], v[92:95], a[240:255]
    s_waitcnt vmcnt(12)
    v_mfma_f32_32x32x16_bf16 a[224:239], a[32:35], v[96:99], a[224:239]
    s_add_u32 s54, s69, 16384
    buffer_load_dwordx4 v[92:95], v2, s[44:47], s54 offen offset:3072 sc1
    v_mfma_f32_32x32x16_bf16 a[240:255], a[144:147], v[96:99], a[240:255]
    s_waitcnt vmcnt(12)
    v_mfma_f32_32x32x16_bf16 a[224:239], a[36:39], v[100:103], a[224:239]
    s_add_u32 s54, s69, 20480
    buffer_load_dwordx4 v[96:99], v2, s[44:47], s54 offen sc1
    v_mfma_f32_32x32x16_bf16 a[240:255], a[148:151], v[100:103], a[240:255]
    s_waitcnt vmcnt(12)
    v_mfma_f32_32x32x16_bf16 a[224:239], a[40:43], v[104:107], a[224:239]
    s_add_u32 s54, s69, 20480
    buffer_load_dwordx4 v[100:103], v2, s[44:47], s54 offen offset:1024 sc1
    v_mfma_f32_32x32x16_bf16 a[240:255], a[152:155], v[104:107], a[240:255]
    buffer_load_dword v126, v125, s[44:47], 0 offen sc1
    s_waitcnt vmcnt(13)
    v_mfma_f32_32x32x16_bf16 a[224:239], a[44:47], v[108:111], a[224:239]
    s_add_u32 s54, s69, 20480
    buffer_load_dwordx4 v[104:107], v2, s[44:47], s54 offen offset:2048 sc1
    v_mfma_f32_32x32x16_bf16 a[240:255], a[156:159], v[108:111], a[240:255]
    s_waitcnt vmcnt(11)
    v_mfma_f32_32x32x16_bf16 a[224:239], a[48:51], v[64:67], a[224:239]
    s_add_u32 s54, s69, 20480
    buffer_load_dwordx4 v[108:111], v2, s[44:47], s54 offen offset:3072 sc1
    v_mfma_f32_32x32x16_bf16 a[240:255], a[160:163], v[64:67], a[240:255]
    s_waitcnt vmcnt(11)
    v_mfma_f32_32x32x16_bf16 a[224:239], a[52:55], v[68:71], a[224:239]
    s_add_u32 s54, s69, 24576
    buffer_load_dwordx4 v[64:67], v2, s[44:47], s54 offen sc1
    v_mfma_f32_32x32x16_bf16 a[240:255], a[164:167], v[68:71], a[240:255]
    s_waitcnt vmcnt(11)
    v_mfma_f32_32x32x16_bf16 a[224:239], a[56:59], v[72:75], a[224:239]
    s_add_u32 s54, s69, 24576
    buffer_load_dwordx4 v[68:71], v2, s[44:47], s54 offen offset:1024 sc1
    v_mfma_f32_32x32x16_bf16 a[240:255], a[168:171], v[72:75], a[240:255]
    s_waitcnt vmcnt(11)
    v_mfma_f32_32x32x16_bf16 a[224:239], a[60:63], v[76:79], a[224:239]
    s_add_u32 s54, s69, 24576
    buffer_load_dwordx4 v[72:75], v2, s[44:47], s54 offen offset:2048 sc1
    v_mfma_f32_32x32x16_bf16 a[240:255], a[172:175], v[76:79], a[240:255]
    s_waitcnt vmcnt(5)
    v_cmp_ne_u32 vcc, s51, v126
    s_cbranch_vccz L_pcd_28
    s_mov_b32 s53, 0
L_pc_27:
    buffer_load_dword v126, v125, s[44:47], 0 offen sc1
    s_waitcnt vmcnt(0)
    v_cmp_ne_u32 vcc, s51, v126
    s_cbranch_vccz L_pcd_28
    s_add_u32 s53, s53, 1
    s_cmp_lg_u32 s52, 0
    s_cbranch_scc1 L_pcd_28
    s_cmp_lt_u32 s53, 0x8000
    s_cbranch_scc1 L_pc_27
    s_mov_b32 s52, 1
L_pcd_28:
    v_mfma_f32_32x32x16_bf16 a[224:239], a[64:67], v[80:83], a[224:239]
    s_add_u32 s54, s69, 24576
    buffer_load_dwordx4 v[76:79], v2, s[44:47], s54 offen offset:3072 sc1
    v_mfma_f32_32x32x16_bf16 a[240:255], a[176:179], v[80:83], a[240:255]
    v_mfma_f32_32x32x16_bf16 a[224:239], a[68:71], v[84:87], a[224:239]
    s_add_u32 s54, s69, 229376
    buffer_load_dwordx4 v[80:83], v2, s[44:47], s54 offen sc1
    v_mfma_f32_32x32x16_bf16 a[240:255], a[180:183], v[84:87], a[240:255]
    v_mfma_f32_32x32x16_bf16 a[224:239], a[72:75], v[88:91], a[224:239]
    s_add_u32 s54, s69, 229376
    buffer_load_dwordx4 v[84:87], v2, s[44:47], s54 offen offset:1024 sc1
    v_mfma_f32_32x32x16_bf16 a[240:255], a[184:187], v[88:91], a[240:255]
    v_mfma_f32_32x32x16_bf16 a[224:239], a[76:79], v[92:95], a[224:239]
    s_add_u32 s54, s69, 229376
    buffer_load_dwordx4 v[88:91], v2, s[44:47], s54 offen offset:2048 sc1
    v_mfma_f32_32x32x16_bf16 a[240:255], a[188:191], v[92:95], a[240:255]
    v_mfma_f32_32x32x16_bf16 a[224:239], a[80:83], v[96:99], a[224:239]
    s_add_u32 s54, s69, 229376
    buffer_load_dwordx4 v[92:95], v2, s[44:47], s54 offen offset:3072 sc1
    v_mfma_f32_32x32x16_bf16 a[240:255], a[192:195], v[96:99], a[240:255]
    v_mfma_f32_32x32x16_bf16 a[224:239], a[84:87], v[100:103], a[224:239]
    s_add_u32 s54, s69, 233472
    buffer_load_dwordx4 v[96:99], v2, s[44:47], s54 offen sc1
    v_mfma_f32_32x32x16_bf16 a[240:255], a[196:199], v[100:103], a[240:255]
    s_waitcnt vmcnt(10)
    v_mfma_f32_32x32x16_bf16 a[224:239], a[88:91], v[104:107], a[224:239]
    s_add_u32 s54, s69, 233472
    buffer_load_dwordx4 v[100:103], v2, s[44:47], s54 offen offset:1024 sc1
    v_mfma_f32_32x32x16_bf16 a[240:255], a[200:203], v[104:107], a[240:255]
    s_waitcnt vmcnt(10)
    v_mfma_f32_32x32x16_bf16 a[224:239], a[92:95], v[108:111], a[224:239]
    s_add_u32 s54, s69, 233472
    buffer_load_dwordx4 v[104:107], v2, s[44:47], s54 offen offset:2048 sc1
    v_mfma_f32_32x32x16_bf16 a[240:255], a[204:207], v[108:111], a[240:255]
    s_waitcnt vmcnt(10)
    v_mfma_f32_32x32x16_bf16 a[224:239], a[96:99], v[64:67], a[224:239]
    s_add_u32 s54, s69, 233472
    buffer_load_dwordx4 v[108:111], v2, s[44:47], s54 offen offset:3072 sc1
    v_mfma_f32_32x32x16_bf16 a[240:255], a[208:211], v[64:67], a[240:255]
    s_waitcnt vmcnt(10)
    v_mfma_f32_32x32x16_bf16 a[224:239], a[100:103], v[68:71], a[224:239]
    s_add_u32 s54, s69, 237568
    buffer_load_dwordx4 v[64:67], v2, s[44:47], s54 offen sc1
    v_mfma_f32_32x32x16_bf16 a[240:255], a[212:215], v[68:71], a[240:255]
    s_waitcnt vmcnt(10)
    v_mfma_f32_32x32x16_bf16 a[224:239], a[104:107], v[72:75], a[224:239]
    s_add_u32 s54, s69, 237568
    buffer_load_dwordx4 v[68:71], v2, s[44:47], s54 offen offset:1024 sc1
    v_mfma_f32_32x32x16_bf16 a[240:255], a[216:219], v[72:75], a[240:255]
    s_waitcnt vmcnt(10)
    v_mfma_f32_32x32x16_bf16 a[224:239], a[108:111], v[76:79], a[224:239]
    s_add_u32 s54, s69, 237568
    buffer_load_dwordx4 v[72:75], v2, s[44:47], s54 offen offset:2048 sc1
    v_mfma_f32_32x32x16_bf16 a[240:255], a[220:223], v[76:79], a[240:255]
    s_waitcnt vmcnt(10)
    v_mfma_f32_32x32x16_bf16 v[16:31], a[0:3], v[80:83], 0
    s_add_u32 s54, s69, 237568
    buffer_load_dwordx4 v[76:79], v2, s[44:47], s54 offen offset:3072 sc1
    v_mfma_f32_32x32x16_bf16 v[32:47], a[112:115], v[80:83], 0
    s_waitcnt vmcnt(10)
    v_mfma_f32_32x32x16_bf16 v[16:31], a[4:7], v[84:87], v[16:31]
    s_add_u32 s54, s69, 241664
    buffer_load_dwordx4 v[80:83], v2, s[44:47], s54 offen sc1
    v_mfma_f32_32x32x16_bf16 v[32:47], a[116:119], v[84:87], v[32:47]
    s_waitcnt vmcnt(10)
    v_mfma_f32_32x32x16_bf16 v[16:31], a[8:11], v[88:91], v[16:31]
    s_add_u32 s54, s69, 241664
    buffer_load_dwordx4 v[84:87], v2, s[44:47], s54 offen offset:1024 sc1
    v_mfma_f32_32x32x16_bf16 v[32:47], a[120:123], v[88:91], v[32:47]
    ds_write_b128 v115, a[224:227] offset:0
    ds_write_b128 v116, a[228:231] offset:0
    s_waitcnt vmcnt(10)
    v_mfma_f32_32x32x16_bf16 v[16:31], a[12:15], v[92:95], v[16:31]
    s_add_u32 s54, s69, 241664
    buffer_load_dwordx4 v[88:91], v2, s[44:47], s54 offen offset:2048 sc1
    v_mfma_f32_32x32x16_bf16 v[32:47], a[124:127], v[92:95], v[32:47]
    ds_write_b128 v117, a[232:235] offset:0
    ds_write_b128 v118, a[236:239] offset:0
    s_waitcnt vmcnt(10)
    v_mfma_f32_32x32x16_bf16 v[16:31], a[16:19], v[96:99], v[16:31]
    s_add_u32 s54, s69, 241664
    buffer_load_dwordx4 v[92:95], v2, s[44:47], s54 offen offset:3072 sc1
    v_mfma_f32_32x32x16_bf16 v[32:47], a[128:131], v[96:99], v[32:47]
    ds_write_b128 v115, a[240:243] offset:128
    ds_write_b128 v116, a[244:247] offset:128
    s_waitcnt vmcnt(10)
    v_mfma_f32_32x32x16_bf16 v[16:31], a[20:23], v[100:103], v[16:31]
    s_add_u32 s54, s69, 245760
    buffer_load_dwordx4 v[96:99], v2, s[44:47], s54 offen sc1
    v_mfma_f32_32x32x16_bf16 v[32:47], a[132:135], v[100:103], v[32:47]
    ds_write_b128 v117, a[248:251] offset:128
    ds_write_b128 v118, a[252:255] offset:128
    s_waitcnt vmcnt(10)
    v_mfma_f32_32x32x16_bf16 v[16:31], a[24:27], v[104:107], v[16:31]
    s_add_u32 s54, s69, 245760
    buffer_load_dwordx4 v[100:103], v2, s[44:47], s54 offen offset:1024 sc1
    v_mfma_f32_32x32x16_bf16 v[32:47], a[136:139], v[104:107], v[32:47]
    s_waitcnt vmcnt(10)
    v_mfma_f32_32x32x16_bf16 v[16:31], a[28:31], v[108:111], v[16:31]
    s_add_u32 s54, s69, 245760
    buffer_load_dwordx4 v[104:107], v2, s[44:47], s54 offen offset:2048 sc1
    v_mfma_f32_32x32x16_bf16 v[32:47], a[140:143], v[108:111], v[32:47]
    s_waitcnt lgkmcnt(0)
    s_barrier
    s_waitcnt vmcnt(10)
    v_mfma_f32_32x32x16_bf16 v[16:31], a[32:35], v[64:67], v[16:31]
    s_add_u32 s54, s69, 245760
    buffer_load_dwordx4 v[108:111], v2, s[44:47], s54 offen offset:3072 sc1
    v_mfma_f32_32x32x16_bf16 v[32:47], a[144:147], v[64:67], v[32:47]
    ds_read_b128 v[48:51], v113 offset:0
    ds_read_b128 v[52:55], v113 offset:8192
    s_waitcnt lgkmcnt(0)
    v_add_f32 v48, v48, v52
    v_add_f32 v49, v49, v53
    v_add_f32 v50, v50, v54
    v_add_f32 v51, v51, v55
    ds_read_b128 v[52:55], v113 offset:16384
    s_waitcnt vmcnt(10)
    v_mfma_f32_32x32x16_bf16 v[16:31], a[36:39], v[68:71], v[16:31]
    s_add_u32 s54, s69, 249856
    buffer_load_dwordx4 v[64:67], v2, s[44:47], s54 offen sc1
    v_mfma_f32_32x32x16_bf16 v[32:47], a[148:151], v[68:71], v[32:47]
    s_waitcnt lgkmcnt(0)
    v_add_f32 v48, v48, v52
    v_add_f32 v49, v49, v53
    v_add_f32 v50, v50, v54
    v_add_f32 v51, v51, v55
    ds_read_b128 v[52:55], v113 offset:24576
    s_waitcnt vmcnt(10)
    v_mfma_f32_32x32x16_bf16 v[16:31], a[40:43], v[72:75], v[16:31]
    s_add_u32 s54, s69, 249856
    buffer_load_dwordx4 v[68:71], v2, s[44:47], s54 offen offset:1024 sc1
    v_mfma_f32_32x32x16_bf16 v[32:47], a[152:155], v[72:75], v[32:47]
    s_waitcnt lgkmcnt(0)
    v_add_f32 v48, v48, v52
    v_add_f32 v49, v49, v53
    v_add_f32 v50, v50, v54
    v_add_f32 v51, v51, v55
    v_lshlrev_b32 v52, 16, v56
    v_and_b32 v53, 0xffff0000, v56
    v_lshlrev_b32 v54, 16, v57
    v_and_b32 v55, 0xffff0000, v57
    v_add_f32 v48, v48, v52
    v_add_f32 v49, v49, v53
    v_add_f32 v50, v50, v54
    v_add_f32 v51, v51, v55
    s_waitcnt vmcnt(10)
    v_mfma_f32_32x32x16_bf16 v[16:31], a[44:47], v[76:79], v[16:31]
    s_add_u32 s54, s69, 249856
    buffer_load_dwordx4 v[72:75], v2, s[44:47], s54 offen offset:2048 sc1
    v_mfma_f32_32x32x16_bf16 v[32:47], a[156:159], v[76:79], v[32:47]
    v_cvt_pk_bf16_f32 v52, v48, v49
    v_cvt_pk_bf16_f32 v53, v50, v51
    v_lshlrev_b32 v48, 16, v52
    v_and_b32 v49, 0xffff0000, v52
    v_lshlrev_b32 v50, 16, v53
    v_and_b32 v51, 0xffff0000, v53
    s_waitcnt vmcnt(10)
    v_mfma_f32_32x32x16_bf16 v[16:31], a[48:51], v[80:83], v[16:31]
    s_add_u32 s54, s69, 249856
    buffer_load_dwordx4 v[76:79], v2, s[44:47], s54 offen offset:3072 sc1
    v_mfma_f32_32x32x16_bf16 v[32:47], a[160:163], v[80:83], v[32:47]
    v_lshlrev_b32 v52, 16, v60
    v_and_b32 v53, 0xffff0000, v60
    v_lshlrev_b32 v54, 16, v61
    v_and_b32 v55, 0xffff0000, v61
    v_add_f32 v48, v48, v52
    v_add_f32 v49, v49, v53
    v_add_f32 v50, v50, v54
    v_add_f32 v51, v51, v55
    v_cvt_pk_bf16_f32 v12, v48, v49
    v_cvt_pk_bf16_f32 v13, v50, v51
    s_waitcnt vmcnt(10)
    v_mfma_f32_32x32x16_bf16 v[16:31], a[52:55], v[84:87], v[16:31]
    s_add_u32 s54, s69, 253952
    buffer_load_dwordx4 v[80:83], v2, s[44:47], s54 offen sc1
    v_mfma_f32_32x32x16_bf16 v[32:47], a[164:167], v[84:87], v[32:47]
    ds_read_b128 v[48:51], v114 offset:0
    ds_read_b128 v[52:55], v114 offset:8192
    s_waitcnt vmcnt(10)
    v_mfma_f32_32x32x16_bf16 v[16:31], a[56:59], v[88:91], v[16:31]
    s_add_u32 s54, s69, 253952
    buffer_load_dwordx4 v[84:87], v2, s[44:47], s54 offen offset:1024 sc1
    v_mfma_f32_32x32x16_bf16 v[32:47], a[168:171], v[88:91], v[32:47]
    s_waitcnt lgkmcnt(0)
    v_add_f32 v48, v48, v52
    v_add_f32 v49, v49, v53
    v_add_f32 v50, v50, v54
    v_add_f32 v51, v51, v55
    ds_read_b128 v[52:55], v114 offset:16384
    s_waitcnt lgkmcnt(0)
    v_add_f32 v48, v48, v52
    v_add_f32 v49, v49, v53
    v_add_f32 v50, v50, v54
    v_add_f32 v51, v51, v55
    ds_read_b128 v[52:55], v114 offset:24576
    s_waitcnt vmcnt(10)
    v_mfma_f32_32x32x16_bf16 v[16:31], a[60:63], v[92:95], v[16:31]
    s_add_u32 s54, s69, 253952
    buffer_load_dwordx4 v[88:91], v2, s[44:47], s54 offen offset:2048 sc1
    v_mfma_f32_32x32x16_bf16 v[32:47], a[172:175], v[92:95], v[32:47]
    s_waitcnt lgkmcnt(0)
    v_add_f32 v48, v48, v52
    v_add_f32 v49, v49, v53
    v_add_f32 v50, v50, v54
    v_add_f32 v51, v51, v55
    s_waitcnt vmcnt(10)
    v_mfma_f32_32x32x16_bf16 v[16:31], a[64:67], v[96:99], v[16:31]
    s_add_u32 s54, s69, 253952
    buffer_load_dwordx4 v[92:95], v2, s[44:47], s54 offen offset:3072 sc1
    v_mfma_f32_32x32x16_bf16 v[32:47], a[176:179], v[96:99], v[32:47]
    v_lshlrev_b32 v52, 16, v58
    v_and_b32 v53, 0xffff0000, v58
    v_lshlrev_b32 v54, 16, v59
    v_and_b32 v55, 0xffff0000, v59
    v_add_f32 v48, v48, v52
    v_add_f32 v49, v49, v53
    v_add_f32 v50, v50, v54
    v_add_f32 v51, v51, v55
    v_cvt_pk_bf16_f32 v52, v48, v49
    v_cvt_pk_bf16_f32 v53, v50, v51
    v_lshlrev_b32 v48, 16, v52
    v_and_b32 v49, 0xffff0000, v52
    v_lshlrev_b32 v50, 16, v53
    v_and_b32 v51, 0xffff0000, v53
    s_waitcnt vmcnt(10)
    v_mfma_f32_32x32x16_bf16 v[16:31], a[68:71], v[100:103], v[16:31]
    v_mfma_f32_32x32x16_bf16 v[32:47], a[180:183], v[100:103], v[32:47]
    v_lshlrev_b32 v52, 16, v62
    v_and_b32 v53, 0xffff0000, v62
    v_lshlrev_b32 v54, 16, v63
    v_and_b32 v55, 0xffff0000, v63
    v_add_f32 v48, v48, v52
    v_add_f32 v49, v49, v53
    v_add_f32 v50, v50, v54
    v_add_f32 v51, v51, v55
    s_waitcnt vmcnt(9)
    v_mfma_f32_32x32x16_bf16 v[16:31], a[72:75], v[104:107], v[16:31]
    v_mfma_f32_32x32x16_bf16 v[32:47], a[184:187], v[104:107], v[32:47]
    v_cvt_pk_bf16_f32 v14, v48, v49
    v_cvt_pk_bf16_f32 v15, v50, v51
    s_mov_b32 s53, 15728640
    buffer_store_dwordx4 v[12:15], v112, s[44:47], s53 offen sc1
    s_waitcnt vmcnt(9)
    v_mfma_f32_32x32x16_bf16 v[16:31], a[76:79], v[108:111], v[16:31]
    v_mfma_f32_32x32x16_bf16 v[32:47], a[188:191], v[108:111], v[32:47]
    s_waitcnt vmcnt(8)
    v_mfma_f32_32x32x16_bf16 v[16:31], a[80:83], v[64:67], v[16:31]
    v_mfma_f32_32x32x16_bf16 v[32:47], a[192:195], v[64:67], v[32:47]
    s_waitcnt vmcnt(7)
    v_mfma_f32_32x32x16_bf16 v[16:31], a[84:87], v[68:71], v[16:31]
    v_mfma_f32_32x32x16_bf16 v[32:47], a[196:199], v[68:71], v[32:47]
    s_waitcnt vmcnt(6)
    v_mfma_f32_32x32x16_bf16 v[16:31], a[88:91], v[72:75], v[16:31]
    v_mfma_f32_32x32x16_bf16 v[32:47], a[200:203], v[72:75], v[32:47]
    s_mov_b32 s53, 13635584
    buffer_load_dwordx4 v[60:63], v112, s[44:47], s53 offen sc1
    s_waitcnt vmcnt(6)
    v_mfma_f32_32x32x16_bf16 v[16:31], a[92:95], v[76:79], v[16:31]
    v_mfma_f32_32x32x16_bf16 v[32:47], a[204:207], v[76:79], v[32:47]
    s_waitcnt vmcnt(5)
    v_mfma_f32_32x32x16_bf16 v[16:31], a[96:99], v[80:83], v[16:31]
    v_mfma_f32_32x32x16_bf16 v[32:47], a[208:211], v[80:83], v[32:47]
    s_waitcnt vmcnt(4)
    v_mfma_f32_32x32x16_bf16 v[16:31], a[100:103], v[84:87], v[16:31]
    v_mfma_f32_32x32x16_bf16 v[32:47], a[212:215], v[84:87], v[32:47]
    s_waitcnt vmcnt(3)
    v_mfma_f32_32x32x16_bf16 v[16:31], a[104:107], v[88:91], v[16:31]
    v_mfma_f32_32x32x16_bf16 v[32:47], a[216:219], v[88:91], v[32:47]
    s_waitcnt vmcnt(2)
    v_mfma_f32_32x32x16_bf16 v[16:31], a[108:111], v[92:95], v[16:31]
    v_mfma_f32_32x32x16_bf16 v[32:47], a[220:223], v[92:95], v[32:47]
L_ldone_16:
    s_waitcnt vmcnt(1)
    s_add_u32 s53, s67, 0
    buffer_store_dword v3, off, s[44:47], s53
    s_nop 11
    ds_write_b128 v115, v[16:19] offset:32768
    ds_write_b128 v116, v[20:23] offset:32768
    ds_write_b128 v117, v[24:27] offset:32768
    ds_write_b128 v118, v[28:31] offset:32768
    ds_write_b128 v115, v[32:35] offset:32896
    ds_write_b128 v116, v[36:39] offset:32896
    ds_write_b128 v117, v[40:43] offset:32896
    ds_write_b128 v118, v[44:47] offset:32896
    s_waitcnt lgkmcnt(0)
    s_barrier
    buffer_load_dword v110, v122, s[44:47], 0 offen sc1
    ds_read_b128 v[64:67], v113 offset:32768
    ds_read_b128 v[68:71], v114 offset:32768
    ds_read_b128 v[72:75], v113 offset:40960
    ds_read_b128 v[76:79], v114 offset:40960
    ds_read_b128 v[80:83], v113 offset:49152
    ds_read_b128 v[84:87], v114 offset:49152
    ds_read_b128 v[88:91], v113 offset:57344
    ds_read_b128 v[92:95], v114 offset:57344
    v_lshlrev_b32 v96, 16, v56
    v_and_b32 v97, 0xffff0000, v56
    v_lshlrev_b32 v98, 16, v57
    v_and_b32 v99, 0xffff0000, v57
    v_lshlrev_b32 v100, 16, v58
    v_and_b32 v101, 0xffff0000, v58
    v_lshlrev_b32 v102, 16, v59
    v_and_b32 v103, 0xffff0000, v59
    s_waitcnt lgkmcnt(4)
    v_pk_add_f32 v[64:65], v[64:65], v[72:73]
    v_pk_add_f32 v[66:67], v[66:67], v[74:75]
    v_pk_add_f32 v[68:69], v[68:69], v[76:77]
    v_pk_add_f32 v[70:71], v[70:71], v[78:79]
    v_pk_add_f32 v[64:65], v[64:65], v[96:97]
    v_pk_add_f32 v[66:67], v[66:67], v[98:99]
    v_pk_add_f32 v[68:69], v[68:69], v[100:101]
    v_pk_add_f32 v[70:71], v[70:71], v[102:103]
    s_waitcnt lgkmcnt(0)
    v_pk_add_f32 v[80:81], v[80:81], v[88:89]
    v_pk_add_f32 v[82:83], v[82:83], v[90:91]
    v_pk_add_f32 v[84:85], v[84:85], v[92:93]
    v_pk_add_f32 v[86:87], v[86:87], v[94:95]
    v_pk_add_f32 v[64:65], v[64:65], v[80:81]
    v_pk_add_f32 v[66:67], v[66:67], v[82:83]
    v_pk_add_f32 v[68:69], v[68:69], v[84:85]
    v_pk_add_f32 v[70:71], v[70:71], v[86:87]
    v_cvt_pk_bf16_f32 v72, v64, v65
    v_cvt_pk_bf16_f32 v73, v66, v67
    v_cvt_pk_bf16_f32 v74, v68, v69
    v_cvt_pk_bf16_f32 v75, v70, v71
    v_lshlrev_b32 v64, 16, v72
    v_and_b32 v65, 0xffff0000, v72
    v_lshlrev_b32 v66, 16, v73
    v_and_b32 v67, 0xffff0000, v73
    v_lshlrev_b32 v68, 16, v74
    v_and_b32 v69, 0xffff0000, v74
    v_lshlrev_b32 v70, 16, v75
    v_and_b32 v71, 0xffff0000, v75
    s_waitcnt vmcnt(0)
    v_cmp_ne_u32 vcc, s51, v110
    s_cbranch_vccz L_pcd_30
    s_mov_b32 s53, 0
L_pc_29:
    buffer_load_dword v110, v122, s[44:47], 0 offen sc1
    s_waitcnt vmcnt(0)
    v_cmp_ne_u32 vcc, s51, v110
    s_cbranch_vccz L_pcd_30
    s_add_u32 s53, s53, 1
    s_cmp_lg_u32 s52, 0
    s_cbranch_scc1 L_pcd_30
    s_cmp_lt_u32 s53, 0x8000
    s_cbranch_scc1 L_pc_29
    s_mov_b32 s52, 1
L_pcd_30:
    s_add_u32 s53, s75, 15728640
    buffer_load_dwordx4 v[104:107], v2, s[44:47], s53 offen sc1
    v_lshlrev_b32 v80, 16, v60
    v_and_b32 v81, 0xffff0000, v60
    v_lshlrev_b32 v82, 16, v61
    v_and_b32 v83, 0xffff0000, v61
    v_lshlrev_b32 v84, 16, v62
    v_and_b32 v85, 0xffff0000, v62
    v_lshlrev_b32 v86, 16, v63
    v_and_b32 v87, 0xffff0000, v63
    v_pk_add_f32 v[64:65], v[64:65], v[80:81]
    v_pk_add_f32 v[66:67], v[66:67], v[82:83]
    v_pk_add_f32 v[68:69], v[68:69], v[84:85]
    v_pk_add_f32 v[70:71], v[70:71], v[86:87]
    v_cvt_pk_bf16_f32 v72, v64, v65
    v_cvt_pk_bf16_f32 v73, v66, v67
    v_cvt_pk_bf16_f32 v74, v68, v69
    v_cvt_pk_bf16_f32 v75, v70, v71
    s_mov_b32 s53, 15732736
    buffer_store_dwordx4 v[72:75], v112, s[44:47], s53 offen sc1
    v_mov_b32 v108, 0x3b000000
    v_add_u32 v109, 512, v122
    s_waitcnt vmcnt(1)
    v_lshlrev_b32 v16, 16, v104
    v_and_b32 v17, 0xffff0000, v104
    v_lshlrev_b32 v18, 16, v105
    v_and_b32 v19, 0xffff0000, v105
    v_lshlrev_b32 v20, 16, v106
    v_and_b32 v21, 0xffff0000, v106
    v_lshlrev_b32 v22, 16, v107
    v_and_b32 v23, 0xffff0000, v107
    v_pk_add_f32 v[52:53], v[16:17], v[18:19]
    v_pk_mul_f32 v[54:55], v[16:17], v[16:17]
    v_pk_add_f32 v[56:57], v[20:21], v[22:23]
    v_pk_fma_f32 v[54:55], v[18:19], v[18:19], v[54:55]
    v_pk_add_f32 v[52:53], v[52:53], v[56:57]
    v_pk_fma_f32 v[54:55], v[20:21], v[20:21], v[54:55]
    v_add_f32 v52, v52, v53
    v_pk_fma_f32 v[54:55], v[22:23], v[22:23], v[54:55]
    v_add_f32 v54, v54, v55
    s_nop 0
    v_add_f32_dpp v52, v52, v52 quad_perm:[1,0,3,2] row_mask:0xf bank_mask:0xf
    v_add_f32_dpp v54, v54, v54 quad_perm:[1,0,3,2] row_mask:0xf bank_mask:0xf
    s_nop 0
    v_add_f32_dpp v52, v52, v52 quad_perm:[2,3,0,1] row_mask:0xf bank_mask:0xf
    v_add_f32_dpp v54, v54, v54 quad_perm:[2,3,0,1] row_mask:0xf bank_mask:0xf
    s_nop 0
    v_add_f32_dpp v52, v52, v52 row_half_mirror row_mask:0xf bank_mask:0xf
    v_add_f32_dpp v54, v54, v54 row_half_mirror row_mask:0xf bank_mask:0xf
    s_nop 0
    v_add_f32_dpp v52, v52, v52 row_mirror row_mask:0xf bank_mask:0xf
    v_add_f32_dpp v54, v54, v54 row_mirror row_mask:0xf bank_mask:0xf
    s_nop 0
    v_add_f32_dpp v52, v52, v52 row_bcast:15 row_mask:0xa bank_mask:0xf
    v_add_f32_dpp v54, v54, v54 row_bcast:15 row_mask:0xa bank_mask:0xf
    s_nop 0
    v_add_f32_dpp v52, v52, v52 row_bcast:31 row_mask:0xc bank_mask:0xf
    v_add_f32_dpp v54, v54, v54 row_bcast:31 row_mask:0xc bank_mask:0xf
    s_nop 0
    v_readlane_b32 s58, v52, 63
    v_readlane_b32 s59, v54, 63
    s_nop 1
    v_mul_f32 v56, s58, v108
    v_mul_f32 v54, s59, v108
    v_fma_f32 v54, -v56, v56, v54
    v_max_f32 v54, 0, v54
    v_add_f32 v54, 0x3727c5ac, v54
    v_rsq_f32 v54, v54
    s_nop 0
    v_mul_f32 v56, v56, v54
    v_pk_fma_f32 v[24:25], v[16:17], v[54:55], v[56:57] op_sel_hi:[1,0,0] neg_lo:[0,0,1] neg_hi:[0,0,1]
    v_pk_fma_f32 v[26:27], v[18:19], v[54:55], v[56:57] op_sel_hi:[1,0,0] neg_lo:[0,0,1] neg_hi:[0,0,1]
    v_pk_fma_f32 v[28:29], v[20:21], v[54:55], v[56:57] op_sel_hi:[1,0,0] neg_lo:[0,0,1] neg_hi:[0,0,1]
    v_pk_fma_f32 v[30:31], v[22:23], v[54:55], v[56:57] op_sel_hi:[1,0,0] neg_lo:[0,0,1] neg_hi:[0,0,1]
    s_waitcnt vmcnt(0)
    s_add_u32 s53, s67, 512
    buffer_store_dword v3, off, s[44:47], s53
    v_add_u32 v125, 512, v122
    s_lshl_b32 s53, s50, 10
    s_add_u32 s53, s53, 155648
    v_add_u32 v44, s53, v2
    ds_read_b128 v[32:35], v44
    s_waitcnt lgkmcnt(0)
    v_lshlrev_b32 v36, 16, v32
    v_and_b32 v37, 0xffff0000, v32
    v_lshlrev_b32 v38, 16, v33
    v_and_b32 v39, 0xffff0000, v33
    v_lshlrev_b32 v40, 16, v34
    v_and_b32 v41, 0xffff0000, v34
    v_lshlrev_b32 v42, 16, v35
    v_and_b32 v43, 0xffff0000, v35
    v_pk_fma_f32 v[16:17], v[24:25], v[36:37], v[16:17]
    v_pk_fma_f32 v[18:19], v[26:27], v[38:39], v[18:19]
    v_pk_fma_f32 v[20:21], v[28:29], v[40:41], v[20:21]
    v_pk_fma_f32 v[22:23], v[30:31], v[42:43], v[22:23]
    v_cvt_pk_bf16_f32 v48, v16, v17
    v_cvt_pk_bf16_f32 v49, v18, v19
    v_cvt_pk_bf16_f32 v50, v20, v21
    v_cvt_pk_bf16_f32 v51, v22, v23
    v_lshlrev_b32 v16, 16, v48
    v_and_b32 v17, 0xffff0000, v48
    v_lshlrev_b32 v18, 16, v49
    v_and_b32 v19, 0xffff0000, v49
    v_lshlrev_b32 v20, 16, v50
    v_and_b32 v21, 0xffff0000, v50
    v_lshlrev_b32 v22, 16, v51
    v_and_b32 v23, 0xffff0000, v51
    s_add_u32 s54, s75, 13631488
    buffer_store_dwordx4 v[48:51], v2, s[44:47], s54 offen sc1
    v_pk_add_f32 v[52:53], v[16:17], v[18:19]
    v_pk_mul_f32 v[54:55], v[16:17], v[16:17]
    v_pk_add_f32 v[56:57], v[20:21], v[22:23]
    v_pk_fma_f32 v[54:55], v[18:19], v[18:19], v[54:55]
    v_pk_add_f32 v[52:53], v[52:53], v[56:57]
    v_pk_fma_f32 v[54:55], v[20:21], v[20:21], v[54:55]
    v_add_f32 v52, v52, v53
    v_pk_fma_f32 v[54:55], v[22:23], v[22:23], v[54:55]
    v_add_f32 v54, v54, v55
    s_nop 0
    v_add_f32_dpp v52, v52, v52 quad_perm:[1,0,3,2] row_mask:0xf bank_mask:0xf
    v_add_f32_dpp v54, v54, v54 quad_perm:[1,0,3,2] row_mask:0xf bank_mask:0xf
    s_nop 0
    v_add_f32_dpp v52, v52, v52 quad_perm:[2,3,0,1] row_mask:0xf bank_mask:0xf
    v_add_f32_dpp v54, v54, v54 quad_perm:[2,3,0,1] row_mask:0xf bank_mask:0xf
    s_nop 0
    v_add_f32_dpp v52, v52, v52 row_half_mirror row_mask:0xf bank_mask:0xf
    v_add_f32_dpp v54, v54, v54 row_half_mirror row_mask:0xf bank_mask:0xf
    s_nop 0
    v_add_f32_dpp v52, v52, v52 row_mirror row_mask:0xf bank_mask:0xf
    v_add_f32_dpp v54, v54, v54 row_mirror row_mask:0xf bank_mask:0xf
    s_nop 0
    v_add_f32_dpp v52, v52, v52 row_bcast:15 row_mask:0xa bank_mask:0xf
    v_add_f32_dpp v54, v54, v54 row_bcast:15 row_mask:0xa bank_mask:0xf
    s_nop 0
    v_add_f32_dpp v52, v52, v52 row_bcast:31 row_mask:0xc bank_mask:0xf
    v_add_f32_dpp v54, v54, v54 row_bcast:31 row_mask:0xc bank_mask:0xf
    s_nop 0
    v_readlane_b32 s58, v52, 63
    v_readlane_b32 s59, v54, 63
    s_nop 1
    v_mul_f32 v56, s58, v108
    v_mul_f32 v54, s59, v108
    v_fma_f32 v54, -v56, v56, v54
    v_max_f32 v54, 0, v54
    v_add_f32 v52, 0x3727c5ac, v54
    v_rsq_f32 v52, v52
    s_nop 0
    v_mul_f32 v54, v54, v52
    v_fmaak_f32 v54, v54, v52, 0x3727c5ac
    v_rsq_f32 v54, v54
    s_nop 0
    v_mul_f32 v54, v54, v52
    v_mul_f32 v56, v56, v54
    v_pk_fma_f32 v[24:25], v[16:17], v[54:55], v[56:57] op_sel_hi:[1,0,0] neg_lo:[0,0,1] neg_hi:[0,0,1]
    v_pk_fma_f32 v[26:27], v[18:19], v[54:55], v[56:57] op_sel_hi:[1,0,0] neg_lo:[0,0,1] neg_hi:[0,0,1]
    v_pk_fma_f32 v[28:29], v[20:21], v[54:55], v[56:57] op_sel_hi:[1,0,0] neg_lo:[0,0,1] neg_hi:[0,0,1]
    v_pk_fma_f32 v[30:31], v[22:23], v[54:55], v[56:57] op_sel_hi:[1,0,0] neg_lo:[0,0,1] neg_hi:[0,0,1]
    v_cvt_pk_bf16_f32 v32, v24, v25
    v_cvt_pk_bf16_f32 v33, v26, v27
    v_cvt_pk_bf16_f32 v34, v28, v29
    v_cvt_pk_bf16_f32 v35, v30, v31
    s_add_u32 s54, s75, 9437184
    buffer_store_dwordx4 v[32:35], v2, s[44:47], s54 offen
    s_lshl_b32 s53, s50, 10
    s_add_u32 s53, s53, 159744
    v_add_u32 v111, s53, v2
    ds_read_b128 v[44:47], v111
    s_waitcnt vmcnt(0)
    s_add_u32 s53, s61, 8192
    buffer_store_dword v3, off, s[44:47], s53
    s_mov_b32 s64, 1
    s_cmp_ge_u32 s49, 28
    s_cbranch_scc1 L_idle_31
    v_add_u32 v100, 8192, v120
    v_add_u32 v101, 12288, v120
    buffer_load_dword v102, v100, s[44:47], 0 offen sc1
    s_barrier
    s_mov_b32 s4, s32
    s_and_b32 s5, s33, 0xffff
    s_mov_b32 s6, 3584
    s_mov_b32 s7, 0x00020000
    v_lshrrev_b32 v14, 5, v1
    v_lshlrev_b32 v15, 3, v14
    s_lshl_b32 s53, s68, 6
    buffer_load_dwordx2 v[104:105], v15, s[4:7], s53 offen
    buffer_load_dwordx2 v[106:107], v15, s[4:7], s53 offen offset:16
    buffer_load_dwordx2 v[108:109], v15, s[4:7], s53 offen offset:32
    buffer_load_dwordx2 v[110:111], v15, s[4:7], s53 offen offset:48
    v_mov_b32 v12, 0xbdd2d3e8
    v_mov_b32 v13, 0xc0135761
    v_mov_b32 v14, 1.0
    v_mov_b32 v15, 1.0
    s_waitcnt vmcnt(4)
    v_cmp_ne_u32 vcc, s51, v102
    s_cbranch_vccz L_pcd_34
    s_mov_b32 s53, 0
L_pc_33:
    buffer_load_dword v102, v100, s[44:47], 0 offen sc1
    s_waitcnt vmcnt(0)
    v_cmp_ne_u32 vcc, s51, v102
    s_cbranch_vccz L_pcd_34
    s_add_u32 s53, s53, 1
    s_cmp_lg_u32 s52, 0
    s_cbranch_scc1 L_pcd_34
    s_cmp_lt_u32 s53, 0x8000
    s_cbranch_scc1 L_pc_33
    s_mov_b32 s52, 1
L_pcd_34:
    s_add_u32 m0, s73, 0
    s_add_u32 s57, s72, 0
    v_xor_b32 v103, 0, v121
    buffer_load_dwordx4 v103, s[44:47], s57 offen sc1 lds
    v_xor_b32 v103, 16, v121
    buffer_load_dwordx4 v103, s[44:47], s57 offen offset:1024 sc1 lds
    v_xor_b32 v103, 32, v121
    buffer_load_dwordx4 v103, s[44:47], s57 offen offset:2048 sc1 lds
    v_xor_b32 v103, 48, v121
    buffer_load_dwordx4 v103, s[44:47], s57 offen offset:3072 sc1 lds
    s_add_u32 m0, s73, 4096
    s_add_u32 s57, s72, 8192
    v_xor_b32 v103, 64, v121
    buffer_load_dwordx4 v103, s[44:47], s57 offen sc1 lds
    v_xor_b32 v103, 80, v121
    buffer_load_dwordx4 v103, s[44:47], s57 offen offset:1024 sc1 lds
    v_xor_b32 v103, 96, v121
    buffer_load_dwordx4 v103, s[44:47], s57 offen offset:2048 sc1 lds
    v_xor_b32 v103, 112, v121
    buffer_load_dwordx4 v103, s[44:47], s57 offen offset:3072 sc1 lds
    buffer_load_dword v126, v125, s[44:47], 0 offen sc1
    s_waitcnt vmcnt(9)
    v_lshlrev_b32 v48, 16, v104
    v_and_b32 v49, 0xffff0000, v104
    v_lshlrev_b32 v50, 16, v105
    v_and_b32 v51, 0xffff0000, v105
    v_lshlrev_b32 v52, 16, v106
    v_and_b32 v53, 0xffff0000, v106
    v_lshlrev_b32 v54, 16, v107
    v_and_b32 v55, 0xffff0000, v107
    v_lshlrev_b32 v56, 16, v108
    v_and_b32 v57, 0xffff0000, v108
    v_lshlrev_b32 v58, 16, v109
    v_and_b32 v59, 0xffff0000, v109
    v_lshlrev_b32 v60, 16, v110
    v_and_b32 v61, 0xffff0000, v110
    v_lshlrev_b32 v62, 16, v111
    v_and_b32 v63, 0xffff0000, v111
    s_waitcnt vmcnt(0)
    v_cmp_ne_u32 vcc, s51, v126
    s_cbranch_vccz L_pcd_36
    s_mov_b32 s53, 0
L_pc_35:
    buffer_load_dword v126, v125, s[44:47], 0 offen sc1
    s_waitcnt vmcnt(0)
    v_cmp_ne_u32 vcc, s51, v126
    s_cbranch_vccz L_pcd_36
    s_add_u32 s53, s53, 1
    s_cmp_lg_u32 s52, 0
    s_cbranch_scc1 L_pcd_36
    s_cmp_lt_u32 s53, 0x8000
    s_cbranch_scc1 L_pc_35
    s_mov_b32 s52, 1
L_pcd_36:
    s_add_u32 s53, s75, 15732736
    buffer_load_dwordx4 v[40:43], v2, s[44:47], s53 offen sc1
    s_barrier
    ds_read_b128 v[64:67], v4 offset:0
    ds_read_b128 v[68:71], v5 offset:0
    ds_read_b128 v[72:75], v6 offset:0
    ds_read_b128 v[76:79], v7 offset:0
    ds_read_b128 v[80:83], v8 offset:0
    ds_read_b128 v[84:87], v9 offset:0
    ds_read_b128 v[88:91], v10 offset:0
    s_waitcnt lgkmcnt(3)
    v_mfma_f32_32x32x16_bf16 v[16:31], v[128:131], v[64:67], v[48:63]
    ds_read_b128 v[92:95], v11 offset:0
    s_add_u32 m0, s73, 32768
    s_add_u32 s57, s72, 65536
    v_xor_b32 v103, 0, v121
    buffer_load_dwordx4 v103, s[44:47], s57 offen sc1 lds
    v_mfma_f32_32x32x16_bf16 v[16:31], v[132:135], v[68:71], v[16:31]
    ds_read_b128 v[64:67], v4 offset:256
    v_xor_b32 v103, 16, v121
    buffer_load_dwordx4 v103, s[44:47], s57 offen offset:1024 sc1 lds
    v_mfma_f32_32x32x16_bf16 v[16:31], v[136:139], v[72:75], v[16:31]
    ds_read_b128 v[68:71], v5 offset:256
    v_xor_b32 v103, 32, v121
    buffer_load_dwordx4 v103, s[44:47], s57 offen offset:2048 sc1 lds
    v_mfma_f32_32x32x16_bf16 v[16:31], v[140:143], v[76:79], v[16:31]
    ds_read_b128 v[72:75], v6 offset:256
    v_xor_b32 v103, 48, v121
    buffer_load_dwordx4 v103, s[44:47], s57 offen offset:3072 sc1 lds
    s_waitcnt lgkmcnt(3)
    v_mfma_f32_32x32x16_bf16 v[16:31], v[144:147], v[80:83], v[16:31]
    ds_read_b128 v[76:79], v7 offset:256
    s_add_u32 m0, s73, 36864
    s_add_u32 s57, s72, 73728
    v_xor_b32 v103, 64, v121
    buffer_load_dwordx4 v103, s[44:47], s57 offen sc1 lds
    v_mfma_f32_32x32x16_bf16 v[16:31], v[148:151], v[84:87], v[16:31]
    ds_read_b128 v[80:83], v8 offset:256
    s_waitcnt vmcnt(5)
    v_lshlrev_b32 v32, 16, v40
    v_and_b32 v33, 0xffff0000, v40
    v_lshlrev_b32 v34, 16, v41
    v_and_b32 v35, 0xffff0000, v41
    v_lshlrev_b32 v36, 16, v42
    v_and_b32 v37, 0xffff0000, v42
    v_lshlrev_b32 v38, 16, v43
    v_xor_b32 v103, 80, v121
    buffer_load_dwordx4 v103, s[44:47], s57 offen offset:1024 sc1 lds
    v_mfma_f32_32x32x16_bf16 v[16:31], v[152:155], v[88:91], v[16:31]
    ds_read_b128 v[84:87], v9 offset:256
    v_and_b32 v39, 0xffff0000, v43
    v_add_f32 v124, v32, v33
    v_mul_f32 v125, v32, v32
    v_fmac_f32 v125, v33, v33
    v_add_f32 v124, v124, v34
    v_fmac_f32 v125, v34, v34
    v_add_f32 v124, v124, v35
    v_fmac_f32 v125, v35, v35
    v_xor_b32 v103, 96, v121
    buffer_load_dwordx4 v103, s[44:47], s57 offen offset:2048 sc1 lds
    v_mfma_f32_32x32x16_bf16 v[16:31], v[156:159], v[92:95], v[16:31]
    ds_read_b128 v[88:91], v10 offset:256
    v_add_f32 v124, v124, v36
    v_fmac_f32 v125, v36, v36
    v_add_f32 v124, v124, v37
    v_fmac_f32 v125, v37, v37
    v_add_f32 v124, v124, v38
    v_fmac_f32 v125, v38, v38
    v_add_f32 v124, v124, v39
    v_fmac_f32 v125, v39, v39
    v_xor_b32 v103, 112, v121
    buffer_load_dwordx4 v103, s[44:47], s57 offen offset:3072 sc1 lds
    s_waitcnt lgkmcnt(3)
    v_mfma_f32_32x32x16_bf16 v[16:31], v[160:163], v[64:67], v[16:31]
    ds_read_b128 v[92:95], v11 offset:256
    s_nop 1
    v_add_f32_dpp v124, v124, v124 quad_perm:[1,0,3,2] row_mask:0xf bank_mask:0xf
    v_add_f32_dpp v125, v125, v125 quad_perm:[1,0,3,2] row_mask:0xf bank_mask:0xf
    s_nop 0
    v_add_f32_dpp v124, v124, v124 quad_perm:[2,3,0,1] row_mask:0xf bank_mask:0xf
    v_add_f32_dpp v125, v125, v125 quad_perm:[2,3,0,1] row_mask:0xf bank_mask:0xf
    s_nop 0
    v_add_f32_dpp v124, v124, v124 row_half_mirror row_mask:0xf bank_mask:0xf
    v_mfma_f32_32x32x16_bf16 v[16:31], v[164:167], v[68:71], v[16:31]
    ds_read_b128 v[64:67], v4 offset:512
    v_add_f32_dpp v125, v125, v125 row_half_mirror row_mask:0xf bank_mask:0xf
    s_nop 0
    v_add_f32_dpp v124, v124, v124 row_mirror row_mask:0xf bank_mask:0xf
    v_add_f32_dpp v125, v125, v125 row_mirror row_mask:0xf bank_mask:0xf
    s_nop 0
    v_add_f32_dpp v124, v124, v124 row_bcast:15 row_mask:0xa bank_mask:0xf
    v_add_f32_dpp v125, v125, v125 row_bcast:15 row_mask:0xa bank_mask:0xf
    s_nop 0
    v_mfma_f32_32x32x16_bf16 v[16:31], v[168:171], v[72:75], v[16:31]
    ds_read_b128 v[68:71], v5 offset:512
    v_add_f32_dpp v124, v124, v124 row_bcast:31 row_mask:0xc bank_mask:0xf
    v_add_f32_dpp v125, v125, v125 row_bcast:31 row_mask:0xc bank_mask:0xf
    s_nop 0
    v_readlane_b32 s58, v124, 63
    v_readlane_b32 s59, v125, 63
    s_nop 1
    v_mov_b32 v126, s58
    v_mov_b32 v127, s59
    v_mfma_f32_32x32x16_bf16 v[16:31], v[172:175], v[76:79], v[16:31]
    ds_read_b128 v[72:75], v6 offset:512
    v_mul_f32 v126, 0x3b000000, v126
    v_mul_f32 v127, 0x3b000000, v127
    v_fma_f32 v127, -v126, v126, v127
    v_max_f32 v127, 0, v127
    v_add_f32 v127, 0x3727c5ac, v127
    v_rsq_f32 v127, v127
    s_nop 0
    v_mul_f32 v126, v126, v127
    s_waitcnt lgkmcnt(3)
    v_mfma_f32_32x32x16_bf16 v[16:31], v[176:179], v[80:83], v[16:31]
    ds_read_b128 v[76:79], v7 offset:512
    v_fma_f32 v109, v32, v127, -v126
    v_lshlrev_b32 v110, 16, v44
    v_fma_f32 v32, v109, v110, v32
    v_fma_f32 v109, v33, v127, -v126
    v_and_b32 v110, 0xffff0000, v44
    v_fma_f32 v33, v109, v110, v33
    v_fma_f32 v109, v34, v127, -v126
    v_lshlrev_b32 v110, 16, v45
    v_mfma_f32_32x32x16_bf16 v[16:31], v[180:183], v[84:87], v[16:31]
    ds_read_b128 v[80:83], v8 offset:512
    v_fma_f32 v34, v109, v110, v34
    v_fma_f32 v109, v35, v127, -v126
    v_and_b32 v110, 0xffff0000, v45
    v_fma_f32 v35, v109, v110, v35
    v_fma_f32 v109, v36, v127, -v126
    v_lshlrev_b32 v110, 16, v46
    v_fma_f32 v36, v109, v110, v36
    v_fma_f32 v109, v37, v127, -v126
    v_mfma_f32_32x32x16_bf16 v[16:31], v[184:187], v[88:91], v[16:31]
    ds_read_b128 v[84:87], v9 offset:512
    v_and_b32 v110, 0xffff0000, v46
    v_fma_f32 v37, v109, v110, v37
    v_fma_f32 v109, v38, v127, -v126
    v_lshlrev_b32 v110, 16, v47
    v_fma_f32 v38, v109, v110, v38
    v_fma_f32 v109, v39, v127, -v126
    v_and_b32 v110, 0xffff0000, v47
    v_mfma_f32_32x32x16_bf16 v[16:31], v[188:191], v[92:95], v[16:31]
    ds_read_b128 v[88:91], v10 offset:512
    v_fma_f32 v39, v109, v110, v39
    v_cvt_pk_bf16_f32 v40, v32, v33
    v_cvt_pk_bf16_f32 v41, v34, v35
    v_cvt_pk_bf16_f32 v42, v36, v37
    v_cvt_pk_bf16_f32 v43, v38, v39
    v_lshlrev_b32 v32, 16, v40
    v_and_b32 v33, 0xffff0000, v40
    v_lshlrev_b32 v34, 16, v41
    s_waitcnt lgkmcnt(3)
    v_mfma_f32_32x32x16_bf16 v[16:31], v[192:195], v[64:67], v[16:31]
    ds_read_b128 v[92:95], v11 offset:512
    v_and_b32 v35, 0xffff0000, v41
    v_lshlrev_b32 v36, 16, v42
    v_and_b32 v37, 0xffff0000, v42
    v_lshlrev_b32 v38, 16, v43
    v_and_b32 v39, 0xffff0000, v43
    s_add_u32 s54, s75, 13635584
    buffer_store_dwordx4 v[40:43], v2, s[44:47], s54 offen sc1
    v_add_f32 v124, v32, v33
    v_mul_f32 v125, v32, v32
    v_mfma_f32_32x32x16_bf16 v[16:31], v[196:199], v[68:71], v[16:31]
    ds_read_b128 v[64:67], v4 offset:768
    v_fmac_f32 v125, v33, v33
    v_add_f32 v124, v124, v34
    v_fmac_f32 v125, v34, v34
    v_add_f32 v124, v124, v35
    v_fmac_f32 v125, v35, v35
    v_add_f32 v124, v124, v36
    v_fmac_f32 v125, v36, v36
    v_add_f32 v124, v124, v37
    v_mfma_f32_32x32x16_bf16 v[16:31], v[200:203], v[72:75], v[16:31]
    ds_read_b128 v[68:71], v5 offset:768
    v_fmac_f32 v125, v37, v37
    v_add_f32 v124, v124, v38
    v_fmac_f32 v125, v38, v38
    v_add_f32 v124, v124, v39
    v_fmac_f32 v125, v39, v39
    s_nop 1
    v_add_f32_dpp v124, v124, v124 quad_perm:[1,0,3,2] row_mask:0xf bank_mask:0xf
    v_add_f32_dpp v125, v125, v125 quad_perm:[1,0,3,2] row_mask:0xf bank_mask:0xf
    v_mfma_f32_32x32x16_bf16 v[16:31], v[204:207], v[76:79], v[16:31]
    ds_read_b128 v[72:75], v6 offset:768
    s_nop 0
    v_add_f32_dpp v124, v124, v124 quad_perm:[2,3,0,1] row_mask:0xf bank_mask:0xf
    v_add_f32_dpp v125, v125, v125 quad_perm:[2,3,0,1] row_mask:0xf bank_mask:0xf
    s_nop 0
    v_add_f32_dpp v124, v124, v124 row_half_mirror row_mask:0xf bank_mask:0xf
    v_add_f32_dpp v125, v125, v125 row_half_mirror row_mask:0xf bank_mask:0xf
    s_nop 0
    v_add_f32_dpp v124, v124, v124 row_mirror row_mask:0xf bank_mask:0xf
    s_waitcnt lgkmcnt(3)
    v_mfma_f32_32x32x16_bf16 v[16:31], v[208:211], v[80:83], v[16:31]
    ds_read_b128 v[76:79], v7 offset:768
    v_add_f32_dpp v125, v125, v125 row_mirror row_mask:0xf bank_mask:0xf
    s_nop 0
    v_add_f32_dpp v124, v124, v124 row_bcast:15 row_mask:0xa bank_mask:0xf
    v_add_f32_dpp v125, v125, v125 row_bcast:15 row_mask:0xa bank_mask:0xf
    s_nop 0
    v_add_f32_dpp v124, v124, v124 row_bcast:31 row_mask:0xc bank_mask:0xf
    v_add_f32_dpp v125, v125, v125 row_bcast:31 row_mask:0xc bank_mask:0xf
    s_nop 0
    v_mfma_f32_32x32x16_bf16 v[16:31], v[212:215], v[84:87], v[16:31]
    ds_read_b128 v[80:83], v8 offset:768
    v_readlane_b32 s58, v124, 63
    v_readlane_b32 s59, v125, 63
    s_nop 1
    v_mov_b32 v126, s58
    v_mov_b32 v127, s59
    v_mul_f32 v126, 0x3b000000, v126
    v_mul_f32 v127, 0x3b000000, v127
    v_fma_f32 v127, -v126, v126, v127
    v_mfma_f32_32x32x16_bf16 v[16:31], v[216:219], v[88:91], v[16:31]
    ds_read_b128 v[84:87], v9 offset:768
    v_max_f32 v127, 0, v127
    v_add_f32 v124, 0x3727c5ac, v127
    v_rsq_f32 v124, v124
    s_nop 0
    v_mul_f32 v127, v127, v124
    v_fmaak_f32 v127, v127, v124, 0x3727c5ac
    v_rsq_f32 v127, v127
    s_nop 0
    v_mfma_f32_32x32x16_bf16 v[16:31], v[220:223], v[92:95], v[16:31]
    ds_read_b128 v[88:91], v10 offset:768
    v_mul_f32 v127, v127, v124
    v_mul_f32 v126, v126, v127
    v_fma_f32 v32, v32, v127, -v126
    v_fma_f32 v33, v33, v127, -v126
    v_fma_f32 v34, v34, v127, -v126
    v_fma_f32 v35, v35, v127, -v126
    v_fma_f32 v36, v36, v127, -v126
    v_fma_f32 v37, v37, v127, -v126
    s_waitcnt lgkmcnt(3)
    v_mfma_f32_32x32x16_bf16 v[16:31], v[224:227], v[64:67], v[16:31]
    ds_read_b128 v[92:95], v11 offset:768
    v_fma_f32 v38, v38, v127, -v126
    v_fma_f32 v39, v39, v127, -v126
    v_cvt_pk_bf16_f32 v44, v32, v33
    v_cvt_pk_bf16_f32 v45, v34, v35
    v_cvt_pk_bf16_f32 v46, v36, v37
    v_cvt_pk_bf16_f32 v47, v38, v39
    s_add_u32 s54, s75, 9441280
    buffer_store_dwordx4 v[44:47], v2, s[44:47], s54 offen
    v_mfma_f32_32x32x16_bf16 v[16:31], v[228:231], v[68:71], v[16:31]
    s_waitcnt vmcnt(2)
    s_barrier
    ds_read_b128 v[64:67], v4 offset:32768
    v_mfma_f32_32x32x16_bf16 v[16:31], v[232:235], v[72:75], v[16:31]
    ds_read_b128 v[68:71], v5 offset:32768
    v_mfma_f32_32x32x16_bf16 v[16:31], v[236:239], v[76:79], v[16:31]
    ds_read_b128 v[72:75], v6 offset:32768
    s_waitcnt lgkmcnt(3)
    v_mfma_f32_32x32x16_bf16 v[16:31], v[240:243], v[80:83], v[16:31]
    ds_read_b128 v[76:79], v7 offset:32768
    v_mfma_f32_32x32x16_bf16 v[16:31], v[244:247], v[84:87], v[16:31]
    ds_read_b128 v[80:83], v8 offset:32768
    v_mfma_f32_32x32x16_bf16 v[16:31], v[248:251], v[88:91], v[16:31]
    ds_read_b128 v[84:87], v9 offset:32768
    v_mfma_f32_32x32x16_bf16 v[16:31], v[252:255], v[92:95], v[16:31]
    ds_read_b128 v[88:91], v10 offset:32768
    s_waitcnt lgkmcnt(3)
    v_mfma_f32_32x32x16_bf16 v[32:47], v[128:131], v[64:67], v[48:63]
    ds_read_b128 v[92:95], v11 offset:32768
    s_waitcnt vmcnt(0)
    s_add_u32 s53, s61, 12288
    buffer_store_dword v3, off, s[44:47], s53
    v_mfma_f32_32x32x16_bf16 v[32:47], v[132:135], v[68:71], v[32:47]
    ds_read_b128 v[64:67], v4 offset:33024
    v_mfma_f32_32x32x16_bf16 v[32:47], v[136:139], v[72:75], v[32:47]
    ds_read_b128 v[68:71], v5 offset:33024
    v_mfma_f32_32x32x16_bf16 v[32:47], v[140:143], v[76:79], v[32:47]
    ds_read_b128 v[72:75], v6 offset:33024
    s_waitcnt lgkmcnt(3)
    v_mfma_f32_32x32x16_bf16 v[32:47], v[144:147], v[80:83], v[32:47]
    ds_read_b128 v[76:79], v7 offset:33024
    s_add_u32 s74, s71, 0
    v_mul_f32 v96, v16, v16
    v_mul_f32 v97, v17, v17
    v_fma_f32 v96, v96, v12, v13
    v_fma_f32 v97, v97, v12, v13
    v_mul_f32 v96, v96, v16
    buffer_load_dword v102, v101, s[44:47], 0 offen sc1
    v_mfma_f32_32x32x16_bf16 v[32:47], v[148:151], v[84:87], v[32:47]
    ds_read_b128 v[80:83], v8 offset:33024
    v_mul_f32 v97, v97, v17
    v_exp_f32 v96, v96
    v_exp_f32 v97, v97
    v_add_f32 v96, 1.0, v96
    v_add_f32 v97, 1.0, v97
    v_mfma_f32_32x32x16_bf16 v[32:47], v[152:155], v[88:91], v[32:47]
    ds_read_b128 v[84:87], v9 offset:33024
    v_rcp_f32 v96, v96
    v_rcp_f32 v97, v97
    v_mul_f32 v16, v16, v96
    v_mul_f32 v17, v17, v97
    v_cvt_pk_bf16_f32 v104, v16, v17
    v_mfma_f32_32x32x16_bf16 v[32:47], v[156:159], v[92:95], v[32:47]
    ds_read_b128 v[88:91], v10 offset:33024
    v_mul_f32 v98, v18, v18
    v_mul_f32 v99, v19, v19
    v_fma_f32 v98, v98, v12, v13
    v_fma_f32 v99, v99, v12, v13
    v_mul_f32 v98, v98, v18
    s_waitcnt lgkmcnt(3)
    v_mfma_f32_32x32x16_bf16 v[32:47], v[160:163], v[64:67], v[32:47]
    ds_read_b128 v[92:95], v11 offset:33024
    v_mul_f32 v99, v99, v19
    v_exp_f32 v98, v98
    v_exp_f32 v99, v99
    v_add_f32 v98, 1.0, v98
    v_add_f32 v99, 1.0, v99
    v_mfma_f32_32x32x16_bf16 v[32:47], v[164:167], v[68:71], v[32:47]
    ds_read_b128 v[64:67], v4 offset:33280
    v_rcp_f32 v98, v98
    v_rcp_f32 v99, v99
    v_mul_f32 v18, v18, v98
    v_mul_f32 v19, v19, v99
    v_cvt_pk_bf16_f32 v105, v18, v19
    s_waitcnt vmcnt(0)
    v_cmp_ne_u32 vcc, s51, v102
    s_cbranch_vccz L_pcd_38
    s_mov_b32 s53, 0
L_pc_37:
    buffer_load_dword v102, v101, s[44:47], 0 offen sc1
    s_waitcnt vmcnt(0)
    v_cmp_ne_u32 vcc, s51, v102
    s_cbranch_vccz L_pcd_38
    s_add_u32 s53, s53, 1
    s_cmp_lg_u32 s52, 0
    s_cbranch_scc1 L_pcd_38
    s_cmp_lt_u32 s53, 0x8000
    s_cbranch_scc1 L_pc_37
    s_mov_b32 s52, 1
L_pcd_38:
    v_mfma_f32_32x32x16_bf16 v[32:47], v[168:171], v[72:75], v[32:47]
    ds_read_b128 v[68:71], v5 offset:33280
    v_mul_f32 v96, v20, v20
    v_mul_f32 v97, v21, v21
    v_fma_f32 v96, v96, v12, v13
    v_fma_f32 v97, v97, v12, v13
    v_mul_f32 v96, v96, v20
    s_add_u32 m0, s73, 65536
    s_add_u32 s57, s72, 4096
    v_xor_b32 v103, 0, v121
    buffer_load_dwordx4 v103, s[44:47], s57 offen sc1 lds
    v_mfma_f32_32x32x16_bf16 v[32:47], v[172:175], v[76:79], v[32:47]
    ds_read_b128 v[72:75], v6 offset:33280
    v_mul_f32 v97, v97, v21
    v_exp_f32 v96, v96
    v_exp_f32 v97, v97
    v_add_f32 v96, 1.0, v96
    v_add_f32 v97, 1.0, v97
    v_xor_b32 v103, 16, v121
    buffer_load_dwordx4 v103, s[44:47], s57 offen offset:1024 sc1 lds
    s_waitcnt lgkmcnt(3)
    v_mfma_f32_32x32x16_bf16 v[32:47], v[176:179], v[80:83], v[32:47]
    ds_read_b128 v[76:79], v7 offset:33280
    v_rcp_f32 v96, v96
    v_rcp_f32 v97, v97
    v_mul_f32 v20, v20, v96
    v_mul_f32 v21, v21, v97
    v_cvt_pk_bf16_f32 v106, v20, v21
    v_mul_f32 v98, v22, v22
    v_xor_b32 v103, 32, v121
    buffer_load_dwordx4 v103, s[44:47], s57 offen offset:2048 sc1 lds
    v_mfma_f32_32x32x16_bf16 v[32:47], v[180:183], v[84:87], v[32:47]
    ds_read_b128 v[80:83], v8 offset:33280
    v_mul_f32 v99, v23, v23
    v_fma_f32 v98, v98, v12, v13
    v_fma_f32 v99, v99, v12, v13
    v_mul_f32 v98, v98, v22
    v_mul_f32 v99, v99, v23
    v_xor_b32 v103, 48, v121
    buffer_load_dwordx4 v103, s[44:47], s57 offen offset:3072 sc1 lds
    v_mfma_f32_32x32x16_bf16 v[32:47], v[184:187], v[88:91], v[32:47]
    ds_read_b128 v[84:87], v9 offset:33280
    v_exp_f32 v98, v98
    v_exp_f32 v99, v99
    v_add_f32 v98, 1.0, v98
    v_add_f32 v99, 1.0, v99
    v_rcp_f32 v98, v98
    v_mfma_f32_32x32x16_bf16 v[32:47], v[188:191], v[92:95], v[32:47]
    ds_read_b128 v[88:91], v10 offset:33280
    v_rcp_f32 v99, v99
    v_mul_f32 v22, v22, v98
    v_mul_f32 v23, v23, v99
    v_cvt_pk_bf16_f32 v107, v22, v23
    buffer_store_dwordx4 v[104:107], v2, s[44:47], s74 offen sc1
    s_add_u32 m0, s73, 69632
    s_add_u32 s57, s72, 12288
    v_xor_b32 v103, 64, v121
    buffer_load_dwordx4 v103, s[44:47], s57 offen sc1 lds
    s_waitcnt lgkmcnt(3)
    v_mfma_f32_32x32x16_bf16 v[32:47], v[192:195], v[64:67], v[32:47]
    ds_read_b128 v[92:95], v11 offset:33280
    v_mul_f32 v96, v24, v24
    v_mul_f32 v97, v25, v25
    v_fma_f32 v96, v96, v12, v13
    v_fma_f32 v97, v97, v12, v13
    v_mul_f32 v96, v96, v24
    v_xor_b32 v103, 80, v121
    buffer_load_dwordx4 v103, s[44:47], s57 offen offset:1024 sc1 lds
    v_mfma_f32_32x32x16_bf16 v[32:47], v[196:199], v[68:71], v[32:47]
    ds_read_b128 v[64:67], v4 offset:33536
    v_mul_f32 v97, v97, v25
    v_exp_f32 v96, v96
    v_exp_f32 v97, v97
    v_add_f32 v96, 1.0, v96
    v_add_f32 v97, 1.0, v97
    v_xor_b32 v103, 96, v121
    buffer_load_dwordx4 v103, s[44:47], s57 offen offset:2048 sc1 lds
    v_mfma_f32_32x32x16_bf16 v[32:47], v[200:203], v[72:75], v[32:47]
    ds_read_b128 v[68:71], v5 offset:33536
    v_rcp_f32 v96, v96
    v_rcp_f32 v97, v97
    v_mul_f32 v24, v24, v96
    v_mul_f32 v25, v25, v97
    v_cvt_pk_bf16_f32 v108, v24, v25
    v_mfma_f32_32x32x16_bf16 v[32:47], v[204:207], v[76:79], v[32:47]
    ds_read_b128 v[72:75], v6 offset:33536
    v_mul_f32 v98, v26, v26
    v_mul_f32 v99, v27, v27
    v_fma_f32 v98, v98, v12, v13
    v_fma_f32 v99, v99, v12, v13
    v_mul_f32 v98, v98, v26
    v_xor_b32 v103, 112, v121
    buffer_load_dwordx4 v103, s[44:47], s57 offen offset:3072 sc1 lds
    s_waitcnt lgkmcnt(3)
    v_mfma_f32_32x32x16_bf16 v[32:47], v[208:211], v[80:83], v[32:47]
    ds_read_b128 v[76:79], v7 offset:33536
    v_mul_f32 v99, v99, v27
    v_exp_f32 v98, v98
    v_exp_f32 v99, v99
    v_add_f32 v98, 1.0, v98
    v_add_f32 v99, 1.0, v99
    v_rcp_f32 v98, v98
    s_add_u32 m0, s73, 98304
    s_add_u32 s57, s72, 69632
    v_xor_b32 v103, 0, v121
    buffer_load_dwordx4 v103, s[44:47], s57 offen sc1 lds
    v_mfma_f32_32x32x16_bf16 v[32:47], v[212:215], v[84:87], v[32:47]
    ds_read_b128 v[80:83], v8 offset:33536
    v_rcp_f32 v99, v99
    v_mul_f32 v26, v26, v98
    v_mul_f32 v27, v27, v99
    v_cvt_pk_bf16_f32 v109, v26, v27
    v_mul_f32 v96, v28, v28
    v_xor_b32 v103, 16, v121
    buffer_load_dwordx4 v103, s[44:47], s57 offen offset:1024 sc1 lds
    v_mfma_f32_32x32x16_bf16 v[32:47], v[216:219], v[88:91], v[32:47]
    ds_read_b128 v[84:87], v9 offset:33536
    v_mul_f32 v97, v29, v29
    v_fma_f32 v96, v96, v12, v13
    v_fma_f32 v97, v97, v12, v13
    v_mul_f32 v96, v96, v28
    v_mul_f32 v97, v97, v29
    v_mfma_f32_32x32x16_bf16 v[32:47], v[220:223], v[92:95], v[32:47]
    ds_read_b128 v[88:91], v10 offset:33536
    v_exp_f32 v96, v96
    v_exp_f32 v97, v97
    v_add_f32 v96, 1.0, v96
    v_add_f32 v97, 1.0, v97
    v_rcp_f32 v96, v96
    v_xor_b32 v103, 32, v121
    buffer_load_dwordx4 v103, s[44:47], s57 offen offset:2048 sc1 lds
    s_waitcnt lgkmcnt(3)
    v_mfma_f32_32x32x16_bf16 v[32:47], v[224:227], v[64:67], v[32:47]
    ds_read_b128 v[92:95], v11 offset:33536
    v_rcp_f32 v97, v97
    v_mul_f32 v28, v28, v96
    v_mul_f32 v29, v29, v97
    v_cvt_pk_bf16_f32 v110, v28, v29
    v_mul_f32 v98, v30, v30
    v_xor_b32 v103, 48, v121
    buffer_load_dwordx4 v103, s[44:47], s57 offen offset:3072 sc1 lds
    v_mfma_f32_32x32x16_bf16 v[32:47], v[228:231], v[68:71], v[32:47]
    v_mul_f32 v99, v31, v31
    v_fma_f32 v98, v98, v12, v13
    v_fma_f32 v99, v99, v12, v13
    v_mul_f32 v98, v98, v30
    v_mul_f32 v99, v99, v31
    s_add_u32 m0, s73, 102400
    s_add_u32 s57, s72, 77824
    v_xor_b32 v103, 64, v121
    buffer_load_dwordx4 v103, s[44:47], s57 offen sc1 lds
    v_mfma_f32_32x32x16_bf16 v[32:47], v[232:235], v[72:75], v[32:47]
    v_exp_f32 v98, v98
    v_exp_f32 v99, v99
    v_add_f32 v98, 1.0, v98
    v_add_f32 v99, 1.0, v99
    v_rcp_f32 v98, v98
    v_mfma_f32_32x32x16_bf16 v[32:47], v[236:239], v[76:79], v[32:47]
    v_rcp_f32 v99, v99
    v_mul_f32 v30, v30, v98
    v_mul_f32 v31, v31, v99
    v_cvt_pk_bf16_f32 v111, v30, v31
    buffer_store_dwordx4 v[108:111], v2, s[44:47], s74 offen offset:1024 sc1
    v_xor_b32 v103, 80, v121
    buffer_load_dwordx4 v103, s[44:47], s57 offen offset:1024 sc1 lds
    s_waitcnt lgkmcnt(0)
    v_mfma_f32_32x32x16_bf16 v[32:47], v[240:243], v[80:83], v[32:47]
    v_xor_b32 v103, 96, v121
    buffer_load_dwordx4 v103, s[44:47], s57 offen offset:2048 sc1 lds
    v_mfma_f32_32x32x16_bf16 v[32:47], v[244:247], v[84:87], v[32:47]
    v_xor_b32 v103, 112, v121
    buffer_load_dwordx4 v103, s[44:47], s57 offen offset:3072 sc1 lds
    v_mfma_f32_32x32x16_bf16 v[32:47], v[248:251], v[88:91], v[32:47]
    v_mfma_f32_32x32x16_bf16 v[32:47], v[252:255], v[92:95], v[32:47]
    s_waitcnt vmcnt(9)
    s_barrier
    v_add_u32 v4, 0x10000, v4
    v_add_u32 v5, 0x10000, v5
    v_add_u32 v6, 0x10000, v6
    v_add_u32 v7, 0x10000, v7
    v_add_u32 v8, 0x10000, v8
    v_add_u32 v9, 0x10000, v9
    v_add_u32 v10, 0x10000, v10
    v_add_u32 v11, 0x10000, v11
    ds_read_b128 v[64:67], v4 offset:0
    ds_read_b128 v[68:71], v5 offset:0
    ds_read_b128 v[72:75], v6 offset:0
    ds_read_b128 v[76:79], v7 offset:0
    ds_read_b128 v[80:83], v8 offset:0
    ds_read_b128 v[84:87], v9 offset:0
    ds_read_b128 v[88:91], v10 offset:0
    s_waitcnt lgkmcnt(3)
    v_mfma_f32_32x32x16_bf16 v[16:31], v[128:131], v[64:67], v[48:63]
    ds_read_b128 v[92:95], v11 offset:0
    v_mfma_f32_32x32x16_bf16 v[16:31], v[132:135], v[68:71], v[16:31]
    ds_read_b128 v[64:67], v4 offset:256
    v_mfma_f32_32x32x16_bf16 v[16:31], v[136:139], v[72:75], v[16:31]
    ds_read_b128 v[68:71], v5 offset:256
    v_mfma_f32_32x32x16_bf16 v[16:31], v[140:143], v[76:79], v[16:31]
    ds_read_b128 v[72:75], v6 offset:256
    s_waitcnt lgkmcnt(3)
    v_mfma_f32_32x32x16_bf16 v[16:31], v[144:147], v[80:83], v[16:31]
    ds_read_b128 v[76:79], v7 offset:256
    s_add_u32 s74, s71, 114688
    v_mul_f32 v96, v32, v32
    v_mul_f32 v97, v33, v33
    v_fma_f32 v96, v96, v12, v13
    v_fma_f32 v97, v97, v12, v13
    v_mul_f32 v96, v96, v32
    v_mfma_f32_32x32x16_bf16 v[16:31], v[148:151], v[84:87], v[16:31]
    ds_read_b128 v[80:83], v8 offset:256
    v_mul_f32 v97, v97, v33
    v_exp_f32 v96, v96
    v_exp_f32 v97, v97
    v_add_f32 v96, 1.0, v96
    v_add_f32 v97, 1.0, v97
    v_mfma_f32_32x32x16_bf16 v[16:31], v[152:155], v[88:91], v[16:31]
    ds_read_b128 v[84:87], v9 offset:256
    v_rcp_f32 v96, v96
    v_rcp_f32 v97, v97
    v_mul_f32 v32, v32, v96
    v_mul_f32 v33, v33, v97
    v_cvt_pk_bf16_f32 v104, v32, v33
    v_mfma_f32_32x32x16_bf16 v[16:31], v[156:159], v[92:95], v[16:31]
    ds_read_b128 v[88:91], v10 offset:256
    v_mul_f32 v98, v34, v34
    v_mul_f32 v99, v35, v35
    v_fma_f32 v98, v98, v12, v13
    v_fma_f32 v99, v99, v12, v13
    v_mul_f32 v98, v98, v34
    s_waitcnt lgkmcnt(3)
    v_mfma_f32_32x32x16_bf16 v[16:31], v[160:163], v[64:67], v[16:31]
    ds_read_b128 v[92:95], v11 offset:256
    v_mul_f32 v99, v99, v35
    v_exp_f32 v98, v98
    v_exp_f32 v99, v99
    v_add_f32 v98, 1.0, v98
    v_add_f32 v99, 1.0, v99
    v_mfma_f32_32x32x16_bf16 v[16:31], v[164:167], v[68:71], v[16:31]
    ds_read_b128 v[64:67], v4 offset:512
    v_rcp_f32 v98, v98
    v_rcp_f32 v99, v99
    v_mul_f32 v34, v34, v98
    v_mul_f32 v35, v35, v99
    v_cvt_pk_bf16_f32 v105, v34, v35
    v_mfma_f32_32x32x16_bf16 v[16:31], v[168:171], v[72:75], v[16:31]
    ds_read_b128 v[68:71], v5 offset:512
    v_mul_f32 v96, v36, v36
    v_mul_f32 v97, v37, v37
    v_fma_f32 v96, v96, v12, v13
    v_fma_f32 v97, v97, v12, v13
    v_mul_f32 v96, v96, v36
    v_mfma_f32_32x32x16_bf16 v[16:31], v[172:175], v[76:79], v[16:31]
    ds_read_b128 v[72:75], v6 offset:512
    v_mul_f32 v97, v97, v37
    v_exp_f32 v96, v96
    v_exp_f32 v97, v97
    v_add_f32 v96, 1.0, v96
    v_add_f32 v97, 1.0, v97
    s_waitcnt lgkmcnt(3)
    v_mfma_f32_32x32x16_bf16 v[16:31], v[176:179], v[80:83], v[16:31]
    ds_read_b128 v[76:79], v7 offset:512
    v_rcp_f32 v96, v96
    v_rcp_f32 v97, v97
    v_mul_f32 v36, v36, v96
    v_mul_f32 v37, v37, v97
    v_cvt_pk_bf16_f32 v106, v36, v37
    v_mul_f32 v98, v38, v38
    v_mfma_f32_32x32x16_bf16 v[16:31], v[180:183], v[84:87], v[16:31]
    ds_read_b128 v[80:83], v8 offset:512
    v_mul_f32 v99, v39, v39
    v_fma_f32 v98, v98, v12, v13
    v_fma_f32 v99, v99, v12, v13
    v_mul_f32 v98, v98, v38
    v_mul_f32 v99, v99, v39
    v_mfma_f32_32x32x16_bf16 v[16:31], v[184:187], v[88:91], v[16:31]
    ds_read_b128 v[84:87], v9 offset:512
    v_exp_f32 v98, v98
    v_exp_f32 v99, v99
    v_add_f32 v98, 1.0, v98
    v_add_f32 v99, 1.0, v99
    v_rcp_f32 v98, v98
    v_mfma_f32_32x32x16_bf16 v[16:31], v[188:191], v[92:95], v[16:31]
    ds_read_b128 v[88:91], v10 offset:512
    v_rcp_f32 v99, v99
    v_mul_f32 v38, v38, v98
    v_mul_f32 v39, v39, v99
    v_cvt_pk_bf16_f32 v107, v38, v39
    buffer_store_dwordx4 v[104:107], v2, s[44:47], s74 offen sc1
    s_waitcnt lgkmcnt(3)
    v_mfma_f32_32x32x16_bf16 v[16:31], v[192:195], v[64:67], v[16:31]
    ds_read_b128 v[92:95], v11 offset:512
    v_mul_f32 v96, v40, v40
    v_mul_f32 v97, v41, v41
    v_fma_f32 v96, v96, v12, v13
    v_fma_f32 v97, v97, v12, v13
    v_mul_f32 v96, v96, v40
    v_mfma_f32_32x32x16_bf16 v[16:31], v[196:199], v[68:71], v[16:31]
    ds_read_b128 v[64:67], v4 offset:768
    v_mul_f32 v97, v97, v41
    v_exp_f32 v96, v96
    v_exp_f32 v97, v97
    v_add_f32 v96, 1.0, v96
    v_add_f32 v97, 1.0, v97
    v_mfma_f32_32x32x16_bf16 v[16:31], v[200:203], v[72:75], v[16:31]
    ds_read_b128 v[68:71], v5 offset:768
    v_rcp_f32 v96, v96
    v_rcp_f32 v97, v97
    v_mul_f32 v40, v40, v96
    v_mul_f32 v41, v41, v97
    v_cvt_pk_bf16_f32 v108, v40, v41
    v_mfma_f32_32x32x16_bf16 v[16:31], v[204:207], v[76:79], v[16:31]
    ds_read_b128 v[72:75], v6 offset:768
    v_mul_f32 v98, v42, v42
    v_mul_f32 v99, v43, v43
    v_fma_f32 v98, v98, v12, v13
    v_fma_f32 v99, v99, v12, v13
    v_mul_f32 v98, v98, v42
    s_waitcnt lgkmcnt(3)
    v_mfma_f32_32x32x16_bf16 v[16:31], v[208:211], v[80:83], v[16:31]
    ds_read_b128 v[76:79], v7 offset:768
    v_mul_f32 v99, v99, v43
    v_exp_f32 v98, v98
    v_exp_f32 v99, v99
    v_add_f32 v98, 1.0, v98
    v_add_f32 v99, 1.0, v99
    v_rcp_f32 v98, v98
    v_mfma_f32_32x32x16_bf16 v[16:31], v[212:215], v[84:87], v[16:31]
    ds_read_b128 v[80:83], v8 offset:768
    v_rcp_f32 v99, v99
    v_mul_f32 v42, v42, v98
    v_mul_f32 v43, v43, v99
    v_cvt_pk_bf16_f32 v109, v42, v43
    v_mul_f32 v96, v44, v44
    v_mfma_f32_32x32x16_bf16 v[16:31], v[216:219], v[88:91], v[16:31]
    ds_read_b128 v[84:87], v9 offset:768
    v_mul_f32 v97, v45, v45
    v_fma_f32 v96, v96, v12, v13
    v_fma_f32 v97, v97, v12, v13
    v_mul_f32 v96, v96, v44
    v_mul_f32 v97, v97, v45
    v_mfma_f32_32x32x16_bf16 v[16:31], v[220:223], v[92:95], v[16:31]
    ds_read_b128 v[88:91], v10 offset:768
    v_exp_f32 v96, v96
    v_exp_f32 v97, v97
    v_add_f32 v96, 1.0, v96
    v_add_f32 v97, 1.0, v97
    v_rcp_f32 v96, v96
    s_waitcnt lgkmcnt(3)
    v_mfma_f32_32x32x16_bf16 v[16:31], v[224:227], v[64:67], v[16:31]
    ds_read_b128 v[92:95], v11 offset:768
    v_rcp_f32 v97, v97
    v_mul_f32 v44, v44, v96
    v_mul_f32 v45, v45, v97
    v_cvt_pk_bf16_f32 v110, v44, v45
    v_mul_f32 v98, v46, v46
    v_mfma_f32_32x32x16_bf16 v[16:31], v[228:231], v[68:71], v[16:31]
    v_mul_f32 v99, v47, v47
    v_fma_f32 v98, v98, v12, v13
    v_fma_f32 v99, v99, v12, v13
    v_mul_f32 v98, v98, v46
    v_mul_f32 v99, v99, v47
    s_waitcnt vmcnt(1)
    s_barrier
    ds_read_b128 v[64:67], v4 offset:32768
    v_mfma_f32_32x32x16_bf16 v[16:31], v[232:235], v[72:75], v[16:31]
    v_exp_f32 v98, v98
    v_exp_f32 v99, v99
    v_add_f32 v98, 1.0, v98
    v_add_f32 v99, 1.0, v99
    v_rcp_f32 v98, v98
    ds_read_b128 v[68:71], v5 offset:32768
    v_mfma_f32_32x32x16_bf16 v[16:31], v[236:239], v[76:79], v[16:31]
    v_rcp_f32 v99, v99
    v_mul_f32 v46, v46, v98
    v_mul_f32 v47, v47, v99
    v_cvt_pk_bf16_f32 v111, v46, v47
    buffer_store_dwordx4 v[108:111], v2, s[44:47], s74 offen offset:1024 sc1
    ds_read_b128 v[72:75], v6 offset:32768
    s_waitcnt lgkmcnt(3)
    v_mfma_f32_32x32x16_bf16 v[16:31], v[240:243], v[80:83], v[16:31]
    ds_read_b128 v[76:79], v7 offset:32768
    v_mfma_f32_32x32x16_bf16 v[16:31], v[244:247], v[84:87], v[16:31]
    ds_read_b128 v[80:83], v8 offset:32768
    v_mfma_f32_32x32x16_bf16 v[16:31], v[248:251], v[88:91], v[16:31]
    ds_read_b128 v[84:87], v9 offset:32768
    v_mfma_f32_32x32x16_bf16 v[16:31], v[252:255], v[92:95], v[16:31]
    ds_read_b128 v[88:91], v10 offset:32768
    s_waitcnt lgkmcnt(3)
    v_mfma_f32_32x32x16_bf16 v[32:47], v[128:131], v[64:67], v[48:63]
    ds_read_b128 v[92:95], v11 offset:32768
    v_mfma_f32_32x32x16_bf16 v[32:47], v[132:135], v[68:71], v[32:47]
    ds_read_b128 v[64:67], v4 offset:33024
    v_mfma_f32_32x32x16_bf16 v[32:47], v[136:139], v[72:75], v[32:47]
    ds_read_b128 v[68:71], v5 offset:33024
    s_add_u32 s56, s70, 16384
    buffer_store_dword v3, off, s[44:47], s56
    v_mfma_f32_32x32x16_bf16 v[32:47], v[140:143], v[76:79], v[32:47]
    ds_read_b128 v[72:75], v6 offset:33024
    s_waitcnt lgkmcnt(3)
    v_mfma_f32_32x32x16_bf16 v[32:47], v[144:147], v[80:83], v[32:47]
    ds_read_b128 v[76:79], v7 offset:33024
    s_add_u32 s74, s71, 229376
    v_mul_f32 v96, v16, v16
    v_mul_f32 v97, v17, v17
    v_fma_f32 v96, v96, v12, v13
    v_fma_f32 v97, v97, v12, v13
    v_mul_f32 v96, v96, v16
    v_mfma_f32_32x32x16_bf16 v[32:47], v[148:151], v[84:87], v[32:47]
    ds_read_b128 v[80:83], v8 offset:33024
    v_mul_f32 v97, v97, v17
    v_exp_f32 v96, v96
    v_exp_f32 v97, v97
    v_add_f32 v96, 1.0, v96
    v_add_f32 v97, 1.0, v97
    v_mfma_f32_32x32x16_bf16 v[32:47], v[152:155], v[88:91], v[32:47]
    ds_read_b128 v[84:87], v9 offset:33024
    v_rcp_f32 v96, v96
    v_rcp_f32 v97, v97
    v_mul_f32 v16, v16, v96
    v_mul_f32 v17, v17, v97
    v_cvt_pk_bf16_f32 v104, v16, v17
    v_mfma_f32_32x32x16_bf16 v[32:47], v[156:159], v[92:95], v[32:47]
    ds_read_b128 v[88:91], v10 offset:33024
    v_mul_f32 v98, v18, v18
    v_mul_f32 v99, v19, v19
    v_fma_f32 v98, v98, v12, v13
    v_fma_f32 v99, v99, v12, v13
    v_mul_f32 v98, v98, v18
    s_waitcnt lgkmcnt(3)
    v_mfma_f32_32x32x16_bf16 v[32:47], v[160:163], v[64:67], v[32:47]
    ds_read_b128 v[92:95], v11 offset:33024
    v_mul_f32 v99, v99, v19
    v_exp_f32 v98, v98
    v_exp_f32 v99, v99
    v_add_f32 v98, 1.0, v98
    v_add_f32 v99, 1.0, v99
    v_mfma_f32_32x32x16_bf16 v[32:47], v[164:167], v[68:71], v[32:47]
    ds_read_b128 v[64:67], v4 offset:33280
    v_rcp_f32 v98, v98
    v_rcp_f32 v99, v99
    v_mul_f32 v18, v18, v98
    v_mul_f32 v19, v19, v99
    v_cvt_pk_bf16_f32 v105, v18, v19
    v_mfma_f32_32x32x16_bf16 v[32:47], v[168:171], v[72:75], v[32:47]
    ds_read_b128 v[68:71], v5 offset:33280
    v_mul_f32 v96, v20, v20
    v_mul_f32 v97, v21, v21
    v_fma_f32 v96, v96, v12, v13
    v_fma_f32 v97, v97, v12, v13
    v_mul_f32 v96, v96, v20
    v_mfma_f32_32x32x16_bf16 v[32:47], v[172:175], v[76:79], v[32:47]
    ds_read_b128 v[72:75], v6 offset:33280
    v_mul_f32 v97, v97, v21
    v_exp_f32 v96, v96
    v_exp_f32 v97, v97
    v_add_f32 v96, 1.0, v96
    v_add_f32 v97, 1.0, v97
    s_waitcnt lgkmcnt(3)
    v_mfma_f32_32x32x16_bf16 v[32:47], v[176:179], v[80:83], v[32:47]
    ds_read_b128 v[76:79], v7 offset:33280
    v_rcp_f32 v96, v96
    v_rcp_f32 v97, v97
    v_mul_f32 v20, v20, v96
    v_mul_f32 v21, v21, v97
    v_cvt_pk_bf16_f32 v106, v20, v21
    v_mul_f32 v98, v22, v22
    v_mfma_f32_32x32x16_bf16 v[32:47], v[180:183], v[84:87], v[32:47]
    ds_read_b128 v[80:83], v8 offset:33280
    v_mul_f32 v99, v23, v23
    v_fma_f32 v98, v98, v12, v13
    v_fma_f32 v99, v99, v12, v13
    v_mul_f32 v98, v98, v22
    v_mul_f32 v99, v99, v23
    v_mfma_f32_32x32x16_bf16 v[32:47], v[184:187], v[88:91], v[32:47]
    ds_read_b128 v[84:87], v9 offset:33280
    v_exp_f32 v98, v98
    v_exp_f32 v99, v99
    v_add_f32 v98, 1.0, v98
    v_add_f32 v99, 1.0, v99
    v_rcp_f32 v98, v98
    v_mfma_f32_32x32x16_bf16 v[32:47], v[188:191], v[92:95], v[32:47]
    ds_read_b128 v[88:91], v10 offset:33280
    v_rcp_f32 v99, v99
    v_mul_f32 v22, v22, v98
    v_mul_f32 v23, v23, v99
    v_cvt_pk_bf16_f32 v107, v22, v23
    buffer_store_dwordx4 v[104:107], v2, s[44:47], s74 offen sc1
    s_waitcnt lgkmcnt(3)
    v_mfma_f32_32x32x16_bf16 v[32:47], v[192:195], v[64:67], v[32:47]
    ds_read_b128 v[92:95], v11 offset:33280
    v_mul_f32 v96, v24, v24
    v_mul_f32 v97, v25, v25
    v_fma_f32 v96, v96, v12, v13
    v_fma_f32 v97, v97, v12, v13
    v_mul_f32 v96, v96, v24
    v_mfma_f32_32x32x16_bf16 v[32:47], v[196:199], v[68:71], v[32:47]
    ds_read_b128 v[64:67], v4 offset:33536
    v_mul_f32 v97, v97, v25
    v_exp_f32 v96, v96
    v_exp_f32 v97, v97
    v_add_f32 v96, 1.0, v96
    v_add_f32 v97, 1.0, v97
    v_mfma_f32_32x32x16_bf16 v[32:47], v[200:203], v[72:75], v[32:47]
    ds_read_b128 v[68:71], v5 offset:33536
    v_rcp_f32 v96, v96
    v_rcp_f32 v97, v97
    v_mul_f32 v24, v24, v96
    v_mul_f32 v25, v25, v97
    v_cvt_pk_bf16_f32 v108, v24, v25
    v_mfma_f32_32x32x16_bf16 v[32:47], v[204:207], v[76:79], v[32:47]
    ds_read_b128 v[72:75], v6 offset:33536
    v_mul_f32 v98, v26, v26
    v_mul_f32 v99, v27, v27
    v_fma_f32 v98, v98, v12, v13
    v_fma_f32 v99, v99, v12, v13
    v_mul_f32 v98, v98, v26
    s_waitcnt lgkmcnt(3)
    v_mfma_f32_32x32x16_bf16 v[32:47], v[208:211], v[80:83], v[32:47]
    ds_read_b128 v[76:79], v7 offset:33536
    v_mul_f32 v99, v99, v27
    v_exp_f32 v98, v98
    v_exp_f32 v99, v99
    v_add_f32 v98, 1.0, v98
    v_add_f32 v99, 1.0, v99
    v_rcp_f32 v98, v98
    v_mfma_f32_32x32x16_bf16 v[32:47], v[212:215], v[84:87], v[32:47]
    ds_read_b128 v[80:83], v8 offset:33536
    v_rcp_f32 v99, v99
    v_mul_f32 v26, v26, v98
    v_mul_f32 v27, v27, v99
    v_cvt_pk_bf16_f32 v109, v26, v27
    v_mul_f32 v96, v28, v28
    v_mfma_f32_32x32x16_bf16 v[32:47], v[216:219], v[88:91], v[32:47]
    ds_read_b128 v[84:87], v9 offset:33536
    v_mul_f32 v97, v29, v29
    v_fma_f32 v96, v96, v12, v13
    v_fma_f32 v97, v97, v12, v13
    v_mul_f32 v96, v96, v28
    v_mul_f32 v97, v97, v29
    v_mfma_f32_32x32x16_bf16 v[32:47], v[220:223], v[92:95], v[32:47]
    ds_read_b128 v[88:91], v10 offset:33536
    v_exp_f32 v96, v96
    v_exp_f32 v97, v97
    v_add_f32 v96, 1.0, v96
    v_add_f32 v97, 1.0, v97
    v_rcp_f32 v96, v96
    s_waitcnt lgkmcnt(3)
    v_mfma_f32_32x32x16_bf16 v[32:47], v[224:227], v[64:67], v[32:47]
    ds_read_b128 v[92:95], v11 offset:33536
    v_rcp_f32 v97, v97
    v_mul_f32 v28, v28, v96
    v_mul_f32 v29, v29, v97
    v_cvt_pk_bf16_f32 v110, v28, v29
    v_mul_f32 v98, v30, v30
    v_mfma_f32_32x32x16_bf16 v[32:47], v[228:231], v[68:71], v[32:47]
    v_mul_f32 v99, v31, v31
    v_fma_f32 v98, v98, v12, v13
    v_fma_f32 v99, v99, v12, v13
    v_mul_f32 v98, v98, v30
    v_mul_f32 v99, v99, v31
    v_mfma_f32_32x32x16_bf16 v[32:47], v[232:235], v[72:75], v[32:47]
    v_exp_f32 v98, v98
    v_exp_f32 v99, v99
    v_add_f32 v98, 1.0, v98
    v_add_f32 v99, 1.0, v99
    v_rcp_f32 v98, v98
    v_mfma_f32_32x32x16_bf16 v[32:47], v[236:239], v[76:79], v[32:47]
    v_rcp_f32 v99, v99
    v_mul_f32 v30, v30, v98
    v_mul_f32 v31, v31, v99
    v_cvt_pk_bf16_f32 v111, v30, v31
    buffer_store_dwordx4 v[108:111], v2, s[44:47], s74 offen offset:1024 sc1
    s_waitcnt lgkmcnt(0)
    v_mfma_f32_32x32x16_bf16 v[32:47], v[240:243], v[80:83], v[32:47]
    s_waitcnt vmcnt(3)
    s_add_u32 s56, s70, 16640
    buffer_store_dword v3, off, s[44:47], s56
    v_mfma_f32_32x32x16_bf16 v[32:47], v[244:247], v[84:87], v[32:47]
    v_add_u32 v100, 16384, v119
    v_add_u32 v101, 512, v100
    buffer_load_dword v102, v100, s[44:47], 0 offen sc1
    v_mfma_f32_32x32x16_bf16 v[32:47], v[248:251], v[88:91], v[32:47]
    v_mfma_f32_32x32x16_bf16 v[32:47], v[252:255], v[92:95], v[32:47]
    v_subrev_u32 v4, 0x10000, v4
    v_subrev_u32 v5, 0x10000, v5
    v_subrev_u32 v6, 0x10000, v6
    v_subrev_u32 v7, 0x10000, v7
    v_subrev_u32 v8, 0x10000, v8
    v_subrev_u32 v9, 0x10000, v9
    v_subrev_u32 v10, 0x10000, v10
    v_subrev_u32 v11, 0x10000, v11
    v_mov_b32 v124, v100
    v_mov_b32 v125, v101
    s_waitcnt vmcnt(0)
    v_cmp_ne_u32 vcc, s51, v102
    s_cbranch_vccz L_pcd_40
    s_mov_b32 s53, 0
L_pc_39:
    buffer_load_dword v102, v100, s[44:47], 0 offen sc1
    s_waitcnt vmcnt(0)
    v_cmp_ne_u32 vcc, s51, v102
    s_cbranch_vccz L_pcd_40
    s_add_u32 s53, s53, 1
    s_cmp_lg_u32 s52, 0
    s_cbranch_scc1 L_pcd_40
    s_cmp_lt_u32 s53, 0x8000
    s_cbranch_scc1 L_pc_39
    s_mov_b32 s52, 1
L_pcd_40:
    s_add_u32 s54, s69, 0
    buffer_load_dwordx4 v[64:67], v2, s[44:47], s54 offen sc1
    s_add_u32 s54, s69, 0
    buffer_load_dwordx4 v[68:71], v2, s[44:47], s54 offen offset:1024 sc1
    s_add_u32 s54, s69, 0
    buffer_load_dwordx4 v[72:75], v2, s[44:47], s54 offen offset:2048 sc1
    s_add_u32 s54, s69, 0
    buffer_load_dwordx4 v[76:79], v2, s[44:47], s54 offen offset:3072 sc1
    s_add_u32 s54, s69, 4096
    buffer_load_dwordx4 v[80:83], v2, s[44:47], s54 offen sc1
    s_add_u32 s54, s69, 4096
    buffer_load_dwordx4 v[84:87], v2, s[44:47], s54 offen offset:1024 sc1
    s_add_u32 s54, s69, 4096
    buffer_load_dwordx4 v[88:91], v2, s[44:47], s54 offen offset:2048 sc1
    s_add_u32 s54, s69, 4096
    buffer_load_dwordx4 v[92:95], v2, s[44:47], s54 offen offset:3072 sc1
    s_add_u32 s54, s69, 8192
    buffer_load_dwordx4 v[96:99], v2, s[44:47], s54 offen sc1
    s_add_u32 s54, s69, 8192
    buffer_load_dwordx4 v[100:103], v2, s[44:47], s54 offen offset:1024 sc1
    s_add_u32 s54, s69, 8192
    buffer_load_dwordx4 v[104:107], v2, s[44:47], s54 offen offset:2048 sc1
    s_add_u32 s54, s69, 8192
    buffer_load_dwordx4 v[108:111], v2, s[44:47], s54 offen offset:3072 sc1
    s_nop 1
    s_add_u32 s74, s71, 344064
    v_pk_mul_f32 v[60:61], v[32:33], v[32:33]
    v_pk_mul_f32 v[62:63], v[34:35], v[34:35]
    v_pk_fma_f32 v[60:61], v[60:61], v[12:13], v[12:13] op_sel:[0,0,1] op_sel_hi:[1,0,1]
    v_pk_fma_f32 v[62:63], v[62:63], v[12:13], v[12:13] op_sel:[0,0,1] op_sel_hi:[1,0,1]
    v_pk_mul_f32 v[60:61], v[60:61], v[32:33]
    v_pk_mul_f32 v[62:63], v[62:63], v[34:35]
    v_exp_f32 v60, v60
    v_exp_f32 v62, v62
    v_exp_f32 v61, v61
    v_exp_f32 v63, v63
    v_pk_add_f32 v[60:61], v[60:61], v[14:15]
    v_pk_add_f32 v[62:63], v[62:63], v[14:15]
    v_rcp_f32 v60, v60
    v_rcp_f32 v62, v62
    v_rcp_f32 v61, v61
    v_rcp_f32 v63, v63
    v_pk_mul_f32 v[32:33], v[32:33], v[60:61]
    v_pk_mul_f32 v[34:35], v[34:35], v[62:63]
    v_cvt_pk_bf16_f32 v48, v32, v33
    v_cvt_pk_bf16_f32 v49, v34, v35
    v_pk_mul_f32 v[60:61], v[36:37], v[36:37]
    v_pk_mul_f32 v[62:63], v[38:39], v[38:39]
    v_pk_fma_f32 v[60:61], v[60:61], v[12:13], v[12:13] op_sel:[0,0,1] op_sel_hi:[1,0,1]
    v_pk_fma_f32 v[62:63], v[62:63], v[12:13], v[12:13] op_sel:[0,0,1] op_sel_hi:[1,0,1]
    v_pk_mul_f32 v[60:61], v[60:61], v[36:37]
    v_pk_mul_f32 v[62:63], v[62:63], v[38:39]
    v_exp_f32 v60, v60
    v_exp_f32 v62, v62
    v_exp_f32 v61, v61
    v_exp_f32 v63, v63
    v_pk_add_f32 v[60:61], v[60:61], v[14:15]
    v_pk_add_f32 v[62:63], v[62:63], v[14:15]
    v_rcp_f32 v60, v60
    v_rcp_f32 v62, v62
    v_rcp_f32 v61, v61
    v_rcp_f32 v63, v63
    v_pk_mul_f32 v[36:37], v[36:37], v[60:61]
    v_pk_mul_f32 v[38:39], v[38:39], v[62:63]
    v_cvt_pk_bf16_f32 v50, v36, v37
    v_cvt_pk_bf16_f32 v51, v38, v39
    s_add_u32 s56, s70, 16896
    buffer_store_dword v3, off, s[44:47], s56
    buffer_store_dwordx4 v[48:51], v2, s[44:47], s74 offen sc1
    v_pk_mul_f32 v[60:61], v[40:41], v[40:41]
    v_pk_mul_f32 v[62:63], v[42:43], v[42:43]
    v_pk_fma_f32 v[60:61], v[60:61], v[12:13], v[12:13] op_sel:[0,0,1] op_sel_hi:[1,0,1]
    v_pk_fma_f32 v[62:63], v[62:63], v[12:13], v[12:13] op_sel:[0,0,1] op_sel_hi:[1,0,1]
    v_pk_mul_f32 v[60:61], v[60:61], v[40:41]
    v_pk_mul_f32 v[62:63], v[62:63], v[42:43]
    v_exp_f32 v60, v60
    v_exp_f32 v62, v62
    v_exp_f32 v61, v61
    v_exp_f32 v63, v63
    v_pk_add_f32 v[60:61], v[60:61], v[14:15]
    v_pk_add_f32 v[62:63], v[62:63], v[14:15]
    v_rcp_f32 v60, v60
    v_rcp_f32 v62, v62
    v_rcp_f32 v61, v61
    v_rcp_f32 v63, v63
    v_pk_mul_f32 v[40:41], v[40:41], v[60:61]
    v_pk_mul_f32 v[42:43], v[42:43], v[62:63]
    v_cvt_pk_bf16_f32 v52, v40, v41
    v_cvt_pk_bf16_f32 v53, v42, v43
    v_pk_mul_f32 v[60:61], v[44:45], v[44:45]
    v_pk_mul_f32 v[62:63], v[46:47], v[46:47]
    v_pk_fma_f32 v[60:61], v[60:61], v[12:13], v[12:13] op_sel:[0,0,1] op_sel_hi:[1,0,1]
    v_pk_fma_f32 v[62:63], v[62:63], v[12:13], v[12:13] op_sel:[0,0,1] op_sel_hi:[1,0,1]
    v_pk_mul_f32 v[60:61], v[60:61], v[44:45]
    v_pk_mul_f32 v[62:63], v[62:63], v[46:47]
    v_exp_f32 v60, v60
    v_exp_f32 v62, v62
    v_exp_f32 v61, v61
    v_exp_f32 v63, v63
    v_pk_add_f32 v[60:61], v[60:61], v[14:15]
    v_pk_add_f32 v[62:63], v[62:63], v[14:15]
    v_rcp_f32 v60, v60
    v_rcp_f32 v62, v62
    v_rcp_f32 v61, v61
    v_rcp_f32 v63, v63
    v_pk_mul_f32 v[44:45], v[44:45], v[60:61]
    v_pk_mul_f32 v[46:47], v[46:47], v[62:63]
    v_cvt_pk_bf16_f32 v54, v44, v45
    v_cvt_pk_bf16_f32 v55, v46, v47
    buffer_store_dwordx4 v[52:55], v2, s[44:47], s74 offen offset:1024 sc1
    s_mov_b32 s4, s36
    s_and_b32 s5, s37, 0xffff
    s_mov_b32 s6, 1024
    s_mov_b32 s7, 0x00020000
    buffer_load_dwordx4 v[56:59], v123, s[4:7], 0 offen
    s_mov_b32 s53, 13631488
    buffer_load_dwordx4 v[60:63], v112, s[44:47], s53 offen sc1
    s_mov_b32 s8, s38
    s_and_b32 s9, s39, 0xffff
    s_mov_b32 s10, 2097152
    s_mov_b32 s11, 0x00020000
    s_waitcnt vmcnt(16)
    v_mfma_f32_32x32x16_bf16 a[224:239], a[0:3], v[64:67], 0
    v_mfma_f32_32x32x16_bf16 a[240:255], a[112:115], v[64:67], 0
    s_waitcnt vmcnt(15)
    v_mfma_f32_32x32x16_bf16 a[224:239], a[4:7], v[68:71], a[224:239]
    s_add_u32 s54, s69, 12288
    buffer_load_dwordx4 v[64:67], v2, s[44:47], s54 offen sc1
    v_mfma_f32_32x32x16_bf16 a[240:255], a[116:119], v[68:71], a[240:255]
    s_waitcnt vmcnt(15)
    v_mfma_f32_32x32x16_bf16 a[224:239], a[8:11], v[72:75], a[224:239]
    s_add_u32 s54, s69, 12288
    buffer_load_dwordx4 v[68:71], v2, s[44:47], s54 offen offset:1024 sc1
    v_mfma_f32_32x32x16_bf16 a[240:255], a[120:123], v[72:75], a[240:255]
    s_waitcnt vmcnt(15)
    v_mfma_f32_32x32x16_bf16 a[224:239], a[12:15], v[76:79], a[224:239]
    s_add_u32 s54, s69, 12288
    buffer_load_dwordx4 v[72:75], v2, s[44:47], s54 offen offset:2048 sc1
    v_mfma_f32_32x32x16_bf16 a[240:255], a[124:127], v[76:79], a[240:255]
    s_waitcnt vmcnt(5)
    s_add_u32 s56, s70, 17152
    buffer_store_dword v3, off, s[44:47], s56
    v_mfma_f32_32x32x16_bf16 a[224:239], a[16:19], v[80:83], a[224:239]
    s_add_u32 s54, s69, 12288
    buffer_load_dwordx4 v[76:79], v2, s[44:47], s54 offen offset:3072 sc1
    v_mfma_f32_32x32x16_bf16 a[240:255], a[128:131], v[80:83], a[240:255]
    v_mfma_f32_32x32x16_bf16 a[224:239], a[20:23], v[84:87], a[224:239]
    s_add_u32 s54, s69, 16384
    buffer_load_dwordx4 v[80:83], v2, s[44:47], s54 offen sc1
    v_mfma_f32_32x32x16_bf16 a[240:255], a[132:135], v[84:87], a[240:255]
    v_mfma_f32_32x32x16_bf16 a[224:239], a[24:27], v[88:91], a[224:239]
    s_add_u32 s54, s69, 16384
    buffer_load_dwordx4 v[84:87], v2, s[44:47], s54 offen offset:1024 sc1
    v_mfma_f32_32x32x16_bf16 a[240:255], a[136:139], v[88:91], a[240:255]
    v_mfma_f32_32x32x16_bf16 a[224:239], a[28:31], v[92:95], a[224:239]
    s_add_u32 s54, s69, 16384
    buffer_load_dwordx4 v[88:91], v2, s[44:47], s54 offen offset:2048 sc1
    v_mfma_f32_32x32x16_bf16 a[240:255], a[140:143], v[92:95], a[240:255]
    v_mfma_f32_32x32x16_bf16 a[224:239], a[32:35], v[96:99], a[224:239]
    s_add_u32 s54, s69, 16384
    buffer_load_dwordx4 v[92:95], v2, s[44:47], s54 offen offset:3072 sc1
    v_mfma_f32_32x32x16_bf16 a[240:255], a[144:147], v[96:99], a[240:255]
    v_mfma_f32_32x32x16_bf16 a[224:239], a[36:39], v[100:103], a[224:239]
    s_add_u32 s54, s69, 20480
    buffer_load_dwordx4 v[96:99], v2, s[44:47], s54 offen sc1
    v_mfma_f32_32x32x16_bf16 a[240:255], a[148:151], v[100:103], a[240:255]
    v_mfma_f32_32x32x16_bf16 a[224:239], a[40:43], v[104:107], a[224:239]
    s_add_u32 s54, s69, 20480
    buffer_load_dwordx4 v[100:103], v2, s[44:47], s54 offen offset:1024 sc1
    v_mfma_f32_32x32x16_bf16 a[240:255], a[152:155], v[104:107], a[240:255]
    buffer_load_dword v126, v125, s[44:47], 0 offen sc1
    v_mfma_f32_32x32x16_bf16 a[224:239], a[44:47], v[108:111], a[224:239]
    s_add_u32 s54, s69, 20480
    buffer_load_dwordx4 v[104:107], v2, s[44:47], s54 offen offset:2048 sc1
    v_mfma_f32_32x32x16_bf16 a[240:255], a[156:159], v[108:111], a[240:255]
    s_waitcnt vmcnt(12)
    v_mfma_f32_32x32x16_bf16 a[224:239], a[48:51], v[64:67], a[224:239]
    s_add_u32 s54, s69, 20480
    buffer_load_dwordx4 v[108:111], v2, s[44:47], s54 offen offset:3072 sc1
    v_mfma_f32_32x32x16_bf16 a[240:255], a[160:163], v[64:67], a[240:255]
    s_waitcnt vmcnt(12)
    v_mfma_f32_32x32x16_bf16 a[224:239], a[52:55], v[68:71], a[224:239]
    s_add_u32 s54, s69, 24576
    buffer_load_dwordx4 v[64:67], v2, s[44:47], s54 offen sc1
    v_mfma_f32_32x32x16_bf16 a[240:255], a[164:167], v[68:71], a[240:255]
    s_waitcnt vmcnt(12)
    v_mfma_f32_32x32x16_bf16 a[224:239], a[56:59], v[72:75], a[224:239]
    s_add_u32 s54, s69, 24576
    buffer_load_dwordx4 v[68:71], v2, s[44:47], s54 offen offset:1024 sc1
    v_mfma_f32_32x32x16_bf16 a[240:255], a[168:171], v[72:75], a[240:255]
    s_waitcnt vmcnt(11)
    v_mfma_f32_32x32x16_bf16 a[224:239], a[60:63], v[76:79], a[224:239]
    s_add_u32 s54, s69, 24576
    buffer_load_dwordx4 v[72:75], v2, s[44:47], s54 offen offset:2048 sc1
    v_mfma_f32_32x32x16_bf16 a[240:255], a[172:175], v[76:79], a[240:255]
    s_waitcnt vmcnt(5)
    v_cmp_ne_u32 vcc, s51, v126
    s_cbranch_vccz L_pcd_42
    s_mov_b32 s53, 0
L_pc_41:
    buffer_load_dword v126, v125, s[44:47], 0 offen sc1
    s_waitcnt vmcnt(0)
    v_cmp_ne_u32 vcc, s51, v126
    s_cbranch_vccz L_pcd_42
    s_add_u32 s53, s53, 1
    s_cmp_lg_u32 s52, 0
    s_cbranch_scc1 L_pcd_42
    s_cmp_lt_u32 s53, 0x8000
    s_cbranch_scc1 L_pc_41
    s_mov_b32 s52, 1
L_pcd_42:
    v_mfma_f32_32x32x16_bf16 a[224:239], a[64:67], v[80:83], a[224:239]
    s_add_u32 s54, s69, 24576
    buffer_load_dwordx4 v[76:79], v2, s[44:47], s54 offen offset:3072 sc1
    v_mfma_f32_32x32x16_bf16 a[240:255], a[176:179], v[80:83], a[240:255]
    v_mfma_f32_32x32x16_bf16 a[224:239], a[68:71], v[84:87], a[224:239]
    s_add_u32 s54, s69, 229376
    buffer_load_dwordx4 v[80:83], v2, s[44:47], s54 offen sc1
    v_mfma_f32_32x32x16_bf16 a[240:255], a[180:183], v[84:87], a[240:255]
    v_mfma_f32_32x32x16_bf16 a[224:239], a[72:75], v[88:91], a[224:239]
    s_add_u32 s54, s69, 229376
    buffer_load_dwordx4 v[84:87], v2, s[44:47], s54 offen offset:1024 sc1
    v_mfma_f32_32x32x16_bf16 a[240:255], a[184:187], v[88:91], a[240:255]
    v_mfma_f32_32x32x16_bf16 a[224:239], a[76:79], v[92:95], a[224:239]
    s_add_u32 s54, s69, 229376
    buffer_load_dwordx4 v[88:91], v2, s[44:47], s54 offen offset:2048 sc1
    v_mfma_f32_32x32x16_bf16 a[240:255], a[188:191], v[92:95], a[240:255]
    v_mfma_f32_32x32x16_bf16 a[224:239], a[80:83], v[96:99], a[224:239]
    s_add_u32 s54, s69, 229376
    buffer_load_dwordx4 v[92:95], v2, s[44:47], s54 offen offset:3072 sc1
    v_mfma_f32_32x32x16_bf16 a[240:255], a[192:195], v[96:99], a[240:255]
    v_mfma_f32_32x32x16_bf16 a[224:239], a[84:87], v[100:103], a[224:239]
    s_add_u32 s54, s69, 233472
    buffer_load_dwordx4 v[96:99], v2, s[44:47], s54 offen sc1
    v_mfma_f32_32x32x16_bf16 a[240:255], a[196:199], v[100:103], a[240:255]
    s_waitcnt vmcnt(10)
    v_mfma_f32_32x32x16_bf16 a[224:239], a[88:91], v[104:107], a[224:239]
    s_add_u32 s54, s69, 233472
    buffer_load_dwordx4 v[100:103], v2, s[44:47], s54 offen offset:1024 sc1
    v_mfma_f32_32x32x16_bf16 a[240:255], a[200:203], v[104:107], a[240:255]
    s_waitcnt vmcnt(10)
    v_mfma_f32_32x32x16_bf16 a[224:239], a[92:95], v[108:111], a[224:239]
    s_add_u32 s54, s69, 233472
    buffer_load_dwordx4 v[104:107], v2, s[44:47], s54 offen offset:2048 sc1
    v_mfma_f32_32x32x16_bf16 a[240:255], a[204:207], v[108:111], a[240:255]
    s_waitcnt vmcnt(10)
    v_mfma_f32_32x32x16_bf16 a[224:239], a[96:99], v[64:67], a[224:239]
    s_add_u32 s54, s69, 233472
    buffer_load_dwordx4 v[108:111], v2, s[44:47], s54 offen offset:3072 sc1
    v_mfma_f32_32x32x16_bf16 a[240:255], a[208:211], v[64:67], a[240:255]
    s_waitcnt vmcnt(10)
    v_mfma_f32_32x32x16_bf16 a[224:239], a[100:103], v[68:71], a[224:239]
    s_add_u32 s54, s69, 237568
    buffer_load_dwordx4 v[64:67], v2, s[44:47], s54 offen sc1
    v_mfma_f32_32x32x16_bf16 a[240:255], a[212:215], v[68:71], a[240:255]
    s_waitcnt vmcnt(10)
    v_mfma_f32_32x32x16_bf16 a[224:239], a[104:107], v[72:75], a[224:239]
    s_add_u32 s54, s69, 237568
    buffer_load_dwordx4 v[68:71], v2, s[44:47], s54 offen offset:1024 sc1
    v_mfma_f32_32x32x16_bf16 a[240:255], a[216:219], v[72:75], a[240:255]
    s_waitcnt vmcnt(10)
    v_mfma_f32_32x32x16_bf16 a[224:239], a[108:111], v[76:79], a[224:239]
    s_add_u32 s54, s69, 237568
    buffer_load_dwordx4 v[72:75], v2, s[44:47], s54 offen offset:2048 sc1
    v_mfma_f32_32x32x16_bf16 a[240:255], a[220:223], v[76:79], a[240:255]
    s_waitcnt vmcnt(10)
    v_mfma_f32_32x32x16_bf16 v[16:31], a[0:3], v[80:83], 0
    s_add_u32 s54, s69, 237568
    buffer_load_dwordx4 v[76:79], v2, s[44:47], s54 offen offset:3072 sc1
    v_mfma_f32_32x32x16_bf16 v[32:47], a[112:115], v[80:83], 0
    s_waitcnt vmcnt(10)
    v_mfma_f32_32x32x16_bf16 v[16:31], a[4:7], v[84:87], v[16:31]
    s_add_u32 s54, s69, 241664
    buffer_load_dwordx4 v[80:83], v2, s[44:47], s54 offen sc1
    v_mfma_f32_32x32x16_bf16 v[32:47], a[116:119], v[84:87], v[32:47]
    s_waitcnt vmcnt(10)
    v_mfma_f32_32x32x16_bf16 v[16:31], a[8:11], v[88:91], v[16:31]
    s_add_u32 s54, s69, 241664
    buffer_load_dwordx4 v[84:87], v2, s[44:47], s54 offen offset:1024 sc1
    v_mfma_f32_32x32x16_bf16 v[32:47], a[120:123], v[88:91], v[32:47]
    ds_write_b128 v115, a[224:227] offset:0
    ds_write_b128 v116, a[228:231] offset:0
    s_waitcnt vmcnt(10)
    v_mfma_f32_32x32x16_bf16 v[16:31], a[12:15], v[92:95], v[16:31]
    s_add_u32 s54, s69, 241664
    buffer_load_dwordx4 v[88:91], v2, s[44:47], s54 offen offset:2048 sc1
    v_mfma_f32_32x32x16_bf16 v[32:47], a[124:127], v[92:95], v[32:47]
    ds_write_b128 v117, a[232:235] offset:0
    ds_write_b128 v118, a[236:239] offset:0
    s_waitcnt vmcnt(10)
    v_mfma_f32_32x32x16_bf16 v[16:31], a[16:19], v[96:99], v[16:31]
    s_add_u32 s54, s69, 241664
    buffer_load_dwordx4 v[92:95], v2, s[44:47], s54 offen offset:3072 sc1
    v_mfma_f32_32x32x16_bf16 v[32:47], a[128:131], v[96:99], v[32:47]
    ds_write_b128 v115, a[240:243] offset:128
    ds_write_b128 v116, a[244:247] offset:128
    s_waitcnt vmcnt(10)
    v_mfma_f32_32x32x16_bf16 v[16:31], a[20:23], v[100:103], v[16:31]
    s_add_u32 s54, s69, 245760
    buffer_load_dwordx4 v[96:99], v2, s[44:47], s54 offen sc1
    v_mfma_f32_32x32x16_bf16 v[32:47], a[132:135], v[100:103], v[32:47]
    ds_write_b128 v117, a[248:251] offset:128
    ds_write_b128 v118, a[252:255] offset:128
    s_waitcnt vmcnt(10)
    v_mfma_f32_32x32x16_bf16 v[16:31], a[24:27], v[104:107], v[16:31]
    s_add_u32 s54, s69, 245760
    buffer_load_dwordx4 v[100:103], v2, s[44:47], s54 offen offset:1024 sc1
    v_mfma_f32_32x32x16_bf16 v[32:47], a[136:139], v[104:107], v[32:47]
    s_waitcnt vmcnt(10)
    v_mfma_f32_32x32x16_bf16 v[16:31], a[28:31], v[108:111], v[16:31]
    s_add_u32 s54, s69, 245760
    buffer_load_dwordx4 v[104:107], v2, s[44:47], s54 offen offset:2048 sc1
    v_mfma_f32_32x32x16_bf16 v[32:47], a[140:143], v[108:111], v[32:47]
    s_waitcnt lgkmcnt(0)
    s_barrier
    s_waitcnt vmcnt(10)
    v_mfma_f32_32x32x16_bf16 v[16:31], a[32:35], v[64:67], v[16:31]
    s_add_u32 s54, s69, 245760
    buffer_load_dwordx4 v[108:111], v2, s[44:47], s54 offen offset:3072 sc1
    v_mfma_f32_32x32x16_bf16 v[32:47], a[144:147], v[64:67], v[32:47]
    ds_read_b128 v[48:51], v113 offset:0
    ds_read_b128 v[52:55], v113 offset:8192
    s_waitcnt lgkmcnt(0)
    v_add_f32 v48, v48, v52
    v_add_f32 v49, v49, v53
    v_add_f32 v50, v50, v54
    v_add_f32 v51, v51, v55
    ds_read_b128 v[52:55], v113 offset:16384
    s_waitcnt vmcnt(10)
    v_mfma_f32_32x32x16_bf16 v[16:31], a[36:39], v[68:71], v[16:31]
    s_add_u32 s54, s69, 249856
    buffer_load_dwordx4 v[64:67], v2, s[44:47], s54 offen sc1
    v_mfma_f32_32x32x16_bf16 v[32:47], a[148:151], v[68:71], v[32:47]
    s_waitcnt lgkmcnt(0)
    v_add_f32 v48, v48, v52
    v_add_f32 v49, v49, v53
    v_add_f32 v50, v50, v54
    v_add_f32 v51, v51, v55
    ds_read_b128 v[52:55], v113 offset:24576
    s_waitcnt vmcnt(10)
    v_mfma_f32_32x32x16_bf16 v[16:31], a[40:43], v[72:75], v[16:31]
    s_add_u32 s54, s69, 249856
    buffer_load_dwordx4 v[68:71], v2, s[44:47], s54 offen offset:1024 sc1
    v_mfma_f32_32x32x16_bf16 v[32:47], a[152:155], v[72:75], v[32:47]
    s_waitcnt lgkmcnt(0)
    v_add_f32 v48, v48, v52
    v_add_f32 v49, v49, v53
    v_add_f32 v50, v50, v54
    v_add_f32 v51, v51, v55
    v_lshlrev_b32 v52, 16, v56
    v_and_b32 v53, 0xffff0000, v56
    v_lshlrev_b32 v54, 16, v57
    v_and_b32 v55, 0xffff0000, v57
    v_add_f32 v48, v48, v52
    v_add_f32 v49, v49, v53
    v_add_f32 v50, v50, v54
    v_add_f32 v51, v51, v55
    s_waitcnt vmcnt(10)
    v_mfma_f32_32x32x16_bf16 v[16:31], a[44:47], v[76:79], v[16:31]
    s_add_u32 s54, s69, 249856
    buffer_load_dwordx4 v[72:75], v2, s[44:47], s54 offen offset:2048 sc1
    v_mfma_f32_32x32x16_bf16 v[32:47], a[156:159], v[76:79], v[32:47]
    v_cvt_pk_bf16_f32 v52, v48, v49
    v_cvt_pk_bf16_f32 v53, v50, v51
    v_lshlrev_b32 v48, 16, v52
    v_and_b32 v49, 0xffff0000, v52
    v_lshlrev_b32 v50, 16, v53
    v_and_b32 v51, 0xffff0000, v53
    s_waitcnt vmcnt(10)
    v_mfma_f32_32x32x16_bf16 v[16:31], a[48:51], v[80:83], v[16:31]
    s_add_u32 s54, s69, 249856
    buffer_load_dwordx4 v[76:79], v2, s[44:47], s54 offen offset:3072 sc1
    v_mfma_f32_32x32x16_bf16 v[32:47], a[160:163], v[80:83], v[32:47]
    v_lshlrev_b32 v52, 16, v60
    v_and_b32 v53, 0xffff0000, v60
    v_lshlrev_b32 v54, 16, v61
    v_and_b32 v55, 0xffff0000, v61
    v_add_f32 v48, v48, v52
    v_add_f32 v49, v49, v53
    v_add_f32 v50, v50, v54
    v_add_f32 v51, v51, v55
    v_cvt_pk_bf16_f32 v12, v48, v49
    v_cvt_pk_bf16_f32 v13, v50, v51
    s_waitcnt vmcnt(10)
    v_mfma_f32_32x32x16_bf16 v[16:31], a[52:55], v[84:87], v[16:31]
    s_add_u32 s54, s69, 253952
    buffer_load_dwordx4 v[80:83], v2, s[44:47], s54 offen sc1
    v_mfma_f32_32x32x16_bf16 v[32:47], a[164:167], v[84:87], v[32:47]
    ds_read_b128 v[48:51], v114 offset:0
    ds_read_b128 v[52:55], v114 offset:8192
    s_waitcnt vmcnt(10)
    v_mfma_f32_32x32x16_bf16 v[16:31], a[56:59], v[88:91], v[16:31]
    s_add_u32 s54, s69, 253952
    buffer_load_dwordx4 v[84:87], v2, s[44:47], s54 offen offset:1024 sc1
    v_mfma_f32_32x32x16_bf16 v[32:47], a[168:171], v[88:91], v[32:47]
    s_waitcnt lgkmcnt(0)
    v_add_f32 v48, v48, v52
    v_add_f32 v49, v49, v53
    v_add_f32 v50, v50, v54
    v_add_f32 v51, v51, v55
    ds_read_b128 v[52:55], v114 offset:16384
    s_waitcnt lgkmcnt(0)
    v_add_f32 v48, v48, v52
    v_add_f32 v49, v49, v53
    v_add_f32 v50, v50, v54
    v_add_f32 v51, v51, v55
    ds_read_b128 v[52:55], v114 offset:24576
    s_waitcnt vmcnt(10)
    v_mfma_f32_32x32x16_bf16 v[16:31], a[60:63], v[92:95], v[16:31]
    s_add_u32 s54, s69, 253952
    buffer_load_dwordx4 v[88:91], v2, s[44:47], s54 offen offset:2048 sc1
    v_mfma_f32_32x32x16_bf16 v[32:47], a[172:175], v[92:95], v[32:47]
    s_waitcnt lgkmcnt(0)
    v_add_f32 v48, v48, v52
    v_add_f32 v49, v49, v53
    v_add_f32 v50, v50, v54
    v_add_f32 v51, v51, v55
    s_waitcnt vmcnt(10)
    v_mfma_f32_32x32x16_bf16 v[16:31], a[64:67], v[96:99], v[16:31]
    s_add_u32 s54, s69, 253952
    buffer_load_dwordx4 v[92:95], v2, s[44:47], s54 offen offset:3072 sc1
    v_mfma_f32_32x32x16_bf16 v[32:47], a[176:179], v[96:99], v[32:47]
    v_lshlrev_b32 v52, 16, v58
    v_and_b32 v53, 0xffff0000, v58
    v_lshlrev_b32 v54, 16, v59
    v_and_b32 v55, 0xffff0000, v59
    v_add_f32 v48, v48, v52
    v_add_f32 v49, v49, v53
    v_add_f32 v50, v50, v54
    v_add_f32 v51, v51, v55
    v_cvt_pk_bf16_f32 v52, v48, v49
    v_cvt_pk_bf16_f32 v53, v50, v51
    v_lshlrev_b32 v48, 16, v52
    v_and_b32 v49, 0xffff0000, v52
    v_lshlrev_b32 v50, 16, v53
    v_and_b32 v51, 0xffff0000, v53
    s_waitcnt vmcnt(10)
    v_mfma_f32_32x32x16_bf16 v[16:31], a[68:71], v[100:103], v[16:31]
    v_mfma_f32_32x32x16_bf16 v[32:47], a[180:183], v[100:103], v[32:47]
    v_lshlrev_b32 v52, 16, v62
    v_and_b32 v53, 0xffff0000, v62
    v_lshlrev_b32 v54, 16, v63
    v_and_b32 v55, 0xffff0000, v63
    v_add_f32 v48, v48, v52
    v_add_f32 v49, v49, v53
    v_add_f32 v50, v50, v54
    v_add_f32 v51, v51, v55
    s_waitcnt vmcnt(9)
    v_mfma_f32_32x32x16_bf16 v[16:31], a[72:75], v[104:107], v[16:31]
    v_mfma_f32_32x32x16_bf16 v[32:47], a[184:187], v[104:107], v[32:47]
    v_cvt_pk_bf16_f32 v14, v48, v49
    v_cvt_pk_bf16_f32 v15, v50, v51
    s_mov_b32 s53, 0
    buffer_store_dwordx4 v[12:15], v112, s[8:11], s53 offen sc1
    s_waitcnt vmcnt(9)
    v_mfma_f32_32x32x16_bf16 v[16:31], a[76:79], v[108:111], v[16:31]
    v_mfma_f32_32x32x16_bf16 v[32:47], a[188:191], v[108:111], v[32:47]
    s_waitcnt vmcnt(8)
    v_mfma_f32_32x32x16_bf16 v[16:31], a[80:83], v[64:67], v[16:31]
    v_mfma_f32_32x32x16_bf16 v[32:47], a[192:195], v[64:67], v[32:47]
    s_waitcnt vmcnt(7)
    v_mfma_f32_32x32x16_bf16 v[16:31], a[84:87], v[68:71], v[16:31]
    v_mfma_f32_32x32x16_bf16 v[32:47], a[196:199], v[68:71], v[32:47]
    s_waitcnt vmcnt(6)
    v_mfma_f32_32x32x16_bf16 v[16:31], a[88:91], v[72:75], v[16:31]
    v_mfma_f32_32x32x16_bf16 v[32:47], a[200:203], v[72:75], v[32:47]
    s_mov_b32 s53, 13635584
    buffer_load_dwordx4 v[60:63], v112, s[44:47], s53 offen sc1
    s_waitcnt vmcnt(6)
    v_mfma_f32_32x32x16_bf16 v[16:31], a[92:95], v[76:79], v[16:31]
    v_mfma_f32_32x32x16_bf16 v[32:47], a[204:207], v[76:79], v[32:47]
    s_waitcnt vmcnt(5)
    v_mfma_f32_32x32x16_bf16 v[16:31], a[96:99], v[80:83], v[16:31]
    v_mfma_f32_32x32x16_bf16 v[32:47], a[208:211], v[80:83], v[32:47]
    s_waitcnt vmcnt(4)
    v_mfma_f32_32x32x16_bf16 v[16:31], a[100:103], v[84:87], v[16:31]
    v_mfma_f32_32x32x16_bf16 v[32:47], a[212:215], v[84:87], v[32:47]
    s_waitcnt vmcnt(3)
    v_mfma_f32_32x32x16_bf16 v[16:31], a[104:107], v[88:91], v[16:31]
    v_mfma_f32_32x32x16_bf16 v[32:47], a[216:219], v[88:91], v[32:47]
    s_waitcnt vmcnt(2)
    v_mfma_f32_32x32x16_bf16 v[16:31], a[108:111], v[92:95], v[16:31]
    v_mfma_f32_32x32x16_bf16 v[32:47], a[220:223], v[92:95], v[32:47]
    s_branch L_ldone_32
L_idle_31:
    s_barrier
    buffer_load_dword v126, v125, s[44:47], 0 offen sc1
    s_waitcnt vmcnt(0)
    v_cmp_ne_u32 vcc, s51, v126
    s_cbranch_vccz L_pcd_44
    s_mov_b32 s53, 0
L_pc_43:
    buffer_load_dword v126, v125, s[44:47], 0 offen sc1
    s_waitcnt vmcnt(0)
    v_cmp_ne_u32 vcc, s51, v126
    s_cbranch_vccz L_pcd_44
    s_add_u32 s53, s53, 1
    s_cmp_lg_u32 s52, 0
    s_cbranch_scc1 L_pcd_44
    s_cmp_lt_u32 s53, 0x8000
    s_cbranch_scc1 L_pc_43
    s_mov_b32 s52, 1
L_pcd_44:
    s_add_u32 s53, s75, 15732736
    buffer_load_dwordx4 v[40:43], v2, s[44:47], s53 offen sc1
    s_waitcnt lgkmcnt(0)
    s_waitcnt vmcnt(0)
    v_lshlrev_b32 v32, 16, v40
    v_and_b32 v33, 0xffff0000, v40
    v_lshlrev_b32 v34, 16, v41
    v_and_b32 v35, 0xffff0000, v41
    v_lshlrev_b32 v36, 16, v42
    v_and_b32 v37, 0xffff0000, v42
    v_lshlrev_b32 v38, 16, v43
    v_and_b32 v39, 0xffff0000, v43
    v_add_f32 v124, v32, v33
    v_mul_f32 v125, v32, v32
    v_fmac_f32 v125, v33, v33
    v_add_f32 v124, v124, v34
    v_fmac_f32 v125, v34, v34
    v_add_f32 v124, v124, v35
    v_fmac_f32 v125, v35, v35
    v_add_f32 v124, v124, v36
    v_fmac_f32 v125, v36, v36
    v_add_f32 v124, v124, v37
    v_fmac_f32 v125, v37, v37
    v_add_f32 v124, v124, v38
    v_fmac_f32 v125, v38, v38
    v_add_f32 v124, v124, v39
    v_fmac_f32 v125, v39, v39
    s_nop 1
    v_add_f32_dpp v124, v124, v124 quad_perm:[1,0,3,2] row_mask:0xf bank_mask:0xf
    v_add_f32_dpp v125, v125, v125 quad_perm:[1,0,3,2] row_mask:0xf bank_mask:0xf
    s_nop 0
    v_add_f32_dpp v124, v124, v124 quad_perm:[2,3,0,1] row_mask:0xf bank_mask:0xf
    v_add_f32_dpp v125, v125, v125 quad_perm:[2,3,0,1] row_mask:0xf bank_mask:0xf
    s_nop 0
    v_add_f32_dpp v124, v124, v124 row_half_mirror row_mask:0xf bank_mask:0xf
    v_add_f32_dpp v125, v125, v125 row_half_mirror row_mask:0xf bank_mask:0xf
    s_nop 0
    v_add_f32_dpp v124, v124, v124 row_mirror row_mask:0xf bank_mask:0xf
    v_add_f32_dpp v125, v125, v125 row_mirror row_mask:0xf bank_mask:0xf
    s_nop 0
    v_add_f32_dpp v124, v124, v124 row_bcast:15 row_mask:0xa bank_mask:0xf
    v_add_f32_dpp v125, v125, v125 row_bcast:15 row_mask:0xa bank_mask:0xf
    s_nop 0
    v_add_f32_dpp v124, v124, v124 row_bcast:31 row_mask:0xc bank_mask:0xf
    v_add_f32_dpp v125, v125, v125 row_bcast:31 row_mask:0xc bank_mask:0xf
    s_nop 0
    v_readlane_b32 s58, v124, 63
    v_readlane_b32 s59, v125, 63
    s_nop 1
    v_mov_b32 v126, s58
    v_mov_b32 v127, s59
    v_mul_f32 v126, 0x3b000000, v126
    v_mul_f32 v127, 0x3b000000, v127
    v_fma_f32 v127, -v126, v126, v127
    v_max_f32 v127, 0, v127
    v_add_f32 v127, 0x3727c5ac, v127
    v_rsq_f32 v127, v127
    s_nop 0
    v_mul_f32 v126, v126, v127
    v_fma_f32 v109, v32, v127, -v126
    v_lshlrev_b32 v110, 16, v44
    v_fma_f32 v32, v109, v110, v32
    v_fma_f32 v109, v33, v127, -v126
    v_and_b32 v110, 0xffff0000, v44
    v_fma_f32 v33, v109, v110, v33
    v_fma_f32 v109, v34, v127, -v126
    v_lshlrev_b32 v110, 16, v45
    v_fma_f32 v34, v109, v110, v34
    v_fma_f32 v109, v35, v127, -v126
    v_and_b32 v110, 0xffff0000, v45
    v_fma_f32 v35, v109, v110, v35
    v_fma_f32 v109, v36, v127, -v126
    v_lshlrev_b32 v110, 16, v46
    v_fma_f32 v36, v109, v110, v36
    v_fma_f32 v109, v37, v127, -v126
    v_and_b32 v110, 0xffff0000, v46
    v_fma_f32 v37, v109, v110, v37
    v_fma_f32 v109, v38, v127, -v126
    v_lshlrev_b32 v110, 16, v47
    v_fma_f32 v38, v109, v110, v38
    v_fma_f32 v109, v39, v127, -v126
    v_and_b32 v110, 0xffff0000, v47
    v_fma_f32 v39, v109, v110, v39
    v_cvt_pk_bf16_f32 v40, v32, v33
    v_cvt_pk_bf16_f32 v41, v34, v35
    v_cvt_pk_bf16_f32 v42, v36, v37
    v_cvt_pk_bf16_f32 v43, v38, v39
    v_lshlrev_b32 v32, 16, v40
    v_and_b32 v33, 0xffff0000, v40
    v_lshlrev_b32 v34, 16, v41
    v_and_b32 v35, 0xffff0000, v41
    v_lshlrev_b32 v36, 16, v42
    v_and_b32 v37, 0xffff0000, v42
    v_lshlrev_b32 v38, 16, v43
    v_and_b32 v39, 0xffff0000, v43
    s_add_u32 s54, s75, 13635584
    buffer_store_dwordx4 v[40:43], v2, s[44:47], s54 offen sc1
    v_add_f32 v124, v32, v33
    v_mul_f32 v125, v32, v32
    v_fmac_f32 v125, v33, v33
    v_add_f32 v124, v124, v34
    v_fmac_f32 v125, v34, v34
    v_add_f32 v124, v124, v35
    v_fmac_f32 v125, v35, v35
    v_add_f32 v124, v124, v36
    v_fmac_f32 v125, v36, v36
    v_add_f32 v124, v124, v37
    v_fmac_f32 v125, v37, v37
    v_add_f32 v124, v124, v38
    v_fmac_f32 v125, v38, v38
    v_add_f32 v124, v124, v39
    v_fmac_f32 v125, v39, v39
    s_nop 1
    v_add_f32_dpp v124, v124, v124 quad_perm:[1,0,3,2] row_mask:0xf bank_mask:0xf
    v_add_f32_dpp v125, v125, v125 quad_perm:[1,0,3,2] row_mask:0xf bank_mask:0xf
    s_nop 0
    v_add_f32_dpp v124, v124, v124 quad_perm:[2,3,0,1] row_mask:0xf bank_mask:0xf
    v_add_f32_dpp v125, v125, v125 quad_perm:[2,3,0,1] row_mask:0xf bank_mask:0xf
    s_nop 0
    v_add_f32_dpp v124, v124, v124 row_half_mirror row_mask:0xf bank_mask:0xf
    v_add_f32_dpp v125, v125, v125 row_half_mirror row_mask:0xf bank_mask:0xf
    s_nop 0
    v_add_f32_dpp v124, v124, v124 row_mirror row_mask:0xf bank_mask:0xf
    v_add_f32_dpp v125, v125, v125 row_mirror row_mask:0xf bank_mask:0xf
    s_nop 0
    v_add_f32_dpp v124, v124, v124 row_bcast:15 row_mask:0xa bank_mask:0xf
    v_add_f32_dpp v125, v125, v125 row_bcast:15 row_mask:0xa bank_mask:0xf
    s_nop 0
    v_add_f32_dpp v124, v124, v124 row_bcast:31 row_mask:0xc bank_mask:0xf
    v_add_f32_dpp v125, v125, v125 row_bcast:31 row_mask:0xc bank_mask:0xf
    s_nop 0
    v_readlane_b32 s58, v124, 63
    v_readlane_b32 s59, v125, 63
    s_nop 1
    v_mov_b32 v126, s58
    v_mov_b32 v127, s59
    v_mul_f32 v126, 0x3b000000, v126
    v_mul_f32 v127, 0x3b000000, v127
    v_fma_f32 v127, -v126, v126, v127
    v_max_f32 v127, 0, v127
    v_add_f32 v124, 0x3727c5ac, v127
    v_rsq_f32 v124, v124
    s_nop 0
    v_mul_f32 v127, v127, v124
    v_fmaak_f32 v127, v127, v124, 0x3727c5ac
    v_rsq_f32 v127, v127
    s_nop 0
    v_mul_f32 v127, v127, v124
    v_mul_f32 v126, v126, v127
    v_fma_f32 v32, v32, v127, -v126
    v_fma_f32 v33, v33, v127, -v126
    v_fma_f32 v34, v34, v127, -v126
    v_fma_f32 v35, v35, v127, -v126
    v_fma_f32 v36, v36, v127, -v126
    v_fma_f32 v37, v37, v127, -v126
    v_fma_f32 v38, v38, v127, -v126
    v_fma_f32 v39, v39, v127, -v126
    v_cvt_pk_bf16_f32 v44, v32, v33
    v_cvt_pk_bf16_f32 v45, v34, v35
    v_cvt_pk_bf16_f32 v46, v36, v37
    v_cvt_pk_bf16_f32 v47, v38, v39
    s_add_u32 s54, s75, 9441280
    buffer_store_dwordx4 v[44:47], v2, s[44:47], s54 offen
    s_waitcnt vmcnt(0)
    s_add_u32 s53, s61, 12288
    buffer_store_dword v3, off, s[44:47], s53
    v_add_u32 v100, 16384, v119
    v_add_u32 v101, 512, v100
    buffer_load_dword v102, v100, s[44:47], 0 offen sc1
    v_mov_b32 v124, v100
    v_mov_b32 v125, v101
    s_waitcnt vmcnt(0)
    v_cmp_ne_u32 vcc, s51, v102
    s_cbranch_vccz L_pcd_46
    s_mov_b32 s53, 0
L_pc_45:
    buffer_load_dword v102, v100, s[44:47], 0 offen sc1
    s_waitcnt vmcnt(0)
    v_cmp_ne_u32 vcc, s51, v102
    s_cbranch_vccz L_pcd_46
    s_add_u32 s53, s53, 1
    s_cmp_lg_u32 s52, 0
    s_cbranch_scc1 L_pcd_46
    s_cmp_lt_u32 s53, 0x8000
    s_cbranch_scc1 L_pc_45
    s_mov_b32 s52, 1
L_pcd_46:
    s_add_u32 s54, s69, 0
    buffer_load_dwordx4 v[64:67], v2, s[44:47], s54 offen sc1
    s_add_u32 s54, s69, 0
    buffer_load_dwordx4 v[68:71], v2, s[44:47], s54 offen offset:1024 sc1
    s_add_u32 s54, s69, 0
    buffer_load_dwordx4 v[72:75], v2, s[44:47], s54 offen offset:2048 sc1
    s_add_u32 s54, s69, 0
    buffer_load_dwordx4 v[76:79], v2, s[44:47], s54 offen offset:3072 sc1
    s_add_u32 s54, s69, 4096
    buffer_load_dwordx4 v[80:83], v2, s[44:47], s54 offen sc1
    s_add_u32 s54, s69, 4096
    buffer_load_dwordx4 v[84:87], v2, s[44:47], s54 offen offset:1024 sc1
    s_add_u32 s54, s69, 4096
    buffer_load_dwordx4 v[88:91], v2, s[44:47], s54 offen offset:2048 sc1
    s_add_u32 s54, s69, 4096
    buffer_load_dwordx4 v[92:95], v2, s[44:47], s54 offen offset:3072 sc1
    s_add_u32 s54, s69, 8192
    buffer_load_dwordx4 v[96:99], v2, s[44:47], s54 offen sc1
    s_add_u32 s54, s69, 8192
    buffer_load_dwordx4 v[100:103], v2, s[44:47], s54 offen offset:1024 sc1
    s_add_u32 s54, s69, 8192
    buffer_load_dwordx4 v[104:107], v2, s[44:47], s54 offen offset:2048 sc1
    s_add_u32 s54, s69, 8192
    buffer_load_dwordx4 v[108:111], v2, s[44:47], s54 offen offset:3072 sc1
    s_mov_b32 s4, s36
    s_and_b32 s5, s37, 0xffff
    s_mov_b32 s6, 1024
    s_mov_b32 s7, 0x00020000
    buffer_load_dwordx4 v[56:59], v123, s[4:7], 0 offen
    s_mov_b32 s53, 13631488
    buffer_load_dwordx4 v[60:63], v112, s[44:47], s53 offen sc1
    s_mov_b32 s8, s38
    s_and_b32 s9, s39, 0xffff
    s_mov_b32 s10, 2097152
    s_mov_b32 s11, 0x00020000
    s_waitcnt vmcnt(13)
    v_mfma_f32_32x32x16_bf16 a[224:239], a[0:3], v[64:67], 0
    v_mfma_f32_32x32x16_bf16 a[240:255], a[112:115], v[64:67], 0
    s_waitcnt vmcnt(12)
    v_mfma_f32_32x32x16_bf16 a[224:239], a[4:7], v[68:71], a[224:239]
    s_add_u32 s54, s69, 12288
    buffer_load_dwordx4 v[64:67], v2, s[44:47], s54 offen sc1
    v_mfma_f32_32x32x16_bf16 a[240:255], a[116:119], v[68:71], a[240:255]
    s_waitcnt vmcnt(12)
    v_mfma_f32_32x32x16_bf16 a[224:239], a[8:11], v[72:75], a[224:239]
    s_add_u32 s54, s69, 12288
    buffer_load_dwordx4 v[68:71], v2, s[44:47], s54 offen offset:1024 sc1
    v_mfma_f32_32x32x16_bf16 a[240:255], a[120:123], v[72:75], a[240:255]
    s_waitcnt vmcnt(12)
    v_mfma_f32_32x32x16_bf16 a[224:239], a[12:15], v[76:79], a[224:239]
    s_add_u32 s54, s69, 12288
    buffer_load_dwordx4 v[72:75], v2, s[44:47], s54 offen offset:2048 sc1
    v_mfma_f32_32x32x16_bf16 a[240:255], a[124:127], v[76:79], a[240:255]
    s_waitcnt vmcnt(12)
    v_mfma_f32_32x32x16_bf16 a[224:239], a[16:19], v[80:83], a[224:239]
    s_add_u32 s54, s69, 12288
    buffer_load_dwordx4 v[76:79], v2, s[44:47], s54 offen offset:3072 sc1
    v_mfma_f32_32x32x16_bf16 a[240:255], a[128:131], v[80:83], a[240:255]
    s_waitcnt vmcnt(12)
    v_mfma_f32_32x32x16_bf16 a[224:239], a[20:23], v[84:87], a[224:239]
    s_add_u32 s54, s69, 16384
    buffer_load_dwordx4 v[80:83], v2, s[44:47], s54 offen sc1
    v_mfma_f32_32x32x16_bf16 a[240:255], a[132:135], v[84:87], a[240:255]
    s_waitcnt vmcnt(12)
    v_mfma_f32_32x32x16_bf16 a[224:239], a[24:27], v[88:91], a[224:239]
    s_add_u32 s54, s69, 16384
    buffer_load_dwordx4 v[84:87], v2, s[44:47], s54 offen offset:1024 sc1
    v_mfma_f32_32x32x16_bf16 a[240:255], a[136:139], v[88:91], a[240:255]
    s_waitcnt vmcnt(12)
    v_mfma_f32_32x32x16_bf16 a[224:239], a[28:31], v[92:95], a[224:239]
    s_add_u32 s54, s69, 16384
    buffer_load_dwordx4 v[88:91], v2, s[44:47], s54 offen offset:2048 sc1
    v_mfma_f32_32x32x16_bf16 a[240:255], a[140:143], v[92:95], a[240:255]
    s_waitcnt vmcnt(12)
    v_mfma_f32_32x32x16_bf16 a[224:239], a[32:35], v[96:99], a[224:239]
    s_add_u32 s54, s69, 16384
    buffer_load_dwordx4 v[92:95], v2, s[44:47], s54 offen offset:3072 sc1
    v_mfma_f32_32x32x16_bf16 a[240:255], a[144:147], v[96:99], a[240:255]
    s_waitcnt vmcnt(12)
    v_mfma_f32_32x32x16_bf16 a[224:239], a[36:39], v[100:103], a[224:239]
    s_add_u32 s54, s69, 20480
    buffer_load_dwordx4 v[96:99], v2, s[44:47], s54 offen sc1
    v_mfma_f32_32x32x16_bf16 a[240:255], a[148:151], v[100:103], a[240:255]
    s_waitcnt vmcnt(12)
    v_mfma_f32_32x32x16_bf16 a[224:239], a[40:43], v[104:107], a[224:239]
    s_add_u32 s54, s69, 20480
    buffer_load_dwordx4 v[100:103], v2, s[44:47], s54 offen offset:1024 sc1
    v_mfma_f32_32x32x16_bf16 a[240:255], a[152:155], v[104:107], a[240:255]
    buffer_load_dword v126, v125, s[44:47], 0 offen sc1
    s_waitcnt vmcnt(13)
    v_mfma_f32_32x32x16_bf16 a[224:239], a[44:47], v[108:111], a[224:239]
    s_add_u32 s54, s69, 20480
    buffer_load_dwordx4 v[104:107], v2, s[44:47], s54 offen offset:2048 sc1
    v_mfma_f32_32x32x16_bf16 a[240:255], a[156:159], v[108:111], a[240:255]
    s_waitcnt vmcnt(11)
    v_mfma_f32_32x32x16_bf16 a[224:239], a[48:51], v[64:67], a[224:239]
    s_add_u32 s54, s69, 20480
    buffer_load_dwordx4 v[108:111], v2, s[44:47], s54 offen offset:3072 sc1
    v_mfma_f32_32x32x16_bf16 a[240:255], a[160:163], v[64:67], a[240:255]
    s_waitcnt vmcnt(11)
    v_mfma_f32_32x32x16_bf16 a[224:239], a[52:55], v[68:71], a[224:239]
    s_add_u32 s54, s69, 24576
    buffer_load_dwordx4 v[64:67], v2, s[44:47], s54 offen sc1
    v_mfma_f32_32x32x16_bf16 a[240:255], a[164:167], v[68:71], a[240:255]
    s_waitcnt vmcnt(11)
    v_mfma_f32_32x32x16_bf16 a[224:239], a[56:59], v[72:75], a[224:239]
    s_add_u32 s54, s69, 24576
    buffer_load_dwordx4 v[68:71], v2, s[44:47], s54 offen offset:1024 sc1
    v_mfma_f32_32x32x16_bf16 a[240:255], a[168:171], v[72:75], a[240:255]
    s_waitcnt vmcnt(11)
    v_mfma_f32_32x32x16_bf16 a[224:239], a[60:63], v[76:79], a[224:239]
    s_add_u32 s54, s69, 24576
    buffer_load_dwordx4 v[72:75], v2, s[44:47], s54 offen offset:2048 sc1
    v_mfma_f32_32x32x16_bf16 a[240:255], a[172:175], v[76:79], a[240:255]
    s_waitcnt vmcnt(5)
    v_cmp_ne_u32 vcc, s51, v126
    s_cbranch_vccz L_pcd_48
    s_mov_b32 s53, 0
L_pc_47:
    buffer_load_dword v126, v125, s[44:47], 0 offen sc1
    s_waitcnt vmcnt(0)
    v_cmp_ne_u32 vcc, s51, v126
    s_cbranch_vccz L_pcd_48
    s_add_u32 s53, s53, 1
    s_cmp_lg_u32 s52, 0
    s_cbranch_scc1 L_pcd_48
    s_cmp_lt_u32 s53, 0x8000
    s_cbranch_scc1 L_pc_47
    s_mov_b32 s52, 1
L_pcd_48:
    v_mfma_f32_32x32x16_bf16 a[224:239], a[64:67], v[80:83], a[224:239]
    s_add_u32 s54, s69, 24576
    buffer_load_dwordx4 v[76:79], v2, s[44:47], s54 offen offset:3072 sc1
    v_mfma_f32_32x32x16_bf16 a[240:255], a[176:179], v[80:83], a[240:255]
    v_mfma_f32_32x32x16_bf16 a[224:239], a[68:71], v[84:87], a[224:239]
    s_add_u32 s54, s69, 229376
    buffer_load_dwordx4 v[80:83], v2, s[44:47], s54 offen sc1
    v_mfma_f32_32x32x16_bf16 a[240:255], a[180:183], v[84:87], a[240:255]
    v_mfma_f32_32x32x16_bf16 a[224:239], a[72:75], v[88:91], a[224:239]
    s_add_u32 s54, s69, 229376
    buffer_load_dwordx4 v[84:87], v2, s[44:47], s54 offen offset:1024 sc1
    v_mfma_f32_32x32x16_bf16 a[240:255], a[184:187], v[88:91], a[240:255]
    v_mfma_f32_32x32x16_bf16 a[224:239], a[76:79], v[92:95], a[224:239]
    s_add_u32 s54, s69, 229376
    buffer_load_dwordx4 v[88:91], v2, s[44:47], s54 offen offset:2048 sc1
    v_mfma_f32_32x32x16_bf16 a[240:255], a[188:191], v[92:95], a[240:255]
    v_mfma_f32_32x32x16_bf16 a[224:239], a[80:83], v[96:99], a[224:239]
    s_add_u32 s54, s69, 229376
    buffer_load_dwordx4 v[92:95], v2, s[44:47], s54 offen offset:3072 sc1
    v_mfma_f32_32x32x16_bf16 a[240:255], a[192:195], v[96:99], a[240:255]
    v_mfma_f32_32x32x16_bf16 a[224:239], a[84:87], v[100:103], a[224:239]
    s_add_u32 s54, s69, 233472
    buffer_load_dwordx4 v[96:99], v2, s[44:47], s54 offen sc1
    v_mfma_f32_32x32x16_bf16 a[240:255], a[196:199], v[100:103], a[240:255]
    s_waitcnt vmcnt(10)
    v_mfma_f32_32x32x16_bf16 a[224:239], a[88:91], v[104:107], a[224:239]
    s_add_u32 s54, s69, 233472
    buffer_load_dwordx4 v[100:103], v2, s[44:47], s54 offen offset:1024 sc1
    v_mfma_f32_32x32x16_bf16 a[240:255], a[200:203], v[104:107], a[240:255]
    s_waitcnt vmcnt(10)
    v_mfma_f32_32x32x16_bf16 a[224:239], a[92:95], v[108:111], a[224:239]
    s_add_u32 s54, s69, 233472
    buffer_load_dwordx4 v[104:107], v2, s[44:47], s54 offen offset:2048 sc1
    v_mfma_f32_32x32x16_bf16 a[240:255], a[204:207], v[108:111], a[240:255]
    s_waitcnt vmcnt(10)
    v_mfma_f32_32x32x16_bf16 a[224:239], a[96:99], v[64:67], a[224:239]
    s_add_u32 s54, s69, 233472
    buffer_load_dwordx4 v[108:111], v2, s[44:47], s54 offen offset:3072 sc1
    v_mfma_f32_32x32x16_bf16 a[240:255], a[208:211], v[64:67], a[240:255]
    s_waitcnt vmcnt(10)
    v_mfma_f32_32x32x16_bf16 a[224:239], a[100:103], v[68:71], a[224:239]
    s_add_u32 s54, s69, 237568
    buffer_load_dwordx4 v[64:67], v2, s[44:47], s54 offen sc1
    v_mfma_f32_32x32x16_bf16 a[240:255], a[212:215], v[68:71], a[240:255]
    s_waitcnt vmcnt(10)
    v_mfma_f32_32x32x16_bf16 a[224:239], a[104:107], v[72:75], a[224:239]
    s_add_u32 s54, s69, 237568
    buffer_load_dwordx4 v[68:71], v2, s[44:47], s54 offen offset:1024 sc1
    v_mfma_f32_32x32x16_bf16 a[240:255], a[216:219], v[72:75], a[240:255]
    s_waitcnt vmcnt(10)
    v_mfma_f32_32x32x16_bf16 a[224:239], a[108:111], v[76:79], a[224:239]
    s_add_u32 s54, s69, 237568
    buffer_load_dwordx4 v[72:75], v2, s[44:47], s54 offen offset:2048 sc1
    v_mfma_f32_32x32x16_bf16 a[240:255], a[220:223], v[76:79], a[240:255]
    s_waitcnt vmcnt(10)
    v_mfma_f32_32x32x16_bf16 v[16:31], a[0:3], v[80:83], 0
    s_add_u32 s54, s69, 237568
    buffer_load_dwordx4 v[76:79], v2, s[44:47], s54 offen offset:3072 sc1
    v_mfma_f32_32x32x16_bf16 v[32:47], a[112:115], v[80:83], 0
    s_waitcnt vmcnt(10)
    v_mfma_f32_32x32x16_bf16 v[16:31], a[4:7], v[84:87], v[16:31]
    s_add_u32 s54, s69, 241664
    buffer_load_dwordx4 v[80:83], v2, s[44:47], s54 offen sc1
    v_mfma_f32_32x32x16_bf16 v[32:47], a[116:119], v[84:87], v[32:47]
    s_waitcnt vmcnt(10)
    v_mfma_f32_32x32x16_bf16 v[16:31], a[8:11], v[88:91], v[16:31]
    s_add_u32 s54, s69, 241664
    buffer_load_dwordx4 v[84:87], v2, s[44:47], s54 offen offset:1024 sc1
    v_mfma_f32_32x32x16_bf16 v[32:47], a[120:123], v[88:91], v[32:47]
    ds_write_b128 v115, a[224:227] offset:0
    ds_write_b128 v116, a[228:231] offset:0
    s_waitcnt vmcnt(10)
    v_mfma_f32_32x32x16_bf16 v[16:31], a[12:15], v[92:95], v[16:31]
    s_add_u32 s54, s69, 241664
    buffer_load_dwordx4 v[88:91], v2, s[44:47], s54 offen offset:2048 sc1
    v_mfma_f32_32x32x16_bf16 v[32:47], a[124:127], v[92:95], v[32:47]
    ds_write_b128 v117, a[232:235] offset:0
    ds_write_b128 v118, a[236:239] offset:0
    s_waitcnt vmcnt(10)
    v_mfma_f32_32x32x16_bf16 v[16:31], a[16:19], v[96:99], v[16:31]
    s_add_u32 s54, s69, 241664
    buffer_load_dwordx4 v[92:95], v2, s[44:47], s54 offen offset:3072 sc1
    v_mfma_f32_32x32x16_bf16 v[32:47], a[128:131], v[96:99], v[32:47]
    ds_write_b128 v115, a[240:243] offset:128
    ds_write_b128 v116, a[244:247] offset:128
    s_waitcnt vmcnt(10)
    v_mfma_f32_32x32x16_bf16 v[16:31], a[20:23], v[100:103], v[16:31]
    s_add_u32 s54, s69, 245760
    buffer_load_dwordx4 v[96:99], v2, s[44:47], s54 offen sc1
    v_mfma_f32_32x32x16_bf16 v[32:47], a[132:135], v[100:103], v[32:47]
    ds_write_b128 v117, a[248:251] offset:128
    ds_write_b128 v118, a[252:255] offset:128
    s_waitcnt vmcnt(10)
    v_mfma_f32_32x32x16_bf16 v[16:31], a[24:27], v[104:107], v[16:31]
    s_add_u32 s54, s69, 245760
    buffer_load_dwordx4 v[100:103], v2, s[44:47], s54 offen offset:1024 sc1
    v_mfma_f32_32x32x16_bf16 v[32:47], a[136:139], v[104:107], v[32:47]
    s_waitcnt vmcnt(10)
    v_mfma_f32_32x32x16_bf16 v[16:31], a[28:31], v[108:111], v[16:31]
    s_add_u32 s54, s69, 245760
    buffer_load_dwordx4 v[104:107], v2, s[44:47], s54 offen offset:2048 sc1
    v_mfma_f32_32x32x16_bf16 v[32:47], a[140:143], v[108:111], v[32:47]
    s_waitcnt lgkmcnt(0)
    s_barrier
    s_waitcnt vmcnt(10)
    v_mfma_f32_32x32x16_bf16 v[16:31], a[32:35], v[64:67], v[16:31]
    s_add_u32 s54, s69, 245760
    buffer_load_dwordx4 v[108:111], v2, s[44:47], s54 offen offset:3072 sc1
    v_mfma_f32_32x32x16_bf16 v[32:47], a[144:147], v[64:67], v[32:47]
    ds_read_b128 v[48:51], v113 offset:0
    ds_read_b128 v[52:55], v113 offset:8192
    s_waitcnt lgkmcnt(0)
    v_add_f32 v48, v48, v52
    v_add_f32 v49, v49, v53
    v_add_f32 v50, v50, v54
    v_add_f32 v51, v51, v55
    ds_read_b128 v[52:55], v113 offset:16384
    s_waitcnt vmcnt(10)
    v_mfma_f32_32x32x16_bf16 v[16:31], a[36:39], v[68:71], v[16:31]
    s_add_u32 s54, s69, 249856
    buffer_load_dwordx4 v[64:67], v2, s[44:47], s54 offen sc1
    v_mfma_f32_32x32x16_bf16 v[32:47], a[148:151], v[68:71], v[32:47]
    s_waitcnt lgkmcnt(0)
    v_add_f32 v48, v48, v52
    v_add_f32 v49, v49, v53
    v_add_f32 v50, v50, v54
    v_add_f32 v51, v51, v55
    ds_read_b128 v[52:55], v113 offset:24576
    s_waitcnt vmcnt(10)
    v_mfma_f32_32x32x16_bf16 v[16:31], a[40:43], v[72:75], v[16:31]
    s_add_u32 s54, s69, 249856
    buffer_load_dwordx4 v[68:71], v2, s[44:47], s54 offen offset:1024 sc1
    v_mfma_f32_32x32x16_bf16 v[32:47], a[152:155], v[72:75], v[32:47]
    s_waitcnt lgkmcnt(0)
    v_add_f32 v48, v48, v52
    v_add_f32 v49, v49, v53
    v_add_f32 v50, v50, v54
    v_add_f32 v51, v51, v55
    v_lshlrev_b32 v52, 16, v56
    v_and_b32 v53, 0xffff0000, v56
    v_lshlrev_b32 v54, 16, v57
    v_and_b32 v55, 0xffff0000, v57
    v_add_f32 v48, v48, v52
    v_add_f32 v49, v49, v53
    v_add_f32 v50, v50, v54
    v_add_f32 v51, v51, v55
    s_waitcnt vmcnt(10)
    v_mfma_f32_32x32x16_bf16 v[16:31], a[44:47], v[76:79], v[16:31]
    s_add_u32 s54, s69, 249856
    buffer_load_dwordx4 v[72:75], v2, s[44:47], s54 offen offset:2048 sc1
    v_mfma_f32_32x32x16_bf16 v[32:47], a[156:159], v[76:79], v[32:47]
    v_cvt_pk_bf16_f32 v52, v48, v49
    v_cvt_pk_bf16_f32 v53, v50, v51
    v_lshlrev_b32 v48, 16, v52
    v_and_b32 v49, 0xffff0000, v52
    v_lshlrev_b32 v50, 16, v53
    v_and_b32 v51, 0xffff0000, v53
    s_waitcnt vmcnt(10)
    v_mfma_f32_32x32x16_bf16 v[16:31], a[48:51], v[80:83], v[16:31]
    s_add_u32 s54, s69, 249856
    buffer_load_dwordx4 v[76:79], v2, s[44:47], s54 offen offset:3072 sc1
    v_mfma_f32_32x32x16_bf16 v[32:47], a[160:163], v[80:83], v[32:47]
    v_lshlrev_b32 v52, 16, v60
    v_and_b32 v53, 0xffff0000, v60
    v_lshlrev_b32 v54, 16, v61
    v_and_b32 v55, 0xffff0000, v61
    v_add_f32 v48, v48, v52
    v_add_f32 v49, v49, v53
    v_add_f32 v50, v50, v54
    v_add_f32 v51, v51, v55
    v_cvt_pk_bf16_f32 v12, v48, v49
    v_cvt_pk_bf16_f32 v13, v50, v51
    s_waitcnt vmcnt(10)
    v_mfma_f32_32x32x16_bf16 v[16:31], a[52:55], v[84:87], v[16:31]
    s_add_u32 s54, s69, 253952
    buffer_load_dwordx4 v[80:83], v2, s[44:47], s54 offen sc1
    v_mfma_f32_32x32x16_bf16 v[32:47], a[164:167], v[84:87], v[32:47]
    ds_read_b128 v[48:51], v114 offset:0
    ds_read_b128 v[52:55], v114 offset:8192
    s_waitcnt vmcnt(10)
    v_mfma_f32_32x32x16_bf16 v[16:31], a[56:59], v[88:91], v[16:31]
    s_add_u32 s54, s69, 253952
    buffer_load_dwordx4 v[84:87], v2, s[44:47], s54 offen offset:1024 sc1
    v_mfma_f32_32x32x16_bf16 v[32:47], a[168:171], v[88:91], v[32:47]
    s_waitcnt lgkmcnt(0)
    v_add_f32 v48, v48, v52
    v_add_f32 v49, v49, v53
    v_add_f32 v50, v50, v54
    v_add_f32 v51, v51, v55
    ds_read_b128 v[52:55], v114 offset:16384
    s_waitcnt lgkmcnt(0)
    v_add_f32 v48, v48, v52
    v_add_f32 v49, v49, v53
    v_add_f32 v50, v50, v54
    v_add_f32 v51, v51, v55
    ds_read_b128 v[52:55], v114 offset:24576
    s_waitcnt vmcnt(10)
    v_mfma_f32_32x32x16_bf16 v[16:31], a[60:63], v[92:95], v[16:31]
    s_add_u32 s54, s69, 253952
    buffer_load_dwordx4 v[88:91], v2, s[44:47], s54 offen offset:2048 sc1
    v_mfma_f32_32x32x16_bf16 v[32:47], a[172:175], v[92:95], v[32:47]
    s_waitcnt lgkmcnt(0)
    v_add_f32 v48, v48, v52
    v_add_f32 v49, v49, v53
    v_add_f32 v50, v50, v54
    v_add_f32 v51, v51, v55
    s_waitcnt vmcnt(10)
    v_mfma_f32_32x32x16_bf16 v[16:31], a[64:67], v[96:99], v[16:31]
    s_add_u32 s54, s69, 253952
    buffer_load_dwordx4 v[92:95], v2, s[44:47], s54 offen offset:3072 sc1
    v_mfma_f32_32x32x16_bf16 v[32:47], a[176:179], v[96:99], v[32:47]
    v_lshlrev_b32 v52, 16, v58
    v_and_b32 v53, 0xffff0000, v58
    v_lshlrev_b32 v54, 16, v59
    v_and_b32 v55, 0xffff0000, v59
    v_add_f32 v48, v48, v52
    v_add_f32 v49, v49, v53
    v_add_f32 v50, v50, v54
    v_add_f32 v51, v51, v55
    v_cvt_pk_bf16_f32 v52, v48, v49
    v_cvt_pk_bf16_f32 v53, v50, v51
    v_lshlrev_b32 v48, 16, v52
    v_and_b32 v49, 0xffff0000, v52
    v_lshlrev_b32 v50, 16, v53
    v_and_b32 v51, 0xffff0000, v53
    s_waitcnt vmcnt(10)
    v_mfma_f32_32x32x16_bf16 v[16:31], a[68:71], v[100:103], v[16:31]
    v_mfma_f32_32x32x16_bf16 v[32:47], a[180:183], v[100:103], v[32:47]
    v_lshlrev_b32 v52, 16, v62
    v_and_b32 v53, 0xffff0000, v62
    v_lshlrev_b32 v54, 16, v63
    v_and_b32 v55, 0xffff0000, v63
    v_add_f32 v48, v48, v52
    v_add_f32 v49, v49, v53
    v_add_f32 v50, v50, v54
    v_add_f32 v51, v51, v55
    s_waitcnt vmcnt(9)
    v_mfma_f32_32x32x16_bf16 v[16:31], a[72:75], v[104:107], v[16:31]
    v_mfma_f32_32x32x16_bf16 v[32:47], a[184:187], v[104:107], v[32:47]
    v_cvt_pk_bf16_f32 v14, v48, v49
    v_cvt_pk_bf16_f32 v15, v50, v51
    s_mov_b32 s53, 0
    buffer_store_dwordx4 v[12:15], v112, s[8:11], s53 offen sc1
    s_waitcnt vmcnt(9)
    v_mfma_f32_32x32x16_bf16 v[16:31], a[76:79], v[108:111], v[16:31]
    v_mfma_f32_32x32x16_bf16 v[32:47], a[188:191], v[108:111], v[32:47]
    s_waitcnt vmcnt(8)
    v_mfma_f32_32x32x16_bf16 v[16:31], a[80:83], v[64:67], v[16:31]
    v_mfma_f32_32x32x16_bf16 v[32:47], a[192:195], v[64:67], v[32:47]
    s_waitcnt vmcnt(7)
    v_mfma_f32_32x32x16_bf16 v[16:31], a[84:87], v[68:71], v[16:31]
    v_mfma_f32_32x32x16_bf16 v[32:47], a[196:199], v[68:71], v[32:47]
    s_waitcnt vmcnt(6)
    v_mfma_f32_32x32x16_bf16 v[16:31], a[88:91], v[72:75], v[16:31]
    v_mfma_f32_32x32x16_bf16 v[32:47], a[200:203], v[72:75], v[32:47]
    s_mov_b32 s53, 13635584
    buffer_load_dwordx4 v[60:63], v112, s[44:47], s53 offen sc1
    s_waitcnt vmcnt(6)
    v_mfma_f32_32x32x16_bf16 v[16:31], a[92:95], v[76:79], v[16:31]
    v_mfma_f32_32x32x16_bf16 v[32:47], a[204:207], v[76:79], v[32:47]
    s_waitcnt vmcnt(5)
    v_mfma_f32_32x32x16_bf16 v[16:31], a[96:99], v[80:83], v[16:31]
    v_mfma_f32_32x32x16_bf16 v[32:47], a[208:211], v[80:83], v[32:47]
    s_waitcnt vmcnt(4)
    v_mfma_f32_32x32x16_bf16 v[16:31], a[100:103], v[84:87], v[16:31]
    v_mfma_f32_32x32x16_bf16 v[32:47], a[212:215], v[84:87], v[32:47]
    s_waitcnt vmcnt(3)
    v_mfma_f32_32x32x16_bf16 v[16:31], a[104:107], v[88:91], v[16:31]
    v_mfma_f32_32x32x16_bf16 v[32:47], a[216:219], v[88:91], v[32:47]
    s_waitcnt vmcnt(2)
    v_mfma_f32_32x32x16_bf16 v[16:31], a[108:111], v[92:95], v[16:31]
    v_mfma_f32_32x32x16_bf16 v[32:47], a[220:223], v[92:95], v[32:47]
L_ldone_32:
    s_nop 11
    ds_write_b128 v115, v[16:19] offset:32768
    ds_write_b128 v116, v[20:23] offset:32768
    ds_write_b128 v117, v[24:27] offset:32768
    ds_write_b128 v118, v[28:31] offset:32768
    ds_write_b128 v115, v[32:35] offset:32896
    ds_write_b128 v116, v[36:39] offset:32896
    ds_write_b128 v117, v[40:43] offset:32896
    ds_write_b128 v118, v[44:47] offset:32896
    s_waitcnt lgkmcnt(0)
    s_barrier
    ds_read_b128 v[64:67], v113 offset:32768
    ds_read_b128 v[68:71], v114 offset:32768
    ds_read_b128 v[72:75], v113 offset:40960
    ds_read_b128 v[76:79], v114 offset:40960
    ds_read_b128 v[80:83], v113 offset:49152
    ds_read_b128 v[84:87], v114 offset:49152
    ds_read_b128 v[88:91], v113 offset:57344
    ds_read_b128 v[92:95], v114 offset:57344
    v_lshlrev_b32 v96, 16, v56
    v_and_b32 v97, 0xffff0000, v56
    v_lshlrev_b32 v98, 16, v57
    v_and_b32 v99, 0xffff0000, v57
    v_lshlrev_b32 v100, 16, v58
    v_and_b32 v101, 0xffff0000, v58
    v_lshlrev_b32 v102, 16, v59
    v_and_b32 v103, 0xffff0000, v59
    s_waitcnt lgkmcnt(4)
    v_pk_add_f32 v[64:65], v[64:65], v[72:73]
    v_pk_add_f32 v[66:67], v[66:67], v[74:75]
    v_pk_add_f32 v[68:69], v[68:69], v[76:77]
    v_pk_add_f32 v[70:71], v[70:71], v[78:79]
    v_pk_add_f32 v[64:65], v[64:65], v[96:97]
    v_pk_add_f32 v[66:67], v[66:67], v[98:99]
    v_pk_add_f32 v[68:69], v[68:69], v[100:101]
    v_pk_add_f32 v[70:71], v[70:71], v[102:103]
    s_waitcnt lgkmcnt(0)
    v_pk_add_f32 v[80:81], v[80:81], v[88:89]
    v_pk_add_f32 v[82:83], v[82:83], v[90:91]
    v_pk_add_f32 v[84:85], v[84:85], v[92:93]
    v_pk_add_f32 v[86:87], v[86:87], v[94:95]
    v_pk_add_f32 v[64:65], v[64:65], v[80:81]
    v_pk_add_f32 v[66:67], v[66:67], v[82:83]
    v_pk_add_f32 v[68:69], v[68:69], v[84:85]
    v_pk_add_f32 v[70:71], v[70:71], v[86:87]
    v_cvt_pk_bf16_f32 v72, v64, v65
    v_cvt_pk_bf16_f32 v73, v66, v67
    v_cvt_pk_bf16_f32 v74, v68, v69
    v_cvt_pk_bf16_f32 v75, v70, v71
    v_lshlrev_b32 v64, 16, v72
    v_and_b32 v65, 0xffff0000, v72
    v_lshlrev_b32 v66, 16, v73
    v_and_b32 v67, 0xffff0000, v73
    v_lshlrev_b32 v68, 16, v74
    v_and_b32 v69, 0xffff0000, v74
    v_lshlrev_b32 v70, 16, v75
    v_and_b32 v71, 0xffff0000, v75
    s_waitcnt vmcnt(0)
    v_lshlrev_b32 v80, 16, v60
    v_and_b32 v81, 0xffff0000, v60
    v_lshlrev_b32 v82, 16, v61
    v_and_b32 v83, 0xffff0000, v61
    v_lshlrev_b32 v84, 16, v62
    v_and_b32 v85, 0xffff0000, v62
    v_lshlrev_b32 v86, 16, v63
    v_and_b32 v87, 0xffff0000, v63
    v_pk_add_f32 v[64:65], v[64:65], v[80:81]
    v_pk_add_f32 v[66:67], v[66:67], v[82:83]
    v_pk_add_f32 v[68:69], v[68:69], v[84:85]
    v_pk_add_f32 v[70:71], v[70:71], v[86:87]
    v_cvt_pk_bf16_f32 v72, v64, v65
    v_cvt_pk_bf16_f32 v73, v66, v67
    v_cvt_pk_bf16_f32 v74, v68, v69
    v_cvt_pk_bf16_f32 v75, v70, v71
    s_mov_b32 s53, 4096
    buffer_store_dwordx4 v[72:75], v112, s[8:11], s53 offen sc1
    s_branch L_fin
L_fin:
    s_cmp_lg_u32 s2, 0
    s_cbranch_scc1 L_noep_49
    s_cmp_lg_u32 s50, 0
    s_cbranch_scc1 L_noep_49
    buffer_store_dword v3, off, s[44:47], 0 sc1
L_noep_49:
    s_waitcnt vmcnt(0)
L_end:
    s_endpgm
L_slow:
    s_lshl_b32 s53, s50, 10
    s_add_u32 s53, s53, 155648
    v_add_u32 v44, s53, v2
    ds_read_b128 v[32:35], v44
    s_waitcnt lgkmcnt(0)
    v_lshlrev_b32 v36, 16, v32
    v_and_b32 v37, 0xffff0000, v32
    v_lshlrev_b32 v38, 16, v33
    v_and_b32 v39, 0xffff0000, v33
    v_lshlrev_b32 v40, 16, v34
    v_and_b32 v41, 0xffff0000, v34
    v_lshlrev_b32 v42, 16, v35
    v_and_b32 v43, 0xffff0000, v35
    v_pk_fma_f32 v[16:17], v[24:25], v[36:37], v[16:17]
    v_pk_fma_f32 v[18:19], v[26:27], v[38:39], v[18:19]
    v_pk_fma_f32 v[20:21], v[28:29], v[40:41], v[20:21]
    v_pk_fma_f32 v[22:23], v[30:31], v[42:43], v[22:23]
    v_cvt_pk_bf16_f32 v48, v16, v17
    v_cvt_pk_bf16_f32 v49, v18, v19
    v_cvt_pk_bf16_f32 v50, v20, v21
    v_cvt_pk_bf16_f32 v51, v22, v23
    v_lshlrev_b32 v16, 16, v48
    v_and_b32 v17, 0xffff0000, v48
    v_lshlrev_b32 v18, 16, v49
    v_and_b32 v19, 0xffff0000, v49
    v_lshlrev_b32 v20, 16, v50
    v_and_b32 v21, 0xffff0000, v50
    v_lshlrev_b32 v22, 16, v51
    v_and_b32 v23, 0xffff0000, v51
    s_add_u32 s54, s75, 13631488
    buffer_store_dwordx4 v[48:51], v2, s[44:47], s54 offen sc1
    v_pk_add_f32 v[52:53], v[16:17], v[18:19]
    v_pk_mul_f32 v[54:55], v[16:17], v[16:17]
    v_pk_add_f32 v[56:57], v[20:21], v[22:23]
    v_pk_fma_f32 v[54:55], v[18:19], v[18:19], v[54:55]
    v_pk_add_f32 v[52:53], v[52:53], v[56:57]
    v_pk_fma_f32 v[54:55], v[20:21], v[20:21], v[54:55]
    v_add_f32 v52, v52, v53
    v_pk_fma_f32 v[54:55], v[22:23], v[22:23], v[54:55]
    v_add_f32 v54, v54, v55
    s_nop 0
    v_add_f32_dpp v52, v52, v52 quad_perm:[1,0,3,2] row_mask:0xf bank_mask:0xf
    v_add_f32_dpp v54, v54, v54 quad_perm:[1,0,3,2] row_mask:0xf bank_mask:0xf
    s_nop 0
    v_add_f32_dpp v52, v52, v52 quad_perm:[2,3,0,1] row_mask:0xf bank_mask:0xf
    v_add_f32_dpp v54, v54, v54 quad_perm:[2,3,0,1] row_mask:0xf bank_mask:0xf
    s_nop 0
    v_add_f32_dpp v52, v52, v52 row_half_mirror row_mask:0xf bank_mask:0xf
    v_add_f32_dpp v54, v54, v54 row_half_mirror row_mask:0xf bank_mask:0xf
    s_nop 0
    v_add_f32_dpp v52, v52, v52 row_mirror row_mask:0xf bank_mask:0xf
    v_add_f32_dpp v54, v54, v54 row_mirror row_mask:0xf bank_mask:0xf
    s_nop 0
    v_add_f32_dpp v52, v52, v52 row_bcast:15 row_mask:0xa bank_mask:0xf
    v_add_f32_dpp v54, v54, v54 row_bcast:15 row_mask:0xa bank_mask:0xf
    s_nop 0
    v_add_f32_dpp v52, v52, v52 row_bcast:31 row_mask:0xc bank_mask:0xf
    v_add_f32_dpp v54, v54, v54 row_bcast:31 row_mask:0xc bank_mask:0xf
    s_nop 0
    v_readlane_b32 s58, v52, 63
    v_readlane_b32 s59, v54, 63
    s_nop 1
    v_mul_f32 v56, s58, v108
    v_mul_f32 v54, s59, v108
    v_fma_f32 v54, -v56, v56, v54
    v_max_f32 v54, 0, v54
    v_add_f32 v52, 0x3727c5ac, v54
    v_rsq_f32 v52, v52
    s_nop 0
    v_mul_f32 v54, v54, v52
    v_fmaak_f32 v54, v54, v52, 0x3727c5ac
    v_rsq_f32 v54, v54
    s_nop 0
    v_mul_f32 v54, v54, v52
    v_mul_f32 v56, v56, v54
    v_pk_fma_f32 v[24:25], v[16:17], v[54:55], v[56:57] op_sel_hi:[1,0,0] neg_lo:[0,0,1] neg_hi:[0,0,1]
    v_pk_fma_f32 v[26:27], v[18:19], v[54:55], v[56:57] op_sel_hi:[1,0,0] neg_lo:[0,0,1] neg_hi:[0,0,1]
    v_pk_fma_f32 v[28:29], v[20:21], v[54:55], v[56:57] op_sel_hi:[1,0,0] neg_lo:[0,0,1] neg_hi:[0,0,1]
    v_pk_fma_f32 v[30:31], v[22:23], v[54:55], v[56:57] op_sel_hi:[1,0,0] neg_lo:[0,0,1] neg_hi:[0,0,1]
    v_cvt_pk_bf16_f32 v32, v24, v25
    v_cvt_pk_bf16_f32 v33, v26, v27
    v_cvt_pk_bf16_f32 v34, v28, v29
    v_cvt_pk_bf16_f32 v35, v30, v31
    s_add_u32 s54, s75, 9437184
    buffer_store_dwordx4 v[32:35], v2, s[44:47], s54 offen sc1
    s_add_u32 s13, s14, 1376256
    buffer_load_dwordx4 v[224:227], v2, s[44:47], s13 offen sc1
    s_add_u32 s13, s14, 1433600
    buffer_load_dwordx4 v[228:231], v2, s[44:47], s13 offen sc1
    s_add_u32 s13, s14, 1490944
    buffer_load_dwordx4 v[232:235], v2, s[44:47], s13 offen sc1
    s_lshl_b32 s53, s50, 10
    s_add_u32 s53, s53, 159744
    v_add_u32 v92, s53, v2
    ds_read_b128 v[80:83], v92
    s_waitcnt lgkmcnt(0)
    v_lshlrev_b32 v84, 16, v80
    v_and_b32 v85, 0xffff0000, v80
    v_lshlrev_b32 v86, 16, v81
    v_and_b32 v87, 0xffff0000, v81
    v_lshlrev_b32 v88, 16, v82
    v_and_b32 v89, 0xffff0000, v82
    v_lshlrev_b32 v90, 16, v83
    v_and_b32 v91, 0xffff0000, v83
    v_pk_fma_f32 v[64:65], v[72:73], v[84:85], v[64:65]
    v_pk_fma_f32 v[66:67], v[74:75], v[86:87], v[66:67]
    v_pk_fma_f32 v[68:69], v[76:77], v[88:89], v[68:69]
    v_pk_fma_f32 v[70:71], v[78:79], v[90:91], v[70:71]
    v_cvt_pk_bf16_f32 v96, v64, v65
    v_cvt_pk_bf16_f32 v97, v66, v67
    v_cvt_pk_bf16_f32 v98, v68, v69
    v_cvt_pk_bf16_f32 v99, v70, v71
    v_lshlrev_b32 v64, 16, v96
    v_and_b32 v65, 0xffff0000, v96
    v_lshlrev_b32 v66, 16, v97
    v_and_b32 v67, 0xffff0000, v97
    v_lshlrev_b32 v68, 16, v98
    v_and_b32 v69, 0xffff0000, v98
    v_lshlrev_b32 v70, 16, v99
    v_and_b32 v71, 0xffff0000, v99
    s_add_u32 s54, s75, 13635584
    buffer_store_dwordx4 v[96:99], v2, s[44:47], s54 offen sc1
    s_waitcnt vmcnt(4)
    s_add_u32 s53, s61, 0
    buffer_store_dword v3, off, s[44:47], s53 sc1
    s_add_u32 s13, s14, 1548288
    buffer_load_dwordx4 v[236:239], v2, s[44:47], s13 offen sc1
    s_add_u32 s13, s14, 1605632
    buffer_load_dwordx4 v[240:243], v2, s[44:47], s13 offen sc1
    s_add_u32 s13, s14, 1662976
    buffer_load_dwordx4 v[244:247], v2, s[44:47], s13 offen sc1
    s_add_u32 s13, s14, 1720320
    buffer_load_dwordx4 v[248:251], v2, s[44:47], s13 offen sc1
    s_add_u32 s13, s14, 1777664
    buffer_load_dwordx4 v[252:255], v2, s[44:47], s13 offen sc1
    s_add_u32 s13, s15, 0
    buffer_load_dwordx4 a[0:3], v2, s[44:47], s13 offen sc1
    s_add_u32 s13, s15, 0
    buffer_load_dwordx4 a[112:115], v2, s[44:47], s13 offen offset:1024 sc1
    s_add_u32 s13, s15, 65536
    buffer_load_dwordx4 a[4:7], v2, s[44:47], s13 offen sc1
    v_pk_add_f32 v[100:101], v[64:65], v[66:67]
    v_pk_mul_f32 v[102:103], v[64:65], v[64:65]
    v_pk_add_f32 v[104:105], v[68:69], v[70:71]
    v_pk_fma_f32 v[102:103], v[66:67], v[66:67], v[102:103]
    v_pk_add_f32 v[100:101], v[100:101], v[104:105]
    v_pk_fma_f32 v[102:103], v[68:69], v[68:69], v[102:103]
    v_add_f32 v100, v100, v101
    v_pk_fma_f32 v[102:103], v[70:71], v[70:71], v[102:103]
    v_add_f32 v102, v102, v103
    s_nop 0
    v_add_f32_dpp v100, v100, v100 quad_perm:[1,0,3,2] row_mask:0xf bank_mask:0xf
    v_add_f32_dpp v102, v102, v102 quad_perm:[1,0,3,2] row_mask:0xf bank_mask:0xf
    s_nop 0
    v_add_f32_dpp v100, v100, v100 quad_perm:[2,3,0,1] row_mask:0xf bank_mask:0xf
    v_add_f32_dpp v102, v102, v102 quad_perm:[2,3,0,1] row_mask:0xf bank_mask:0xf
    s_nop 0
    v_add_f32_dpp v100, v100, v100 row_half_mirror row_mask:0xf bank_mask:0xf
    v_add_f32_dpp v102, v102, v102 row_half_mirror row_mask:0xf bank_mask:0xf
    s_nop 0
    v_add_f32_dpp v100, v100, v100 row_mirror row_mask:0xf bank_mask:0xf
    v_add_f32_dpp v102, v102, v102 row_mirror row_mask:0xf bank_mask:0xf
    s_nop 0
    v_add_f32_dpp v100, v100, v100 row_bcast:15 row_mask:0xa bank_mask:0xf
    v_add_f32_dpp v102, v102, v102 row_bcast:15 row_mask:0xa bank_mask:0xf
    s_nop 0
    v_add_f32_dpp v100, v100, v100 row_bcast:31 row_mask:0xc bank_mask:0xf
    v_add_f32_dpp v102, v102, v102 row_bcast:31 row_mask:0xc bank_mask:0xf
    s_nop 0
    v_readlane_b32 s58, v100, 63
    v_readlane_b32 s59, v102, 63
    s_nop 1
    v_mul_f32 v104, s58, v108
    v_mul_f32 v102, s59, v108
    v_fma_f32 v102, -v104, v104, v102
    v_max_f32 v102, 0, v102
    v_add_f32 v100, 0x3727c5ac, v102
    v_rsq_f32 v100, v100
    s_nop 0
    v_mul_f32 v102, v102, v100
    v_fmaak_f32 v102, v102, v100, 0x3727c5ac
    v_rsq_f32 v102, v102
    s_nop 0
    v_mul_f32 v102, v102, v100
    v_mul_f32 v104, v104, v102
    v_pk_fma_f32 v[72:73], v[64:65], v[102:103], v[104:105] op_sel_hi:[1,0,0] neg_lo:[0,0,1] neg_hi:[0,0,1]
    v_pk_fma_f32 v[74:75], v[66:67], v[102:103], v[104:105] op_sel_hi:[1,0,0] neg_lo:[0,0,1] neg_hi:[0,0,1]
    v_pk_fma_f32 v[76:77], v[68:69], v[102:103], v[104:105] op_sel_hi:[1,0,0] neg_lo:[0,0,1] neg_hi:[0,0,1]
    v_pk_fma_f32 v[78:79], v[70:71], v[102:103], v[104:105] op_sel_hi:[1,0,0] neg_lo:[0,0,1] neg_hi:[0,0,1]
    v_cvt_pk_bf16_f32 v80, v72, v73
    v_cvt_pk_bf16_f32 v81, v74, v75
    v_cvt_pk_bf16_f32 v82, v76, v77
    v_cvt_pk_bf16_f32 v83, v78, v79
    s_add_u32 s54, s75, 9441280
    buffer_store_dwordx4 v[80:83], v2, s[44:47], s54 offen sc1
    s_add_u32 s13, s15, 65536
    buffer_load_dwordx4 a[116:119], v2, s[44:47], s13 offen offset:1024 sc1
    s_add_u32 s13, s15, 131072
    buffer_load_dwordx4 a[8:11], v2, s[44:47], s13 offen sc1
    s_add_u32 s13, s15, 131072
    buffer_load_dwordx4 a[120:123], v2, s[44:47], s13 offen offset:1024 sc1
    s_add_u32 s13, s15, 196608
    buffer_load_dwordx4 a[12:15], v2, s[44:47], s13 offen sc1
    s_add_u32 s13, s15, 196608
    buffer_load_dwordx4 a[124:127], v2, s[44:47], s13 offen offset:1024 sc1
    s_waitcnt vmcnt(5)
    s_add_u32 s53, s61, 4096
    buffer_store_dword v3, off, s[44:47], s53 sc1
    s_mov_b32 s64, 0
    s_cmp_ge_u32 s49, 28
    s_cbranch_scc1 L_idle_50
    v_add_u32 v100, 0, v120
    v_add_u32 v101, 4096, v120
    buffer_load_dword v102, v100, s[44:47], 0 offen sc1
    s_barrier
    s_mov_b32 s4, s32
    s_and_b32 s5, s33, 0xffff
    s_mov_b32 s6, 3584
    s_mov_b32 s7, 0x00020000
    v_lshrrev_b32 v14, 5, v1
    v_lshlrev_b32 v15, 3, v14
    s_lshl_b32 s53, s68, 6
    buffer_load_dwordx2 v[104:105], v15, s[4:7], s53 offen
    buffer_load_dwordx2 v[106:107], v15, s[4:7], s53 offen offset:16
    buffer_load_dwordx2 v[108:109], v15, s[4:7], s53 offen offset:32
    buffer_load_dwordx2 v[110:111], v15, s[4:7], s53 offen offset:48
    v_mov_b32 v12, 0xbdd2d3e8
    v_mov_b32 v13, 0xc0135761
    v_mov_b32 v14, 1.0
    v_mov_b32 v15, 1.0
    s_waitcnt vmcnt(4)
    v_cmp_ne_u32 vcc, s51, v102
    s_cbranch_vccz L_pcd_53
    s_mov_b32 s53, 0
L_pc_52:
    buffer_load_dword v102, v100, s[44:47], 0 offen sc1
    s_waitcnt vmcnt(0)
    v_cmp_ne_u32 vcc, s51, v102
    s_cbranch_vccz L_pcd_53
    s_add_u32 s53, s53, 1
    s_cmp_lg_u32 s52, 0
    s_cbranch_scc1 L_pcd_53
    s_cmp_lt_u32 s53, 0x8000
    s_cbranch_scc1 L_pc_52
    s_mov_b32 s52, 1
L_pcd_53:
    s_add_u32 m0, s73, 0
    s_add_u32 s57, s72, 0
    v_xor_b32 v103, 0, v121
    buffer_load_dwordx4 v103, s[44:47], s57 offen sc1 lds
    v_xor_b32 v103, 16, v121
    buffer_load_dwordx4 v103, s[44:47], s57 offen offset:1024 sc1 lds
    v_xor_b32 v103, 32, v121
    buffer_load_dwordx4 v103, s[44:47], s57 offen offset:2048 sc1 lds
    v_xor_b32 v103, 48, v121
    buffer_load_dwordx4 v103, s[44:47], s57 offen offset:3072 sc1 lds
    s_add_u32 m0, s73, 4096
    s_add_u32 s57, s72, 8192
    v_xor_b32 v103, 64, v121
    buffer_load_dwordx4 v103, s[44:47], s57 offen sc1 lds
    v_xor_b32 v103, 80, v121
    buffer_load_dwordx4 v103, s[44:47], s57 offen offset:1024 sc1 lds
    v_xor_b32 v103, 96, v121
    buffer_load_dwordx4 v103, s[44:47], s57 offen offset:2048 sc1 lds
    v_xor_b32 v103, 112, v121
    buffer_load_dwordx4 v103, s[44:47], s57 offen offset:3072 sc1 lds
    buffer_load_dword v102, v101, s[44:47], 0 offen sc1
    s_waitcnt vmcnt(9)
    v_lshlrev_b32 v48, 16, v104
    v_and_b32 v49, 0xffff0000, v104
    v_lshlrev_b32 v50, 16, v105
    v_and_b32 v51, 0xffff0000, v105
    v_lshlrev_b32 v52, 16, v106
    v_and_b32 v53, 0xffff0000, v106
    v_lshlrev_b32 v54, 16, v107
    v_and_b32 v55, 0xffff0000, v107
    v_lshlrev_b32 v56, 16, v108
    v_and_b32 v57, 0xffff0000, v108
    v_lshlrev_b32 v58, 16, v109
    v_and_b32 v59, 0xffff0000, v109
    v_lshlrev_b32 v60, 16, v110
    v_and_b32 v61, 0xffff0000, v110
    v_lshlrev_b32 v62, 16, v111
    v_and_b32 v63, 0xffff0000, v111
    s_waitcnt vmcnt(1)
    s_barrier
    ds_read_b128 v[64:67], v4 offset:0
    ds_read_b128 v[68:71], v5 offset:0
    ds_read_b128 v[72:75], v6 offset:0
    ds_read_b128 v[76:79], v7 offset:0
    ds_read_b128 v[80:83], v8 offset:0
    ds_read_b128 v[84:87], v9 offset:0
    ds_read_b128 v[88:91], v10 offset:0
    s_waitcnt lgkmcnt(3)
    v_mfma_f32_32x32x16_bf16 v[16:31], v[128:131], v[64:67], v[48:63]
    ds_read_b128 v[92:95], v11 offset:0
    s_add_u32 m0, s73, 32768
    s_add_u32 s57, s72, 65536
    v_xor_b32 v103, 0, v121
    buffer_load_dwordx4 v103, s[44:47], s57 offen sc1 lds
    v_mfma_f32_32x32x16_bf16 v[16:31], v[132:135], v[68:71], v[16:31]
    ds_read_b128 v[64:67], v4 offset:256
    v_xor_b32 v103, 16, v121
    buffer_load_dwordx4 v103, s[44:47], s57 offen offset:1024 sc1 lds
    v_mfma_f32_32x32x16_bf16 v[16:31], v[136:139], v[72:75], v[16:31]
    ds_read_b128 v[68:71], v5 offset:256
    v_xor_b32 v103, 32, v121
    buffer_load_dwordx4 v103, s[44:47], s57 offen offset:2048 sc1 lds
    v_mfma_f32_32x32x16_bf16 v[16:31], v[140:143], v[76:79], v[16:31]
    ds_read_b128 v[72:75], v6 offset:256
    v_xor_b32 v103, 48, v121
    buffer_load_dwordx4 v103, s[44:47], s57 offen offset:3072 sc1 lds
    s_waitcnt lgkmcnt(3)
    v_mfma_f32_32x32x16_bf16 v[16:31], v[144:147], v[80:83], v[16:31]
    ds_read_b128 v[76:79], v7 offset:256
    s_add_u32 m0, s73, 36864
    s_add_u32 s57, s72, 73728
    v_xor_b32 v103, 64, v121
    buffer_load_dwordx4 v103, s[44:47], s57 offen sc1 lds
    v_mfma_f32_32x32x16_bf16 v[16:31], v[148:151], v[84:87], v[16:31]
    ds_read_b128 v[80:83], v8 offset:256
    v_xor_b32 v103, 80, v121
    buffer_load_dwordx4 v103, s[44:47], s57 offen offset:1024 sc1 lds
    v_mfma_f32_32x32x16_bf16 v[16:31], v[152:155], v[88:91], v[16:31]
    ds_read_b128 v[84:87], v9 offset:256
    v_xor_b32 v103, 96, v121
    buffer_load_dwordx4 v103, s[44:47], s57 offen offset:2048 sc1 lds
    v_mfma_f32_32x32x16_bf16 v[16:31], v[156:159], v[92:95], v[16:31]
    ds_read_b128 v[88:91], v10 offset:256
    v_xor_b32 v103, 112, v121
    buffer_load_dwordx4 v103, s[44:47], s57 offen offset:3072 sc1 lds
    s_waitcnt lgkmcnt(3)
    v_mfma_f32_32x32x16_bf16 v[16:31], v[160:163], v[64:67], v[16:31]
    ds_read_b128 v[92:95], v11 offset:256
    s_waitcnt vmcnt(8)
    v_cmp_ne_u32 vcc, s51, v102
    s_cbranch_vccz L_pcd_55
    s_mov_b32 s53, 0
L_pc_54:
    buffer_load_dword v102, v101, s[44:47], 0 offen sc1
    s_waitcnt vmcnt(0)
    v_cmp_ne_u32 vcc, s51, v102
    s_cbranch_vccz L_pcd_55
    s_add_u32 s53, s53, 1
    s_cmp_lg_u32 s52, 0
    s_cbranch_scc1 L_pcd_55
    s_cmp_lt_u32 s53, 0x8000
    s_cbranch_scc1 L_pc_54
    s_mov_b32 s52, 1
L_pcd_55:
    v_mfma_f32_32x32x16_bf16 v[16:31], v[164:167], v[68:71], v[16:31]
    ds_read_b128 v[64:67], v4 offset:512
    s_add_u32 m0, s73, 65536
    s_add_u32 s57, s72, 4096
    v_xor_b32 v103, 0, v121
    buffer_load_dwordx4 v103, s[44:47], s57 offen sc1 lds
    v_mfma_f32_32x32x16_bf16 v[16:31], v[168:171], v[72:75], v[16:31]
    ds_read_b128 v[68:71], v5 offset:512
    v_xor_b32 v103, 16, v121
    buffer_load_dwordx4 v103, s[44:47], s57 offen offset:1024 sc1 lds
    v_mfma_f32_32x32x16_bf16 v[16:31], v[172:175], v[76:79], v[16:31]
    ds_read_b128 v[72:75], v6 offset:512
    v_xor_b32 v103, 32, v121
    buffer_load_dwordx4 v103, s[44:47], s57 offen offset:2048 sc1 lds
    s_waitcnt lgkmcnt(3)
    v_mfma_f32_32x32x16_bf16 v[16:31], v[176:179], v[80:83], v[16:31]
    ds_read_b128 v[76:79], v7 offset:512
    v_mfma_f32_32x32x16_bf16 v[16:31], v[180:183], v[84:87], v[16:31]
    ds_read_b128 v[80:83], v8 offset:512
    v_xor_b32 v103, 48, v121
    buffer_load_dwordx4 v103, s[44:47], s57 offen offset:3072 sc1 lds
    v_mfma_f32_32x32x16_bf16 v[16:31], v[184:187], v[88:91], v[16:31]
    ds_read_b128 v[84:87], v9 offset:512
    s_add_u32 m0, s73, 69632
    s_add_u32 s57, s72, 12288
    v_xor_b32 v103, 64, v121
    buffer_load_dwordx4 v103, s[44:47], s57 offen sc1 lds
    v_mfma_f32_32x32x16_bf16 v[16:31], v[188:191], v[92:95], v[16:31]
    ds_read_b128 v[88:91], v10 offset:512
    v_xor_b32 v103, 80, v121
    buffer_load_dwordx4 v103, s[44:47], s57 offen offset:1024 sc1 lds
    s_waitcnt lgkmcnt(3)
    v_mfma_f32_32x32x16_bf16 v[16:31], v[192:195], v[64:67], v[16:31]
    ds_read_b128 v[92:95], v11 offset:512
    v_mfma_f32_32x32x16_bf16 v[16:31], v[196:199], v[68:71], v[16:31]
    ds_read_b128 v[64:67], v4 offset:768
    v_xor_b32 v103, 96, v121
    buffer_load_dwordx4 v103, s[44:47], s57 offen offset:2048 sc1 lds
    v_mfma_f32_32x32x16_bf16 v[16:31], v[200:203], v[72:75], v[16:31]
    ds_read_b128 v[68:71], v5 offset:768
    v_xor_b32 v103, 112, v121
    buffer_load_dwordx4 v103, s[44:47], s57 offen offset:3072 sc1 lds
    v_mfma_f32_32x32x16_bf16 v[16:31], v[204:207], v[76:79], v[16:31]
    ds_read_b128 v[72:75], v6 offset:768
    s_waitcnt lgkmcnt(3)
    v_mfma_f32_32x32x16_bf16 v[16:31], v[208:211], v[80:83], v[16:31]
    ds_read_b128 v[76:79], v7 offset:768
    s_add_u32 m0, s73, 98304
    s_add_u32 s57, s72, 69632
    v_xor_b32 v103, 0, v121
    buffer_load_dwordx4 v103, s[44:47], s57 offen sc1 lds
    v_mfma_f32_32x32x16_bf16 v[16:31], v[212:215], v[84:87], v[16:31]
    ds_read_b128 v[80:83], v8 offset:768
    v_xor_b32 v103, 16, v121
    buffer_load_dwordx4 v103, s[44:47], s57 offen offset:1024 sc1 lds
    v_mfma_f32_32x32x16_bf16 v[16:31], v[216:219], v[88:91], v[16:31]
    ds_read_b128 v[84:87], v9 offset:768
    v_xor_b32 v103, 32, v121
    buffer_load_dwordx4 v103, s[44:47], s57 offen offset:2048 sc1 lds
    v_mfma_f32_32x32x16_bf16 v[16:31], v[220:223], v[92:95], v[16:31]
    ds_read_b128 v[88:91], v10 offset:768
    s_waitcnt lgkmcnt(3)
    v_mfma_f32_32x32x16_bf16 v[16:31], v[224:227], v[64:67], v[16:31]
    ds_read_b128 v[92:95], v11 offset:768
    v_xor_b32 v103, 48, v121
    buffer_load_dwordx4 v103, s[44:47], s57 offen offset:3072 sc1 lds
    v_mfma_f32_32x32x16_bf16 v[16:31], v[228:231], v[68:71], v[16:31]
    s_waitcnt vmcnt(12)
    s_barrier
    s_add_u32 m0, s73, 102400
    s_add_u32 s57, s72, 77824
    v_xor_b32 v103, 64, v121
    buffer_load_dwordx4 v103, s[44:47], s57 offen sc1 lds
    ds_read_b128 v[64:67], v4 offset:32768
    v_mfma_f32_32x32x16_bf16 v[16:31], v[232:235], v[72:75], v[16:31]
    v_xor_b32 v103, 80, v121
    buffer_load_dwordx4 v103, s[44:47], s57 offen offset:1024 sc1 lds
    ds_read_b128 v[68:71], v5 offset:32768
    v_mfma_f32_32x32x16_bf16 v[16:31], v[236:239], v[76:79], v[16:31]
    ds_read_b128 v[72:75], v6 offset:32768
    s_waitcnt lgkmcnt(3)
    v_mfma_f32_32x32x16_bf16 v[16:31], v[240:243], v[80:83], v[16:31]
    v_xor_b32 v103, 96, v121
    buffer_load_dwordx4 v103, s[44:47], s57 offen offset:2048 sc1 lds
    ds_read_b128 v[76:79], v7 offset:32768
    v_mfma_f32_32x32x16_bf16 v[16:31], v[244:247], v[84:87], v[16:31]
    v_xor_b32 v103, 112, v121
    buffer_load_dwordx4 v103, s[44:47], s57 offen offset:3072 sc1 lds
    ds_read_b128 v[80:83], v8 offset:32768
    v_mfma_f32_32x32x16_bf16 v[16:31], v[248:251], v[88:91], v[16:31]
    ds_read_b128 v[84:87], v9 offset:32768
    v_mfma_f32_32x32x16_bf16 v[16:31], v[252:255], v[92:95], v[16:31]
    ds_read_b128 v[88:91], v10 offset:32768
    s_waitcnt lgkmcnt(3)
    v_mfma_f32_32x32x16_bf16 v[32:47], v[128:131], v[64:67], v[48:63]
    ds_read_b128 v[92:95], v11 offset:32768
    v_mfma_f32_32x32x16_bf16 v[32:47], v[132:135], v[68:71], v[32:47]
    ds_read_b128 v[64:67], v4 offset:33024
    s_add_u32 s13, s15, 262144
    buffer_load_dwordx4 a[16:19], v2, s[44:47], s13 offen sc1
    v_mfma_f32_32x32x16_bf16 v[32:47], v[136:139], v[72:75], v[32:47]
    ds_read_b128 v[68:71], v5 offset:33024
    s_add_u32 s13, s15, 262144
    buffer_load_dwordx4 a[128:131], v2, s[44:47], s13 offen offset:1024 sc1
    v_mfma_f32_32x32x16_bf16 v[32:47], v[140:143], v[76:79], v[32:47]
    ds_read_b128 v[72:75], v6 offset:33024
    s_add_u32 s13, s15, 327680
    buffer_load_dwordx4 a[20:23], v2, s[44:47], s13 offen sc1
    s_waitcnt lgkmcnt(3)
    v_mfma_f32_32x32x16_bf16 v[32:47], v[144:147], v[80:83], v[32:47]
    ds_read_b128 v[76:79], v7 offset:33024
    s_add_u32 s74, s71, 0
    v_mul_f32 v96, v16, v16
    v_mul_f32 v97, v17, v17
    v_fma_f32 v96, v96, v12, v13
    v_fma_f32 v97, v97, v12, v13
    v_mul_f32 v96, v96, v16
    v_mfma_f32_32x32x16_bf16 v[32:47], v[148:151], v[84:87], v[32:47]
    ds_read_b128 v[80:83], v8 offset:33024
    v_mul_f32 v97, v97, v17
    v_exp_f32 v96, v96
    v_exp_f32 v97, v97
    v_add_f32 v96, 1.0, v96
    v_add_f32 v97, 1.0, v97
    s_add_u32 s13, s15, 327680
    buffer_load_dwordx4 a[132:135], v2, s[44:47], s13 offen offset:1024 sc1
    v_mfma_f32_32x32x16_bf16 v[32:47], v[152:155], v[88:91], v[32:47]
    ds_read_b128 v[84:87], v9 offset:33024
    v_rcp_f32 v96, v96
    v_rcp_f32 v97, v97
    v_mul_f32 v16, v16, v96
    v_mul_f32 v17, v17, v97
    v_cvt_pk_bf16_f32 v104, v16, v17
    s_add_u32 s13, s15, 393216
    buffer_load_dwordx4 a[24:27], v2, s[44:47], s13 offen sc1
    v_mfma_f32_32x32x16_bf16 v[32:47], v[156:159], v[92:95], v[32:47]
    ds_read_b128 v[88:91], v10 offset:33024
    v_mul_f32 v98, v18, v18
    v_mul_f32 v99, v19, v19
    v_fma_f32 v98, v98, v12, v13
    v_fma_f32 v99, v99, v12, v13
    v_mul_f32 v98, v98, v18
    s_waitcnt lgkmcnt(3)
    v_mfma_f32_32x32x16_bf16 v[32:47], v[160:163], v[64:67], v[32:47]
    ds_read_b128 v[92:95], v11 offset:33024
    v_mul_f32 v99, v99, v19
    v_exp_f32 v98, v98
    v_exp_f32 v99, v99
    v_add_f32 v98, 1.0, v98
    v_add_f32 v99, 1.0, v99
    s_add_u32 s13, s15, 393216
    buffer_load_dwordx4 a[136:139], v2, s[44:47], s13 offen offset:1024 sc1
    v_mfma_f32_32x32x16_bf16 v[32:47], v[164:167], v[68:71], v[32:47]
    ds_read_b128 v[64:67], v4 offset:33280
    v_rcp_f32 v98, v98
    v_rcp_f32 v99, v99
    v_mul_f32 v18, v18, v98
    v_mul_f32 v19, v19, v99
    v_cvt_pk_bf16_f32 v105, v18, v19
    s_add_u32 s13, s15, 458752
    buffer_load_dwordx4 a[28:31], v2, s[44:47], s13 offen sc1
    v_mfma_f32_32x32x16_bf16 v[32:47], v[168:171], v[72:75], v[32:47]
    ds_read_b128 v[68:71], v5 offset:33280
    v_mul_f32 v96, v20, v20
    v_mul_f32 v97, v21, v21
    v_fma_f32 v96, v96, v12, v13
    v_fma_f32 v97, v97, v12, v13
    v_mul_f32 v96, v96, v20
    v_mfma_f32_32x32x16_bf16 v[32:47], v[172:175], v[76:79], v[32:47]
    ds_read_b128 v[72:75], v6 offset:33280
    v_mul_f32 v97, v97, v21
    v_exp_f32 v96, v96
    v_exp_f32 v97, v97
    v_add_f32 v96, 1.0, v96
    v_add_f32 v97, 1.0, v97
    s_add_u32 s13, s15, 458752
    buffer_load_dwordx4 a[140:143], v2, s[44:47], s13 offen offset:1024 sc1
    s_waitcnt lgkmcnt(3)
    v_mfma_f32_32x32x16_bf16 v[32:47], v[176:179], v[80:83], v[32:47]
    ds_read_b128 v[76:79], v7 offset:33280
    v_rcp_f32 v96, v96
    v_rcp_f32 v97, v97
    v_mul_f32 v20, v20, v96
    v_mul_f32 v21, v21, v97
    v_cvt_pk_bf16_f32 v106, v20, v21
    v_mul_f32 v98, v22, v22
    s_add_u32 s13, s15, 524288
    buffer_load_dwordx4 a[32:35], v2, s[44:47], s13 offen sc1
    v_mfma_f32_32x32x16_bf16 v[32:47], v[180:183], v[84:87], v[32:47]
    ds_read_b128 v[80:83], v8 offset:33280
    v_mul_f32 v99, v23, v23
    v_fma_f32 v98, v98, v12, v13
    v_fma_f32 v99, v99, v12, v13
    v_mul_f32 v98, v98, v22
    v_mul_f32 v99, v99, v23
    s_add_u32 s13, s15, 524288
    buffer_load_dwordx4 a[144:147], v2, s[44:47], s13 offen offset:1024 sc1
    v_mfma_f32_32x32x16_bf16 v[32:47], v[184:187], v[88:91], v[32:47]
    ds_read_b128 v[84:87], v9 offset:33280
    v_exp_f32 v98, v98
    v_exp_f32 v99, v99
    v_add_f32 v98, 1.0, v98
    v_add_f32 v99, 1.0, v99
    v_rcp_f32 v98, v98
    v_mfma_f32_32x32x16_bf16 v[32:47], v[188:191], v[92:95], v[32:47]
    ds_read_b128 v[88:91], v10 offset:33280
    v_rcp_f32 v99, v99
    v_mul_f32 v22, v22, v98
    v_mul_f32 v23, v23, v99
    v_cvt_pk_bf16_f32 v107, v22, v23
    buffer_store_dwordx4 v[104:107], v2, s[44:47], s74 offen sc1
    s_add_u32 s13, s15, 589824
    buffer_load_dwordx4 a[36:39], v2, s[44:47], s13 offen sc1
    s_waitcnt lgkmcnt(3)
    v_mfma_f32_32x32x16_bf16 v[32:47], v[192:195], v[64:67], v[32:47]
    ds_read_b128 v[92:95], v11 offset:33280
    v_mul_f32 v96, v24, v24
    v_mul_f32 v97, v25, v25
    v_fma_f32 v96, v96, v12, v13
    v_fma_f32 v97, v97, v12, v13
    v_mul_f32 v96, v96, v24
    s_add_u32 s13, s15, 589824
    buffer_load_dwordx4 a[148:151], v2, s[44:47], s13 offen offset:1024 sc1
    v_mfma_f32_32x32x16_bf16 v[32:47], v[196:199], v[68:71], v[32:47]
    ds_read_b128 v[64:67], v4 offset:33536
    v_mul_f32 v97, v97, v25
    v_exp_f32 v96, v96
    v_exp_f32 v97, v97
    v_add_f32 v96, 1.0, v96
    v_add_f32 v97, 1.0, v97
    v_mfma_f32_32x32x16_bf16 v[32:47], v[200:203], v[72:75], v[32:47]
    ds_read_b128 v[68:71], v5 offset:33536
    v_rcp_f32 v96, v96
    v_rcp_f32 v97, v97
    v_mul_f32 v24, v24, v96
    v_mul_f32 v25, v25, v97
    v_cvt_pk_bf16_f32 v108, v24, v25
    s_add_u32 s13, s15, 655360
    buffer_load_dwordx4 a[40:43], v2, s[44:47], s13 offen sc1
    v_mfma_f32_32x32x16_bf16 v[32:47], v[204:207], v[76:79], v[32:47]
    ds_read_b128 v[72:75], v6 offset:33536
    v_mul_f32 v98, v26, v26
    v_mul_f32 v99, v27, v27
    v_fma_f32 v98, v98, v12, v13
    v_fma_f32 v99, v99, v12, v13
    v_mul_f32 v98, v98, v26
    s_add_u32 s13, s15, 655360
    buffer_load_dwordx4 a[152:155], v2, s[44:47], s13 offen offset:1024 sc1
    s_waitcnt lgkmcnt(3)
    v_mfma_f32_32x32x16_bf16 v[32:47], v[208:211], v[80:83], v[32:47]
    ds_read_b128 v[76:79], v7 offset:33536
    v_mul_f32 v99, v99, v27
    v_exp_f32 v98, v98
    v_exp_f32 v99, v99
    v_add_f32 v98, 1.0, v98
    v_add_f32 v99, 1.0, v99
    v_rcp_f32 v98, v98
    v_mfma_f32_32x32x16_bf16 v[32:47], v[212:215], v[84:87], v[32:47]
    ds_read_b128 v[80:83], v8 offset:33536
    v_rcp_f32 v99, v99
    v_mul_f32 v26, v26, v98
    v_mul_f32 v27, v27, v99
    v_cvt_pk_bf16_f32 v109, v26, v27
    v_mul_f32 v96, v28, v28
    s_add_u32 s13, s15, 720896
    buffer_load_dwordx4 a[44:47], v2, s[44:47], s13 offen sc1
    v_mfma_f32_32x32x16_bf16 v[32:47], v[216:219], v[88:91], v[32:47]
    ds_read_b128 v[84:87], v9 offset:33536
    v_mul_f32 v97, v29, v29
    v_fma_f32 v96, v96, v12, v13
    v_fma_f32 v97, v97, v12, v13
    v_mul_f32 v96, v96, v28
    v_mul_f32 v97, v97, v29
    s_add_u32 s13, s15, 720896
    buffer_load_dwordx4 a[156:159], v2, s[44:47], s13 offen offset:1024 sc1
    v_mfma_f32_32x32x16_bf16 v[32:47], v[220:223], v[92:95], v[32:47]
    ds_read_b128 v[88:91], v10 offset:33536
    v_exp_f32 v96, v96
    v_exp_f32 v97, v97
    v_add_f32 v96, 1.0, v96
    v_add_f32 v97, 1.0, v97
    v_rcp_f32 v96, v96
    s_waitcnt lgkmcnt(3)
    v_mfma_f32_32x32x16_bf16 v[32:47], v[224:227], v[64:67], v[32:47]
    ds_read_b128 v[92:95], v11 offset:33536
    v_rcp_f32 v97, v97
    v_mul_f32 v28, v28, v96
    v_mul_f32 v29, v29, v97
    v_cvt_pk_bf16_f32 v110, v28, v29
    v_mul_f32 v98, v30, v30
    v_mfma_f32_32x32x16_bf16 v[32:47], v[228:231], v[68:71], v[32:47]
    v_mul_f32 v99, v31, v31
    v_fma_f32 v98, v98, v12, v13
    v_fma_f32 v99, v99, v12, v13
    v_mul_f32 v98, v98, v30
    v_mul_f32 v99, v99, v31
    s_waitcnt vmcnt(25)
    s_barrier
    v_add_u32 v4, 0x10000, v4
    v_add_u32 v5, 0x10000, v5
    v_add_u32 v6, 0x10000, v6
    v_add_u32 v7, 0x10000, v7
    v_add_u32 v8, 0x10000, v8
    v_add_u32 v9, 0x10000, v9
    v_add_u32 v10, 0x10000, v10
    v_add_u32 v11, 0x10000, v11
    ds_read_b128 v[64:67], v4 offset:0
    v_mfma_f32_32x32x16_bf16 v[32:47], v[232:235], v[72:75], v[32:47]
    v_exp_f32 v98, v98
    v_exp_f32 v99, v99
    v_add_f32 v98, 1.0, v98
    v_add_f32 v99, 1.0, v99
    v_rcp_f32 v98, v98
    ds_read_b128 v[68:71], v5 offset:0
    v_mfma_f32_32x32x16_bf16 v[32:47], v[236:239], v[76:79], v[32:47]
    v_rcp_f32 v99, v99
    v_mul_f32 v30, v30, v98
    v_mul_f32 v31, v31, v99
    v_cvt_pk_bf16_f32 v111, v30, v31
    buffer_store_dwordx4 v[108:111], v2, s[44:47], s74 offen offset:1024 sc1
    ds_read_b128 v[72:75], v6 offset:0
    s_waitcnt lgkmcnt(3)
    v_mfma_f32_32x32x16_bf16 v[32:47], v[240:243], v[80:83], v[32:47]
    ds_read_b128 v[76:79], v7 offset:0
    v_mfma_f32_32x32x16_bf16 v[32:47], v[244:247], v[84:87], v[32:47]
    ds_read_b128 v[80:83], v8 offset:0
    v_mfma_f32_32x32x16_bf16 v[32:47], v[248:251], v[88:91], v[32:47]
    ds_read_b128 v[84:87], v9 offset:0
    v_mfma_f32_32x32x16_bf16 v[32:47], v[252:255], v[92:95], v[32:47]
    ds_read_b128 v[88:91], v10 offset:0
    s_waitcnt lgkmcnt(3)
    v_mfma_f32_32x32x16_bf16 v[16:31], v[128:131], v[64:67], v[48:63]
    ds_read_b128 v[92:95], v11 offset:0
    v_mfma_f32_32x32x16_bf16 v[16:31], v[132:135], v[68:71], v[16:31]
    ds_read_b128 v[64:67], v4 offset:256
    s_add_u32 s13, s15, 786432
    buffer_load_dwordx4 a[48:51], v2, s[44:47], s13 offen sc1
    v_mfma_f32_32x32x16_bf16 v[16:31], v[136:139], v[72:75], v[16:31]
    ds_read_b128 v[68:71], v5 offset:256
    s_add_u32 s13, s15, 786432
    buffer_load_dwordx4 a[160:163], v2, s[44:47], s13 offen offset:1024 sc1
    v_mfma_f32_32x32x16_bf16 v[16:31], v[140:143], v[76:79], v[16:31]
    ds_read_b128 v[72:75], v6 offset:256
    s_add_u32 s13, s15, 851968
    buffer_load_dwordx4 a[52:55], v2, s[44:47], s13 offen sc1
    s_waitcnt lgkmcnt(3)
    v_mfma_f32_32x32x16_bf16 v[16:31], v[144:147], v[80:83], v[16:31]
    ds_read_b128 v[76:79], v7 offset:256
    s_add_u32 s74, s71, 114688
    v_mul_f32 v96, v32, v32
    v_mul_f32 v97, v33, v33
    v_fma_f32 v96, v96, v12, v13
    v_fma_f32 v97, v97, v12, v13
    v_mul_f32 v96, v96, v32
    v_mfma_f32_32x32x16_bf16 v[16:31], v[148:151], v[84:87], v[16:31]
    ds_read_b128 v[80:83], v8 offset:256
    v_mul_f32 v97, v97, v33
    v_exp_f32 v96, v96
    v_exp_f32 v97, v97
    v_add_f32 v96, 1.0, v96
    v_add_f32 v97, 1.0, v97
    s_add_u32 s13, s15, 851968
    buffer_load_dwordx4 a[164:167], v2, s[44:47], s13 offen offset:1024 sc1
    v_mfma_f32_32x32x16_bf16 v[16:31], v[152:155], v[88:91], v[16:31]
    ds_read_b128 v[84:87], v9 offset:256
    v_rcp_f32 v96, v96
    v_rcp_f32 v97, v97
    v_mul_f32 v32, v32, v96
    v_mul_f32 v33, v33, v97
    v_cvt_pk_bf16_f32 v104, v32, v33
    s_add_u32 s13, s15, 917504
    buffer_load_dwordx4 a[56:59], v2, s[44:47], s13 offen sc1
    v_mfma_f32_32x32x16_bf16 v[16:31], v[156:159], v[92:95], v[16:31]
    ds_read_b128 v[88:91], v10 offset:256
    v_mul_f32 v98, v34, v34
    v_mul_f32 v99, v35, v35
    v_fma_f32 v98, v98, v12, v13
    v_fma_f32 v99, v99, v12, v13
    v_mul_f32 v98, v98, v34
    s_waitcnt lgkmcnt(3)
    v_mfma_f32_32x32x16_bf16 v[16:31], v[160:163], v[64:67], v[16:31]
    ds_read_b128 v[92:95], v11 offset:256
    v_mul_f32 v99, v99, v35
    v_exp_f32 v98, v98
    v_exp_f32 v99, v99
    v_add_f32 v98, 1.0, v98
    v_add_f32 v99, 1.0, v99
    s_add_u32 s13, s15, 917504
    buffer_load_dwordx4 a[168:171], v2, s[44:47], s13 offen offset:1024 sc1
    v_mfma_f32_32x32x16_bf16 v[16:31], v[164:167], v[68:71], v[16:31]
    ds_read_b128 v[64:67], v4 offset:512
    v_rcp_f32 v98, v98
    v_rcp_f32 v99, v99
    v_mul_f32 v34, v34, v98
    v_mul_f32 v35, v35, v99
    v_cvt_pk_bf16_f32 v105, v34, v35
    s_add_u32 s13, s15, 983040
    buffer_load_dwordx4 a[60:63], v2, s[44:47], s13 offen sc1
    v_mfma_f32_32x32x16_bf16 v[16:31], v[168:171], v[72:75], v[16:31]
    ds_read_b128 v[68:71], v5 offset:512
    v_mul_f32 v96, v36, v36
    v_mul_f32 v97, v37, v37
    v_fma_f32 v96, v96, v12, v13
    v_fma_f32 v97, v97, v12, v13
    v_mul_f32 v96, v96, v36
    v_mfma_f32_32x32x16_bf16 v[16:31], v[172:175], v[76:79], v[16:31]
    ds_read_b128 v[72:75], v6 offset:512
    v_mul_f32 v97, v97, v37
    v_exp_f32 v96, v96
    v_exp_f32 v97, v97
    v_add_f32 v96, 1.0, v96
    v_add_f32 v97, 1.0, v97
    s_add_u32 s13, s15, 983040
    buffer_load_dwordx4 a[172:175], v2, s[44:47], s13 offen offset:1024 sc1
    s_waitcnt lgkmcnt(3)
    v_mfma_f32_32x32x16_bf16 v[16:31], v[176:179], v[80:83], v[16:31]
    ds_read_b128 v[76:79], v7 offset:512
    v_rcp_f32 v96, v96
    v_rcp_f32 v97, v97
    v_mul_f32 v36, v36, v96
    v_mul_f32 v37, v37, v97
    v_cvt_pk_bf16_f32 v106, v36, v37
    v_mul_f32 v98, v38, v38
    s_add_u32 s13, s15, 1048576
    buffer_load_dwordx4 a[64:67], v2, s[44:47], s13 offen sc1
    v_mfma_f32_32x32x16_bf16 v[16:31], v[180:183], v[84:87], v[16:31]
    ds_read_b128 v[80:83], v8 offset:512
    v_mul_f32 v99, v39, v39
    v_fma_f32 v98, v98, v12, v13
    v_fma_f32 v99, v99, v12, v13
    v_mul_f32 v98, v98, v38
    v_mul_f32 v99, v99, v39
    s_add_u32 s13, s15, 1048576
    buffer_load_dwordx4 a[176:179], v2, s[44:47], s13 offen offset:1024 sc1
    v_mfma_f32_32x32x16_bf16 v[16:31], v[184:187], v[88:91], v[16:31]
    ds_read_b128 v[84:87], v9 offset:512
    v_exp_f32 v98, v98
    v_exp_f32 v99, v99
    v_add_f32 v98, 1.0, v98
    v_add_f32 v99, 1.0, v99
    v_rcp_f32 v98, v98
    v_mfma_f32_32x32x16_bf16 v[16:31], v[188:191], v[92:95], v[16:31]
    ds_read_b128 v[88:91], v10 offset:512
    v_rcp_f32 v99, v99
    v_mul_f32 v38, v38, v98
    v_mul_f32 v39, v39, v99
    v_cvt_pk_bf16_f32 v107, v38, v39
    buffer_store_dwordx4 v[104:107], v2, s[44:47], s74 offen sc1
    s_add_u32 s13, s15, 1114112
    buffer_load_dwordx4 a[68:71], v2, s[44:47], s13 offen sc1
    s_waitcnt lgkmcnt(3)
    v_mfma_f32_32x32x16_bf16 v[16:31], v[192:195], v[64:67], v[16:31]
    ds_read_b128 v[92:95], v11 offset:512
    v_mul_f32 v96, v40, v40
    v_mul_f32 v97, v41, v41
    v_fma_f32 v96, v96, v12, v13
    v_fma_f32 v97, v97, v12, v13
    v_mul_f32 v96, v96, v40
    s_add_u32 s13, s15, 1114112
    buffer_load_dwordx4 a[180:183], v2, s[44:47], s13 offen offset:1024 sc1
    v_mfma_f32_32x32x16_bf16 v[16:31], v[196:199], v[68:71], v[16:31]
    ds_read_b128 v[64:67], v4 offset:768
    v_mul_f32 v97, v97, v41
    v_exp_f32 v96, v96
    v_exp_f32 v97, v97
    v_add_f32 v96, 1.0, v96
    v_add_f32 v97, 1.0, v97
    v_mfma_f32_32x32x16_bf16 v[16:31], v[200:203], v[72:75], v[16:31]
    ds_read_b128 v[68:71], v5 offset:768
    v_rcp_f32 v96, v96
    v_rcp_f32 v97, v97
    v_mul_f32 v40, v40, v96
    v_mul_f32 v41, v41, v97
    v_cvt_pk_bf16_f32 v108, v40, v41
    s_add_u32 s13, s15, 1179648
    buffer_load_dwordx4 a[72:75], v2, s[44:47], s13 offen sc1
    v_mfma_f32_32x32x16_bf16 v[16:31], v[204:207], v[76:79], v[16:31]
    ds_read_b128 v[72:75], v6 offset:768
    v_mul_f32 v98, v42, v42
    v_mul_f32 v99, v43, v43
    v_fma_f32 v98, v98, v12, v13
    v_fma_f32 v99, v99, v12, v13
    v_mul_f32 v98, v98, v42
    s_add_u32 s13, s15, 1179648
    buffer_load_dwordx4 a[184:187], v2, s[44:47], s13 offen offset:1024 sc1
    s_waitcnt lgkmcnt(3)
    v_mfma_f32_32x32x16_bf16 v[16:31], v[208:211], v[80:83], v[16:31]
    ds_read_b128 v[76:79], v7 offset:768
    v_mul_f32 v99, v99, v43
    v_exp_f32 v98, v98
    v_exp_f32 v99, v99
    v_add_f32 v98, 1.0, v98
    v_add_f32 v99, 1.0, v99
    v_rcp_f32 v98, v98
    v_mfma_f32_32x32x16_bf16 v[16:31], v[212:215], v[84:87], v[16:31]
    ds_read_b128 v[80:83], v8 offset:768
    v_rcp_f32 v99, v99
    v_mul_f32 v42, v42, v98
    v_mul_f32 v43, v43, v99
    v_cvt_pk_bf16_f32 v109, v42, v43
    v_mul_f32 v96, v44, v44
    s_add_u32 s13, s15, 1245184
    buffer_load_dwordx4 a[76:79], v2, s[44:47], s13 offen sc1
    v_mfma_f32_32x32x16_bf16 v[16:31], v[216:219], v[88:91], v[16:31]
    ds_read_b128 v[84:87], v9 offset:768
    v_mul_f32 v97, v45, v45
    v_fma_f32 v96, v96, v12, v13
    v_fma_f32 v97, v97, v12, v13
    v_mul_f32 v96, v96, v44
    v_mul_f32 v97, v97, v45
    s_add_u32 s13, s15, 1245184
    buffer_load_dwordx4 a[188:191], v2, s[44:47], s13 offen offset:1024 sc1
    v_mfma_f32_32x32x16_bf16 v[16:31], v[220:223], v[92:95], v[16:31]
    ds_read_b128 v[88:91], v10 offset:768
    v_exp_f32 v96, v96
    v_exp_f32 v97, v97
    v_add_f32 v96, 1.0, v96
    v_add_f32 v97, 1.0, v97
    v_rcp_f32 v96, v96
    s_waitcnt lgkmcnt(3)
    v_mfma_f32_32x32x16_bf16 v[16:31], v[224:227], v[64:67], v[16:31]
    ds_read_b128 v[92:95], v11 offset:768
    v_rcp_f32 v97, v97
    v_mul_f32 v44, v44, v96
    v_mul_f32 v45, v45, v97
    v_cvt_pk_bf16_f32 v110, v44, v45
    v_mul_f32 v98, v46, v46
    v_mfma_f32_32x32x16_bf16 v[16:31], v[228:231], v[68:71], v[16:31]
    v_mul_f32 v99, v47, v47
    v_fma_f32 v98, v98, v12, v13
    v_fma_f32 v99, v99, v12, v13
    v_mul_f32 v98, v98, v46
    v_mul_f32 v99, v99, v47
    s_waitcnt vmcnt(35)
    s_barrier
    ds_read_b128 v[64:67], v4 offset:32768
    v_mfma_f32_32x32x16_bf16 v[16:31], v[232:235], v[72:75], v[16:31]
    v_exp_f32 v98, v98
    v_exp_f32 v99, v99
    v_add_f32 v98, 1.0, v98
    v_add_f32 v99, 1.0, v99
    v_rcp_f32 v98, v98
    ds_read_b128 v[68:71], v5 offset:32768
    v_mfma_f32_32x32x16_bf16 v[16:31], v[236:239], v[76:79], v[16:31]
    v_rcp_f32 v99, v99
    v_mul_f32 v46, v46, v98
    v_mul_f32 v47, v47, v99
    v_cvt_pk_bf16_f32 v111, v46, v47
    buffer_store_dwordx4 v[108:111], v2, s[44:47], s74 offen offset:1024 sc1
    ds_read_b128 v[72:75], v6 offset:32768
    s_waitcnt lgkmcnt(3)
    v_mfma_f32_32x32x16_bf16 v[16:31], v[240:243], v[80:83], v[16:31]
    ds_read_b128 v[76:79], v7 offset:32768
    v_mfma_f32_32x32x16_bf16 v[16:31], v[244:247], v[84:87], v[16:31]
    ds_read_b128 v[80:83], v8 offset:32768
    v_mfma_f32_32x32x16_bf16 v[16:31], v[248:251], v[88:91], v[16:31]
    ds_read_b128 v[84:87], v9 offset:32768
    v_mfma_f32_32x32x16_bf16 v[16:31], v[252:255], v[92:95], v[16:31]
    ds_read_b128 v[88:91], v10 offset:32768
    s_waitcnt lgkmcnt(3)
    v_mfma_f32_32x32x16_bf16 v[32:47], v[128:131], v[64:67], v[48:63]
    ds_read_b128 v[92:95], v11 offset:32768
    v_mfma_f32_32x32x16_bf16 v[32:47], v[132:135], v[68:71], v[32:47]
    ds_read_b128 v[64:67], v4 offset:33024
    s_add_u32 s13, s15, 1310720
    buffer_load_dwordx4 a[80:83], v2, s[44:47], s13 offen sc1
    v_mfma_f32_32x32x16_bf16 v[32:47], v[136:139], v[72:75], v[32:47]
    ds_read_b128 v[68:71], v5 offset:33024
    s_waitcnt vmcnt(19)
    s_add_u32 s56, s70, 0
    buffer_store_dword v3, off, s[44:47], s56 sc1
    s_add_u32 s13, s15, 1310720
    buffer_load_dwordx4 a[192:195], v2, s[44:47], s13 offen offset:1024 sc1
    v_mfma_f32_32x32x16_bf16 v[32:47], v[140:143], v[76:79], v[32:47]
    ds_read_b128 v[72:75], v6 offset:33024
    s_add_u32 s13, s15, 1376256
    buffer_load_dwordx4 a[84:87], v2, s[44:47], s13 offen sc1
    s_waitcnt lgkmcnt(3)
    v_mfma_f32_32x32x16_bf16 v[32:47], v[144:147], v[80:83], v[32:47]
    ds_read_b128 v[76:79], v7 offset:33024
    s_add_u32 s74, s71, 229376
    v_mul_f32 v96, v16, v16
    v_mul_f32 v97, v17, v17
    v_fma_f32 v96, v96, v12, v13
    v_fma_f32 v97, v97, v12, v13
    v_mul_f32 v96, v96, v16
    v_mfma_f32_32x32x16_bf16 v[32:47], v[148:151], v[84:87], v[32:47]
    ds_read_b128 v[80:83], v8 offset:33024
    v_mul_f32 v97, v97, v17
    v_exp_f32 v96, v96
    v_exp_f32 v97, v97
    v_add_f32 v96, 1.0, v96
    v_add_f32 v97, 1.0, v97
    s_add_u32 s13, s15, 1376256
    buffer_load_dwordx4 a[196:199], v2, s[44:47], s13 offen offset:1024 sc1
    v_mfma_f32_32x32x16_bf16 v[32:47], v[152:155], v[88:91], v[32:47]
    ds_read_b128 v[84:87], v9 offset:33024
    v_rcp_f32 v96, v96
    v_rcp_f32 v97, v97
    v_mul_f32 v16, v16, v96
    v_mul_f32 v17, v17, v97
    v_cvt_pk_bf16_f32 v104, v16, v17
    s_add_u32 s13, s15, 1441792
    buffer_load_dwordx4 a[88:91], v2, s[44:47], s13 offen sc1
    v_mfma_f32_32x32x16_bf16 v[32:47], v[156:159], v[92:95], v[32:47]
    ds_read_b128 v[88:91], v10 offset:33024
    v_mul_f32 v98, v18, v18
    v_mul_f32 v99, v19, v19
    v_fma_f32 v98, v98, v12, v13
    v_fma_f32 v99, v99, v12, v13
    v_mul_f32 v98, v98, v18
    s_waitcnt lgkmcnt(3)
    v_mfma_f32_32x32x16_bf16 v[32:47], v[160:163], v[64:67], v[32:47]
    ds_read_b128 v[92:95], v11 offset:33024
    v_mul_f32 v99, v99, v19
    v_exp_f32 v98, v98
    v_exp_f32 v99, v99
    v_add_f32 v98, 1.0, v98
    v_add_f32 v99, 1.0, v99
    s_add_u32 s13, s15, 1441792
    buffer_load_dwordx4 a[200:203], v2, s[44:47], s13 offen offset:1024 sc1
    v_mfma_f32_32x32x16_bf16 v[32:47], v[164:167], v[68:71], v[32:47]
    ds_read_b128 v[64:67], v4 offset:33280
    v_rcp_f32 v98, v98
    v_rcp_f32 v99, v99
    v_mul_f32 v18, v18, v98
    v_mul_f32 v19, v19, v99
    v_cvt_pk_bf16_f32 v105, v18, v19
    s_add_u32 s13, s15, 1507328
    buffer_load_dwordx4 a[92:95], v2, s[44:47], s13 offen sc1
    v_mfma_f32_32x32x16_bf16 v[32:47], v[168:171], v[72:75], v[32:47]
    ds_read_b128 v[68:71], v5 offset:33280
    v_mul_f32 v96, v20, v20
    v_mul_f32 v97, v21, v21
    v_fma_f32 v96, v96, v12, v13
    v_fma_f32 v97, v97, v12, v13
    v_mul_f32 v96, v96, v20
    v_mfma_f32_32x32x16_bf16 v[32:47], v[172:175], v[76:79], v[32:47]
    ds_read_b128 v[72:75], v6 offset:33280
    v_mul_f32 v97, v97, v21
    v_exp_f32 v96, v96
    v_exp_f32 v97, v97
    v_add_f32 v96, 1.0, v96
    v_add_f32 v97, 1.0, v97
    s_add_u32 s13, s15, 1507328
    buffer_load_dwordx4 a[204:207], v2, s[44:47], s13 offen offset:1024 sc1
    s_waitcnt lgkmcnt(3)
    v_mfma_f32_32x32x16_bf16 v[32:47], v[176:179], v[80:83], v[32:47]
    ds_read_b128 v[76:79], v7 offset:33280
    v_rcp_f32 v96, v96
    v_rcp_f32 v97, v97
    v_mul_f32 v20, v20, v96
    v_mul_f32 v21, v21, v97
    v_cvt_pk_bf16_f32 v106, v20, v21
    v_mul_f32 v98, v22, v22
    s_add_u32 s13, s15, 1572864
    buffer_load_dwordx4 a[96:99], v2, s[44:47], s13 offen sc1
    v_mfma_f32_32x32x16_bf16 v[32:47], v[180:183], v[84:87], v[32:47]
    ds_read_b128 v[80:83], v8 offset:33280
    v_mul_f32 v99, v23, v23
    v_fma_f32 v98, v98, v12, v13
    v_fma_f32 v99, v99, v12, v13
    v_mul_f32 v98, v98, v22
    v_mul_f32 v99, v99, v23
    s_add_u32 s13, s15, 1572864
    buffer_load_dwordx4 a[208:211], v2, s[44:47], s13 offen offset:1024 sc1
    v_mfma_f32_32x32x16_bf16 v[32:47], v[184:187], v[88:91], v[32:47]
    ds_read_b128 v[84:87], v9 offset:33280
    v_exp_f32 v98, v98
    v_exp_f32 v99, v99
    v_add_f32 v98, 1.0, v98
    v_add_f32 v99, 1.0, v99
    v_rcp_f32 v98, v98
    v_mfma_f32_32x32x16_bf16 v[32:47], v[188:191], v[92:95], v[32:47]
    ds_read_b128 v[88:91], v10 offset:33280
    v_rcp_f32 v99, v99
    v_mul_f32 v22, v22, v98
    v_mul_f32 v23, v23, v99
    v_cvt_pk_bf16_f32 v107, v22, v23
    buffer_store_dwordx4 v[104:107], v2, s[44:47], s74 offen sc1
    s_add_u32 s13, s15, 1638400
    buffer_load_dwordx4 a[100:103], v2, s[44:47], s13 offen sc1
    s_waitcnt lgkmcnt(3)
    v_mfma_f32_32x32x16_bf16 v[32:47], v[192:195], v[64:67], v[32:47]
    ds_read_b128 v[92:95], v11 offset:33280
    v_mul_f32 v96, v24, v24
    v_mul_f32 v97, v25, v25
    v_fma_f32 v96, v96, v12, v13
    v_fma_f32 v97, v97, v12, v13
    v_mul_f32 v96, v96, v24
    s_add_u32 s13, s15, 1638400
    buffer_load_dwordx4 a[212:215], v2, s[44:47], s13 offen offset:1024 sc1
    v_mfma_f32_32x32x16_bf16 v[32:47], v[196:199], v[68:71], v[32:47]
    ds_read_b128 v[64:67], v4 offset:33536
    v_mul_f32 v97, v97, v25
    v_exp_f32 v96, v96
    v_exp_f32 v97, v97
    v_add_f32 v96, 1.0, v96
    v_add_f32 v97, 1.0, v97
    v_mfma_f32_32x32x16_bf16 v[32:47], v[200:203], v[72:75], v[32:47]
    ds_read_b128 v[68:71], v5 offset:33536
    v_rcp_f32 v96, v96
    v_rcp_f32 v97, v97
    v_mul_f32 v24, v24, v96
    v_mul_f32 v25, v25, v97
    v_cvt_pk_bf16_f32 v108, v24, v25
    s_add_u32 s13, s15, 1703936
    buffer_load_dwordx4 a[104:107], v2, s[44:47], s13 offen sc1
    v_mfma_f32_32x32x16_bf16 v[32:47], v[204:207], v[76:79], v[32:47]
    ds_read_b128 v[72:75], v6 offset:33536
    v_mul_f32 v98, v26, v26
    v_mul_f32 v99, v27, v27
    v_fma_f32 v98, v98, v12, v13
    v_fma_f32 v99, v99, v12, v13
    v_mul_f32 v98, v98, v26
    s_add_u32 s13, s15, 1703936
    buffer_load_dwordx4 a[216:219], v2, s[44:47], s13 offen offset:1024 sc1
    s_waitcnt lgkmcnt(3)
    v_mfma_f32_32x32x16_bf16 v[32:47], v[208:211], v[80:83], v[32:47]
    ds_read_b128 v[76:79], v7 offset:33536
    v_mul_f32 v99, v99, v27
    v_exp_f32 v98, v98
    v_exp_f32 v99, v99
    v_add_f32 v98, 1.0, v98
    v_add_f32 v99, 1.0, v99
    v_rcp_f32 v98, v98
    v_mfma_f32_32x32x16_bf16 v[32:47], v[212:215], v[84:87], v[32:47]
    ds_read_b128 v[80:83], v8 offset:33536
    v_rcp_f32 v99, v99
    v_mul_f32 v26, v26, v98
    v_mul_f32 v27, v27, v99
    v_cvt_pk_bf16_f32 v109, v26, v27
    v_mul_f32 v96, v28, v28
    s_add_u32 s13, s15, 1769472
    buffer_load_dwordx4 a[108:111], v2, s[44:47], s13 offen sc1
    v_mfma_f32_32x32x16_bf16 v[32:47], v[216:219], v[88:91], v[32:47]
    ds_read_b128 v[84:87], v9 offset:33536
    v_mul_f32 v97, v29, v29
    v_fma_f32 v96, v96, v12, v13
    v_fma_f32 v97, v97, v12, v13
    v_mul_f32 v96, v96, v28
    v_mul_f32 v97, v97, v29
    s_add_u32 s13, s15, 1769472
    buffer_load_dwordx4 a[220:223], v2, s[44:47], s13 offen offset:1024 sc1
    v_mfma_f32_32x32x16_bf16 v[32:47], v[220:223], v[92:95], v[32:47]
    ds_read_b128 v[88:91], v10 offset:33536
    v_exp_f32 v96, v96
    v_exp_f32 v97, v97
    v_add_f32 v96, 1.0, v96
    v_add_f32 v97, 1.0, v97
    v_rcp_f32 v96, v96
    s_waitcnt lgkmcnt(3)
    v_mfma_f32_32x32x16_bf16 v[32:47], v[224:227], v[64:67], v[32:47]
    ds_read_b128 v[92:95], v11 offset:33536
    v_rcp_f32 v97, v97
    v_mul_f32 v28, v28, v96
    v_mul_f32 v29, v29, v97
    v_cvt_pk_bf16_f32 v110, v28, v29
    v_mul_f32 v98, v30, v30
    v_mfma_f32_32x32x16_bf16 v[32:47], v[228:231], v[68:71], v[32:47]
    v_mul_f32 v99, v31, v31
    v_fma_f32 v98, v98, v12, v13
    v_fma_f32 v99, v99, v12, v13
    v_mul_f32 v98, v98, v30
    v_mul_f32 v99, v99, v31
    v_mfma_f32_32x32x16_bf16 v[32:47], v[232:235], v[72:75], v[32:47]
    v_exp_f32 v98, v98
    v_exp_f32 v99, v99
    v_add_f32 v98, 1.0, v98
    v_add_f32 v99, 1.0, v99
    v_rcp_f32 v98, v98
    v_mfma_f32_32x32x16_bf16 v[32:47], v[236:239], v[76:79], v[32:47]
    v_rcp_f32 v99, v99
    v_mul_f32 v30, v30, v98
    v_mul_f32 v31, v31, v99
    v_cvt_pk_bf16_f32 v111, v30, v31
    buffer_store_dwordx4 v[108:111], v2, s[44:47], s74 offen offset:1024 sc1
    s_waitcnt lgkmcnt(0)
    v_mfma_f32_32x32x16_bf16 v[32:47], v[240:243], v[80:83], v[32:47]
    s_waitcnt vmcnt(19)
    s_add_u32 s56, s70, 256
    buffer_store_dword v3, off, s[44:47], s56 sc1
    v_mfma_f32_32x32x16_bf16 v[32:47], v[244:247], v[84:87], v[32:47]
    v_add_u32 v100, 0, v119
    v_add_u32 v101, 512, v100
    buffer_load_dword v102, v100, s[44:47], 0 offen sc1
    v_mfma_f32_32x32x16_bf16 v[32:47], v[248:251], v[88:91], v[32:47]
    v_mfma_f32_32x32x16_bf16 v[32:47], v[252:255], v[92:95], v[32:47]
    v_subrev_u32 v4, 0x10000, v4
    v_subrev_u32 v5, 0x10000, v5
    v_subrev_u32 v6, 0x10000, v6
    v_subrev_u32 v7, 0x10000, v7
    v_subrev_u32 v8, 0x10000, v8
    v_subrev_u32 v9, 0x10000, v9
    v_subrev_u32 v10, 0x10000, v10
    v_subrev_u32 v11, 0x10000, v11
    v_mov_b32 v124, v100
    v_mov_b32 v125, v101
    s_waitcnt vmcnt(0)
    v_cmp_ne_u32 vcc, s51, v102
    s_cbranch_vccz L_pcd_57
    s_mov_b32 s53, 0
L_pc_56:
    buffer_load_dword v102, v100, s[44:47], 0 offen sc1
    s_waitcnt vmcnt(0)
    v_cmp_ne_u32 vcc, s51, v102
    s_cbranch_vccz L_pcd_57
    s_add_u32 s53, s53, 1
    s_cmp_lg_u32 s52, 0
    s_cbranch_scc1 L_pcd_57
    s_cmp_lt_u32 s53, 0x8000
    s_cbranch_scc1 L_pc_56
    s_mov_b32 s52, 1
L_pcd_57:
    s_add_u32 s54, s69, 0
    buffer_load_dwordx4 v[64:67], v2, s[44:47], s54 offen sc1
    s_add_u32 s54, s69, 0
    buffer_load_dwordx4 v[68:71], v2, s[44:47], s54 offen offset:1024 sc1
    s_add_u32 s54, s69, 0
    buffer_load_dwordx4 v[72:75], v2, s[44:47], s54 offen offset:2048 sc1
    s_add_u32 s54, s69, 0
    buffer_load_dwordx4 v[76:79], v2, s[44:47], s54 offen offset:3072 sc1
    s_add_u32 s54, s69, 4096
    buffer_load_dwordx4 v[80:83], v2, s[44:47], s54 offen sc1
    s_add_u32 s54, s69, 4096
    buffer_load_dwordx4 v[84:87], v2, s[44:47], s54 offen offset:1024 sc1
    s_add_u32 s54, s69, 4096
    buffer_load_dwordx4 v[88:91], v2, s[44:47], s54 offen offset:2048 sc1
    s_add_u32 s54, s69, 4096
    buffer_load_dwordx4 v[92:95], v2, s[44:47], s54 offen offset:3072 sc1
    s_add_u32 s54, s69, 8192
    buffer_load_dwordx4 v[96:99], v2, s[44:47], s54 offen sc1
    s_add_u32 s54, s69, 8192
    buffer_load_dwordx4 v[100:103], v2, s[44:47], s54 offen offset:1024 sc1
    s_add_u32 s54, s69, 8192
    buffer_load_dwordx4 v[104:107], v2, s[44:47], s54 offen offset:2048 sc1
    s_add_u32 s54, s69, 8192
    buffer_load_dwordx4 v[108:111], v2, s[44:47], s54 offen offset:3072 sc1
    s_nop 1
    s_add_u32 s74, s71, 344064
    v_pk_mul_f32 v[60:61], v[32:33], v[32:33]
    v_pk_mul_f32 v[62:63], v[34:35], v[34:35]
    v_pk_fma_f32 v[60:61], v[60:61], v[12:13], v[12:13] op_sel:[0,0,1] op_sel_hi:[1,0,1]
    v_pk_fma_f32 v[62:63], v[62:63], v[12:13], v[12:13] op_sel:[0,0,1] op_sel_hi:[1,0,1]
    v_pk_mul_f32 v[60:61], v[60:61], v[32:33]
    v_pk_mul_f32 v[62:63], v[62:63], v[34:35]
    v_exp_f32 v60, v60
    v_exp_f32 v62, v62
    v_exp_f32 v61, v61
    v_exp_f32 v63, v63
    v_pk_add_f32 v[60:61], v[60:61], v[14:15]
    v_pk_add_f32 v[62:63], v[62:63], v[14:15]
    v_rcp_f32 v60, v60
    v_rcp_f32 v62, v62
    v_rcp_f32 v61, v61
    v_rcp_f32 v63, v63
    v_pk_mul_f32 v[32:33], v[32:33], v[60:61]
    v_pk_mul_f32 v[34:35], v[34:35], v[62:63]
    v_cvt_pk_bf16_f32 v48, v32, v33
    v_cvt_pk_bf16_f32 v49, v34, v35
    v_pk_mul_f32 v[60:61], v[36:37], v[36:37]
    v_pk_mul_f32 v[62:63], v[38:39], v[38:39]
    v_pk_fma_f32 v[60:61], v[60:61], v[12:13], v[12:13] op_sel:[0,0,1] op_sel_hi:[1,0,1]
    v_pk_fma_f32 v[62:63], v[62:63], v[12:13], v[12:13] op_sel:[0,0,1] op_sel_hi:[1,0,1]
    v_pk_mul_f32 v[60:61], v[60:61], v[36:37]
    v_pk_mul_f32 v[62:63], v[62:63], v[38:39]
    v_exp_f32 v60, v60
    v_exp_f32 v62, v62
    v_exp_f32 v61, v61
    v_exp_f32 v63, v63
    v_pk_add_f32 v[60:61], v[60:61], v[14:15]
    v_pk_add_f32 v[62:63], v[62:63], v[14:15]
    v_rcp_f32 v60, v60
    v_rcp_f32 v62, v62
    v_rcp_f32 v61, v61
    v_rcp_f32 v63, v63
    v_pk_mul_f32 v[36:37], v[36:37], v[60:61]
    v_pk_mul_f32 v[38:39], v[38:39], v[62:63]
    v_cvt_pk_bf16_f32 v50, v36, v37
    v_cvt_pk_bf16_f32 v51, v38, v39
    s_add_u32 s56, s70, 512
    buffer_store_dword v3, off, s[44:47], s56 sc1
    buffer_store_dwordx4 v[48:51], v2, s[44:47], s74 offen sc1
    v_pk_mul_f32 v[60:61], v[40:41], v[40:41]
    v_pk_mul_f32 v[62:63], v[42:43], v[42:43]
    v_pk_fma_f32 v[60:61], v[60:61], v[12:13], v[12:13] op_sel:[0,0,1] op_sel_hi:[1,0,1]
    v_pk_fma_f32 v[62:63], v[62:63], v[12:13], v[12:13] op_sel:[0,0,1] op_sel_hi:[1,0,1]
    v_pk_mul_f32 v[60:61], v[60:61], v[40:41]
    v_pk_mul_f32 v[62:63], v[62:63], v[42:43]
    v_exp_f32 v60, v60
    v_exp_f32 v62, v62
    v_exp_f32 v61, v61
    v_exp_f32 v63, v63
    v_pk_add_f32 v[60:61], v[60:61], v[14:15]
    v_pk_add_f32 v[62:63], v[62:63], v[14:15]
    v_rcp_f32 v60, v60
    v_rcp_f32 v62, v62
    v_rcp_f32 v61, v61
    v_rcp_f32 v63, v63
    v_pk_mul_f32 v[40:41], v[40:41], v[60:61]
    v_pk_mul_f32 v[42:43], v[42:43], v[62:63]
    v_cvt_pk_bf16_f32 v52, v40, v41
    v_cvt_pk_bf16_f32 v53, v42, v43
    v_pk_mul_f32 v[60:61], v[44:45], v[44:45]
    v_pk_mul_f32 v[62:63], v[46:47], v[46:47]
    v_pk_fma_f32 v[60:61], v[60:61], v[12:13], v[12:13] op_sel:[0,0,1] op_sel_hi:[1,0,1]
    v_pk_fma_f32 v[62:63], v[62:63], v[12:13], v[12:13] op_sel:[0,0,1] op_sel_hi:[1,0,1]
    v_pk_mul_f32 v[60:61], v[60:61], v[44:45]
    v_pk_mul_f32 v[62:63], v[62:63], v[46:47]
    v_exp_f32 v60, v60
    v_exp_f32 v62, v62
    v_exp_f32 v61, v61
    v_exp_f32 v63, v63
    v_pk_add_f32 v[60:61], v[60:61], v[14:15]
    v_pk_add_f32 v[62:63], v[62:63], v[14:15]
    v_rcp_f32 v60, v60
    v_rcp_f32 v62, v62
    v_rcp_f32 v61, v61
    v_rcp_f32 v63, v63
    v_pk_mul_f32 v[44:45], v[44:45], v[60:61]
    v_pk_mul_f32 v[46:47], v[46:47], v[62:63]
    v_cvt_pk_bf16_f32 v54, v44, v45
    v_cvt_pk_bf16_f32 v55, v46, v47
    buffer_store_dwordx4 v[52:55], v2, s[44:47], s74 offen offset:1024 sc1
    s_mov_b32 s4, s36
    s_and_b32 s5, s37, 0xffff
    s_mov_b32 s6, 1024
    s_mov_b32 s7, 0x00020000
    buffer_load_dwordx4 v[56:59], v123, s[4:7], 0 offen
    s_mov_b32 s53, 13631488
    buffer_load_dwordx4 v[60:63], v112, s[44:47], s53 offen sc1
    s_waitcnt vmcnt(16)
    v_mfma_f32_32x32x16_bf16 a[224:239], a[0:3], v[64:67], 0
    v_mfma_f32_32x32x16_bf16 a[240:255], a[112:115], v[64:67], 0
    s_waitcnt vmcnt(15)
    v_mfma_f32_32x32x16_bf16 a[224:239], a[4:7], v[68:71], a[224:239]
    s_add_u32 s54, s69, 12288
    buffer_load_dwordx4 v[64:67], v2, s[44:47], s54 offen sc1
    v_mfma_f32_32x32x16_bf16 a[240:255], a[116:119], v[68:71], a[240:255]
    s_waitcnt vmcnt(15)
    v_mfma_f32_32x32x16_bf16 a[224:239], a[8:11], v[72:75], a[224:239]
    s_add_u32 s54, s69, 12288
    buffer_load_dwordx4 v[68:71], v2, s[44:47], s54 offen offset:1024 sc1
    v_mfma_f32_32x32x16_bf16 a[240:255], a[120:123], v[72:75], a[240:255]
    s_waitcnt vmcnt(15)
    v_mfma_f32_32x32x16_bf16 a[224:239], a[12:15], v[76:79], a[224:239]
    s_add_u32 s54, s69, 12288
    buffer_load_dwordx4 v[72:75], v2, s[44:47], s54 offen offset:2048 sc1
    v_mfma_f32_32x32x16_bf16 a[240:255], a[124:127], v[76:79], a[240:255]
    s_waitcnt vmcnt(5)
    s_add_u32 s56, s70, 768
    buffer_store_dword v3, off, s[44:47], s56 sc1
    v_mfma_f32_32x32x16_bf16 a[224:239], a[16:19], v[80:83], a[224:239]
    s_add_u32 s54, s69, 12288
    buffer_load_dwordx4 v[76:79], v2, s[44:47], s54 offen offset:3072 sc1
    v_mfma_f32_32x32x16_bf16 a[240:255], a[128:131], v[80:83], a[240:255]
    v_mfma_f32_32x32x16_bf16 a[224:239], a[20:23], v[84:87], a[224:239]
    s_add_u32 s54, s69, 16384
    buffer_load_dwordx4 v[80:83], v2, s[44:47], s54 offen sc1
    v_mfma_f32_32x32x16_bf16 a[240:255], a[132:135], v[84:87], a[240:255]
    v_mfma_f32_32x32x16_bf16 a[224:239], a[24:27], v[88:91], a[224:239]
    s_add_u32 s54, s69, 16384
    buffer_load_dwordx4 v[84:87], v2, s[44:47], s54 offen offset:1024 sc1
    v_mfma_f32_32x32x16_bf16 a[240:255], a[136:139], v[88:91], a[240:255]
    v_mfma_f32_32x32x16_bf16 a[224:239], a[28:31], v[92:95], a[224:239]
    s_add_u32 s54, s69, 16384
    buffer_load_dwordx4 v[88:91], v2, s[44:47], s54 offen offset:2048 sc1
    v_mfma_f32_32x32x16_bf16 a[240:255], a[140:143], v[92:95], a[240:255]
    v_mfma_f32_32x32x16_bf16 a[224:239], a[32:35], v[96:99], a[224:239]
    s_add_u32 s54, s69, 16384
    buffer_load_dwordx4 v[92:95], v2, s[44:47], s54 offen offset:3072 sc1
    v_mfma_f32_32x32x16_bf16 a[240:255], a[144:147], v[96:99], a[240:255]
    v_mfma_f32_32x32x16_bf16 a[224:239], a[36:39], v[100:103], a[224:239]
    s_add_u32 s54, s69, 20480
    buffer_load_dwordx4 v[96:99], v2, s[44:47], s54 offen sc1
    v_mfma_f32_32x32x16_bf16 a[240:255], a[148:151], v[100:103], a[240:255]
    v_mfma_f32_32x32x16_bf16 a[224:239], a[40:43], v[104:107], a[224:239]
    s_add_u32 s54, s69, 20480
    buffer_load_dwordx4 v[100:103], v2, s[44:47], s54 offen offset:1024 sc1
    v_mfma_f32_32x32x16_bf16 a[240:255], a[152:155], v[104:107], a[240:255]
    buffer_load_dword v126, v125, s[44:47], 0 offen sc1
    v_mfma_f32_32x32x16_bf16 a[224:239], a[44:47], v[108:111], a[224:239]
    s_add_u32 s54, s69, 20480
    buffer_load_dwordx4 v[104:107], v2, s[44:47], s54 offen offset:2048 sc1
    v_mfma_f32_32x32x16_bf16 a[240:255], a[156:159], v[108:111], a[240:255]
    s_waitcnt vmcnt(12)
    v_mfma_f32_32x32x16_bf16 a[224:239], a[48:51], v[64:67], a[224:239]
    s_add_u32 s54, s69, 20480
    buffer_load_dwordx4 v[108:111], v2, s[44:47], s54 offen offset:3072 sc1
    v_mfma_f32_32x32x16_bf16 a[240:255], a[160:163], v[64:67], a[240:255]
    s_waitcnt vmcnt(12)
    v_mfma_f32_32x32x16_bf16 a[224:239], a[52:55], v[68:71], a[224:239]
    s_add_u32 s54, s69, 24576
    buffer_load_dwordx4 v[64:67], v2, s[44:47], s54 offen sc1
    v_mfma_f32_32x32x16_bf16 a[240:255], a[164:167], v[68:71], a[240:255]
    s_waitcnt vmcnt(12)
    v_mfma_f32_32x32x16_bf16 a[224:239], a[56:59], v[72:75], a[224:239]
    s_add_u32 s54, s69, 24576
    buffer_load_dwordx4 v[68:71], v2, s[44:47], s54 offen offset:1024 sc1
    v_mfma_f32_32x32x16_bf16 a[240:255], a[168:171], v[72:75], a[240:255]
    s_waitcnt vmcnt(11)
    v_mfma_f32_32x32x16_bf16 a[224:239], a[60:63], v[76:79], a[224:239]
    s_add_u32 s54, s69, 24576
    buffer_load_dwordx4 v[72:75], v2, s[44:47], s54 offen offset:2048 sc1
    v_mfma_f32_32x32x16_bf16 a[240:255], a[172:175], v[76:79], a[240:255]
    s_waitcnt vmcnt(5)
    v_cmp_ne_u32 vcc, s51, v126
    s_cbranch_vccz L_pcd_59
    s_mov_b32 s53, 0
L_pc_58:
    buffer_load_dword v126, v125, s[44:47], 0 offen sc1
    s_waitcnt vmcnt(0)
    v_cmp_ne_u32 vcc, s51, v126
    s_cbranch_vccz L_pcd_59
    s_add_u32 s53, s53, 1
    s_cmp_lg_u32 s52, 0
    s_cbranch_scc1 L_pcd_59
    s_cmp_lt_u32 s53, 0x8000
    s_cbranch_scc1 L_pc_58
    s_mov_b32 s52, 1
L_pcd_59:
    v_mfma_f32_32x32x16_bf16 a[224:239], a[64:67], v[80:83], a[224:239]
    s_add_u32 s54, s69, 24576
    buffer_load_dwordx4 v[76:79], v2, s[44:47], s54 offen offset:3072 sc1
    v_mfma_f32_32x32x16_bf16 a[240:255], a[176:179], v[80:83], a[240:255]
    v_mfma_f32_32x32x16_bf16 a[224:239], a[68:71], v[84:87], a[224:239]
    s_add_u32 s54, s69, 229376
    buffer_load_dwordx4 v[80:83], v2, s[44:47], s54 offen sc1
    v_mfma_f32_32x32x16_bf16 a[240:255], a[180:183], v[84:87], a[240:255]
    v_mfma_f32_32x32x16_bf16 a[224:239], a[72:75], v[88:91], a[224:239]
    s_add_u32 s54, s69, 229376
    buffer_load_dwordx4 v[84:87], v2, s[44:47], s54 offen offset:1024 sc1
    v_mfma_f32_32x32x16_bf16 a[240:255], a[184:187], v[88:91], a[240:255]
    v_mfma_f32_32x32x16_bf16 a[224:239], a[76:79], v[92:95], a[224:239]
    s_add_u32 s54, s69, 229376
    buffer_load_dwordx4 v[88:91], v2, s[44:47], s54 offen offset:2048 sc1
    v_mfma_f32_32x32x16_bf16 a[240:255], a[188:191], v[92:95], a[240:255]
    v_mfma_f32_32x32x16_bf16 a[224:239], a[80:83], v[96:99], a[224:239]
    s_add_u32 s54, s69, 229376
    buffer_load_dwordx4 v[92:95], v2, s[44:47], s54 offen offset:3072 sc1
    v_mfma_f32_32x32x16_bf16 a[240:255], a[192:195], v[96:99], a[240:255]
    v_mfma_f32_32x32x16_bf16 a[224:239], a[84:87], v[100:103], a[224:239]
    s_add_u32 s54, s69, 233472
    buffer_load_dwordx4 v[96:99], v2, s[44:47], s54 offen sc1
    v_mfma_f32_32x32x16_bf16 a[240:255], a[196:199], v[100:103], a[240:255]
    s_waitcnt vmcnt(10)
    v_mfma_f32_32x32x16_bf16 a[224:239], a[88:91], v[104:107], a[224:239]
    s_add_u32 s54, s69, 233472
    buffer_load_dwordx4 v[100:103], v2, s[44:47], s54 offen offset:1024 sc1
    v_mfma_f32_32x32x16_bf16 a[240:255], a[200:203], v[104:107], a[240:255]
    s_waitcnt vmcnt(10)
    v_mfma_f32_32x32x16_bf16 a[224:239], a[92:95], v[108:111], a[224:239]
    s_add_u32 s54, s69, 233472
    buffer_load_dwordx4 v[104:107], v2, s[44:47], s54 offen offset:2048 sc1
    v_mfma_f32_32x32x16_bf16 a[240:255], a[204:207], v[108:111], a[240:255]
    s_waitcnt vmcnt(10)
    v_mfma_f32_32x32x16_bf16 a[224:239], a[96:99], v[64:67], a[224:239]
    s_add_u32 s54, s69, 233472
    buffer_load_dwordx4 v[108:111], v2, s[44:47], s54 offen offset:3072 sc1
    v_mfma_f32_32x32x16_bf16 a[240:255], a[208:211], v[64:67], a[240:255]
    s_waitcnt vmcnt(10)
    v_mfma_f32_32x32x16_bf16 a[224:239], a[100:103], v[68:71], a[224:239]
    s_add_u32 s54, s69, 237568
    buffer_load_dwordx4 v[64:67], v2, s[44:47], s54 offen sc1
    v_mfma_f32_32x32x16_bf16 a[240:255], a[212:215], v[68:71], a[240:255]
    s_waitcnt vmcnt(10)
    v_mfma_f32_32x32x16_bf16 a[224:239], a[104:107], v[72:75], a[224:239]
    s_add_u32 s54, s69, 237568
    buffer_load_dwordx4 v[68:71], v2, s[44:47], s54 offen offset:1024 sc1
    v_mfma_f32_32x32x16_bf16 a[240:255], a[216:219], v[72:75], a[240:255]
    s_waitcnt vmcnt(10)
    v_mfma_f32_32x32x16_bf16 a[224:239], a[108:111], v[76:79], a[224:239]
    s_add_u32 s54, s69, 237568
    buffer_load_dwordx4 v[72:75], v2, s[44:47], s54 offen offset:2048 sc1
    v_mfma_f32_32x32x16_bf16 a[240:255], a[220:223], v[76:79], a[240:255]
    s_waitcnt vmcnt(10)
    v_mfma_f32_32x32x16_bf16 v[16:31], a[0:3], v[80:83], 0
    s_add_u32 s54, s69, 237568
    buffer_load_dwordx4 v[76:79], v2, s[44:47], s54 offen offset:3072 sc1
    v_mfma_f32_32x32x16_bf16 v[32:47], a[112:115], v[80:83], 0
    s_waitcnt vmcnt(10)
    v_mfma_f32_32x32x16_bf16 v[16:31], a[4:7], v[84:87], v[16:31]
    s_add_u32 s54, s69, 241664
    buffer_load_dwordx4 v[80:83], v2, s[44:47], s54 offen sc1
    v_mfma_f32_32x32x16_bf16 v[32:47], a[116:119], v[84:87], v[32:47]
    s_waitcnt vmcnt(10)
    v_mfma_f32_32x32x16_bf16 v[16:31], a[8:11], v[88:91], v[16:31]
    s_add_u32 s54, s69, 241664
    buffer_load_dwordx4 v[84:87], v2, s[44:47], s54 offen offset:1024 sc1
    v_mfma_f32_32x32x16_bf16 v[32:47], a[120:123], v[88:91], v[32:47]
    ds_write_b128 v115, a[224:227] offset:0
    ds_write_b128 v116, a[228:231] offset:0
    s_waitcnt vmcnt(10)
    v_mfma_f32_32x32x16_bf16 v[16:31], a[12:15], v[92:95], v[16:31]
    s_add_u32 s54, s69, 241664
    buffer_load_dwordx4 v[88:91], v2, s[44:47], s54 offen offset:2048 sc1
    v_mfma_f32_32x32x16_bf16 v[32:47], a[124:127], v[92:95], v[32:47]
    ds_write_b128 v117, a[232:235] offset:0
    ds_write_b128 v118, a[236:239] offset:0
    s_waitcnt vmcnt(10)
    v_mfma_f32_32x32x16_bf16 v[16:31], a[16:19], v[96:99], v[16:31]
    s_add_u32 s54, s69, 241664
    buffer_load_dwordx4 v[92:95], v2, s[44:47], s54 offen offset:3072 sc1
    v_mfma_f32_32x32x16_bf16 v[32:47], a[128:131], v[96:99], v[32:47]
    ds_write_b128 v115, a[240:243] offset:128
    ds_write_b128 v116, a[244:247] offset:128
    s_waitcnt vmcnt(10)
    v_mfma_f32_32x32x16_bf16 v[16:31], a[20:23], v[100:103], v[16:31]
    s_add_u32 s54, s69, 245760
    buffer_load_dwordx4 v[96:99], v2, s[44:47], s54 offen sc1
    v_mfma_f32_32x32x16_bf16 v[32:47], a[132:135], v[100:103], v[32:47]
    ds_write_b128 v117, a[248:251] offset:128
    ds_write_b128 v118, a[252:255] offset:128
    s_waitcnt vmcnt(10)
    v_mfma_f32_32x32x16_bf16 v[16:31], a[24:27], v[104:107], v[16:31]
    s_add_u32 s54, s69, 245760
    buffer_load_dwordx4 v[100:103], v2, s[44:47], s54 offen offset:1024 sc1
    v_mfma_f32_32x32x16_bf16 v[32:47], a[136:139], v[104:107], v[32:47]
    s_waitcnt vmcnt(10)
    v_mfma_f32_32x32x16_bf16 v[16:31], a[28:31], v[108:111], v[16:31]
    s_add_u32 s54, s69, 245760
    buffer_load_dwordx4 v[104:107], v2, s[44:47], s54 offen offset:2048 sc1
    v_mfma_f32_32x32x16_bf16 v[32:47], a[140:143], v[108:111], v[32:47]
    s_waitcnt lgkmcnt(0)
    s_barrier
    s_waitcnt vmcnt(10)
    v_mfma_f32_32x32x16_bf16 v[16:31], a[32:35], v[64:67], v[16:31]
    s_add_u32 s54, s69, 245760
    buffer_load_dwordx4 v[108:111], v2, s[44:47], s54 offen offset:3072 sc1
    v_mfma_f32_32x32x16_bf16 v[32:47], a[144:147], v[64:67], v[32:47]
    ds_read_b128 v[48:51], v113 offset:0
    ds_read_b128 v[52:55], v113 offset:8192
    s_waitcnt lgkmcnt(0)
    v_add_f32 v48, v48, v52
    v_add_f32 v49, v49, v53
    v_add_f32 v50, v50, v54
    v_add_f32 v51, v51, v55
    ds_read_b128 v[52:55], v113 offset:16384
    s_waitcnt vmcnt(10)
    v_mfma_f32_32x32x16_bf16 v[16:31], a[36:39], v[68:71], v[16:31]
    s_add_u32 s54, s69, 249856
    buffer_load_dwordx4 v[64:67], v2, s[44:47], s54 offen sc1
    v_mfma_f32_32x32x16_bf16 v[32:47], a[148:151], v[68:71], v[32:47]
    s_waitcnt lgkmcnt(0)
    v_add_f32 v48, v48, v52
    v_add_f32 v49, v49, v53
    v_add_f32 v50, v50, v54
    v_add_f32 v51, v51, v55
    ds_read_b128 v[52:55], v113 offset:24576
    s_waitcnt vmcnt(10)
    v_mfma_f32_32x32x16_bf16 v[16:31], a[40:43], v[72:75], v[16:31]
    s_add_u32 s54, s69, 249856
    buffer_load_dwordx4 v[68:71], v2, s[44:47], s54 offen offset:1024 sc1
    v_mfma_f32_32x32x16_bf16 v[32:47], a[152:155], v[72:75], v[32:47]
    s_waitcnt lgkmcnt(0)
    v_add_f32 v48, v48, v52
    v_add_f32 v49, v49, v53
    v_add_f32 v50, v50, v54
    v_add_f32 v51, v51, v55
    v_lshlrev_b32 v52, 16, v56
    v_and_b32 v53, 0xffff0000, v56
    v_lshlrev_b32 v54, 16, v57
    v_and_b32 v55, 0xffff0000, v57
    v_add_f32 v48, v48, v52
    v_add_f32 v49, v49, v53
    v_add_f32 v50, v50, v54
    v_add_f32 v51, v51, v55
    s_waitcnt vmcnt(10)
    v_mfma_f32_32x32x16_bf16 v[16:31], a[44:47], v[76:79], v[16:31]
    s_add_u32 s54, s69, 249856
    buffer_load_dwordx4 v[72:75], v2, s[44:47], s54 offen offset:2048 sc1
    v_mfma_f32_32x32x16_bf16 v[32:47], a[156:159], v[76:79], v[32:47]
    v_cvt_pk_bf16_f32 v52, v48, v49
    v_cvt_pk_bf16_f32 v53, v50, v51
    v_lshlrev_b32 v48, 16, v52
    v_and_b32 v49, 0xffff0000, v52
    v_lshlrev_b32 v50, 16, v53
    v_and_b32 v51, 0xffff0000, v53
    s_waitcnt vmcnt(10)
    v_mfma_f32_32x32x16_bf16 v[16:31], a[48:51], v[80:83], v[16:31]
    s_add_u32 s54, s69, 249856
    buffer_load_dwordx4 v[76:79], v2, s[44:47], s54 offen offset:3072 sc1
    v_mfma_f32_32x32x16_bf16 v[32:47], a[160:163], v[80:83], v[32:47]
    v_lshlrev_b32 v52, 16, v60
    v_and_b32 v53, 0xffff0000, v60
    v_lshlrev_b32 v54, 16, v61
    v_and_b32 v55, 0xffff0000, v61
    v_add_f32 v48, v48, v52
    v_add_f32 v49, v49, v53
    v_add_f32 v50, v50, v54
    v_add_f32 v51, v51, v55
    v_cvt_pk_bf16_f32 v12, v48, v49
    v_cvt_pk_bf16_f32 v13, v50, v51
    s_waitcnt vmcnt(10)
    v_mfma_f32_32x32x16_bf16 v[16:31], a[52:55], v[84:87], v[16:31]
    s_add_u32 s54, s69, 253952
    buffer_load_dwordx4 v[80:83], v2, s[44:47], s54 offen sc1
    v_mfma_f32_32x32x16_bf16 v[32:47], a[164:167], v[84:87], v[32:47]
    ds_read_b128 v[48:51], v114 offset:0
    ds_read_b128 v[52:55], v114 offset:8192
    s_waitcnt vmcnt(10)
    v_mfma_f32_32x32x16_bf16 v[16:31], a[56:59], v[88:91], v[16:31]
    s_add_u32 s54, s69, 253952
    buffer_load_dwordx4 v[84:87], v2, s[44:47], s54 offen offset:1024 sc1
    v_mfma_f32_32x32x16_bf16 v[32:47], a[168:171], v[88:91], v[32:47]
    s_waitcnt lgkmcnt(0)
    v_add_f32 v48, v48, v52
    v_add_f32 v49, v49, v53
    v_add_f32 v50, v50, v54
    v_add_f32 v51, v51, v55
    ds_read_b128 v[52:55], v114 offset:16384
    s_waitcnt lgkmcnt(0)
    v_add_f32 v48, v48, v52
    v_add_f32 v49, v49, v53
    v_add_f32 v50, v50, v54
    v_add_f32 v51, v51, v55
    ds_read_b128 v[52:55], v114 offset:24576
    s_waitcnt vmcnt(10)
    v_mfma_f32_32x32x16_bf16 v[16:31], a[60:63], v[92:95], v[16:31]
    s_add_u32 s54, s69, 253952
    buffer_load_dwordx4 v[88:91], v2, s[44:47], s54 offen offset:2048 sc1
    v_mfma_f32_32x32x16_bf16 v[32:47], a[172:175], v[92:95], v[32:47]
    s_waitcnt lgkmcnt(0)
    v_add_f32 v48, v48, v52
    v_add_f32 v49, v49, v53
    v_add_f32 v50, v50, v54
    v_add_f32 v51, v51, v55
    s_waitcnt vmcnt(10)
    v_mfma_f32_32x32x16_bf16 v[16:31], a[64:67], v[96:99], v[16:31]
    s_add_u32 s54, s69, 253952
    buffer_load_dwordx4 v[92:95], v2, s[44:47], s54 offen offset:3072 sc1
    v_mfma_f32_32x32x16_bf16 v[32:47], a[176:179], v[96:99], v[32:47]
    v_lshlrev_b32 v52, 16, v58
    v_and_b32 v53, 0xffff0000, v58
    v_lshlrev_b32 v54, 16, v59
    v_and_b32 v55, 0xffff0000, v59
    v_add_f32 v48, v48, v52
    v_add_f32 v49, v49, v53
    v_add_f32 v50, v50, v54
    v_add_f32 v51, v51, v55
    v_cvt_pk_bf16_f32 v52, v48, v49
    v_cvt_pk_bf16_f32 v53, v50, v51
    v_lshlrev_b32 v48, 16, v52
    v_and_b32 v49, 0xffff0000, v52
    v_lshlrev_b32 v50, 16, v53
    v_and_b32 v51, 0xffff0000, v53
    s_waitcnt vmcnt(10)
    v_mfma_f32_32x32x16_bf16 v[16:31], a[68:71], v[100:103], v[16:31]
    v_mfma_f32_32x32x16_bf16 v[32:47], a[180:183], v[100:103], v[32:47]
    v_lshlrev_b32 v52, 16, v62
    v_and_b32 v53, 0xffff0000, v62
    v_lshlrev_b32 v54, 16, v63
    v_and_b32 v55, 0xffff0000, v63
    v_add_f32 v48, v48, v52
    v_add_f32 v49, v49, v53
    v_add_f32 v50, v50, v54
    v_add_f32 v51, v51, v55
    s_waitcnt vmcnt(9)
    v_mfma_f32_32x32x16_bf16 v[16:31], a[72:75], v[104:107], v[16:31]
    v_mfma_f32_32x32x16_bf16 v[32:47], a[184:187], v[104:107], v[32:47]
    v_cvt_pk_bf16_f32 v14, v48, v49
    v_cvt_pk_bf16_f32 v15, v50, v51
    s_mov_b32 s53, 15728640
    buffer_store_dwordx4 v[12:15], v112, s[44:47], s53 offen sc1
    s_waitcnt vmcnt(9)
    v_mfma_f32_32x32x16_bf16 v[16:31], a[76:79], v[108:111], v[16:31]
    v_mfma_f32_32x32x16_bf16 v[32:47], a[188:191], v[108:111], v[32:47]
    s_waitcnt vmcnt(8)
    v_mfma_f32_32x32x16_bf16 v[16:31], a[80:83], v[64:67], v[16:31]
    v_mfma_f32_32x32x16_bf16 v[32:47], a[192:195], v[64:67], v[32:47]
    s_waitcnt vmcnt(7)
    v_mfma_f32_32x32x16_bf16 v[16:31], a[84:87], v[68:71], v[16:31]
    v_mfma_f32_32x32x16_bf16 v[32:47], a[196:199], v[68:71], v[32:47]
    s_waitcnt vmcnt(6)
    v_mfma_f32_32x32x16_bf16 v[16:31], a[88:91], v[72:75], v[16:31]
    v_mfma_f32_32x32x16_bf16 v[32:47], a[200:203], v[72:75], v[32:47]
    s_mov_b32 s53, 13635584
    buffer_load_dwordx4 v[60:63], v112, s[44:47], s53 offen sc1
    s_waitcnt vmcnt(6)
    v_mfma_f32_32x32x16_bf16 v[16:31], a[92:95], v[76:79], v[16:31]
    v_mfma_f32_32x32x16_bf16 v[32:47], a[204:207], v[76:79], v[32:47]
    s_waitcnt vmcnt(5)
    v_mfma_f32_32x32x16_bf16 v[16:31], a[96:99], v[80:83], v[16:31]
    v_mfma_f32_32x32x16_bf16 v[32:47], a[208:211], v[80:83], v[32:47]
    s_waitcnt vmcnt(4)
    v_mfma_f32_32x32x16_bf16 v[16:31], a[100:103], v[84:87], v[16:31]
    v_mfma_f32_32x32x16_bf16 v[32:47], a[212:215], v[84:87], v[32:47]
    s_waitcnt vmcnt(3)
    v_mfma_f32_32x32x16_bf16 v[16:31], a[104:107], v[88:91], v[16:31]
    v_mfma_f32_32x32x16_bf16 v[32:47], a[216:219], v[88:91], v[32:47]
    s_waitcnt vmcnt(2)
    v_mfma_f32_32x32x16_bf16 v[16:31], a[108:111], v[92:95], v[16:31]
    v_mfma_f32_32x32x16_bf16 v[32:47], a[220:223], v[92:95], v[32:47]
    s_branch L_ldone_51
L_idle_50:
    s_barrier
    s_add_u32 s13, s15, 262144
    buffer_load_dwordx4 a[16:19], v2, s[44:47], s13 offen sc1
    s_add_u32 s13, s15, 262144
    buffer_load_dwordx4 a[128:131], v2, s[44:47], s13 offen offset:1024 sc1
    s_add_u32 s13, s15, 327680
    buffer_load_dwordx4 a[20:23], v2, s[44:47], s13 offen sc1
    s_add_u32 s13, s15, 327680
    buffer_load_dwordx4 a[132:135], v2, s[44:47], s13 offen offset:1024 sc1
    s_add_u32 s13, s15, 393216
    buffer_load_dwordx4 a[24:27], v2, s[44:47], s13 offen sc1
    s_add_u32 s13, s15, 393216
    buffer_load_dwordx4 a[136:139], v2, s[44:47], s13 offen offset:1024 sc1
    s_add_u32 s13, s15, 458752
    buffer_load_dwordx4 a[28:31], v2, s[44:47], s13 offen sc1
    s_add_u32 s13, s15, 458752
    buffer_load_dwordx4 a[140:143], v2, s[44:47], s13 offen offset:1024 sc1
    s_add_u32 s13, s15, 524288
    buffer_load_dwordx4 a[32:35], v2, s[44:47], s13 offen sc1
    s_add_u32 s13, s15, 524288
    buffer_load_dwordx4 a[144:147], v2, s[44:47], s13 offen offset:1024 sc1
    s_add_u32 s13, s15, 589824
    buffer_load_dwordx4 a[36:39], v2, s[44:47], s13 offen sc1
    s_add_u32 s13, s15, 589824
    buffer_load_dwordx4 a[148:151], v2, s[44:47], s13 offen offset:1024 sc1
    s_add_u32 s13, s15, 655360
    buffer_load_dwordx4 a[40:43], v2, s[44:47], s13 offen sc1
    s_add_u32 s13, s15, 655360
    buffer_load_dwordx4 a[152:155], v2, s[44:47], s13 offen offset:1024 sc1
    s_add_u32 s13, s15, 720896
    buffer_load_dwordx4 a[44:47], v2, s[44:47], s13 offen sc1
    s_add_u32 s13, s15, 720896
    buffer_load_dwordx4 a[156:159], v2, s[44:47], s13 offen offset:1024 sc1
    s_add_u32 s13, s15, 786432
    buffer_load_dwordx4 a[48:51], v2, s[44:47], s13 offen sc1
    s_add_u32 s13, s15, 786432
    buffer_load_dwordx4 a[160:163], v2, s[44:47], s13 offen offset:1024 sc1
    s_add_u32 s13, s15, 851968
    buffer_load_dwordx4 a[52:55], v2, s[44:47], s13 offen sc1
    s_add_u32 s13, s15, 851968
    buffer_load_dwordx4 a[164:167], v2, s[44:47], s13 offen offset:1024 sc1
    s_add_u32 s13, s15, 917504
    buffer_load_dwordx4 a[56:59], v2, s[44:47], s13 offen sc1
    s_add_u32 s13, s15, 917504
    buffer_load_dwordx4 a[168:171], v2, s[44:47], s13 offen offset:1024 sc1
    s_add_u32 s13, s15, 983040
    buffer_load_dwordx4 a[60:63], v2, s[44:47], s13 offen sc1
    s_add_u32 s13, s15, 983040
    buffer_load_dwordx4 a[172:175], v2, s[44:47], s13 offen offset:1024 sc1
    s_add_u32 s13, s15, 1048576
    buffer_load_dwordx4 a[64:67], v2, s[44:47], s13 offen sc1
    s_add_u32 s13, s15, 1048576
    buffer_load_dwordx4 a[176:179], v2, s[44:47], s13 offen offset:1024 sc1
    s_add_u32 s13, s15, 1114112
    buffer_load_dwordx4 a[68:71], v2, s[44:47], s13 offen sc1
    s_add_u32 s13, s15, 1114112
    buffer_load_dwordx4 a[180:183], v2, s[44:47], s13 offen offset:1024 sc1
    s_add_u32 s13, s15, 1179648
    buffer_load_dwordx4 a[72:75], v2, s[44:47], s13 offen sc1
    s_add_u32 s13, s15, 1179648
    buffer_load_dwordx4 a[184:187], v2, s[44:47], s13 offen offset:1024 sc1
    s_add_u32 s13, s15, 1245184
    buffer_load_dwordx4 a[76:79], v2, s[44:47], s13 offen sc1
    s_add_u32 s13, s15, 1245184
    buffer_load_dwordx4 a[188:191], v2, s[44:47], s13 offen offset:1024 sc1
    s_add_u32 s13, s15, 1310720
    buffer_load_dwordx4 a[80:83], v2, s[44:47], s13 offen sc1
    s_add_u32 s13, s15, 1310720
    buffer_load_dwordx4 a[192:195], v2, s[44:47], s13 offen offset:1024 sc1
    s_add_u32 s13, s15, 1376256
    buffer_load_dwordx4 a[84:87], v2, s[44:47], s13 offen sc1
    s_add_u32 s13, s15, 1376256
    buffer_load_dwordx4 a[196:199], v2, s[44:47], s13 offen offset:1024 sc1
    s_add_u32 s13, s15, 1441792
    buffer_load_dwordx4 a[88:91], v2, s[44:47], s13 offen sc1
    s_add_u32 s13, s15, 1441792
    buffer_load_dwordx4 a[200:203], v2, s[44:47], s13 offen offset:1024 sc1
    s_add_u32 s13, s15, 1507328
    buffer_load_dwordx4 a[92:95], v2, s[44:47], s13 offen sc1
    s_add_u32 s13, s15, 1507328
    buffer_load_dwordx4 a[204:207], v2, s[44:47], s13 offen offset:1024 sc1
    s_add_u32 s13, s15, 1572864
    buffer_load_dwordx4 a[96:99], v2, s[44:47], s13 offen sc1
    s_add_u32 s13, s15, 1572864
    buffer_load_dwordx4 a[208:211], v2, s[44:47], s13 offen offset:1024 sc1
    s_add_u32 s13, s15, 1638400
    buffer_load_dwordx4 a[100:103], v2, s[44:47], s13 offen sc1
    s_add_u32 s13, s15, 1638400
    buffer_load_dwordx4 a[212:215], v2, s[44:47], s13 offen offset:1024 sc1
    s_add_u32 s13, s15, 1703936
    buffer_load_dwordx4 a[104:107], v2, s[44:47], s13 offen sc1
    s_add_u32 s13, s15, 1703936
    buffer_load_dwordx4 a[216:219], v2, s[44:47], s13 offen offset:1024 sc1
    s_add_u32 s13, s15, 1769472
    buffer_load_dwordx4 a[108:111], v2, s[44:47], s13 offen sc1
    s_add_u32 s13, s15, 1769472
    buffer_load_dwordx4 a[220:223], v2, s[44:47], s13 offen offset:1024 sc1
    v_add_u32 v100, 0, v119
    v_add_u32 v101, 512, v100
    buffer_load_dword v102, v100, s[44:47], 0 offen sc1
    v_mov_b32 v124, v100
    v_mov_b32 v125, v101
    s_waitcnt vmcnt(0)
    v_cmp_ne_u32 vcc, s51, v102
    s_cbranch_vccz L_pcd_61
    s_mov_b32 s53, 0
L_pc_60:
    buffer_load_dword v102, v100, s[44:47], 0 offen sc1
    s_waitcnt vmcnt(0)
    v_cmp_ne_u32 vcc, s51, v102
    s_cbranch_vccz L_pcd_61
    s_add_u32 s53, s53, 1
    s_cmp_lg_u32 s52, 0
    s_cbranch_scc1 L_pcd_61
    s_cmp_lt_u32 s53, 0x8000
    s_cbranch_scc1 L_pc_60
    s_mov_b32 s52, 1
L_pcd_61:
    s_add_u32 s54, s69, 0
    buffer_load_dwordx4 v[64:67], v2, s[44:47], s54 offen sc1
    s_add_u32 s54, s69, 0
    buffer_load_dwordx4 v[68:71], v2, s[44:47], s54 offen offset:1024 sc1
    s_add_u32 s54, s69, 0
    buffer_load_dwordx4 v[72:75], v2, s[44:47], s54 offen offset:2048 sc1
    s_add_u32 s54, s69, 0
    buffer_load_dwordx4 v[76:79], v2, s[44:47], s54 offen offset:3072 sc1
    s_add_u32 s54, s69, 4096
    buffer_load_dwordx4 v[80:83], v2, s[44:47], s54 offen sc1
    s_add_u32 s54, s69, 4096
    buffer_load_dwordx4 v[84:87], v2, s[44:47], s54 offen offset:1024 sc1
    s_add_u32 s54, s69, 4096
    buffer_load_dwordx4 v[88:91], v2, s[44:47], s54 offen offset:2048 sc1
    s_add_u32 s54, s69, 4096
    buffer_load_dwordx4 v[92:95], v2, s[44:47], s54 offen offset:3072 sc1
    s_add_u32 s54, s69, 8192
    buffer_load_dwordx4 v[96:99], v2, s[44:47], s54 offen sc1
    s_add_u32 s54, s69, 8192
    buffer_load_dwordx4 v[100:103], v2, s[44:47], s54 offen offset:1024 sc1
    s_add_u32 s54, s69, 8192
    buffer_load_dwordx4 v[104:107], v2, s[44:47], s54 offen offset:2048 sc1
    s_add_u32 s54, s69, 8192
    buffer_load_dwordx4 v[108:111], v2, s[44:47], s54 offen offset:3072 sc1
    s_mov_b32 s4, s36
    s_and_b32 s5, s37, 0xffff
    s_mov_b32 s6, 1024
    s_mov_b32 s7, 0x00020000
    buffer_load_dwordx4 v[56:59], v123, s[4:7], 0 offen
    s_mov_b32 s53, 13631488
    buffer_load_dwordx4 v[60:63], v112, s[44:47], s53 offen sc1
    s_waitcnt vmcnt(13)
    v_mfma_f32_32x32x16_bf16 a[224:239], a[0:3], v[64:67], 0
    v_mfma_f32_32x32x16_bf16 a[240:255], a[112:115], v[64:67], 0
    s_waitcnt vmcnt(12)
    v_mfma_f32_32x32x16_bf16 a[224:239], a[4:7], v[68:71], a[224:239]
    s_add_u32 s54, s69, 12288
    buffer_load_dwordx4 v[64:67], v2, s[44:47], s54 offen sc1
    v_mfma_f32_32x32x16_bf16 a[240:255], a[116:119], v[68:71], a[240:255]
    s_waitcnt vmcnt(12)
    v_mfma_f32_32x32x16_bf16 a[224:239], a[8:11], v[72:75], a[224:239]
    s_add_u32 s54, s69, 12288
    buffer_load_dwordx4 v[68:71], v2, s[44:47], s54 offen offset:1024 sc1
    v_mfma_f32_32x32x16_bf16 a[240:255], a[120:123], v[72:75], a[240:255]
    s_waitcnt vmcnt(12)
    v_mfma_f32_32x32x16_bf16 a[224:239], a[12:15], v[76:79], a[224:239]
    s_add_u32 s54, s69, 12288
    buffer_load_dwordx4 v[72:75], v2, s[44:47], s54 offen offset:2048 sc1
    v_mfma_f32_32x32x16_bf16 a[240:255], a[124:127], v[76:79], a[240:255]
    s_waitcnt vmcnt(12)
    v_mfma_f32_32x32x16_bf16 a[224:239], a[16:19], v[80:83], a[224:239]
    s_add_u32 s54, s69, 12288
    buffer_load_dwordx4 v[76:79], v2, s[44:47], s54 offen offset:3072 sc1
    v_mfma_f32_32x32x16_bf16 a[240:255], a[128:131], v[80:83], a[240:255]
    s_waitcnt vmcnt(12)
    v_mfma_f32_32x32x16_bf16 a[224:239], a[20:23], v[84:87], a[224:239]
    s_add_u32 s54, s69, 16384
    buffer_load_dwordx4 v[80:83], v2, s[44:47], s54 offen sc1
    v_mfma_f32_32x32x16_bf16 a[240:255], a[132:135], v[84:87], a[240:255]
    s_waitcnt vmcnt(12)
    v_mfma_f32_32x32x16_bf16 a[224:239], a[24:27], v[88:91], a[224:239]
    s_add_u32 s54, s69, 16384
    buffer_load_dwordx4 v[84:87], v2, s[44:47], s54 offen offset:1024 sc1
    v_mfma_f32_32x32x16_bf16 a[240:255], a[136:139], v[88:91], a[240:255]
    s_waitcnt vmcnt(12)
    v_mfma_f32_32x32x16_bf16 a[224:239], a[28:31], v[92:95], a[224:239]
    s_add_u32 s54, s69, 16384
    buffer_load_dwordx4 v[88:91], v2, s[44:47], s54 offen offset:2048 sc1
    v_mfma_f32_32x32x16_bf16 a[240:255], a[140:143], v[92:95], a[240:255]
    s_waitcnt vmcnt(12)
    v_mfma_f32_32x32x16_bf16 a[224:239], a[32:35], v[96:99], a[224:239]
    s_add_u32 s54, s69, 16384
    buffer_load_dwordx4 v[92:95], v2, s[44:47], s54 offen offset:3072 sc1
    v_mfma_f32_32x32x16_bf16 a[240:255], a[144:147], v[96:99], a[240:255]
    s_waitcnt vmcnt(12)
    v_mfma_f32_32x32x16_bf16 a[224:239], a[36:39], v[100:103], a[224:239]
    s_add_u32 s54, s69, 20480
    buffer_load_dwordx4 v[96:99], v2, s[44:47], s54 offen sc1
    v_mfma_f32_32x32x16_bf16 a[240:255], a[148:151], v[100:103], a[240:255]
    s_waitcnt vmcnt(12)
    v_mfma_f32_32x32x16_bf16 a[224:239], a[40:43], v[104:107], a[224:239]
    s_add_u32 s54, s69, 20480
    buffer_load_dwordx4 v[100:103], v2, s[44:47], s54 offen offset:1024 sc1
    v_mfma_f32_32x32x16_bf16 a[240:255], a[152:155], v[104:107], a[240:255]
    buffer_load_dword v126, v125, s[44:47], 0 offen sc1
    s_waitcnt vmcnt(13)
    v_mfma_f32_32x32x16_bf16 a[224:239], a[44:47], v[108:111], a[224:239]
    s_add_u32 s54, s69, 20480
    buffer_load_dwordx4 v[104:107], v2, s[44:47], s54 offen offset:2048 sc1
    v_mfma_f32_32x32x16_bf16 a[240:255], a[156:159], v[108:111], a[240:255]
    s_waitcnt vmcnt(11)
    v_mfma_f32_32x32x16_bf16 a[224:239], a[48:51], v[64:67], a[224:239]
    s_add_u32 s54, s69, 20480
    buffer_load_dwordx4 v[108:111], v2, s[44:47], s54 offen offset:3072 sc1
    v_mfma_f32_32x32x16_bf16 a[240:255], a[160:163], v[64:67], a[240:255]
    s_waitcnt vmcnt(11)
    v_mfma_f32_32x32x16_bf16 a[224:239], a[52:55], v[68:71], a[224:239]
    s_add_u32 s54, s69, 24576
    buffer_load_dwordx4 v[64:67], v2, s[44:47], s54 offen sc1
    v_mfma_f32_32x32x16_bf16 a[240:255], a[164:167], v[68:71], a[240:255]
    s_waitcnt vmcnt(11)
    v_mfma_f32_32x32x16_bf16 a[224:239], a[56:59], v[72:75], a[224:239]
    s_add_u32 s54, s69, 24576
    buffer_load_dwordx4 v[68:71], v2, s[44:47], s54 offen offset:1024 sc1
    v_mfma_f32_32x32x16_bf16 a[240:255], a[168:171], v[72:75], a[240:255]
    s_waitcnt vmcnt(11)
    v_mfma_f32_32x32x16_bf16 a[224:239], a[60:63], v[76:79], a[224:239]
    s_add_u32 s54, s69, 24576
    buffer_load_dwordx4 v[72:75], v2, s[44:47], s54 offen offset:2048 sc1
    v_mfma_f32_32x32x16_bf16 a[240:255], a[172:175], v[76:79], a[240:255]
    s_waitcnt vmcnt(5)
    v_cmp_ne_u32 vcc, s51, v126
    s_cbranch_vccz L_pcd_63
    s_mov_b32 s53, 0
L_pc_62:
    buffer_load_dword v126, v125, s[44:47], 0 offen sc1
    s_waitcnt vmcnt(0)
    v_cmp_ne_u32 vcc, s51, v126
    s_cbranch_vccz L_pcd_63
    s_add_u32 s53, s53, 1
    s_cmp_lg_u32 s52, 0
    s_cbranch_scc1 L_pcd_63
    s_cmp_lt_u32 s53, 0x8000
    s_cbranch_scc1 L_pc_62
    s_mov_b32 s52, 1
L_pcd_63:
    v_mfma_f32_32x32x16_bf16 a[224:239], a[64:67], v[80:83], a[224:239]
    s_add_u32 s54, s69, 24576
    buffer_load_dwordx4 v[76:79], v2, s[44:47], s54 offen offset:3072 sc1
    v_mfma_f32_32x32x16_bf16 a[240:255], a[176:179], v[80:83], a[240:255]
    v_mfma_f32_32x32x16_bf16 a[224:239], a[68:71], v[84:87], a[224:239]
    s_add_u32 s54, s69, 229376
    buffer_load_dwordx4 v[80:83], v2, s[44:47], s54 offen sc1
    v_mfma_f32_32x32x16_bf16 a[240:255], a[180:183], v[84:87], a[240:255]
    v_mfma_f32_32x32x16_bf16 a[224:239], a[72:75], v[88:91], a[224:239]
    s_add_u32 s54, s69, 229376
    buffer_load_dwordx4 v[84:87], v2, s[44:47], s54 offen offset:1024 sc1
    v_mfma_f32_32x32x16_bf16 a[240:255], a[184:187], v[88:91], a[240:255]
    v_mfma_f32_32x32x16_bf16 a[224:239], a[76:79], v[92:95], a[224:239]
    s_add_u32 s54, s69, 229376
    buffer_load_dwordx4 v[88:91], v2, s[44:47], s54 offen offset:2048 sc1
    v_mfma_f32_32x32x16_bf16 a[240:255], a[188:191], v[92:95], a[240:255]
    v_mfma_f32_32x32x16_bf16 a[224:239], a[80:83], v[96:99], a[224:239]
    s_add_u32 s54, s69, 229376
    buffer_load_dwordx4 v[92:95], v2, s[44:47], s54 offen offset:3072 sc1
    v_mfma_f32_32x32x16_bf16 a[240:255], a[192:195], v[96:99], a[240:255]
    v_mfma_f32_32x32x16_bf16 a[224:239], a[84:87], v[100:103], a[224:239]
    s_add_u32 s54, s69, 233472
    buffer_load_dwordx4 v[96:99], v2, s[44:47], s54 offen sc1
    v_mfma_f32_32x32x16_bf16 a[240:255], a[196:199], v[100:103], a[240:255]
    s_waitcnt vmcnt(10)
    v_mfma_f32_32x32x16_bf16 a[224:239], a[88:91], v[104:107], a[224:239]
    s_add_u32 s54, s69, 233472
    buffer_load_dwordx4 v[100:103], v2, s[44:47], s54 offen offset:1024 sc1
    v_mfma_f32_32x32x16_bf16 a[240:255], a[200:203], v[104:107], a[240:255]
    s_waitcnt vmcnt(10)
    v_mfma_f32_32x32x16_bf16 a[224:239], a[92:95], v[108:111], a[224:239]
    s_add_u32 s54, s69, 233472
    buffer_load_dwordx4 v[104:107], v2, s[44:47], s54 offen offset:2048 sc1
    v_mfma_f32_32x32x16_bf16 a[240:255], a[204:207], v[108:111], a[240:255]
    s_waitcnt vmcnt(10)
    v_mfma_f32_32x32x16_bf16 a[224:239], a[96:99], v[64:67], a[224:239]
    s_add_u32 s54, s69, 233472
    buffer_load_dwordx4 v[108:111], v2, s[44:47], s54 offen offset:3072 sc1
    v_mfma_f32_32x32x16_bf16 a[240:255], a[208:211], v[64:67], a[240:255]
    s_waitcnt vmcnt(10)
    v_mfma_f32_32x32x16_bf16 a[224:239], a[100:103], v[68:71], a[224:239]
    s_add_u32 s54, s69, 237568
    buffer_load_dwordx4 v[64:67], v2, s[44:47], s54 offen sc1
    v_mfma_f32_32x32x16_bf16 a[240:255], a[212:215], v[68:71], a[240:255]
    s_waitcnt vmcnt(10)
    v_mfma_f32_32x32x16_bf16 a[224:239], a[104:107], v[72:75], a[224:239]
    s_add_u32 s54, s69, 237568
    buffer_load_dwordx4 v[68:71], v2, s[44:47], s54 offen offset:1024 sc1
    v_mfma_f32_32x32x16_bf16 a[240:255], a[216:219], v[72:75], a[240:255]
    s_waitcnt vmcnt(10)
    v_mfma_f32_32x32x16_bf16 a[224:239], a[108:111], v[76:79], a[224:239]
    s_add_u32 s54, s69, 237568
    buffer_load_dwordx4 v[72:75], v2, s[44:47], s54 offen offset:2048 sc1
    v_mfma_f32_32x32x16_bf16 a[240:255], a[220:223], v[76:79], a[240:255]
    s_waitcnt vmcnt(10)
    v_mfma_f32_32x32x16_bf16 v[16:31], a[0:3], v[80:83], 0
    s_add_u32 s54, s69, 237568
    buffer_load_dwordx4 v[76:79], v2, s[44:47], s54 offen offset:3072 sc1
    v_mfma_f32_32x32x16_bf16 v[32:47], a[112:115], v[80:83], 0
    s_waitcnt vmcnt(10)
    v_mfma_f32_32x32x16_bf16 v[16:31], a[4:7], v[84:87], v[16:31]
    s_add_u32 s54, s69, 241664
    buffer_load_dwordx4 v[80:83], v2, s[44:47], s54 offen sc1
    v_mfma_f32_32x32x16_bf16 v[32:47], a[116:119], v[84:87], v[32:47]
    s_waitcnt vmcnt(10)
    v_mfma_f32_32x32x16_bf16 v[16:31], a[8:11], v[88:91], v[16:31]
    s_add_u32 s54, s69, 241664
    buffer_load_dwordx4 v[84:87], v2, s[44:47], s54 offen offset:1024 sc1
    v_mfma_f32_32x32x16_bf16 v[32:47], a[120:123], v[88:91], v[32:47]
    ds_write_b128 v115, a[224:227] offset:0
    ds_write_b128 v116, a[228:231] offset:0
    s_waitcnt vmcnt(10)
    v_mfma_f32_32x32x16_bf16 v[16:31], a[12:15], v[92:95], v[16:31]
    s_add_u32 s54, s69, 241664
    buffer_load_dwordx4 v[88:91], v2, s[44:47], s54 offen offset:2048 sc1
    v_mfma_f32_32x32x16_bf16 v[32:47], a[124:127], v[92:95], v[32:47]
    ds_write_b128 v117, a[232:235] offset:0
    ds_write_b128 v118, a[236:239] offset:0
    s_waitcnt vmcnt(10)
    v_mfma_f32_32x32x16_bf16 v[16:31], a[16:19], v[96:99], v[16:31]
    s_add_u32 s54, s69, 241664
    buffer_load_dwordx4 v[92:95], v2, s[44:47], s54 offen offset:3072 sc1
    v_mfma_f32_32x32x16_bf16 v[32:47], a[128:131], v[96:99], v[32:47]
    ds_write_b128 v115, a[240:243] offset:128
    ds_write_b128 v116, a[244:247] offset:128
    s_waitcnt vmcnt(10)
    v_mfma_f32_32x32x16_bf16 v[16:31], a[20:23], v[100:103], v[16:31]
    s_add_u32 s54, s69, 245760
    buffer_load_dwordx4 v[96:99], v2, s[44:47], s54 offen sc1
    v_mfma_f32_32x32x16_bf16 v[32:47], a[132:135], v[100:103], v[32:47]
    ds_write_b128 v117, a[248:251] offset:128
    ds_write_b128 v118, a[252:255] offset:128
    s_waitcnt vmcnt(10)
    v_mfma_f32_32x32x16_bf16 v[16:31], a[24:27], v[104:107], v[16:31]
    s_add_u32 s54, s69, 245760
    buffer_load_dwordx4 v[100:103], v2, s[44:47], s54 offen offset:1024 sc1
    v_mfma_f32_32x32x16_bf16 v[32:47], a[136:139], v[104:107], v[32:47]
    s_waitcnt vmcnt(10)
    v_mfma_f32_32x32x16_bf16 v[16:31], a[28:31], v[108:111], v[16:31]
    s_add_u32 s54, s69, 245760
    buffer_load_dwordx4 v[104:107], v2, s[44:47], s54 offen offset:2048 sc1
    v_mfma_f32_32x32x16_bf16 v[32:47], a[140:143], v[108:111], v[32:47]
    s_waitcnt lgkmcnt(0)
    s_barrier
    s_waitcnt vmcnt(10)
    v_mfma_f32_32x32x16_bf16 v[16:31], a[32:35], v[64:67], v[16:31]
    s_add_u32 s54, s69, 245760
    buffer_load_dwordx4 v[108:111], v2, s[44:47], s54 offen offset:3072 sc1
    v_mfma_f32_32x32x16_bf16 v[32:47], a[144:147], v[64:67], v[32:47]
    ds_read_b128 v[48:51], v113 offset:0
    ds_read_b128 v[52:55], v113 offset:8192
    s_waitcnt lgkmcnt(0)
    v_add_f32 v48, v48, v52
    v_add_f32 v49, v49, v53
    v_add_f32 v50, v50, v54
    v_add_f32 v51, v51, v55
    ds_read_b128 v[52:55], v113 offset:16384
    s_waitcnt vmcnt(10)
    v_mfma_f32_32x32x16_bf16 v[16:31], a[36:39], v[68:71], v[16:31]
    s_add_u32 s54, s69, 249856
    buffer_load_dwordx4 v[64:67], v2, s[44:47], s54 offen sc1
    v_mfma_f32_32x32x16_bf16 v[32:47], a[148:151], v[68:71], v[32:47]
    s_waitcnt lgkmcnt(0)
    v_add_f32 v48, v48, v52
    v_add_f32 v49, v49, v53
    v_add_f32 v50, v50, v54
    v_add_f32 v51, v51, v55
    ds_read_b128 v[52:55], v113 offset:24576
    s_waitcnt vmcnt(10)
    v_mfma_f32_32x32x16_bf16 v[16:31], a[40:43], v[72:75], v[16:31]
    s_add_u32 s54, s69, 249856
    buffer_load_dwordx4 v[68:71], v2, s[44:47], s54 offen offset:1024 sc1
    v_mfma_f32_32x32x16_bf16 v[32:47], a[152:155], v[72:75], v[32:47]
    s_waitcnt lgkmcnt(0)
    v_add_f32 v48, v48, v52
    v_add_f32 v49, v49, v53
    v_add_f32 v50, v50, v54
    v_add_f32 v51, v51, v55
    v_lshlrev_b32 v52, 16, v56
    v_and_b32 v53, 0xffff0000, v56
    v_lshlrev_b32 v54, 16, v57
    v_and_b32 v55, 0xffff0000, v57
    v_add_f32 v48, v48, v52
    v_add_f32 v49, v49, v53
    v_add_f32 v50, v50, v54
    v_add_f32 v51, v51, v55
    s_waitcnt vmcnt(10)
    v_mfma_f32_32x32x16_bf16 v[16:31], a[44:47], v[76:79], v[16:31]
    s_add_u32 s54, s69, 249856
    buffer_load_dwordx4 v[72:75], v2, s[44:47], s54 offen offset:2048 sc1
    v_mfma_f32_32x32x16_bf16 v[32:47], a[156:159], v[76:79], v[32:47]
    v_cvt_pk_bf16_f32 v52, v48, v49
    v_cvt_pk_bf16_f32 v53, v50, v51
    v_lshlrev_b32 v48, 16, v52
    v_and_b32 v49, 0xffff0000, v52
    v_lshlrev_b32 v50, 16, v53
    v_and_b32 v51, 0xffff0000, v53
    s_waitcnt vmcnt(10)
    v_mfma_f32_32x32x16_bf16 v[16:31], a[48:51], v[80:83], v[16:31]
    s_add_u32 s54, s69, 249856
    buffer_load_dwordx4 v[76:79], v2, s[44:47], s54 offen offset:3072 sc1
    v_mfma_f32_32x32x16_bf16 v[32:47], a[160:163], v[80:83], v[32:47]
    v_lshlrev_b32 v52, 16, v60
    v_and_b32 v53, 0xffff0000, v60
    v_lshlrev_b32 v54, 16, v61
    v_and_b32 v55, 0xffff0000, v61
    v_add_f32 v48, v48, v52
    v_add_f32 v49, v49, v53
    v_add_f32 v50, v50, v54
    v_add_f32 v51, v51, v55
    v_cvt_pk_bf16_f32 v12, v48, v49
    v_cvt_pk_bf16_f32 v13, v50, v51
    s_waitcnt vmcnt(10)
    v_mfma_f32_32x32x16_bf16 v[16:31], a[52:55], v[84:87], v[16:31]
    s_add_u32 s54, s69, 253952
    buffer_load_dwordx4 v[80:83], v2, s[44:47], s54 offen sc1
    v_mfma_f32_32x32x16_bf16 v[32:47], a[164:167], v[84:87], v[32:47]
    ds_read_b128 v[48:51], v114 offset:0
    ds_read_b128 v[52:55], v114 offset:8192
    s_waitcnt vmcnt(10)
    v_mfma_f32_32x32x16_bf16 v[16:31], a[56:59], v[88:91], v[16:31]
    s_add_u32 s54, s69, 253952
    buffer_load_dwordx4 v[84:87], v2, s[44:47], s54 offen offset:1024 sc1
    v_mfma_f32_32x32x16_bf16 v[32:47], a[168:171], v[88:91], v[32:47]
    s_waitcnt lgkmcnt(0)
    v_add_f32 v48, v48, v52
    v_add_f32 v49, v49, v53
    v_add_f32 v50, v50, v54
    v_add_f32 v51, v51, v55
    ds_read_b128 v[52:55], v114 offset:16384
    s_waitcnt lgkmcnt(0)
    v_add_f32 v48, v48, v52
    v_add_f32 v49, v49, v53
    v_add_f32 v50, v50, v54
    v_add_f32 v51, v51, v55
    ds_read_b128 v[52:55], v114 offset:24576
    s_waitcnt vmcnt(10)
    v_mfma_f32_32x32x16_bf16 v[16:31], a[60:63], v[92:95], v[16:31]
    s_add_u32 s54, s69, 253952
    buffer_load_dwordx4 v[88:91], v2, s[44:47], s54 offen offset:2048 sc1
    v_mfma_f32_32x32x16_bf16 v[32:47], a[172:175], v[92:95], v[32:47]
    s_waitcnt lgkmcnt(0)
    v_add_f32 v48, v48, v52
    v_add_f32 v49, v49, v53
    v_add_f32 v50, v50, v54
    v_add_f32 v51, v51, v55
    s_waitcnt vmcnt(10)
    v_mfma_f32_32x32x16_bf16 v[16:31], a[64:67], v[96:99], v[16:31]
    s_add_u32 s54, s69, 253952
    buffer_load_dwordx4 v[92:95], v2, s[44:47], s54 offen offset:3072 sc1
    v_mfma_f32_32x32x16_bf16 v[32:47], a[176:179], v[96:99], v[32:47]
    v_lshlrev_b32 v52, 16, v58
    v_and_b32 v53, 0xffff0000, v58
    v_lshlrev_b32 v54, 16, v59
    v_and_b32 v55, 0xffff0000, v59
    v_add_f32 v48, v48, v52
    v_add_f32 v49, v49, v53
    v_add_f32 v50, v50, v54
    v_add_f32 v51, v51, v55
    v_cvt_pk_bf16_f32 v52, v48, v49
    v_cvt_pk_bf16_f32 v53, v50, v51
    v_lshlrev_b32 v48, 16, v52
    v_and_b32 v49, 0xffff0000, v52
    v_lshlrev_b32 v50, 16, v53
    v_and_b32 v51, 0xffff0000, v53
    s_waitcnt vmcnt(10)
    v_mfma_f32_32x32x16_bf16 v[16:31], a[68:71], v[100:103], v[16:31]
    v_mfma_f32_32x32x16_bf16 v[32:47], a[180:183], v[100:103], v[32:47]
    v_lshlrev_b32 v52, 16, v62
    v_and_b32 v53, 0xffff0000, v62
    v_lshlrev_b32 v54, 16, v63
    v_and_b32 v55, 0xffff0000, v63
    v_add_f32 v48, v48, v52
    v_add_f32 v49, v49, v53
    v_add_f32 v50, v50, v54
    v_add_f32 v51, v51, v55
    s_waitcnt vmcnt(9)
    v_mfma_f32_32x32x16_bf16 v[16:31], a[72:75], v[104:107], v[16:31]
    v_mfma_f32_32x32x16_bf16 v[32:47], a[184:187], v[104:107], v[32:47]
    v_cvt_pk_bf16_f32 v14, v48, v49
    v_cvt_pk_bf16_f32 v15, v50, v51
    s_mov_b32 s53, 15728640
    buffer_store_dwordx4 v[12:15], v112, s[44:47], s53 offen sc1
    s_waitcnt vmcnt(9)
    v_mfma_f32_32x32x16_bf16 v[16:31], a[76:79], v[108:111], v[16:31]
    v_mfma_f32_32x32x16_bf16 v[32:47], a[188:191], v[108:111], v[32:47]
    s_waitcnt vmcnt(8)
    v_mfma_f32_32x32x16_bf16 v[16:31], a[80:83], v[64:67], v[16:31]
    v_mfma_f32_32x32x16_bf16 v[32:47], a[192:195], v[64:67], v[32:47]
    s_waitcnt vmcnt(7)
    v_mfma_f32_32x32x16_bf16 v[16:31], a[84:87], v[68:71], v[16:31]
    v_mfma_f32_32x32x16_bf16 v[32:47], a[196:199], v[68:71], v[32:47]
    s_waitcnt vmcnt(6)
    v_mfma_f32_32x32x16_bf16 v[16:31], a[88:91], v[72:75], v[16:31]
    v_mfma_f32_32x32x16_bf16 v[32:47], a[200:203], v[72:75], v[32:47]
    s_mov_b32 s53, 13635584
    buffer_load_dwordx4 v[60:63], v112, s[44:47], s53 offen sc1
    s_waitcnt vmcnt(6)
    v_mfma_f32_32x32x16_bf16 v[16:31], a[92:95], v[76:79], v[16:31]
    v_mfma_f32_32x32x16_bf16 v[32:47], a[204:207], v[76:79], v[32:47]
    s_waitcnt vmcnt(5)
    v_mfma_f32_32x32x16_bf16 v[16:31], a[96:99], v[80:83], v[16:31]
    v_mfma_f32_32x32x16_bf16 v[32:47], a[208:211], v[80:83], v[32:47]
    s_waitcnt vmcnt(4)
    v_mfma_f32_32x32x16_bf16 v[16:31], a[100:103], v[84:87], v[16:31]
    v_mfma_f32_32x32x16_bf16 v[32:47], a[212:215], v[84:87], v[32:47]
    s_waitcnt vmcnt(3)
    v_mfma_f32_32x32x16_bf16 v[16:31], a[104:107], v[88:91], v[16:31]
    v_mfma_f32_32x32x16_bf16 v[32:47], a[216:219], v[88:91], v[32:47]
    s_waitcnt vmcnt(2)
    v_mfma_f32_32x32x16_bf16 v[16:31], a[108:111], v[92:95], v[16:31]
    v_mfma_f32_32x32x16_bf16 v[32:47], a[220:223], v[92:95], v[32:47]
L_ldone_51:
    s_waitcnt vmcnt(1)
    s_add_u32 s53, s67, 0
    buffer_store_dword v3, off, s[44:47], s53 sc1
    s_nop 11
    ds_write_b128 v115, v[16:19] offset:32768
    ds_write_b128 v116, v[20:23] offset:32768
    ds_write_b128 v117, v[24:27] offset:32768
    ds_write_b128 v118, v[28:31] offset:32768
    ds_write_b128 v115, v[32:35] offset:32896
    ds_write_b128 v116, v[36:39] offset:32896
    ds_write_b128 v117, v[40:43] offset:32896
    ds_write_b128 v118, v[44:47] offset:32896
    s_waitcnt lgkmcnt(0)
    s_barrier
    buffer_load_dword v110, v122, s[44:47], 0 offen sc1
    ds_read_b128 v[64:67], v113 offset:32768
    ds_read_b128 v[68:71], v114 offset:32768
    ds_read_b128 v[72:75], v113 offset:40960
    ds_read_b128 v[76:79], v114 offset:40960
    ds_read_b128 v[80:83], v113 offset:49152
    ds_read_b128 v[84:87], v114 offset:49152
    ds_read_b128 v[88:91], v113 offset:57344
    ds_read_b128 v[92:95], v114 offset:57344
    v_lshlrev_b32 v96, 16, v56
    v_and_b32 v97, 0xffff0000, v56
    v_lshlrev_b32 v98, 16, v57
    v_and_b32 v99, 0xffff0000, v57
    v_lshlrev_b32 v100, 16, v58
    v_and_b32 v101, 0xffff0000, v58
    v_lshlrev_b32 v102, 16, v59
    v_and_b32 v103, 0xffff0000, v59
    s_waitcnt lgkmcnt(4)
    v_pk_add_f32 v[64:65], v[64:65], v[72:73]
    v_pk_add_f32 v[66:67], v[66:67], v[74:75]
    v_pk_add_f32 v[68:69], v[68:69], v[76:77]
    v_pk_add_f32 v[70:71], v[70:71], v[78:79]
    v_pk_add_f32 v[64:65], v[64:65], v[96:97]
    v_pk_add_f32 v[66:67], v[66:67], v[98:99]
    v_pk_add_f32 v[68:69], v[68:69], v[100:101]
    v_pk_add_f32 v[70:71], v[70:71], v[102:103]
    s_waitcnt lgkmcnt(0)
    v_pk_add_f32 v[80:81], v[80:81], v[88:89]
    v_pk_add_f32 v[82:83], v[82:83], v[90:91]
    v_pk_add_f32 v[84:85], v[84:85], v[92:93]
    v_pk_add_f32 v[86:87], v[86:87], v[94:95]
    v_pk_add_f32 v[64:65], v[64:65], v[80:81]
    v_pk_add_f32 v[66:67], v[66:67], v[82:83]
    v_pk_add_f32 v[68:69], v[68:69], v[84:85]
    v_pk_add_f32 v[70:71], v[70:71], v[86:87]
    v_cvt_pk_bf16_f32 v72, v64, v65
    v_cvt_pk_bf16_f32 v73, v66, v67
    v_cvt_pk_bf16_f32 v74, v68, v69
    v_cvt_pk_bf16_f32 v75, v70, v71
    v_lshlrev_b32 v64, 16, v72
    v_and_b32 v65, 0xffff0000, v72
    v_lshlrev_b32 v66, 16, v73
    v_and_b32 v67, 0xffff0000, v73
    v_lshlrev_b32 v68, 16, v74
    v_and_b32 v69, 0xffff0000, v74
    v_lshlrev_b32 v70, 16, v75
    v_and_b32 v71, 0xffff0000, v75
    s_waitcnt vmcnt(0)
    v_cmp_ne_u32 vcc, s51, v110
    s_cbranch_vccz L_pcd_65
    s_mov_b32 s53, 0
L_pc_64:
    buffer_load_dword v110, v122, s[44:47], 0 offen sc1
    s_waitcnt vmcnt(0)
    v_cmp_ne_u32 vcc, s51, v110
    s_cbranch_vccz L_pcd_65
    s_add_u32 s53, s53, 1
    s_cmp_lg_u32 s52, 0
    s_cbranch_scc1 L_pcd_65
    s_cmp_lt_u32 s53, 0x8000
    s_cbranch_scc1 L_pc_64
    s_mov_b32 s52, 1
L_pcd_65:
    s_add_u32 s53, s75, 15728640
    buffer_load_dwordx4 v[104:107], v2, s[44:47], s53 offen sc1
    v_lshlrev_b32 v80, 16, v60
    v_and_b32 v81, 0xffff0000, v60
    v_lshlrev_b32 v82, 16, v61
    v_and_b32 v83, 0xffff0000, v61
    v_lshlrev_b32 v84, 16, v62
    v_and_b32 v85, 0xffff0000, v62
    v_lshlrev_b32 v86, 16, v63
    v_and_b32 v87, 0xffff0000, v63
    v_pk_add_f32 v[64:65], v[64:65], v[80:81]
    v_pk_add_f32 v[66:67], v[66:67], v[82:83]
    v_pk_add_f32 v[68:69], v[68:69], v[84:85]
    v_pk_add_f32 v[70:71], v[70:71], v[86:87]
    v_cvt_pk_bf16_f32 v72, v64, v65
    v_cvt_pk_bf16_f32 v73, v66, v67
    v_cvt_pk_bf16_f32 v74, v68, v69
    v_cvt_pk_bf16_f32 v75, v70, v71
    s_mov_b32 s53, 15732736
    buffer_store_dwordx4 v[72:75], v112, s[44:47], s53 offen sc1
    v_mov_b32 v108, 0x3b000000
    v_add_u32 v109, 512, v122
    s_waitcnt vmcnt(1)
    v_lshlrev_b32 v16, 16, v104
    v_and_b32 v17, 0xffff0000, v104
    v_lshlrev_b32 v18, 16, v105
    v_and_b32 v19, 0xffff0000, v105
    v_lshlrev_b32 v20, 16, v106
    v_and_b32 v21, 0xffff0000, v106
    v_lshlrev_b32 v22, 16, v107
    v_and_b32 v23, 0xffff0000, v107
    v_pk_add_f32 v[52:53], v[16:17], v[18:19]
    v_pk_mul_f32 v[54:55], v[16:17], v[16:17]
    v_pk_add_f32 v[56:57], v[20:21], v[22:23]
    v_pk_fma_f32 v[54:55], v[18:19], v[18:19], v[54:55]
    v_pk_add_f32 v[52:53], v[52:53], v[56:57]
    v_pk_fma_f32 v[54:55], v[20:21], v[20:21], v[54:55]
    v_add_f32 v52, v52, v53
    v_pk_fma_f32 v[54:55], v[22:23], v[22:23], v[54:55]
    v_add_f32 v54, v54, v55
    s_nop 0
    v_add_f32_dpp v52, v52, v52 quad_perm:[1,0,3,2] row_mask:0xf bank_mask:0xf
    v_add_f32_dpp v54, v54, v54 quad_perm:[1,0,3,2] row_mask:0xf bank_mask:0xf
    s_nop 0
    v_add_f32_dpp v52, v52, v52 quad_perm:[2,3,0,1] row_mask:0xf bank_mask:0xf
    v_add_f32_dpp v54, v54, v54 quad_perm:[2,3,0,1] row_mask:0xf bank_mask:0xf
    s_nop 0
    v_add_f32_dpp v52, v52, v52 row_half_mirror row_mask:0xf bank_mask:0xf
    v_add_f32_dpp v54, v54, v54 row_half_mirror row_mask:0xf bank_mask:0xf
    s_nop 0
    v_add_f32_dpp v52, v52, v52 row_mirror row_mask:0xf bank_mask:0xf
    v_add_f32_dpp v54, v54, v54 row_mirror row_mask:0xf bank_mask:0xf
    s_nop 0
    v_add_f32_dpp v52, v52, v52 row_bcast:15 row_mask:0xa bank_mask:0xf
    v_add_f32_dpp v54, v54, v54 row_bcast:15 row_mask:0xa bank_mask:0xf
    s_nop 0
    v_add_f32_dpp v52, v52, v52 row_bcast:31 row_mask:0xc bank_mask:0xf
    v_add_f32_dpp v54, v54, v54 row_bcast:31 row_mask:0xc bank_mask:0xf
    s_nop 0
    v_readlane_b32 s58, v52, 63
    v_readlane_b32 s59, v54, 63
    s_nop 1
    v_mul_f32 v56, s58, v108
    v_mul_f32 v54, s59, v108
    v_fma_f32 v54, -v56, v56, v54
    v_max_f32 v54, 0, v54
    v_add_f32 v54, 0x3727c5ac, v54
    v_rsq_f32 v54, v54
    s_nop 0
    v_mul_f32 v56, v56, v54
    v_pk_fma_f32 v[24:25], v[16:17], v[54:55], v[56:57] op_sel_hi:[1,0,0] neg_lo:[0,0,1] neg_hi:[0,0,1]
    v_pk_fma_f32 v[26:27], v[18:19], v[54:55], v[56:57] op_sel_hi:[1,0,0] neg_lo:[0,0,1] neg_hi:[0,0,1]
    v_pk_fma_f32 v[28:29], v[20:21], v[54:55], v[56:57] op_sel_hi:[1,0,0] neg_lo:[0,0,1] neg_hi:[0,0,1]
    v_pk_fma_f32 v[30:31], v[22:23], v[54:55], v[56:57] op_sel_hi:[1,0,0] neg_lo:[0,0,1] neg_hi:[0,0,1]
    s_waitcnt vmcnt(0)
    s_add_u32 s53, s67, 512
    buffer_store_dword v3, off, s[44:47], s53 sc1
    v_add_u32 v125, 512, v122
    s_lshl_b32 s53, s50, 10
    s_add_u32 s53, s53, 155648
    v_add_u32 v44, s53, v2
    ds_read_b128 v[32:35], v44
    s_waitcnt lgkmcnt(0)
    v_lshlrev_b32 v36, 16, v32
    v_and_b32 v37, 0xffff0000, v32
    v_lshlrev_b32 v38, 16, v33
    v_and_b32 v39, 0xffff0000, v33
    v_lshlrev_b32 v40, 16, v34
    v_and_b32 v41, 0xffff0000, v34
    v_lshlrev_b32 v42, 16, v35
    v_and_b32 v43, 0xffff0000, v35
    v_pk_fma_f32 v[16:17], v[24:25], v[36:37], v[16:17]
    v_pk_fma_f32 v[18:19], v[26:27], v[38:39], v[18:19]
    v_pk_fma_f32 v[20:21], v[28:29], v[40:41], v[20:21]
    v_pk_fma_f32 v[22:23], v[30:31], v[42:43], v[22:23]
    v_cvt_pk_bf16_f32 v48, v16, v17
    v_cvt_pk_bf16_f32 v49, v18, v19
    v_cvt_pk_bf16_f32 v50, v20, v21
    v_cvt_pk_bf16_f32 v51, v22, v23
    v_lshlrev_b32 v16, 16, v48
    v_and_b32 v17, 0xffff0000, v48
    v_lshlrev_b32 v18, 16, v49
    v_and_b32 v19, 0xffff0000, v49
    v_lshlrev_b32 v20, 16, v50
    v_and_b32 v21, 0xffff0000, v50
    v_lshlrev_b32 v22, 16, v51
    v_and_b32 v23, 0xffff0000, v51
    s_add_u32 s54, s75, 17825792
    buffer_store_dwordx4 v[48:51], v2, s[44:47], s54 offen sc1
    v_pk_add_f32 v[52:53], v[16:17], v[18:19]
    v_pk_mul_f32 v[54:55], v[16:17], v[16:17]
    v_pk_add_f32 v[56:57], v[20:21], v[22:23]
    v_pk_fma_f32 v[54:55], v[18:19], v[18:19], v[54:55]
    v_pk_add_f32 v[52:53], v[52:53], v[56:57]
    v_pk_fma_f32 v[54:55], v[20:21], v[20:21], v[54:55]
    v_add_f32 v52, v52, v53
    v_pk_fma_f32 v[54:55], v[22:23], v[22:23], v[54:55]
    v_add_f32 v54, v54, v55
    s_nop 0
    v_add_f32_dpp v52, v52, v52 quad_perm:[1,0,3,2] row_mask:0xf bank_mask:0xf
    v_add_f32_dpp v54, v54, v54 quad_perm:[1,0,3,2] row_mask:0xf bank_mask:0xf
    s_nop 0
    v_add_f32_dpp v52, v52, v52 quad_perm:[2,3,0,1] row_mask:0xf bank_mask:0xf
    v_add_f32_dpp v54, v54, v54 quad_perm:[2,3,0,1] row_mask:0xf bank_mask:0xf
    s_nop 0
    v_add_f32_dpp v52, v52, v52 row_half_mirror row_mask:0xf bank_mask:0xf
    v_add_f32_dpp v54, v54, v54 row_half_mirror row_mask:0xf bank_mask:0xf
    s_nop 0
    v_add_f32_dpp v52, v52, v52 row_mirror row_mask:0xf bank_mask:0xf
    v_add_f32_dpp v54, v54, v54 row_mirror row_mask:0xf bank_mask:0xf
    s_nop 0
    v_add_f32_dpp v52, v52, v52 row_bcast:15 row_mask:0xa bank_mask:0xf
    v_add_f32_dpp v54, v54, v54 row_bcast:15 row_mask:0xa bank_mask:0xf
    s_nop 0
    v_add_f32_dpp v52, v52, v52 row_bcast:31 row_mask:0xc bank_mask:0xf
    v_add_f32_dpp v54, v54, v54 row_bcast:31 row_mask:0xc bank_mask:0xf
    s_nop 0
    v_readlane_b32 s58, v52, 63
    v_readlane_b32 s59, v54, 63
    s_nop 1
    v_mul_f32 v56, s58, v108
    v_mul_f32 v54, s59, v108
    v_fma_f32 v54, -v56, v56, v54
    v_max_f32 v54, 0, v54
    v_add_f32 v52, 0x3727c5ac, v54
    v_rsq_f32 v52, v52
    s_nop 0
    v_mul_f32 v54, v54, v52
    v_fmaak_f32 v54, v54, v52, 0x3727c5ac
    v_rsq_f32 v54, v54
    s_nop 0
    v_mul_f32 v54, v54, v52
    v_mul_f32 v56, v56, v54
    v_pk_fma_f32 v[24:25], v[16:17], v[54:55], v[56:57] op_sel_hi:[1,0,0] neg_lo:[0,0,1] neg_hi:[0,0,1]
    v_pk_fma_f32 v[26:27], v[18:19], v[54:55], v[56:57] op_sel_hi:[1,0,0] neg_lo:[0,0,1] neg_hi:[0,0,1]
    v_pk_fma_f32 v[28:29], v[20:21], v[54:55], v[56:57] op_sel_hi:[1,0,0] neg_lo:[0,0,1] neg_hi:[0,0,1]
    v_pk_fma_f32 v[30:31], v[22:23], v[54:55], v[56:57] op_sel_hi:[1,0,0] neg_lo:[0,0,1] neg_hi:[0,0,1]
    v_cvt_pk_bf16_f32 v32, v24, v25
    v_cvt_pk_bf16_f32 v33, v26, v27
    v_cvt_pk_bf16_f32 v34, v28, v29
    v_cvt_pk_bf16_f32 v35, v30, v31
    s_add_u32 s54, s75, 11534336
    buffer_store_dwordx4 v[32:35], v2, s[44:47], s54 offen sc1
    s_lshl_b32 s53, s50, 10
    s_add_u32 s53, s53, 159744
    v_add_u32 v111, s53, v2
    ds_read_b128 v[44:47], v111
    s_waitcnt vmcnt(0)
    s_add_u32 s53, s61, 8192
    buffer_store_dword v3, off, s[44:47], s53 sc1
    s_mov_b32 s64, 1
    s_cmp_ge_u32 s49, 28
    s_cbranch_scc1 L_idle_66
    v_add_u32 v100, 8192, v120
    v_add_u32 v101, 12288, v120
    buffer_load_dword v102, v100, s[44:47], 0 offen sc1
    s_barrier
    s_mov_b32 s4, s32
    s_and_b32 s5, s33, 0xffff
    s_mov_b32 s6, 3584
    s_mov_b32 s7, 0x00020000
    v_lshrrev_b32 v14, 5, v1
    v_lshlrev_b32 v15, 3, v14
    s_lshl_b32 s53, s68, 6
    buffer_load_dwordx2 v[104:105], v15, s[4:7], s53 offen
    buffer_load_dwordx2 v[106:107], v15, s[4:7], s53 offen offset:16
    buffer_load_dwordx2 v[108:109], v15, s[4:7], s53 offen offset:32
    buffer_load_dwordx2 v[110:111], v15, s[4:7], s53 offen offset:48
    v_mov_b32 v12, 0xbdd2d3e8
    v_mov_b32 v13, 0xc0135761
    v_mov_b32 v14, 1.0
    v_mov_b32 v15, 1.0
    s_waitcnt vmcnt(4)
    v_cmp_ne_u32 vcc, s51, v102
    s_cbranch_vccz L_pcd_69
    s_mov_b32 s53, 0
L_pc_68:
    buffer_load_dword v102, v100, s[44:47], 0 offen sc1
    s_waitcnt vmcnt(0)
    v_cmp_ne_u32 vcc, s51, v102
    s_cbranch_vccz L_pcd_69
    s_add_u32 s53, s53, 1
    s_cmp_lg_u32 s52, 0
    s_cbranch_scc1 L_pcd_69
    s_cmp_lt_u32 s53, 0x8000
    s_cbranch_scc1 L_pc_68
    s_mov_b32 s52, 1
L_pcd_69:
    s_add_u32 m0, s73, 0
    s_add_u32 s57, s72, 2097152
    v_xor_b32 v103, 0, v121
    buffer_load_dwordx4 v103, s[44:47], s57 offen sc1 lds
    v_xor_b32 v103, 16, v121
    buffer_load_dwordx4 v103, s[44:47], s57 offen offset:1024 sc1 lds
    v_xor_b32 v103, 32, v121
    buffer_load_dwordx4 v103, s[44:47], s57 offen offset:2048 sc1 lds
    v_xor_b32 v103, 48, v121
    buffer_load_dwordx4 v103, s[44:47], s57 offen offset:3072 sc1 lds
    s_add_u32 m0, s73, 4096
    s_add_u32 s57, s72, 2105344
    v_xor_b32 v103, 64, v121
    buffer_load_dwordx4 v103, s[44:47], s57 offen sc1 lds
    v_xor_b32 v103, 80, v121
    buffer_load_dwordx4 v103, s[44:47], s57 offen offset:1024 sc1 lds
    v_xor_b32 v103, 96, v121
    buffer_load_dwordx4 v103, s[44:47], s57 offen offset:2048 sc1 lds
    v_xor_b32 v103, 112, v121
    buffer_load_dwordx4 v103, s[44:47], s57 offen offset:3072 sc1 lds
    buffer_load_dword v126, v125, s[44:47], 0 offen sc1
    s_waitcnt vmcnt(9)
    v_lshlrev_b32 v48, 16, v104
    v_and_b32 v49, 0xffff0000, v104
    v_lshlrev_b32 v50, 16, v105
    v_and_b32 v51, 0xffff0000, v105
    v_lshlrev_b32 v52, 16, v106
    v_and_b32 v53, 0xffff0000, v106
    v_lshlrev_b32 v54, 16, v107
    v_and_b32 v55, 0xffff0000, v107
    v_lshlrev_b32 v56, 16, v108
    v_and_b32 v57, 0xffff0000, v108
    v_lshlrev_b32 v58, 16, v109
    v_and_b32 v59, 0xffff0000, v109
    v_lshlrev_b32 v60, 16, v110
    v_and_b32 v61, 0xffff0000, v110
    v_lshlrev_b32 v62, 16, v111
    v_and_b32 v63, 0xffff0000, v111
    s_waitcnt vmcnt(0)
    v_cmp_ne_u32 vcc, s51, v126
    s_cbranch_vccz L_pcd_71
    s_mov_b32 s53, 0
L_pc_70:
    buffer_load_dword v126, v125, s[44:47], 0 offen sc1
    s_waitcnt vmcnt(0)
    v_cmp_ne_u32 vcc, s51, v126
    s_cbranch_vccz L_pcd_71
    s_add_u32 s53, s53, 1
    s_cmp_lg_u32 s52, 0
    s_cbranch_scc1 L_pcd_71
    s_cmp_lt_u32 s53, 0x8000
    s_cbranch_scc1 L_pc_70
    s_mov_b32 s52, 1
L_pcd_71:
    s_add_u32 s53, s75, 15732736
    buffer_load_dwordx4 v[40:43], v2, s[44:47], s53 offen sc1
    s_barrier
    ds_read_b128 v[64:67], v4 offset:0
    ds_read_b128 v[68:71], v5 offset:0
    ds_read_b128 v[72:75], v6 offset:0
    ds_read_b128 v[76:79], v7 offset:0
    ds_read_b128 v[80:83], v8 offset:0
    ds_read_b128 v[84:87], v9 offset:0
    ds_read_b128 v[88:91], v10 offset:0
    s_waitcnt lgkmcnt(3)
    v_mfma_f32_32x32x16_bf16 v[16:31], v[128:131], v[64:67], v[48:63]
    ds_read_b128 v[92:95], v11 offset:0
    s_add_u32 m0, s73, 32768
    s_add_u32 s57, s72, 2162688
    v_xor_b32 v103, 0, v121
    buffer_load_dwordx4 v103, s[44:47], s57 offen sc1 lds
    v_mfma_f32_32x32x16_bf16 v[16:31], v[132:135], v[68:71], v[16:31]
    ds_read_b128 v[64:67], v4 offset:256
    v_xor_b32 v103, 16, v121
    buffer_load_dwordx4 v103, s[44:47], s57 offen offset:1024 sc1 lds
    v_mfma_f32_32x32x16_bf16 v[16:31], v[136:139], v[72:75], v[16:31]
    ds_read_b128 v[68:71], v5 offset:256
    v_xor_b32 v103, 32, v121
    buffer_load_dwordx4 v103, s[44:47], s57 offen offset:2048 sc1 lds
    v_mfma_f32_32x32x16_bf16 v[16:31], v[140:143], v[76:79], v[16:31]
    ds_read_b128 v[72:75], v6 offset:256
    v_xor_b32 v103, 48, v121
    buffer_load_dwordx4 v103, s[44:47], s57 offen offset:3072 sc1 lds
    s_waitcnt lgkmcnt(3)
    v_mfma_f32_32x32x16_bf16 v[16:31], v[144:147], v[80:83], v[16:31]
    ds_read_b128 v[76:79], v7 offset:256
    s_add_u32 m0, s73, 36864
    s_add_u32 s57, s72, 2170880
    v_xor_b32 v103, 64, v121
    buffer_load_dwordx4 v103, s[44:47], s57 offen sc1 lds
    v_mfma_f32_32x32x16_bf16 v[16:31], v[148:151], v[84:87], v[16:31]
    ds_read_b128 v[80:83], v8 offset:256
    s_waitcnt vmcnt(5)
    v_lshlrev_b32 v32, 16, v40
    v_and_b32 v33, 0xffff0000, v40
    v_lshlrev_b32 v34, 16, v41
    v_and_b32 v35, 0xffff0000, v41
    v_lshlrev_b32 v36, 16, v42
    v_and_b32 v37, 0xffff0000, v42
    v_lshlrev_b32 v38, 16, v43
    v_xor_b32 v103, 80, v121
    buffer_load_dwordx4 v103, s[44:47], s57 offen offset:1024 sc1 lds
    v_mfma_f32_32x32x16_bf16 v[16:31], v[152:155], v[88:91], v[16:31]
    ds_read_b128 v[84:87], v9 offset:256
    v_and_b32 v39, 0xffff0000, v43
    v_add_f32 v124, v32, v33
    v_mul_f32 v125, v32, v32
    v_fmac_f32 v125, v33, v33
    v_add_f32 v124, v124, v34
    v_fmac_f32 v125, v34, v34
    v_add_f32 v124, v124, v35
    v_fmac_f32 v125, v35, v35
    v_xor_b32 v103, 96, v121
    buffer_load_dwordx4 v103, s[44:47], s57 offen offset:2048 sc1 lds
    v_mfma_f32_32x32x16_bf16 v[16:31], v[156:159], v[92:95], v[16:31]
    ds_read_b128 v[88:91], v10 offset:256
    v_add_f32 v124, v124, v36
    v_fmac_f32 v125, v36, v36
    v_add_f32 v124, v124, v37
    v_fmac_f32 v125, v37, v37
    v_add_f32 v124, v124, v38
    v_fmac_f32 v125, v38, v38
    v_add_f32 v124, v124, v39
    v_fmac_f32 v125, v39, v39
    v_xor_b32 v103, 112, v121
    buffer_load_dwordx4 v103, s[44:47], s57 offen offset:3072 sc1 lds
    s_waitcnt lgkmcnt(3)
    v_mfma_f32_32x32x16_bf16 v[16:31], v[160:163], v[64:67], v[16:31]
    ds_read_b128 v[92:95], v11 offset:256
    s_nop 1
    v_add_f32_dpp v124, v124, v124 quad_perm:[1,0,3,2] row_mask:0xf bank_mask:0xf
    v_add_f32_dpp v125, v125, v125 quad_perm:[1,0,3,2] row_mask:0xf bank_mask:0xf
    s_nop 0
    v_add_f32_dpp v124, v124, v124 quad_perm:[2,3,0,1] row_mask:0xf bank_mask:0xf
    v_add_f32_dpp v125, v125, v125 quad_perm:[2,3,0,1] row_mask:0xf bank_mask:0xf
    s_nop 0
    v_add_f32_dpp v124, v124, v124 row_half_mirror row_mask:0xf bank_mask:0xf
    v_mfma_f32_32x32x16_bf16 v[16:31], v[164:167], v[68:71], v[16:31]
    ds_read_b128 v[64:67], v4 offset:512
    v_add_f32_dpp v125, v125, v125 row_half_mirror row_mask:0xf bank_mask:0xf
    s_nop 0
    v_add_f32_dpp v124, v124, v124 row_mirror row_mask:0xf bank_mask:0xf
    v_add_f32_dpp v125, v125, v125 row_mirror row_mask:0xf bank_mask:0xf
    s_nop 0
    v_add_f32_dpp v124, v124, v124 row_bcast:15 row_mask:0xa bank_mask:0xf
    v_add_f32_dpp v125, v125, v125 row_bcast:15 row_mask:0xa bank_mask:0xf
    s_nop 0
    v_mfma_f32_32x32x16_bf16 v[16:31], v[168:171], v[72:75], v[16:31]
    ds_read_b128 v[68:71], v5 offset:512
    v_add_f32_dpp v124, v124, v124 row_bcast:31 row_mask:0xc bank_mask:0xf
    v_add_f32_dpp v125, v125, v125 row_bcast:31 row_mask:0xc bank_mask:0xf
    s_nop 0
    v_readlane_b32 s58, v124, 63
    v_readlane_b32 s59, v125, 63
    s_nop 1
    v_mov_b32 v126, s58
    v_mov_b32 v127, s59
    v_mfma_f32_32x32x16_bf16 v[16:31], v[172:175], v[76:79], v[16:31]
    ds_read_b128 v[72:75], v6 offset:512
    v_mul_f32 v126, 0x3b000000, v126
    v_mul_f32 v127, 0x3b000000, v127
    v_fma_f32 v127, -v126, v126, v127
    v_max_f32 v127, 0, v127
    v_add_f32 v127, 0x3727c5ac, v127
    v_rsq_f32 v127, v127
    s_nop 0
    v_mul_f32 v126, v126, v127
    s_waitcnt lgkmcnt(3)
    v_mfma_f32_32x32x16_bf16 v[16:31], v[176:179], v[80:83], v[16:31]
    ds_read_b128 v[76:79], v7 offset:512
    v_fma_f32 v109, v32, v127, -v126
    v_lshlrev_b32 v110, 16, v44
    v_fma_f32 v32, v109, v110, v32
    v_fma_f32 v109, v33, v127, -v126
    v_and_b32 v110, 0xffff0000, v44
    v_fma_f32 v33, v109, v110, v33
    v_fma_f32 v109, v34, v127, -v126
    v_lshlrev_b32 v110, 16, v45
    v_mfma_f32_32x32x16_bf16 v[16:31], v[180:183], v[84:87], v[16:31]
    ds_read_b128 v[80:83], v8 offset:512
    v_fma_f32 v34, v109, v110, v34
    v_fma_f32 v109, v35, v127, -v126
    v_and_b32 v110, 0xffff0000, v45
    v_fma_f32 v35, v109, v110, v35
    v_fma_f32 v109, v36, v127, -v126
    v_lshlrev_b32 v110, 16, v46
    v_fma_f32 v36, v109, v110, v36
    v_fma_f32 v109, v37, v127, -v126
    v_mfma_f32_32x32x16_bf16 v[16:31], v[184:187], v[88:91], v[16:31]
    ds_read_b128 v[84:87], v9 offset:512
    v_and_b32 v110, 0xffff0000, v46
    v_fma_f32 v37, v109, v110, v37
    v_fma_f32 v109, v38, v127, -v126
    v_lshlrev_b32 v110, 16, v47
    v_fma_f32 v38, v109, v110, v38
    v_fma_f32 v109, v39, v127, -v126
    v_and_b32 v110, 0xffff0000, v47
    v_mfma_f32_32x32x16_bf16 v[16:31], v[188:191], v[92:95], v[16:31]
    ds_read_b128 v[88:91], v10 offset:512
    v_fma_f32 v39, v109, v110, v39
    v_cvt_pk_bf16_f32 v40, v32, v33
    v_cvt_pk_bf16_f32 v41, v34, v35
    v_cvt_pk_bf16_f32 v42, v36, v37
    v_cvt_pk_bf16_f32 v43, v38, v39
    v_lshlrev_b32 v32, 16, v40
    v_and_b32 v33, 0xffff0000, v40
    v_lshlrev_b32 v34, 16, v41
    s_waitcnt lgkmcnt(3)
    v_mfma_f32_32x32x16_bf16 v[16:31], v[192:195], v[64:67], v[16:31]
    ds_read_b128 v[92:95], v11 offset:512
    v_and_b32 v35, 0xffff0000, v41
    v_lshlrev_b32 v36, 16, v42
    v_and_b32 v37, 0xffff0000, v42
    v_lshlrev_b32 v38, 16, v43
    v_and_b32 v39, 0xffff0000, v43
    s_add_u32 s54, s75, 17829888
    buffer_store_dwordx4 v[40:43], v2, s[44:47], s54 offen sc1
    v_add_f32 v124, v32, v33
    v_mul_f32 v125, v32, v32
    v_mfma_f32_32x32x16_bf16 v[16:31], v[196:199], v[68:71], v[16:31]
    ds_read_b128 v[64:67], v4 offset:768
    v_fmac_f32 v125, v33, v33
    v_add_f32 v124, v124, v34
    v_fmac_f32 v125, v34, v34
    v_add_f32 v124, v124, v35
    v_fmac_f32 v125, v35, v35
    v_add_f32 v124, v124, v36
    v_fmac_f32 v125, v36, v36
    v_add_f32 v124, v124, v37
    v_mfma_f32_32x32x16_bf16 v[16:31], v[200:203], v[72:75], v[16:31]
    ds_read_b128 v[68:71], v5 offset:768
    v_fmac_f32 v125, v37, v37
    v_add_f32 v124, v124, v38
    v_fmac_f32 v125, v38, v38
    v_add_f32 v124, v124, v39
    v_fmac_f32 v125, v39, v39
    s_nop 1
    v_add_f32_dpp v124, v124, v124 quad_perm:[1,0,3,2] row_mask:0xf bank_mask:0xf
    v_add_f32_dpp v125, v125, v125 quad_perm:[1,0,3,2] row_mask:0xf bank_mask:0xf
    v_mfma_f32_32x32x16_bf16 v[16:31], v[204:207], v[76:79], v[16:31]
    ds_read_b128 v[72:75], v6 offset:768
    s_nop 0
    v_add_f32_dpp v124, v124, v124 quad_perm:[2,3,0,1] row_mask:0xf bank_mask:0xf
    v_add_f32_dpp v125, v125, v125 quad_perm:[2,3,0,1] row_mask:0xf bank_mask:0xf
    s_nop 0
    v_add_f32_dpp v124, v124, v124 row_half_mirror row_mask:0xf bank_mask:0xf
    v_add_f32_dpp v125, v125, v125 row_half_mirror row_mask:0xf bank_mask:0xf
    s_nop 0
    v_add_f32_dpp v124, v124, v124 row_mirror row_mask:0xf bank_mask:0xf
    s_waitcnt lgkmcnt(3)
    v_mfma_f32_32x32x16_bf16 v[16:31], v[208:211], v[80:83], v[16:31]
    ds_read_b128 v[76:79], v7 offset:768
    v_add_f32_dpp v125, v125, v125 row_mirror row_mask:0xf bank_mask:0xf
    s_nop 0
    v_add_f32_dpp v124, v124, v124 row_bcast:15 row_mask:0xa bank_mask:0xf
    v_add_f32_dpp v125, v125, v125 row_bcast:15 row_mask:0xa bank_mask:0xf
    s_nop 0
    v_add_f32_dpp v124, v124, v124 row_bcast:31 row_mask:0xc bank_mask:0xf
    v_add_f32_dpp v125, v125, v125 row_bcast:31 row_mask:0xc bank_mask:0xf
    s_nop 0
    v_mfma_f32_32x32x16_bf16 v[16:31], v[212:215], v[84:87], v[16:31]
    ds_read_b128 v[80:83], v8 offset:768
    v_readlane_b32 s58, v124, 63
    v_readlane_b32 s59, v125, 63
    s_nop 1
    v_mov_b32 v126, s58
    v_mov_b32 v127, s59
    v_mul_f32 v126, 0x3b000000, v126
    v_mul_f32 v127, 0x3b000000, v127
    v_fma_f32 v127, -v126, v126, v127
    v_mfma_f32_32x32x16_bf16 v[16:31], v[216:219], v[88:91], v[16:31]
    ds_read_b128 v[84:87], v9 offset:768
    v_max_f32 v127, 0, v127
    v_add_f32 v124, 0x3727c5ac, v127
    v_rsq_f32 v124, v124
    s_nop 0
    v_mul_f32 v127, v127, v124
    v_fmaak_f32 v127, v127, v124, 0x3727c5ac
    v_rsq_f32 v127, v127
    s_nop 0
    v_mfma_f32_32x32x16_bf16 v[16:31], v[220:223], v[92:95], v[16:31]
    ds_read_b128 v[88:91], v10 offset:768
    v_mul_f32 v127, v127, v124
    v_mul_f32 v126, v126, v127
    v_fma_f32 v32, v32, v127, -v126
    v_fma_f32 v33, v33, v127, -v126
    v_fma_f32 v34, v34, v127, -v126
    v_fma_f32 v35, v35, v127, -v126
    v_fma_f32 v36, v36, v127, -v126
    v_fma_f32 v37, v37, v127, -v126
    s_waitcnt lgkmcnt(3)
    v_mfma_f32_32x32x16_bf16 v[16:31], v[224:227], v[64:67], v[16:31]
    ds_read_b128 v[92:95], v11 offset:768
    v_fma_f32 v38, v38, v127, -v126
    v_fma_f32 v39, v39, v127, -v126
    v_cvt_pk_bf16_f32 v44, v32, v33
    v_cvt_pk_bf16_f32 v45, v34, v35
    v_cvt_pk_bf16_f32 v46, v36, v37
    v_cvt_pk_bf16_f32 v47, v38, v39
    s_add_u32 s54, s75, 11538432
    buffer_store_dwordx4 v[44:47], v2, s[44:47], s54 offen sc1
    v_mfma_f32_32x32x16_bf16 v[16:31], v[228:231], v[68:71], v[16:31]
    s_waitcnt vmcnt(2)
    s_barrier
    ds_read_b128 v[64:67], v4 offset:32768
    v_mfma_f32_32x32x16_bf16 v[16:31], v[232:235], v[72:75], v[16:31]
    ds_read_b128 v[68:71], v5 offset:32768
    v_mfma_f32_32x32x16_bf16 v[16:31], v[236:239], v[76:79], v[16:31]
    ds_read_b128 v[72:75], v6 offset:32768
    s_waitcnt lgkmcnt(3)
    v_mfma_f32_32x32x16_bf16 v[16:31], v[240:243], v[80:83], v[16:31]
    ds_read_b128 v[76:79], v7 offset:32768
    v_mfma_f32_32x32x16_bf16 v[16:31], v[244:247], v[84:87], v[16:31]
    ds_read_b128 v[80:83], v8 offset:32768
    v_mfma_f32_32x32x16_bf16 v[16:31], v[248:251], v[88:91], v[16:31]
    ds_read_b128 v[84:87], v9 offset:32768
    v_mfma_f32_32x32x16_bf16 v[16:31], v[252:255], v[92:95], v[16:31]
    ds_read_b128 v[88:91], v10 offset:32768
    s_waitcnt lgkmcnt(3)
    v_mfma_f32_32x32x16_bf16 v[32:47], v[128:131], v[64:67], v[48:63]
    ds_read_b128 v[92:95], v11 offset:32768
    s_waitcnt vmcnt(0)
    s_add_u32 s53, s61, 12288
    buffer_store_dword v3, off, s[44:47], s53 sc1
    v_mfma_f32_32x32x16_bf16 v[32:47], v[132:135], v[68:71], v[32:47]
    ds_read_b128 v[64:67], v4 offset:33024
    v_mfma_f32_32x32x16_bf16 v[32:47], v[136:139], v[72:75], v[32:47]
    ds_read_b128 v[68:71], v5 offset:33024
    v_mfma_f32_32x32x16_bf16 v[32:47], v[140:143], v[76:79], v[32:47]
    ds_read_b128 v[72:75], v6 offset:33024
    s_waitcnt lgkmcnt(3)
    v_mfma_f32_32x32x16_bf16 v[32:47], v[144:147], v[80:83], v[32:47]
    ds_read_b128 v[76:79], v7 offset:33024
    s_add_u32 s74, s71, 8388608
    v_mul_f32 v96, v16, v16
    v_mul_f32 v97, v17, v17
    v_fma_f32 v96, v96, v12, v13
    v_fma_f32 v97, v97, v12, v13
    v_mul_f32 v96, v96, v16
    buffer_load_dword v102, v101, s[44:47], 0 offen sc1
    v_mfma_f32_32x32x16_bf16 v[32:47], v[148:151], v[84:87], v[32:47]
    ds_read_b128 v[80:83], v8 offset:33024
    v_mul_f32 v97, v97, v17
    v_exp_f32 v96, v96
    v_exp_f32 v97, v97
    v_add_f32 v96, 1.0, v96
    v_add_f32 v97, 1.0, v97
    v_mfma_f32_32x32x16_bf16 v[32:47], v[152:155], v[88:91], v[32:47]
    ds_read_b128 v[84:87], v9 offset:33024
    v_rcp_f32 v96, v96
    v_rcp_f32 v97, v97
    v_mul_f32 v16, v16, v96
    v_mul_f32 v17, v17, v97
    v_cvt_pk_bf16_f32 v104, v16, v17
    v_mfma_f32_32x32x16_bf16 v[32:47], v[156:159], v[92:95], v[32:47]
    ds_read_b128 v[88:91], v10 offset:33024
    v_mul_f32 v98, v18, v18
    v_mul_f32 v99, v19, v19
    v_fma_f32 v98, v98, v12, v13
    v_fma_f32 v99, v99, v12, v13
    v_mul_f32 v98, v98, v18
    s_waitcnt lgkmcnt(3)
    v_mfma_f32_32x32x16_bf16 v[32:47], v[160:163], v[64:67], v[32:47]
    ds_read_b128 v[92:95], v11 offset:33024
    v_mul_f32 v99, v99, v19
    v_exp_f32 v98, v98
    v_exp_f32 v99, v99
    v_add_f32 v98, 1.0, v98
    v_add_f32 v99, 1.0, v99
    v_mfma_f32_32x32x16_bf16 v[32:47], v[164:167], v[68:71], v[32:47]
    ds_read_b128 v[64:67], v4 offset:33280
    v_rcp_f32 v98, v98
    v_rcp_f32 v99, v99
    v_mul_f32 v18, v18, v98
    v_mul_f32 v19, v19, v99
    v_cvt_pk_bf16_f32 v105, v18, v19
    s_waitcnt vmcnt(0)
    v_cmp_ne_u32 vcc, s51, v102
    s_cbranch_vccz L_pcd_73
    s_mov_b32 s53, 0
L_pc_72:
    buffer_load_dword v102, v101, s[44:47], 0 offen sc1
    s_waitcnt vmcnt(0)
    v_cmp_ne_u32 vcc, s51, v102
    s_cbranch_vccz L_pcd_73
    s_add_u32 s53, s53, 1
    s_cmp_lg_u32 s52, 0
    s_cbranch_scc1 L_pcd_73
    s_cmp_lt_u32 s53, 0x8000
    s_cbranch_scc1 L_pc_72
    s_mov_b32 s52, 1
L_pcd_73:
    v_mfma_f32_32x32x16_bf16 v[32:47], v[168:171], v[72:75], v[32:47]
    ds_read_b128 v[68:71], v5 offset:33280
    v_mul_f32 v96, v20, v20
    v_mul_f32 v97, v21, v21
    v_fma_f32 v96, v96, v12, v13
    v_fma_f32 v97, v97, v12, v13
    v_mul_f32 v96, v96, v20
    s_add_u32 m0, s73, 65536
    s_add_u32 s57, s72, 2101248
    v_xor_b32 v103, 0, v121
    buffer_load_dwordx4 v103, s[44:47], s57 offen sc1 lds
    v_mfma_f32_32x32x16_bf16 v[32:47], v[172:175], v[76:79], v[32:47]
    ds_read_b128 v[72:75], v6 offset:33280
    v_mul_f32 v97, v97, v21
    v_exp_f32 v96, v96
    v_exp_f32 v97, v97
    v_add_f32 v96, 1.0, v96
    v_add_f32 v97, 1.0, v97
    v_xor_b32 v103, 16, v121
    buffer_load_dwordx4 v103, s[44:47], s57 offen offset:1024 sc1 lds
    s_waitcnt lgkmcnt(3)
    v_mfma_f32_32x32x16_bf16 v[32:47], v[176:179], v[80:83], v[32:47]
    ds_read_b128 v[76:79], v7 offset:33280
    v_rcp_f32 v96, v96
    v_rcp_f32 v97, v97
    v_mul_f32 v20, v20, v96
    v_mul_f32 v21, v21, v97
    v_cvt_pk_bf16_f32 v106, v20, v21
    v_mul_f32 v98, v22, v22
    v_xor_b32 v103, 32, v121
    buffer_load_dwordx4 v103, s[44:47], s57 offen offset:2048 sc1 lds
    v_mfma_f32_32x32x16_bf16 v[32:47], v[180:183], v[84:87], v[32:47]
    ds_read_b128 v[80:83], v8 offset:33280
    v_mul_f32 v99, v23, v23
    v_fma_f32 v98, v98, v12, v13
    v_fma_f32 v99, v99, v12, v13
    v_mul_f32 v98, v98, v22
    v_mul_f32 v99, v99, v23
    v_xor_b32 v103, 48, v121
    buffer_load_dwordx4 v103, s[44:47], s57 offen offset:3072 sc1 lds
    v_mfma_f32_32x32x16_bf16 v[32:47], v[184:187], v[88:91], v[32:47]
    ds_read_b128 v[84:87], v9 offset:33280
    v_exp_f32 v98, v98
    v_exp_f32 v99, v99
    v_add_f32 v98, 1.0, v98
    v_add_f32 v99, 1.0, v99
    v_rcp_f32 v98, v98
    v_mfma_f32_32x32x16_bf16 v[32:47], v[188:191], v[92:95], v[32:47]
    ds_read_b128 v[88:91], v10 offset:33280
    v_rcp_f32 v99, v99
    v_mul_f32 v22, v22, v98
    v_mul_f32 v23, v23, v99
    v_cvt_pk_bf16_f32 v107, v22, v23
    buffer_store_dwordx4 v[104:107], v2, s[44:47], s74 offen sc1
    s_add_u32 m0, s73, 69632
    s_add_u32 s57, s72, 2109440
    v_xor_b32 v103, 64, v121
    buffer_load_dwordx4 v103, s[44:47], s57 offen sc1 lds
    s_waitcnt lgkmcnt(3)
    v_mfma_f32_32x32x16_bf16 v[32:47], v[192:195], v[64:67], v[32:47]
    ds_read_b128 v[92:95], v11 offset:33280
    v_mul_f32 v96, v24, v24
    v_mul_f32 v97, v25, v25
    v_fma_f32 v96, v96, v12, v13
    v_fma_f32 v97, v97, v12, v13
    v_mul_f32 v96, v96, v24
    v_xor_b32 v103, 80, v121
    buffer_load_dwordx4 v103, s[44:47], s57 offen offset:1024 sc1 lds
    v_mfma_f32_32x32x16_bf16 v[32:47], v[196:199], v[68:71], v[32:47]
    ds_read_b128 v[64:67], v4 offset:33536
    v_mul_f32 v97, v97, v25
    v_exp_f32 v96, v96
    v_exp_f32 v97, v97
    v_add_f32 v96, 1.0, v96
    v_add_f32 v97, 1.0, v97
    v_xor_b32 v103, 96, v121
    buffer_load_dwordx4 v103, s[44:47], s57 offen offset:2048 sc1 lds
    v_mfma_f32_32x32x16_bf16 v[32:47], v[200:203], v[72:75], v[32:47]
    ds_read_b128 v[68:71], v5 offset:33536
    v_rcp_f32 v96, v96
    v_rcp_f32 v97, v97
    v_mul_f32 v24, v24, v96
    v_mul_f32 v25, v25, v97
    v_cvt_pk_bf16_f32 v108, v24, v25
    v_mfma_f32_32x32x16_bf16 v[32:47], v[204:207], v[76:79], v[32:47]
    ds_read_b128 v[72:75], v6 offset:33536
    v_mul_f32 v98, v26, v26
    v_mul_f32 v99, v27, v27
    v_fma_f32 v98, v98, v12, v13
    v_fma_f32 v99, v99, v12, v13
    v_mul_f32 v98, v98, v26
    v_xor_b32 v103, 112, v121
    buffer_load_dwordx4 v103, s[44:47], s57 offen offset:3072 sc1 lds
    s_waitcnt lgkmcnt(3)
    v_mfma_f32_32x32x16_bf16 v[32:47], v[208:211], v[80:83], v[32:47]
    ds_read_b128 v[76:79], v7 offset:33536
    v_mul_f32 v99, v99, v27
    v_exp_f32 v98, v98
    v_exp_f32 v99, v99
    v_add_f32 v98, 1.0, v98
    v_add_f32 v99, 1.0, v99
    v_rcp_f32 v98, v98
    s_add_u32 m0, s73, 98304
    s_add_u32 s57, s72, 2166784
    v_xor_b32 v103, 0, v121
    buffer_load_dwordx4 v103, s[44:47], s57 offen sc1 lds
    v_mfma_f32_32x32x16_bf16 v[32:47], v[212:215], v[84:87], v[32:47]
    ds_read_b128 v[80:83], v8 offset:33536
    v_rcp_f32 v99, v99
    v_mul_f32 v26, v26, v98
    v_mul_f32 v27, v27, v99
    v_cvt_pk_bf16_f32 v109, v26, v27
    v_mul_f32 v96, v28, v28
    v_xor_b32 v103, 16, v121
    buffer_load_dwordx4 v103, s[44:47], s57 offen offset:1024 sc1 lds
    v_mfma_f32_32x32x16_bf16 v[32:47], v[216:219], v[88:91], v[32:47]
    ds_read_b128 v[84:87], v9 offset:33536
    v_mul_f32 v97, v29, v29
    v_fma_f32 v96, v96, v12, v13
    v_fma_f32 v97, v97, v12, v13
    v_mul_f32 v96, v96, v28
    v_mul_f32 v97, v97, v29
    v_mfma_f32_32x32x16_bf16 v[32:47], v[220:223], v[92:95], v[32:47]
    ds_read_b128 v[88:91], v10 offset:33536
    v_exp_f32 v96, v96
    v_exp_f32 v97, v97
    v_add_f32 v96, 1.0, v96
    v_add_f32 v97, 1.0, v97
    v_rcp_f32 v96, v96
    v_xor_b32 v103, 32, v121
    buffer_load_dwordx4 v103, s[44:47], s57 offen offset:2048 sc1 lds
    s_waitcnt lgkmcnt(3)
    v_mfma_f32_32x32x16_bf16 v[32:47], v[224:227], v[64:67], v[32:47]
    ds_read_b128 v[92:95], v11 offset:33536
    v_rcp_f32 v97, v97
    v_mul_f32 v28, v28, v96
    v_mul_f32 v29, v29, v97
    v_cvt_pk_bf16_f32 v110, v28, v29
    v_mul_f32 v98, v30, v30
    v_xor_b32 v103, 48, v121
    buffer_load_dwordx4 v103, s[44:47], s57 offen offset:3072 sc1 lds
    v_mfma_f32_32x32x16_bf16 v[32:47], v[228:231], v[68:71], v[32:47]
    v_mul_f32 v99, v31, v31
    v_fma_f32 v98, v98, v12, v13
    v_fma_f32 v99, v99, v12, v13
    v_mul_f32 v98, v98, v30
    v_mul_f32 v99, v99, v31
    s_add_u32 m0, s73, 102400
    s_add_u32 s57, s72, 2174976
    v_xor_b32 v103, 64, v121
    buffer_load_dwordx4 v103, s[44:47], s57 offen sc1 lds
    v_mfma_f32_32x32x16_bf16 v[32:47], v[232:235], v[72:75], v[32:47]
    v_exp_f32 v98, v98
    v_exp_f32 v99, v99
    v_add_f32 v98, 1.0, v98
    v_add_f32 v99, 1.0, v99
    v_rcp_f32 v98, v98
    v_mfma_f32_32x32x16_bf16 v[32:47], v[236:239], v[76:79], v[32:47]
    v_rcp_f32 v99, v99
    v_mul_f32 v30, v30, v98
    v_mul_f32 v31, v31, v99
    v_cvt_pk_bf16_f32 v111, v30, v31
    buffer_store_dwordx4 v[108:111], v2, s[44:47], s74 offen offset:1024 sc1
    v_xor_b32 v103, 80, v121
    buffer_load_dwordx4 v103, s[44:47], s57 offen offset:1024 sc1 lds
    s_waitcnt lgkmcnt(0)
    v_mfma_f32_32x32x16_bf16 v[32:47], v[240:243], v[80:83], v[32:47]
    v_xor_b32 v103, 96, v121
    buffer_load_dwordx4 v103, s[44:47], s57 offen offset:2048 sc1 lds
    v_mfma_f32_32x32x16_bf16 v[32:47], v[244:247], v[84:87], v[32:47]
    v_xor_b32 v103, 112, v121
    buffer_load_dwordx4 v103, s[44:47], s57 offen offset:3072 sc1 lds
    v_mfma_f32_32x32x16_bf16 v[32:47], v[248:251], v[88:91], v[32:47]
    v_mfma_f32_32x32x16_bf16 v[32:47], v[252:255], v[92:95], v[32:47]
    s_waitcnt vmcnt(9)
    s_barrier
    v_add_u32 v4, 0x10000, v4
    v_add_u32 v5, 0x10000, v5
    v_add_u32 v6, 0x10000, v6
    v_add_u32 v7, 0x10000, v7
    v_add_u32 v8, 0x10000, v8
    v_add_u32 v9, 0x10000, v9
    v_add_u32 v10, 0x10000, v10
    v_add_u32 v11, 0x10000, v11
    ds_read_b128 v[64:67], v4 offset:0
    ds_read_b128 v[68:71], v5 offset:0
    ds_read_b128 v[72:75], v6 offset:0
    ds_read_b128 v[76:79], v7 offset:0
    ds_read_b128 v[80:83], v8 offset:0
    ds_read_b128 v[84:87], v9 offset:0
    ds_read_b128 v[88:91], v10 offset:0
    s_waitcnt lgkmcnt(3)
    v_mfma_f32_32x32x16_bf16 v[16:31], v[128:131], v[64:67], v[48:63]
    ds_read_b128 v[92:95], v11 offset:0
    v_mfma_f32_32x32x16_bf16 v[16:31], v[132:135], v[68:71], v[16:31]
    ds_read_b128 v[64:67], v4 offset:256
    v_mfma_f32_32x32x16_bf16 v[16:31], v[136:139], v[72:75], v[16:31]
    ds_read_b128 v[68:71], v5 offset:256
    v_mfma_f32_32x32x16_bf16 v[16:31], v[140:143], v[76:79], v[16:31]
    ds_read_b128 v[72:75], v6 offset:256
    s_waitcnt lgkmcnt(3)
    v_mfma_f32_32x32x16_bf16 v[16:31], v[144:147], v[80:83], v[16:31]
    ds_read_b128 v[76:79], v7 offset:256
    s_add_u32 s74, s71, 8503296
    v_mul_f32 v96, v32, v32
    v_mul_f32 v97, v33, v33
    v_fma_f32 v96, v96, v12, v13
    v_fma_f32 v97, v97, v12, v13
    v_mul_f32 v96, v96, v32
    v_mfma_f32_32x32x16_bf16 v[16:31], v[148:151], v[84:87], v[16:31]
    ds_read_b128 v[80:83], v8 offset:256
    v_mul_f32 v97, v97, v33
    v_exp_f32 v96, v96
    v_exp_f32 v97, v97
    v_add_f32 v96, 1.0, v96
    v_add_f32 v97, 1.0, v97
    v_mfma_f32_32x32x16_bf16 v[16:31], v[152:155], v[88:91], v[16:31]
    ds_read_b128 v[84:87], v9 offset:256
    v_rcp_f32 v96, v96
    v_rcp_f32 v97, v97
    v_mul_f32 v32, v32, v96
    v_mul_f32 v33, v33, v97
    v_cvt_pk_bf16_f32 v104, v32, v33
    v_mfma_f32_32x32x16_bf16 v[16:31], v[156:159], v[92:95], v[16:31]
    ds_read_b128 v[88:91], v10 offset:256
    v_mul_f32 v98, v34, v34
    v_mul_f32 v99, v35, v35
    v_fma_f32 v98, v98, v12, v13
    v_fma_f32 v99, v99, v12, v13
    v_mul_f32 v98, v98, v34
    s_waitcnt lgkmcnt(3)
    v_mfma_f32_32x32x16_bf16 v[16:31], v[160:163], v[64:67], v[16:31]
    ds_read_b128 v[92:95], v11 offset:256
    v_mul_f32 v99, v99, v35
    v_exp_f32 v98, v98
    v_exp_f32 v99, v99
    v_add_f32 v98, 1.0, v98
    v_add_f32 v99, 1.0, v99
    v_mfma_f32_32x32x16_bf16 v[16:31], v[164:167], v[68:71], v[16:31]
    ds_read_b128 v[64:67], v4 offset:512
    v_rcp_f32 v98, v98
    v_rcp_f32 v99, v99
    v_mul_f32 v34, v34, v98
    v_mul_f32 v35, v35, v99
    v_cvt_pk_bf16_f32 v105, v34, v35
    v_mfma_f32_32x32x16_bf16 v[16:31], v[168:171], v[72:75], v[16:31]
    ds_read_b128 v[68:71], v5 offset:512
    v_mul_f32 v96, v36, v36
    v_mul_f32 v97, v37, v37
    v_fma_f32 v96, v96, v12, v13
    v_fma_f32 v97, v97, v12, v13
    v_mul_f32 v96, v96, v36
    v_mfma_f32_32x32x16_bf16 v[16:31], v[172:175], v[76:79], v[16:31]
    ds_read_b128 v[72:75], v6 offset:512
    v_mul_f32 v97, v97, v37
    v_exp_f32 v96, v96
    v_exp_f32 v97, v97
    v_add_f32 v96, 1.0, v96
    v_add_f32 v97, 1.0, v97
    s_waitcnt lgkmcnt(3)
    v_mfma_f32_32x32x16_bf16 v[16:31], v[176:179], v[80:83], v[16:31]
    ds_read_b128 v[76:79], v7 offset:512
    v_rcp_f32 v96, v96
    v_rcp_f32 v97, v97
    v_mul_f32 v36, v36, v96
    v_mul_f32 v37, v37, v97
    v_cvt_pk_bf16_f32 v106, v36, v37
    v_mul_f32 v98, v38, v38
    v_mfma_f32_32x32x16_bf16 v[16:31], v[180:183], v[84:87], v[16:31]
    ds_read_b128 v[80:83], v8 offset:512
    v_mul_f32 v99, v39, v39
    v_fma_f32 v98, v98, v12, v13
    v_fma_f32 v99, v99, v12, v13
    v_mul_f32 v98, v98, v38
    v_mul_f32 v99, v99, v39
    v_mfma_f32_32x32x16_bf16 v[16:31], v[184:187], v[88:91], v[16:31]
    ds_read_b128 v[84:87], v9 offset:512
    v_exp_f32 v98, v98
    v_exp_f32 v99, v99
    v_add_f32 v98, 1.0, v98
    v_add_f32 v99, 1.0, v99
    v_rcp_f32 v98, v98
    v_mfma_f32_32x32x16_bf16 v[16:31], v[188:191], v[92:95], v[16:31]
    ds_read_b128 v[88:91], v10 offset:512
    v_rcp_f32 v99, v99
    v_mul_f32 v38, v38, v98
    v_mul_f32 v39, v39, v99
    v_cvt_pk_bf16_f32 v107, v38, v39
    buffer_store_dwordx4 v[104:107], v2, s[44:47], s74 offen sc1
    s_waitcnt lgkmcnt(3)
    v_mfma_f32_32x32x16_bf16 v[16:31], v[192:195], v[64:67], v[16:31]
    ds_read_b128 v[92:95], v11 offset:512
    v_mul_f32 v96, v40, v40
    v_mul_f32 v97, v41, v41
    v_fma_f32 v96, v96, v12, v13
    v_fma_f32 v97, v97, v12, v13
    v_mul_f32 v96, v96, v40
    v_mfma_f32_32x32x16_bf16 v[16:31], v[196:199], v[68:71], v[16:31]
    ds_read_b128 v[64:67], v4 offset:768
    v_mul_f32 v97, v97, v41
    v_exp_f32 v96, v96
    v_exp_f32 v97, v97
    v_add_f32 v96, 1.0, v96
    v_add_f32 v97, 1.0, v97
    v_mfma_f32_32x32x16_bf16 v[16:31], v[200:203], v[72:75], v[16:31]
    ds_read_b128 v[68:71], v5 offset:768
    v_rcp_f32 v96, v96
    v_rcp_f32 v97, v97
    v_mul_f32 v40, v40, v96
    v_mul_f32 v41, v41, v97
    v_cvt_pk_bf16_f32 v108, v40, v41
    v_mfma_f32_32x32x16_bf16 v[16:31], v[204:207], v[76:79], v[16:31]
    ds_read_b128 v[72:75], v6 offset:768
    v_mul_f32 v98, v42, v42
    v_mul_f32 v99, v43, v43
    v_fma_f32 v98, v98, v12, v13
    v_fma_f32 v99, v99, v12, v13
    v_mul_f32 v98, v98, v42
    s_waitcnt lgkmcnt(3)
    v_mfma_f32_32x32x16_bf16 v[16:31], v[208:211], v[80:83], v[16:31]
    ds_read_b128 v[76:79], v7 offset:768
    v_mul_f32 v99, v99, v43
    v_exp_f32 v98, v98
    v_exp_f32 v99, v99
    v_add_f32 v98, 1.0, v98
    v_add_f32 v99, 1.0, v99
    v_rcp_f32 v98, v98
    v_mfma_f32_32x32x16_bf16 v[16:31], v[212:215], v[84:87], v[16:31]
    ds_read_b128 v[80:83], v8 offset:768
    v_rcp_f32 v99, v99
    v_mul_f32 v42, v42, v98
    v_mul_f32 v43, v43, v99
    v_cvt_pk_bf16_f32 v109, v42, v43
    v_mul_f32 v96, v44, v44
    v_mfma_f32_32x32x16_bf16 v[16:31], v[216:219], v[88:91], v[16:31]
    ds_read_b128 v[84:87], v9 offset:768
    v_mul_f32 v97, v45, v45
    v_fma_f32 v96, v96, v12, v13
    v_fma_f32 v97, v97, v12, v13
    v_mul_f32 v96, v96, v44
    v_mul_f32 v97, v97, v45
    v_mfma_f32_32x32x16_bf16 v[16:31], v[220:223], v[92:95], v[16:31]
    ds_read_b128 v[88:91], v10 offset:768
    v_exp_f32 v96, v96
    v_exp_f32 v97, v97
    v_add_f32 v96, 1.0, v96
    v_add_f32 v97, 1.0, v97
    v_rcp_f32 v96, v96
    s_waitcnt lgkmcnt(3)
    v_mfma_f32_32x32x16_bf16 v[16:31], v[224:227], v[64:67], v[16:31]
    ds_read_b128 v[92:95], v11 offset:768
    v_rcp_f32 v97, v97
    v_mul_f32 v44, v44, v96
    v_mul_f32 v45, v45, v97
    v_cvt_pk_bf16_f32 v110, v44, v45
    v_mul_f32 v98, v46, v46
    v_mfma_f32_32x32x16_bf16 v[16:31], v[228:231], v[68:71], v[16:31]
    v_mul_f32 v99, v47, v47
    v_fma_f32 v98, v98, v12, v13
    v_fma_f32 v99, v99, v12, v13
    v_mul_f32 v98, v98, v46
    v_mul_f32 v99, v99, v47
    s_waitcnt vmcnt(1)
    s_barrier
    ds_read_b128 v[64:67], v4 offset:32768
    v_mfma_f32_32x32x16_bf16 v[16:31], v[232:235], v[72:75], v[16:31]
    v_exp_f32 v98, v98
    v_exp_f32 v99, v99
    v_add_f32 v98, 1.0, v98
    v_add_f32 v99, 1.0, v99
    v_rcp_f32 v98, v98
    ds_read_b128 v[68:71], v5 offset:32768
    v_mfma_f32_32x32x16_bf16 v[16:31], v[236:239], v[76:79], v[16:31]
    v_rcp_f32 v99, v99
    v_mul_f32 v46, v46, v98
    v_mul_f32 v47, v47, v99
    v_cvt_pk_bf16_f32 v111, v46, v47
    buffer_store_dwordx4 v[108:111], v2, s[44:47], s74 offen offset:1024 sc1
    ds_read_b128 v[72:75], v6 offset:32768
    s_waitcnt lgkmcnt(3)
    v_mfma_f32_32x32x16_bf16 v[16:31], v[240:243], v[80:83], v[16:31]
    ds_read_b128 v[76:79], v7 offset:32768
    v_mfma_f32_32x32x16_bf16 v[16:31], v[244:247], v[84:87], v[16:31]
    ds_read_b128 v[80:83], v8 offset:32768
    v_mfma_f32_32x32x16_bf16 v[16:31], v[248:251], v[88:91], v[16:31]
    ds_read_b128 v[84:87], v9 offset:32768
    v_mfma_f32_32x32x16_bf16 v[16:31], v[252:255], v[92:95], v[16:31]
    ds_read_b128 v[88:91], v10 offset:32768
    s_waitcnt lgkmcnt(3)
    v_mfma_f32_32x32x16_bf16 v[32:47], v[128:131], v[64:67], v[48:63]
    ds_read_b128 v[92:95], v11 offset:32768
    v_mfma_f32_32x32x16_bf16 v[32:47], v[132:135], v[68:71], v[32:47]
    ds_read_b128 v[64:67], v4 offset:33024
    v_mfma_f32_32x32x16_bf16 v[32:47], v[136:139], v[72:75], v[32:47]
    ds_read_b128 v[68:71], v5 offset:33024
    s_add_u32 s56, s70, 16384
    buffer_store_dword v3, off, s[44:47], s56 sc1
    v_mfma_f32_32x32x16_bf16 v[32:47], v[140:143], v[76:79], v[32:47]
    ds_read_b128 v[72:75], v6 offset:33024
    s_waitcnt lgkmcnt(3)
    v_mfma_f32_32x32x16_bf16 v[32:47], v[144:147], v[80:83], v[32:47]
    ds_read_b128 v[76:79], v7 offset:33024
    s_add_u32 s74, s71, 8617984
    v_mul_f32 v96, v16, v16
    v_mul_f32 v97, v17, v17
    v_fma_f32 v96, v96, v12, v13
    v_fma_f32 v97, v97, v12, v13
    v_mul_f32 v96, v96, v16
    v_mfma_f32_32x32x16_bf16 v[32:47], v[148:151], v[84:87], v[32:47]
    ds_read_b128 v[80:83], v8 offset:33024
    v_mul_f32 v97, v97, v17
    v_exp_f32 v96, v96
    v_exp_f32 v97, v97
    v_add_f32 v96, 1.0, v96
    v_add_f32 v97, 1.0, v97
    v_mfma_f32_32x32x16_bf16 v[32:47], v[152:155], v[88:91], v[32:47]
    ds_read_b128 v[84:87], v9 offset:33024
    v_rcp_f32 v96, v96
    v_rcp_f32 v97, v97
    v_mul_f32 v16, v16, v96
    v_mul_f32 v17, v17, v97
    v_cvt_pk_bf16_f32 v104, v16, v17
    v_mfma_f32_32x32x16_bf16 v[32:47], v[156:159], v[92:95], v[32:47]
    ds_read_b128 v[88:91], v10 offset:33024
    v_mul_f32 v98, v18, v18
    v_mul_f32 v99, v19, v19
    v_fma_f32 v98, v98, v12, v13
    v_fma_f32 v99, v99, v12, v13
    v_mul_f32 v98, v98, v18
    s_waitcnt lgkmcnt(3)
    v_mfma_f32_32x32x16_bf16 v[32:47], v[160:163], v[64:67], v[32:47]
    ds_read_b128 v[92:95], v11 offset:33024
    v_mul_f32 v99, v99, v19
    v_exp_f32 v98, v98
    v_exp_f32 v99, v99
    v_add_f32 v98, 1.0, v98
    v_add_f32 v99, 1.0, v99
    v_mfma_f32_32x32x16_bf16 v[32:47], v[164:167], v[68:71], v[32:47]
    ds_read_b128 v[64:67], v4 offset:33280
    v_rcp_f32 v98, v98
    v_rcp_f32 v99, v99
    v_mul_f32 v18, v18, v98
    v_mul_f32 v19, v19, v99
    v_cvt_pk_bf16_f32 v105, v18, v19
    v_mfma_f32_32x32x16_bf16 v[32:47], v[168:171], v[72:75], v[32:47]
    ds_read_b128 v[68:71], v5 offset:33280
    v_mul_f32 v96, v20, v20
    v_mul_f32 v97, v21, v21
    v_fma_f32 v96, v96, v12, v13
    v_fma_f32 v97, v97, v12, v13
    v_mul_f32 v96, v96, v20
    v_mfma_f32_32x32x16_bf16 v[32:47], v[172:175], v[76:79], v[32:47]
    ds_read_b128 v[72:75], v6 offset:33280
    v_mul_f32 v97, v97, v21
    v_exp_f32 v96, v96
    v_exp_f32 v97, v97
    v_add_f32 v96, 1.0, v96
    v_add_f32 v97, 1.0, v97
    s_waitcnt lgkmcnt(3)
    v_mfma_f32_32x32x16_bf16 v[32:47], v[176:179], v[80:83], v[32:47]
    ds_read_b128 v[76:79], v7 offset:33280
    v_rcp_f32 v96, v96
    v_rcp_f32 v97, v97
    v_mul_f32 v20, v20, v96
    v_mul_f32 v21, v21, v97
    v_cvt_pk_bf16_f32 v106, v20, v21
    v_mul_f32 v98, v22, v22
    v_mfma_f32_32x32x16_bf16 v[32:47], v[180:183], v[84:87], v[32:47]
    ds_read_b128 v[80:83], v8 offset:33280
    v_mul_f32 v99, v23, v23
    v_fma_f32 v98, v98, v12, v13
    v_fma_f32 v99, v99, v12, v13
    v_mul_f32 v98, v98, v22
    v_mul_f32 v99, v99, v23
    v_mfma_f32_32x32x16_bf16 v[32:47], v[184:187], v[88:91], v[32:47]
    ds_read_b128 v[84:87], v9 offset:33280
    v_exp_f32 v98, v98
    v_exp_f32 v99, v99
    v_add_f32 v98, 1.0, v98
    v_add_f32 v99, 1.0, v99
    v_rcp_f32 v98, v98
    v_mfma_f32_32x32x16_bf16 v[32:47], v[188:191], v[92:95], v[32:47]
    ds_read_b128 v[88:91], v10 offset:33280
    v_rcp_f32 v99, v99
    v_mul_f32 v22, v22, v98
    v_mul_f32 v23, v23, v99
    v_cvt_pk_bf16_f32 v107, v22, v23
    buffer_store_dwordx4 v[104:107], v2, s[44:47], s74 offen sc1
    s_waitcnt lgkmcnt(3)
    v_mfma_f32_32x32x16_bf16 v[32:47], v[192:195], v[64:67], v[32:47]
    ds_read_b128 v[92:95], v11 offset:33280
    v_mul_f32 v96, v24, v24
    v_mul_f32 v97, v25, v25
    v_fma_f32 v96, v96, v12, v13
    v_fma_f32 v97, v97, v12, v13
    v_mul_f32 v96, v96, v24
    v_mfma_f32_32x32x16_bf16 v[32:47], v[196:199], v[68:71], v[32:47]
    ds_read_b128 v[64:67], v4 offset:33536
    v_mul_f32 v97, v97, v25
    v_exp_f32 v96, v96
    v_exp_f32 v97, v97
    v_add_f32 v96, 1.0, v96
    v_add_f32 v97, 1.0, v97
    v_mfma_f32_32x32x16_bf16 v[32:47], v[200:203], v[72:75], v[32:47]
    ds_read_b128 v[68:71], v5 offset:33536
    v_rcp_f32 v96, v96
    v_rcp_f32 v97, v97
    v_mul_f32 v24, v24, v96
    v_mul_f32 v25, v25, v97
    v_cvt_pk_bf16_f32 v108, v24, v25
    v_mfma_f32_32x32x16_bf16 v[32:47], v[204:207], v[76:79], v[32:47]
    ds_read_b128 v[72:75], v6 offset:33536
    v_mul_f32 v98, v26, v26
    v_mul_f32 v99, v27, v27
    v_fma_f32 v98, v98, v12, v13
    v_fma_f32 v99, v99, v12, v13
    v_mul_f32 v98, v98, v26
    s_waitcnt lgkmcnt(3)
    v_mfma_f32_32x32x16_bf16 v[32:47], v[208:211], v[80:83], v[32:47]
    ds_read_b128 v[76:79], v7 offset:33536
    v_mul_f32 v99, v99, v27
    v_exp_f32 v98, v98
    v_exp_f32 v99, v99
    v_add_f32 v98, 1.0, v98
    v_add_f32 v99, 1.0, v99
    v_rcp_f32 v98, v98
    v_mfma_f32_32x32x16_bf16 v[32:47], v[212:215], v[84:87], v[32:47]
    ds_read_b128 v[80:83], v8 offset:33536
    v_rcp_f32 v99, v99
    v_mul_f32 v26, v26, v98
    v_mul_f32 v27, v27, v99
    v_cvt_pk_bf16_f32 v109, v26, v27
    v_mul_f32 v96, v28, v28
    v_mfma_f32_32x32x16_bf16 v[32:47], v[216:219], v[88:91], v[32:47]
    ds_read_b128 v[84:87], v9 offset:33536
    v_mul_f32 v97, v29, v29
    v_fma_f32 v96, v96, v12, v13
    v_fma_f32 v97, v97, v12, v13
    v_mul_f32 v96, v96, v28
    v_mul_f32 v97, v97, v29
    v_mfma_f32_32x32x16_bf16 v[32:47], v[220:223], v[92:95], v[32:47]
    ds_read_b128 v[88:91], v10 offset:33536
    v_exp_f32 v96, v96
    v_exp_f32 v97, v97
    v_add_f32 v96, 1.0, v96
    v_add_f32 v97, 1.0, v97
    v_rcp_f32 v96, v96
    s_waitcnt lgkmcnt(3)
    v_mfma_f32_32x32x16_bf16 v[32:47], v[224:227], v[64:67], v[32:47]
    ds_read_b128 v[92:95], v11 offset:33536
    v_rcp_f32 v97, v97
    v_mul_f32 v28, v28, v96
    v_mul_f32 v29, v29, v97
    v_cvt_pk_bf16_f32 v110, v28, v29
    v_mul_f32 v98, v30, v30
    v_mfma_f32_32x32x16_bf16 v[32:47], v[228:231], v[68:71], v[32:47]
    v_mul_f32 v99, v31, v31
    v_fma_f32 v98, v98, v12, v13
    v_fma_f32 v99, v99, v12, v13
    v_mul_f32 v98, v98, v30
    v_mul_f32 v99, v99, v31
    v_mfma_f32_32x32x16_bf16 v[32:47], v[232:235], v[72:75], v[32:47]
    v_exp_f32 v98, v98
    v_exp_f32 v99, v99
    v_add_f32 v98, 1.0, v98
    v_add_f32 v99, 1.0, v99
    v_rcp_f32 v98, v98
    v_mfma_f32_32x32x16_bf16 v[32:47], v[236:239], v[76:79], v[32:47]
    v_rcp_f32 v99, v99
    v_mul_f32 v30, v30, v98
    v_mul_f32 v31, v31, v99
    v_cvt_pk_bf16_f32 v111, v30, v31
    buffer_store_dwordx4 v[108:111], v2, s[44:47], s74 offen offset:1024 sc1
    s_waitcnt lgkmcnt(0)
    v_mfma_f32_32x32x16_bf16 v[32:47], v[240:243], v[80:83], v[32:47]
    s_waitcnt vmcnt(3)
    s_add_u32 s56, s70, 16640
    buffer_store_dword v3, off, s[44:47], s56 sc1
    v_mfma_f32_32x32x16_bf16 v[32:47], v[244:247], v[84:87], v[32:47]
    v_add_u32 v100, 16384, v119
    v_add_u32 v101, 512, v100
    buffer_load_dword v102, v100, s[44:47], 0 offen sc1
    v_mfma_f32_32x32x16_bf16 v[32:47], v[248:251], v[88:91], v[32:47]
    v_mfma_f32_32x32x16_bf16 v[32:47], v[252:255], v[92:95], v[32:47]
    v_subrev_u32 v4, 0x10000, v4
    v_subrev_u32 v5, 0x10000, v5
    v_subrev_u32 v6, 0x10000, v6
    v_subrev_u32 v7, 0x10000, v7
    v_subrev_u32 v8, 0x10000, v8
    v_subrev_u32 v9, 0x10000, v9
    v_subrev_u32 v10, 0x10000, v10
    v_subrev_u32 v11, 0x10000, v11
    v_mov_b32 v124, v100
    v_mov_b32 v125, v101
    s_waitcnt vmcnt(0)
    v_cmp_ne_u32 vcc, s51, v102
    s_cbranch_vccz L_pcd_75
    s_mov_b32 s53, 0
L_pc_74:
    buffer_load_dword v102, v100, s[44:47], 0 offen sc1
    s_waitcnt vmcnt(0)
    v_cmp_ne_u32 vcc, s51, v102
    s_cbranch_vccz L_pcd_75
    s_add_u32 s53, s53, 1
    s_cmp_lg_u32 s52, 0
    s_cbranch_scc1 L_pcd_75
    s_cmp_lt_u32 s53, 0x8000
    s_cbranch_scc1 L_pc_74
    s_mov_b32 s52, 1
L_pcd_75:
    s_add_u32 s54, s69, 8388608
    buffer_load_dwordx4 v[64:67], v2, s[44:47], s54 offen sc1
    s_add_u32 s54, s69, 8388608
    buffer_load_dwordx4 v[68:71], v2, s[44:47], s54 offen offset:1024 sc1
    s_add_u32 s54, s69, 8388608
    buffer_load_dwordx4 v[72:75], v2, s[44:47], s54 offen offset:2048 sc1
    s_add_u32 s54, s69, 8388608
    buffer_load_dwordx4 v[76:79], v2, s[44:47], s54 offen offset:3072 sc1
    s_add_u32 s54, s69, 8392704
    buffer_load_dwordx4 v[80:83], v2, s[44:47], s54 offen sc1
    s_add_u32 s54, s69, 8392704
    buffer_load_dwordx4 v[84:87], v2, s[44:47], s54 offen offset:1024 sc1
    s_add_u32 s54, s69, 8392704
    buffer_load_dwordx4 v[88:91], v2, s[44:47], s54 offen offset:2048 sc1
    s_add_u32 s54, s69, 8392704
    buffer_load_dwordx4 v[92:95], v2, s[44:47], s54 offen offset:3072 sc1
    s_add_u32 s54, s69, 8396800
    buffer_load_dwordx4 v[96:99], v2, s[44:47], s54 offen sc1
    s_add_u32 s54, s69, 8396800
    buffer_load_dwordx4 v[100:103], v2, s[44:47], s54 offen offset:1024 sc1
    s_add_u32 s54, s69, 8396800
    buffer_load_dwordx4 v[104:107], v2, s[44:47], s54 offen offset:2048 sc1
    s_add_u32 s54, s69, 8396800
    buffer_load_dwordx4 v[108:111], v2, s[44:47], s54 offen offset:3072 sc1
    s_nop 1
    s_add_u32 s74, s71, 8732672
    v_pk_mul_f32 v[60:61], v[32:33], v[32:33]
    v_pk_mul_f32 v[62:63], v[34:35], v[34:35]
    v_pk_fma_f32 v[60:61], v[60:61], v[12:13], v[12:13] op_sel:[0,0,1] op_sel_hi:[1,0,1]
    v_pk_fma_f32 v[62:63], v[62:63], v[12:13], v[12:13] op_sel:[0,0,1] op_sel_hi:[1,0,1]
    v_pk_mul_f32 v[60:61], v[60:61], v[32:33]
    v_pk_mul_f32 v[62:63], v[62:63], v[34:35]
    v_exp_f32 v60, v60
    v_exp_f32 v62, v62
    v_exp_f32 v61, v61
    v_exp_f32 v63, v63
    v_pk_add_f32 v[60:61], v[60:61], v[14:15]
    v_pk_add_f32 v[62:63], v[62:63], v[14:15]
    v_rcp_f32 v60, v60
    v_rcp_f32 v62, v62
    v_rcp_f32 v61, v61
    v_rcp_f32 v63, v63
    v_pk_mul_f32 v[32:33], v[32:33], v[60:61]
    v_pk_mul_f32 v[34:35], v[34:35], v[62:63]
    v_cvt_pk_bf16_f32 v48, v32, v33
    v_cvt_pk_bf16_f32 v49, v34, v35
    v_pk_mul_f32 v[60:61], v[36:37], v[36:37]
    v_pk_mul_f32 v[62:63], v[38:39], v[38:39]
    v_pk_fma_f32 v[60:61], v[60:61], v[12:13], v[12:13] op_sel:[0,0,1] op_sel_hi:[1,0,1]
    v_pk_fma_f32 v[62:63], v[62:63], v[12:13], v[12:13] op_sel:[0,0,1] op_sel_hi:[1,0,1]
    v_pk_mul_f32 v[60:61], v[60:61], v[36:37]
    v_pk_mul_f32 v[62:63], v[62:63], v[38:39]
    v_exp_f32 v60, v60
    v_exp_f32 v62, v62
    v_exp_f32 v61, v61
    v_exp_f32 v63, v63
    v_pk_add_f32 v[60:61], v[60:61], v[14:15]
    v_pk_add_f32 v[62:63], v[62:63], v[14:15]
    v_rcp_f32 v60, v60
    v_rcp_f32 v62, v62
    v_rcp_f32 v61, v61
    v_rcp_f32 v63, v63
    v_pk_mul_f32 v[36:37], v[36:37], v[60:61]
    v_pk_mul_f32 v[38:39], v[38:39], v[62:63]
    v_cvt_pk_bf16_f32 v50, v36, v37
    v_cvt_pk_bf16_f32 v51, v38, v39
    s_add_u32 s56, s70, 16896
    buffer_store_dword v3, off, s[44:47], s56 sc1
    buffer_store_dwordx4 v[48:51], v2, s[44:47], s74 offen sc1
    v_pk_mul_f32 v[60:61], v[40:41], v[40:41]
    v_pk_mul_f32 v[62:63], v[42:43], v[42:43]
    v_pk_fma_f32 v[60:61], v[60:61], v[12:13], v[12:13] op_sel:[0,0,1] op_sel_hi:[1,0,1]
    v_pk_fma_f32 v[62:63], v[62:63], v[12:13], v[12:13] op_sel:[0,0,1] op_sel_hi:[1,0,1]
    v_pk_mul_f32 v[60:61], v[60:61], v[40:41]
    v_pk_mul_f32 v[62:63], v[62:63], v[42:43]
    v_exp_f32 v60, v60
    v_exp_f32 v62, v62
    v_exp_f32 v61, v61
    v_exp_f32 v63, v63
    v_pk_add_f32 v[60:61], v[60:61], v[14:15]
    v_pk_add_f32 v[62:63], v[62:63], v[14:15]
    v_rcp_f32 v60, v60
    v_rcp_f32 v62, v62
    v_rcp_f32 v61, v61
    v_rcp_f32 v63, v63
    v_pk_mul_f32 v[40:41], v[40:41], v[60:61]
    v_pk_mul_f32 v[42:43], v[42:43], v[62:63]
    v_cvt_pk_bf16_f32 v52, v40, v41
    v_cvt_pk_bf16_f32 v53, v42, v43
    v_pk_mul_f32 v[60:61], v[44:45], v[44:45]
    v_pk_mul_f32 v[62:63], v[46:47], v[46:47]
    v_pk_fma_f32 v[60:61], v[60:61], v[12:13], v[12:13] op_sel:[0,0,1] op_sel_hi:[1,0,1]
    v_pk_fma_f32 v[62:63], v[62:63], v[12:13], v[12:13] op_sel:[0,0,1] op_sel_hi:[1,0,1]
    v_pk_mul_f32 v[60:61], v[60:61], v[44:45]
    v_pk_mul_f32 v[62:63], v[62:63], v[46:47]
    v_exp_f32 v60, v60
    v_exp_f32 v62, v62
    v_exp_f32 v61, v61
    v_exp_f32 v63, v63
    v_pk_add_f32 v[60:61], v[60:61], v[14:15]
    v_pk_add_f32 v[62:63], v[62:63], v[14:15]
    v_rcp_f32 v60, v60
    v_rcp_f32 v62, v62
    v_rcp_f32 v61, v61
    v_rcp_f32 v63, v63
    v_pk_mul_f32 v[44:45], v[44:45], v[60:61]
    v_pk_mul_f32 v[46:47], v[46:47], v[62:63]
    v_cvt_pk_bf16_f32 v54, v44, v45
    v_cvt_pk_bf16_f32 v55, v46, v47
    buffer_store_dwordx4 v[52:55], v2, s[44:47], s74 offen offset:1024 sc1
    s_mov_b32 s4, s36
    s_and_b32 s5, s37, 0xffff
    s_mov_b32 s6, 1024
    s_mov_b32 s7, 0x00020000
    buffer_load_dwordx4 v[56:59], v123, s[4:7], 0 offen
    s_mov_b32 s53, 17825792
    buffer_load_dwordx4 v[60:63], v112, s[44:47], s53 offen sc1
    s_mov_b32 s8, s38
    s_and_b32 s9, s39, 0xffff
    s_mov_b32 s10, 2097152
    s_mov_b32 s11, 0x00020000
    s_waitcnt vmcnt(16)
    v_mfma_f32_32x32x16_bf16 a[224:239], a[0:3], v[64:67], 0
    v_mfma_f32_32x32x16_bf16 a[240:255], a[112:115], v[64:67], 0
    s_waitcnt vmcnt(15)
    v_mfma_f32_32x32x16_bf16 a[224:239], a[4:7], v[68:71], a[224:239]
    s_add_u32 s54, s69, 8400896
    buffer_load_dwordx4 v[64:67], v2, s[44:47], s54 offen sc1
    v_mfma_f32_32x32x16_bf16 a[240:255], a[116:119], v[68:71], a[240:255]
    s_waitcnt vmcnt(15)
    v_mfma_f32_32x32x16_bf16 a[224:239], a[8:11], v[72:75], a[224:239]
    s_add_u32 s54, s69, 8400896
    buffer_load_dwordx4 v[68:71], v2, s[44:47], s54 offen offset:1024 sc1
    v_mfma_f32_32x32x16_bf16 a[240:255], a[120:123], v[72:75], a[240:255]
    s_waitcnt vmcnt(15)
    v_mfma_f32_32x32x16_bf16 a[224:239], a[12:15], v[76:79], a[224:239]
    s_add_u32 s54, s69, 8400896
    buffer_load_dwordx4 v[72:75], v2, s[44:47], s54 offen offset:2048 sc1
    v_mfma_f32_32x32x16_bf16 a[240:255], a[124:127], v[76:79], a[240:255]
    s_waitcnt vmcnt(5)
    s_add_u32 s56, s70, 17152
    buffer_store_dword v3, off, s[44:47], s56 sc1
    v_mfma_f32_32x32x16_bf16 a[224:239], a[16:19], v[80:83], a[224:239]
    s_add_u32 s54, s69, 8400896
    buffer_load_dwordx4 v[76:79], v2, s[44:47], s54 offen offset:3072 sc1
    v_mfma_f32_32x32x16_bf16 a[240:255], a[128:131], v[80:83], a[240:255]
    v_mfma_f32_32x32x16_bf16 a[224:239], a[20:23], v[84:87], a[224:239]
    s_add_u32 s54, s69, 8404992
    buffer_load_dwordx4 v[80:83], v2, s[44:47], s54 offen sc1
    v_mfma_f32_32x32x16_bf16 a[240:255], a[132:135], v[84:87], a[240:255]
    v_mfma_f32_32x32x16_bf16 a[224:239], a[24:27], v[88:91], a[224:239]
    s_add_u32 s54, s69, 8404992
    buffer_load_dwordx4 v[84:87], v2, s[44:47], s54 offen offset:1024 sc1
    v_mfma_f32_32x32x16_bf16 a[240:255], a[136:139], v[88:91], a[240:255]
    v_mfma_f32_32x32x16_bf16 a[224:239], a[28:31], v[92:95], a[224:239]
    s_add_u32 s54, s69, 8404992
    buffer_load_dwordx4 v[88:91], v2, s[44:47], s54 offen offset:2048 sc1
    v_mfma_f32_32x32x16_bf16 a[240:255], a[140:143], v[92:95], a[240:255]
    v_mfma_f32_32x32x16_bf16 a[224:239], a[32:35], v[96:99], a[224:239]
    s_add_u32 s54, s69, 8404992
    buffer_load_dwordx4 v[92:95], v2, s[44:47], s54 offen offset:3072 sc1
    v_mfma_f32_32x32x16_bf16 a[240:255], a[144:147], v[96:99], a[240:255]
    v_mfma_f32_32x32x16_bf16 a[224:239], a[36:39], v[100:103], a[224:239]
    s_add_u32 s54, s69, 8409088
    buffer_load_dwordx4 v[96:99], v2, s[44:47], s54 offen sc1
    v_mfma_f32_32x32x16_bf16 a[240:255], a[148:151], v[100:103], a[240:255]
    v_mfma_f32_32x32x16_bf16 a[224:239], a[40:43], v[104:107], a[224:239]
    s_add_u32 s54, s69, 8409088
    buffer_load_dwordx4 v[100:103], v2, s[44:47], s54 offen offset:1024 sc1
    v_mfma_f32_32x32x16_bf16 a[240:255], a[152:155], v[104:107], a[240:255]
    buffer_load_dword v126, v125, s[44:47], 0 offen sc1
    v_mfma_f32_32x32x16_bf16 a[224:239], a[44:47], v[108:111], a[224:239]
    s_add_u32 s54, s69, 8409088
    buffer_load_dwordx4 v[104:107], v2, s[44:47], s54 offen offset:2048 sc1
    v_mfma_f32_32x32x16_bf16 a[240:255], a[156:159], v[108:111], a[240:255]
    s_waitcnt vmcnt(12)
    v_mfma_f32_32x32x16_bf16 a[224:239], a[48:51], v[64:67], a[224:239]
    s_add_u32 s54, s69, 8409088
    buffer_load_dwordx4 v[108:111], v2, s[44:47], s54 offen offset:3072 sc1
    v_mfma_f32_32x32x16_bf16 a[240:255], a[160:163], v[64:67], a[240:255]
    s_waitcnt vmcnt(12)
    v_mfma_f32_32x32x16_bf16 a[224:239], a[52:55], v[68:71], a[224:239]
    s_add_u32 s54, s69, 8413184
    buffer_load_dwordx4 v[64:67], v2, s[44:47], s54 offen sc1
    v_mfma_f32_32x32x16_bf16 a[240:255], a[164:167], v[68:71], a[240:255]
    s_waitcnt vmcnt(12)
    v_mfma_f32_32x32x16_bf16 a[224:239], a[56:59], v[72:75], a[224:239]
    s_add_u32 s54, s69, 8413184
    buffer_load_dwordx4 v[68:71], v2, s[44:47], s54 offen offset:1024 sc1
    v_mfma_f32_32x32x16_bf16 a[240:255], a[168:171], v[72:75], a[240:255]
    s_waitcnt vmcnt(11)
    v_mfma_f32_32x32x16_bf16 a[224:239], a[60:63], v[76:79], a[224:239]
    s_add_u32 s54, s69, 8413184
    buffer_load_dwordx4 v[72:75], v2, s[44:47], s54 offen offset:2048 sc1
    v_mfma_f32_32x32x16_bf16 a[240:255], a[172:175], v[76:79], a[240:255]
    s_waitcnt vmcnt(5)
    v_cmp_ne_u32 vcc, s51, v126
    s_cbranch_vccz L_pcd_77
    s_mov_b32 s53, 0
L_pc_76:
    buffer_load_dword v126, v125, s[44:47], 0 offen sc1
    s_waitcnt vmcnt(0)
    v_cmp_ne_u32 vcc, s51, v126
    s_cbranch_vccz L_pcd_77
    s_add_u32 s53, s53, 1
    s_cmp_lg_u32 s52, 0
    s_cbranch_scc1 L_pcd_77
    s_cmp_lt_u32 s53, 0x8000
    s_cbranch_scc1 L_pc_76
    s_mov_b32 s52, 1
L_pcd_77:
    v_mfma_f32_32x32x16_bf16 a[224:239], a[64:67], v[80:83], a[224:239]
    s_add_u32 s54, s69, 8413184
    buffer_load_dwordx4 v[76:79], v2, s[44:47], s54 offen offset:3072 sc1
    v_mfma_f32_32x32x16_bf16 a[240:255], a[176:179], v[80:83], a[240:255]
    v_mfma_f32_32x32x16_bf16 a[224:239], a[68:71], v[84:87], a[224:239]
    s_add_u32 s54, s69, 8617984
    buffer_load_dwordx4 v[80:83], v2, s[44:47], s54 offen sc1
    v_mfma_f32_32x32x16_bf16 a[240:255], a[180:183], v[84:87], a[240:255]
    v_mfma_f32_32x32x16_bf16 a[224:239], a[72:75], v[88:91], a[224:239]
    s_add_u32 s54, s69, 8617984
    buffer_load_dwordx4 v[84:87], v2, s[44:47], s54 offen offset:1024 sc1
    v_mfma_f32_32x32x16_bf16 a[240:255], a[184:187], v[88:91], a[240:255]
    v_mfma_f32_32x32x16_bf16 a[224:239], a[76:79], v[92:95], a[224:239]
    s_add_u32 s54, s69, 8617984
    buffer_load_dwordx4 v[88:91], v2, s[44:47], s54 offen offset:2048 sc1
    v_mfma_f32_32x32x16_bf16 a[240:255], a[188:191], v[92:95], a[240:255]
    v_mfma_f32_32x32x16_bf16 a[224:239], a[80:83], v[96:99], a[224:239]
    s_add_u32 s54, s69, 8617984
    buffer_load_dwordx4 v[92:95], v2, s[44:47], s54 offen offset:3072 sc1
    v_mfma_f32_32x32x16_bf16 a[240:255], a[192:195], v[96:99], a[240:255]
    v_mfma_f32_32x32x16_bf16 a[224:239], a[84:87], v[100:103], a[224:239]
    s_add_u32 s54, s69, 8622080
    buffer_load_dwordx4 v[96:99], v2, s[44:47], s54 offen sc1
    v_mfma_f32_32x32x16_bf16 a[240:255], a[196:199], v[100:103], a[240:255]
    s_waitcnt vmcnt(10)
    v_mfma_f32_32x32x16_bf16 a[224:239], a[88:91], v[104:107], a[224:239]
    s_add_u32 s54, s69, 8622080
    buffer_load_dwordx4 v[100:103], v2, s[44:47], s54 offen offset:1024 sc1
    v_mfma_f32_32x32x16_bf16 a[240:255], a[200:203], v[104:107], a[240:255]
    s_waitcnt vmcnt(10)
    v_mfma_f32_32x32x16_bf16 a[224:239], a[92:95], v[108:111], a[224:239]
    s_add_u32 s54, s69, 8622080
    buffer_load_dwordx4 v[104:107], v2, s[44:47], s54 offen offset:2048 sc1
    v_mfma_f32_32x32x16_bf16 a[240:255], a[204:207], v[108:111], a[240:255]
    s_waitcnt vmcnt(10)
    v_mfma_f32_32x32x16_bf16 a[224:239], a[96:99], v[64:67], a[224:239]
    s_add_u32 s54, s69, 8622080
    buffer_load_dwordx4 v[108:111], v2, s[44:47], s54 offen offset:3072 sc1
    v_mfma_f32_32x32x16_bf16 a[240:255], a[208:211], v[64:67], a[240:255]
    s_waitcnt vmcnt(10)
    v_mfma_f32_32x32x16_bf16 a[224:239], a[100:103], v[68:71], a[224:239]
    s_add_u32 s54, s69, 8626176
    buffer_load_dwordx4 v[64:67], v2, s[44:47], s54 offen sc1
    v_mfma_f32_32x32x16_bf16 a[240:255], a[212:215], v[68:71], a[240:255]
    s_waitcnt vmcnt(10)
    v_mfma_f32_32x32x16_bf16 a[224:239], a[104:107], v[72:75], a[224:239]
    s_add_u32 s54, s69, 8626176
    buffer_load_dwordx4 v[68:71], v2, s[44:47], s54 offen offset:1024 sc1
    v_mfma_f32_32x32x16_bf16 a[240:255], a[216:219], v[72:75], a[240:255]
    s_waitcnt vmcnt(10)
    v_mfma_f32_32x32x16_bf16 a[224:239], a[108:111], v[76:79], a[224:239]
    s_add_u32 s54, s69, 8626176
    buffer_load_dwordx4 v[72:75], v2, s[44:47], s54 offen offset:2048 sc1
    v_mfma_f32_32x32x16_bf16 a[240:255], a[220:223], v[76:79], a[240:255]
    s_waitcnt vmcnt(10)
    v_mfma_f32_32x32x16_bf16 v[16:31], a[0:3], v[80:83], 0
    s_add_u32 s54, s69, 8626176
    buffer_load_dwordx4 v[76:79], v2, s[44:47], s54 offen offset:3072 sc1
    v_mfma_f32_32x32x16_bf16 v[32:47], a[112:115], v[80:83], 0
    s_waitcnt vmcnt(10)
    v_mfma_f32_32x32x16_bf16 v[16:31], a[4:7], v[84:87], v[16:31]
    s_add_u32 s54, s69, 8630272
    buffer_load_dwordx4 v[80:83], v2, s[44:47], s54 offen sc1
    v_mfma_f32_32x32x16_bf16 v[32:47], a[116:119], v[84:87], v[32:47]
    s_waitcnt vmcnt(10)
    v_mfma_f32_32x32x16_bf16 v[16:31], a[8:11], v[88:91], v[16:31]
    s_add_u32 s54, s69, 8630272
    buffer_load_dwordx4 v[84:87], v2, s[44:47], s54 offen offset:1024 sc1
    v_mfma_f32_32x32x16_bf16 v[32:47], a[120:123], v[88:91], v[32:47]
    ds_write_b128 v115, a[224:227] offset:0
    ds_write_b128 v116, a[228:231] offset:0
    s_waitcnt vmcnt(10)
    v_mfma_f32_32x32x16_bf16 v[16:31], a[12:15], v[92:95], v[16:31]
    s_add_u32 s54, s69, 8630272
    buffer_load_dwordx4 v[88:91], v2, s[44:47], s54 offen offset:2048 sc1
    v_mfma_f32_32x32x16_bf16 v[32:47], a[124:127], v[92:95], v[32:47]
    ds_write_b128 v117, a[232:235] offset:0
    ds_write_b128 v118, a[236:239] offset:0
    s_waitcnt vmcnt(10)
    v_mfma_f32_32x32x16_bf16 v[16:31], a[16:19], v[96:99], v[16:31]
    s_add_u32 s54, s69, 8630272
    buffer_load_dwordx4 v[92:95], v2, s[44:47], s54 offen offset:3072 sc1
    v_mfma_f32_32x32x16_bf16 v[32:47], a[128:131], v[96:99], v[32:47]
    ds_write_b128 v115, a[240:243] offset:128
    ds_write_b128 v116, a[244:247] offset:128
    s_waitcnt vmcnt(10)
    v_mfma_f32_32x32x16_bf16 v[16:31], a[20:23], v[100:103], v[16:31]
    s_add_u32 s54, s69, 8634368
    buffer_load_dwordx4 v[96:99], v2, s[44:47], s54 offen sc1
    v_mfma_f32_32x32x16_bf16 v[32:47], a[132:135], v[100:103], v[32:47]
    ds_write_b128 v117, a[248:251] offset:128
    ds_write_b128 v118, a[252:255] offset:128
    s_waitcnt vmcnt(10)
    v_mfma_f32_32x32x16_bf16 v[16:31], a[24:27], v[104:107], v[16:31]
    s_add_u32 s54, s69, 8634368
    buffer_load_dwordx4 v[100:103], v2, s[44:47], s54 offen offset:1024 sc1
    v_mfma_f32_32x32x16_bf16 v[32:47], a[136:139], v[104:107], v[32:47]
    s_waitcnt vmcnt(10)
    v_mfma_f32_32x32x16_bf16 v[16:31], a[28:31], v[108:111], v[16:31]
    s_add_u32 s54, s69, 8634368
    buffer_load_dwordx4 v[104:107], v2, s[44:47], s54 offen offset:2048 sc1
    v_mfma_f32_32x32x16_bf16 v[32:47], a[140:143], v[108:111], v[32:47]
    s_waitcnt lgkmcnt(0)
    s_barrier
    s_waitcnt vmcnt(10)
    v_mfma_f32_32x32x16_bf16 v[16:31], a[32:35], v[64:67], v[16:31]
    s_add_u32 s54, s69, 8634368
    buffer_load_dwordx4 v[108:111], v2, s[44:47], s54 offen offset:3072 sc1
    v_mfma_f32_32x32x16_bf16 v[32:47], a[144:147], v[64:67], v[32:47]
    ds_read_b128 v[48:51], v113 offset:0
    ds_read_b128 v[52:55], v113 offset:8192
    s_waitcnt lgkmcnt(0)
    v_add_f32 v48, v48, v52
    v_add_f32 v49, v49, v53
    v_add_f32 v50, v50, v54
    v_add_f32 v51, v51, v55
    ds_read_b128 v[52:55], v113 offset:16384
    s_waitcnt vmcnt(10)
    v_mfma_f32_32x32x16_bf16 v[16:31], a[36:39], v[68:71], v[16:31]
    s_add_u32 s54, s69, 8638464
    buffer_load_dwordx4 v[64:67], v2, s[44:47], s54 offen sc1
    v_mfma_f32_32x32x16_bf16 v[32:47], a[148:151], v[68:71], v[32:47]
    s_waitcnt lgkmcnt(0)
    v_add_f32 v48, v48, v52
    v_add_f32 v49, v49, v53
    v_add_f32 v50, v50, v54
    v_add_f32 v51, v51, v55
    ds_read_b128 v[52:55], v113 offset:24576
    s_waitcnt vmcnt(10)
    v_mfma_f32_32x32x16_bf16 v[16:31], a[40:43], v[72:75], v[16:31]
    s_add_u32 s54, s69, 8638464
    buffer_load_dwordx4 v[68:71], v2, s[44:47], s54 offen offset:1024 sc1
    v_mfma_f32_32x32x16_bf16 v[32:47], a[152:155], v[72:75], v[32:47]
    s_waitcnt lgkmcnt(0)
    v_add_f32 v48, v48, v52
    v_add_f32 v49, v49, v53
    v_add_f32 v50, v50, v54
    v_add_f32 v51, v51, v55
    v_lshlrev_b32 v52, 16, v56
    v_and_b32 v53, 0xffff0000, v56
    v_lshlrev_b32 v54, 16, v57
    v_and_b32 v55, 0xffff0000, v57
    v_add_f32 v48, v48, v52
    v_add_f32 v49, v49, v53
    v_add_f32 v50, v50, v54
    v_add_f32 v51, v51, v55
    s_waitcnt vmcnt(10)
    v_mfma_f32_32x32x16_bf16 v[16:31], a[44:47], v[76:79], v[16:31]
    s_add_u32 s54, s69, 8638464
    buffer_load_dwordx4 v[72:75], v2, s[44:47], s54 offen offset:2048 sc1
    v_mfma_f32_32x32x16_bf16 v[32:47], a[156:159], v[76:79], v[32:47]
    v_cvt_pk_bf16_f32 v52, v48, v49
    v_cvt_pk_bf16_f32 v53, v50, v51
    v_lshlrev_b32 v48, 16, v52
    v_and_b32 v49, 0xffff0000, v52
    v_lshlrev_b32 v50, 16, v53
    v_and_b32 v51, 0xffff0000, v53
    s_waitcnt vmcnt(10)
    v_mfma_f32_32x32x16_bf16 v[16:31], a[48:51], v[80:83], v[16:31]
    s_add_u32 s54, s69, 8638464
    buffer_load_dwordx4 v[76:79], v2, s[44:47], s54 offen offset:3072 sc1
    v_mfma_f32_32x32x16_bf16 v[32:47], a[160:163], v[80:83], v[32:47]
    v_lshlrev_b32 v52, 16, v60
    v_and_b32 v53, 0xffff0000, v60
    v_lshlrev_b32 v54, 16, v61
    v_and_b32 v55, 0xffff0000, v61
    v_add_f32 v48, v48, v52
    v_add_f32 v49, v49, v53
    v_add_f32 v50, v50, v54
    v_add_f32 v51, v51, v55
    v_cvt_pk_bf16_f32 v12, v48, v49
    v_cvt_pk_bf16_f32 v13, v50, v51
    s_waitcnt vmcnt(10)
    v_mfma_f32_32x32x16_bf16 v[16:31], a[52:55], v[84:87], v[16:31]
    s_add_u32 s54, s69, 8642560
    buffer_load_dwordx4 v[80:83], v2, s[44:47], s54 offen sc1
    v_mfma_f32_32x32x16_bf16 v[32:47], a[164:167], v[84:87], v[32:47]
    ds_read_b128 v[48:51], v114 offset:0
    ds_read_b128 v[52:55], v114 offset:8192
    s_waitcnt vmcnt(10)
    v_mfma_f32_32x32x16_bf16 v[16:31], a[56:59], v[88:91], v[16:31]
    s_add_u32 s54, s69, 8642560
    buffer_load_dwordx4 v[84:87], v2, s[44:47], s54 offen offset:1024 sc1
    v_mfma_f32_32x32x16_bf16 v[32:47], a[168:171], v[88:91], v[32:47]
    s_waitcnt lgkmcnt(0)
    v_add_f32 v48, v48, v52
    v_add_f32 v49, v49, v53
    v_add_f32 v50, v50, v54
    v_add_f32 v51, v51, v55
    ds_read_b128 v[52:55], v114 offset:16384
    s_waitcnt lgkmcnt(0)
    v_add_f32 v48, v48, v52
    v_add_f32 v49, v49, v53
    v_add_f32 v50, v50, v54
    v_add_f32 v51, v51, v55
    ds_read_b128 v[52:55], v114 offset:24576
    s_waitcnt vmcnt(10)
    v_mfma_f32_32x32x16_bf16 v[16:31], a[60:63], v[92:95], v[16:31]
    s_add_u32 s54, s69, 8642560
    buffer_load_dwordx4 v[88:91], v2, s[44:47], s54 offen offset:2048 sc1
    v_mfma_f32_32x32x16_bf16 v[32:47], a[172:175], v[92:95], v[32:47]
    s_waitcnt lgkmcnt(0)
    v_add_f32 v48, v48, v52
    v_add_f32 v49, v49, v53
    v_add_f32 v50, v50, v54
    v_add_f32 v51, v51, v55
    s_waitcnt vmcnt(10)
    v_mfma_f32_32x32x16_bf16 v[16:31], a[64:67], v[96:99], v[16:31]
    s_add_u32 s54, s69, 8642560
    buffer_load_dwordx4 v[92:95], v2, s[44:47], s54 offen offset:3072 sc1
    v_mfma_f32_32x32x16_bf16 v[32:47], a[176:179], v[96:99], v[32:47]
    v_lshlrev_b32 v52, 16, v58
    v_and_b32 v53, 0xffff0000, v58
    v_lshlrev_b32 v54, 16, v59
    v_and_b32 v55, 0xffff0000, v59
    v_add_f32 v48, v48, v52
    v_add_f32 v49, v49, v53
    v_add_f32 v50, v50, v54
    v_add_f32 v51, v51, v55
    v_cvt_pk_bf16_f32 v52, v48, v49
    v_cvt_pk_bf16_f32 v53, v50, v51
    v_lshlrev_b32 v48, 16, v52
    v_and_b32 v49, 0xffff0000, v52
    v_lshlrev_b32 v50, 16, v53
    v_and_b32 v51, 0xffff0000, v53
    s_waitcnt vmcnt(10)
    v_mfma_f32_32x32x16_bf16 v[16:31], a[68:71], v[100:103], v[16:31]
    v_mfma_f32_32x32x16_bf16 v[32:47], a[180:183], v[100:103], v[32:47]
    v_lshlrev_b32 v52, 16, v62
    v_and_b32 v53, 0xffff0000, v62
    v_lshlrev_b32 v54, 16, v63
    v_and_b32 v55, 0xffff0000, v63
    v_add_f32 v48, v48, v52
    v_add_f32 v49, v49, v53
    v_add_f32 v50, v50, v54
    v_add_f32 v51, v51, v55
    s_waitcnt vmcnt(9)
    v_mfma_f32_32x32x16_bf16 v[16:31], a[72:75], v[104:107], v[16:31]
    v_mfma_f32_32x32x16_bf16 v[32:47], a[184:187], v[104:107], v[32:47]
    v_cvt_pk_bf16_f32 v14, v48, v49
    v_cvt_pk_bf16_f32 v15, v50, v51
    s_mov_b32 s53, 0
    buffer_store_dwordx4 v[12:15], v112, s[8:11], s53 offen sc1
    s_waitcnt vmcnt(9)
    v_mfma_f32_32x32x16_bf16 v[16:31], a[76:79], v[108:111], v[16:31]
    v_mfma_f32_32x32x16_bf16 v[32:47], a[188:191], v[108:111], v[32:47]
    s_waitcnt vmcnt(8)
    v_mfma_f32_32x32x16_bf16 v[16:31], a[80:83], v[64:67], v[16:31]
    v_mfma_f32_32x32x16_bf16 v[32:47], a[192:195], v[64:67], v[32:47]
    s_waitcnt vmcnt(7)
    v_mfma_f32_32x32x16_bf16 v[16:31], a[84:87], v[68:71], v[16:31]
    v_mfma_f32_32x32x16_bf16 v[32:47], a[196:199], v[68:71], v[32:47]
    s_waitcnt vmcnt(6)
    v_mfma_f32_32x32x16_bf16 v[16:31], a[88:91], v[72:75], v[16:31]
    v_mfma_f32_32x32x16_bf16 v[32:47], a[200:203], v[72:75], v[32:47]
    s_mov_b32 s53, 17829888
    buffer_load_dwordx4 v[60:63], v112, s[44:47], s53 offen sc1
    s_waitcnt vmcnt(6)
    v_mfma_f32_32x32x16_bf16 v[16:31], a[92:95], v[76:79], v[16:31]
    v_mfma_f32_32x32x16_bf16 v[32:47], a[204:207], v[76:79], v[32:47]
    s_waitcnt vmcnt(5)
    v_mfma_f32_32x32x16_bf16 v[16:31], a[96:99], v[80:83], v[16:31]
    v_mfma_f32_32x32x16_bf16 v[32:47], a[208:211], v[80:83], v[32:47]
    s_waitcnt vmcnt(4)
    v_mfma_f32_32x32x16_bf16 v[16:31], a[100:103], v[84:87], v[16:31]
    v_mfma_f32_32x32x16_bf16 v[32:47], a[212:215], v[84:87], v[32:47]
    s_waitcnt vmcnt(3)
    v_mfma_f32_32x32x16_bf16 v[16:31], a[104:107], v[88:91], v[16:31]
    v_mfma_f32_32x32x16_bf16 v[32:47], a[216:219], v[88:91], v[32:47]
    s_waitcnt vmcnt(2)
    v_mfma_f32_32x32x16_bf16 v[16:31], a[108:111], v[92:95], v[16:31]
    v_mfma_f32_32x32x16_bf16 v[32:47], a[220:223], v[92:95], v[32:47]
    s_branch L_ldone_67
L_idle_66:
    s_barrier
    buffer_load_dword v126, v125, s[44:47], 0 offen sc1
    s_waitcnt vmcnt(0)
    v_cmp_ne_u32 vcc, s51, v126
    s_cbranch_vccz L_pcd_79
    s_mov_b32 s53, 0
L_pc_78:
    buffer_load_dword v126, v125, s[44:47], 0 offen sc1
    s_waitcnt vmcnt(0)
    v_cmp_ne_u32 vcc, s51, v126
    s_cbranch_vccz L_pcd_79
    s_add_u32 s53, s53, 1
    s_cmp_lg_u32 s52, 0
    s_cbranch_scc1 L_pcd_79
    s_cmp_lt_u32 s53, 0x8000
    s_cbranch_scc1 L_pc_78
    s_mov_b32 s52, 1
L_pcd_79:
    s_add_u32 s53, s75, 15732736
    buffer_load_dwordx4 v[40:43], v2, s[44:47], s53 offen sc1
    s_waitcnt lgkmcnt(0)
    s_waitcnt vmcnt(0)
    v_lshlrev_b32 v32, 16, v40
    v_and_b32 v33, 0xffff0000, v40
    v_lshlrev_b32 v34, 16, v41
    v_and_b32 v35, 0xffff0000, v41
    v_lshlrev_b32 v36, 16, v42
    v_and_b32 v37, 0xffff0000, v42
    v_lshlrev_b32 v38, 16, v43
    v_and_b32 v39, 0xffff0000, v43
    v_add_f32 v124, v32, v33
    v_mul_f32 v125, v32, v32
    v_fmac_f32 v125, v33, v33
    v_add_f32 v124, v124, v34
    v_fmac_f32 v125, v34, v34
    v_add_f32 v124, v124, v35
    v_fmac_f32 v125, v35, v35
    v_add_f32 v124, v124, v36
    v_fmac_f32 v125, v36, v36
    v_add_f32 v124, v124, v37
    v_fmac_f32 v125, v37, v37
    v_add_f32 v124, v124, v38
    v_fmac_f32 v125, v38, v38
    v_add_f32 v124, v124, v39
    v_fmac_f32 v125, v39, v39
    s_nop 1
    v_add_f32_dpp v124, v124, v124 quad_perm:[1,0,3,2] row_mask:0xf bank_mask:0xf
    v_add_f32_dpp v125, v125, v125 quad_perm:[1,0,3,2] row_mask:0xf bank_mask:0xf
    s_nop 0
    v_add_f32_dpp v124, v124, v124 quad_perm:[2,3,0,1] row_mask:0xf bank_mask:0xf
    v_add_f32_dpp v125, v125, v125 quad_perm:[2,3,0,1] row_mask:0xf bank_mask:0xf
    s_nop 0
    v_add_f32_dpp v124, v124, v124 row_half_mirror row_mask:0xf bank_mask:0xf
    v_add_f32_dpp v125, v125, v125 row_half_mirror row_mask:0xf bank_mask:0xf
    s_nop 0
    v_add_f32_dpp v124, v124, v124 row_mirror row_mask:0xf bank_mask:0xf
    v_add_f32_dpp v125, v125, v125 row_mirror row_mask:0xf bank_mask:0xf
    s_nop 0
    v_add_f32_dpp v124, v124, v124 row_bcast:15 row_mask:0xa bank_mask:0xf
    v_add_f32_dpp v125, v125, v125 row_bcast:15 row_mask:0xa bank_mask:0xf
    s_nop 0
    v_add_f32_dpp v124, v124, v124 row_bcast:31 row_mask:0xc bank_mask:0xf
    v_add_f32_dpp v125, v125, v125 row_bcast:31 row_mask:0xc bank_mask:0xf
    s_nop 0
    v_readlane_b32 s58, v124, 63
    v_readlane_b32 s59, v125, 63
    s_nop 1
    v_mov_b32 v126, s58
    v_mov_b32 v127, s59
    v_mul_f32 v126, 0x3b000000, v126
    v_mul_f32 v127, 0x3b000000, v127
    v_fma_f32 v127, -v126, v126, v127
    v_max_f32 v127, 0, v127
    v_add_f32 v127, 0x3727c5ac, v127
    v_rsq_f32 v127, v127
    s_nop 0
    v_mul_f32 v126, v126, v127
    v_fma_f32 v109, v32, v127, -v126
    v_lshlrev_b32 v110, 16, v44
    v_fma_f32 v32, v109, v110, v32
    v_fma_f32 v109, v33, v127, -v126
    v_and_b32 v110, 0xffff0000, v44
    v_fma_f32 v33, v109, v110, v33
    v_fma_f32 v109, v34, v127, -v126
    v_lshlrev_b32 v110, 16, v45
    v_fma_f32 v34, v109, v110, v34
    v_fma_f32 v109, v35, v127, -v126
    v_and_b32 v110, 0xffff0000, v45
    v_fma_f32 v35, v109, v110, v35
    v_fma_f32 v109, v36, v127, -v126
    v_lshlrev_b32 v110, 16, v46
    v_fma_f32 v36, v109, v110, v36
    v_fma_f32 v109, v37, v127, -v126
    v_and_b32 v110, 0xffff0000, v46
    v_fma_f32 v37, v109, v110, v37
    v_fma_f32 v109, v38, v127, -v126
    v_lshlrev_b32 v110, 16, v47
    v_fma_f32 v38, v109, v110, v38
    v_fma_f32 v109, v39, v127, -v126
    v_and_b32 v110, 0xffff0000, v47
    v_fma_f32 v39, v109, v110, v39
    v_cvt_pk_bf16_f32 v40, v32, v33
    v_cvt_pk_bf16_f32 v41, v34, v35
    v_cvt_pk_bf16_f32 v42, v36, v37
    v_cvt_pk_bf16_f32 v43, v38, v39
    v_lshlrev_b32 v32, 16, v40
    v_and_b32 v33, 0xffff0000, v40
    v_lshlrev_b32 v34, 16, v41
    v_and_b32 v35, 0xffff0000, v41
    v_lshlrev_b32 v36, 16, v42
    v_and_b32 v37, 0xffff0000, v42
    v_lshlrev_b32 v38, 16, v43
    v_and_b32 v39, 0xffff0000, v43
    s_add_u32 s54, s75, 17829888
    buffer_store_dwordx4 v[40:43], v2, s[44:47], s54 offen sc1
    v_add_f32 v124, v32, v33
    v_mul_f32 v125, v32, v32
    v_fmac_f32 v125, v33, v33
    v_add_f32 v124, v124, v34
    v_fmac_f32 v125, v34, v34
    v_add_f32 v124, v124, v35
    v_fmac_f32 v125, v35, v35
    v_add_f32 v124, v124, v36
    v_fmac_f32 v125, v36, v36
    v_add_f32 v124, v124, v37
    v_fmac_f32 v125, v37, v37
    v_add_f32 v124, v124, v38
    v_fmac_f32 v125, v38, v38
    v_add_f32 v124, v124, v39
    v_fmac_f32 v125, v39, v39
    s_nop 1
    v_add_f32_dpp v124, v124, v124 quad_perm:[1,0,3,2] row_mask:0xf bank_mask:0xf
    v_add_f32_dpp v125, v125, v125 quad_perm:[1,0,3,2] row_mask:0xf bank_mask:0xf
    s_nop 0
    v_add_f32_dpp v124, v124, v124 quad_perm:[2,3,0,1] row_mask:0xf bank_mask:0xf
    v_add_f32_dpp v125, v125, v125 quad_perm:[2,3,0,1] row_mask:0xf bank_mask:0xf
    s_nop 0
    v_add_f32_dpp v124, v124, v124 row_half_mirror row_mask:0xf bank_mask:0xf
    v_add_f32_dpp v125, v125, v125 row_half_mirror row_mask:0xf bank_mask:0xf
    s_nop 0
    v_add_f32_dpp v124, v124, v124 row_mirror row_mask:0xf bank_mask:0xf
    v_add_f32_dpp v125, v125, v125 row_mirror row_mask:0xf bank_mask:0xf
    s_nop 0
    v_add_f32_dpp v124, v124, v124 row_bcast:15 row_mask:0xa bank_mask:0xf
    v_add_f32_dpp v125, v125, v125 row_bcast:15 row_mask:0xa bank_mask:0xf
    s_nop 0
    v_add_f32_dpp v124, v124, v124 row_bcast:31 row_mask:0xc bank_mask:0xf
    v_add_f32_dpp v125, v125, v125 row_bcast:31 row_mask:0xc bank_mask:0xf
    s_nop 0
    v_readlane_b32 s58, v124, 63
    v_readlane_b32 s59, v125, 63
    s_nop 1
    v_mov_b32 v126, s58
    v_mov_b32 v127, s59
    v_mul_f32 v126, 0x3b000000, v126
    v_mul_f32 v127, 0x3b000000, v127
    v_fma_f32 v127, -v126, v126, v127
    v_max_f32 v127, 0, v127
    v_add_f32 v124, 0x3727c5ac, v127
    v_rsq_f32 v124, v124
    s_nop 0
    v_mul_f32 v127, v127, v124
    v_fmaak_f32 v127, v127, v124, 0x3727c5ac
    v_rsq_f32 v127, v127
    s_nop 0
    v_mul_f32 v127, v127, v124
    v_mul_f32 v126, v126, v127
    v_fma_f32 v32, v32, v127, -v126
    v_fma_f32 v33, v33, v127, -v126
    v_fma_f32 v34, v34, v127, -v126
    v_fma_f32 v35, v35, v127, -v126
    v_fma_f32 v36, v36, v127, -v126
    v_fma_f32 v37, v37, v127, -v126
    v_fma_f32 v38, v38, v127, -v126
    v_fma_f32 v39, v39, v127, -v126
    v_cvt_pk_bf16_f32 v44, v32, v33
    v_cvt_pk_bf16_f32 v45, v34, v35
    v_cvt_pk_bf16_f32 v46, v36, v37
    v_cvt_pk_bf16_f32 v47, v38, v39
    s_add_u32 s54, s75, 11538432
    buffer_store_dwordx4 v[44:47], v2, s[44:47], s54 offen sc1
    s_waitcnt vmcnt(0)
    s_add_u32 s53, s61, 12288
    buffer_store_dword v3, off, s[44:47], s53 sc1
    v_add_u32 v100, 16384, v119
    v_add_u32 v101, 512, v100
    buffer_load_dword v102, v100, s[44:47], 0 offen sc1
    v_mov_b32 v124, v100
    v_mov_b32 v125, v101
    s_waitcnt vmcnt(0)
    v_cmp_ne_u32 vcc, s51, v102
    s_cbranch_vccz L_pcd_81
    s_mov_b32 s53, 0
L_pc_80:
    buffer_load_dword v102, v100, s[44:47], 0 offen sc1
    s_waitcnt vmcnt(0)
    v_cmp_ne_u32 vcc, s51, v102
    s_cbranch_vccz L_pcd_81
    s_add_u32 s53, s53, 1
    s_cmp_lg_u32 s52, 0
    s_cbranch_scc1 L_pcd_81
    s_cmp_lt_u32 s53, 0x8000
    s_cbranch_scc1 L_pc_80
    s_mov_b32 s52, 1
L_pcd_81:
    s_add_u32 s54, s69, 8388608
    buffer_load_dwordx4 v[64:67], v2, s[44:47], s54 offen sc1
    s_add_u32 s54, s69, 8388608
    buffer_load_dwordx4 v[68:71], v2, s[44:47], s54 offen offset:1024 sc1
    s_add_u32 s54, s69, 8388608
    buffer_load_dwordx4 v[72:75], v2, s[44:47], s54 offen offset:2048 sc1
    s_add_u32 s54, s69, 8388608
    buffer_load_dwordx4 v[76:79], v2, s[44:47], s54 offen offset:3072 sc1
    s_add_u32 s54, s69, 8392704
    buffer_load_dwordx4 v[80:83], v2, s[44:47], s54 offen sc1
    s_add_u32 s54, s69, 8392704
    buffer_load_dwordx4 v[84:87], v2, s[44:47], s54 offen offset:1024 sc1
    s_add_u32 s54, s69, 8392704
    buffer_load_dwordx4 v[88:91], v2, s[44:47], s54 offen offset:2048 sc1
    s_add_u32 s54, s69, 8392704
    buffer_load_dwordx4 v[92:95], v2, s[44:47], s54 offen offset:3072 sc1
    s_add_u32 s54, s69, 8396800
    buffer_load_dwordx4 v[96:99], v2, s[44:47], s54 offen sc1
    s_add_u32 s54, s69, 8396800
    buffer_load_dwordx4 v[100:103], v2, s[44:47], s54 offen offset:1024 sc1
    s_add_u32 s54, s69, 8396800
    buffer_load_dwordx4 v[104:107], v2, s[44:47], s54 offen offset:2048 sc1
    s_add_u32 s54, s69, 8396800
    buffer_load_dwordx4 v[108:111], v2, s[44:47], s54 offen offset:3072 sc1
    s_mov_b32 s4, s36
    s_and_b32 s5, s37, 0xffff
    s_mov_b32 s6, 1024
    s_mov_b32 s7, 0x00020000
    buffer_load_dwordx4 v[56:59], v123, s[4:7], 0 offen
    s_mov_b32 s53, 17825792
    buffer_load_dwordx4 v[60:63], v112, s[44:47], s53 offen sc1
    s_mov_b32 s8, s38
    s_and_b32 s9, s39, 0xffff
    s_mov_b32 s10, 2097152
    s_mov_b32 s11, 0x00020000
    s_waitcnt vmcnt(13)
    v_mfma_f32_32x32x16_bf16 a[224:239], a[0:3], v[64:67], 0
    v_mfma_f32_32x32x16_bf16 a[240:255], a[112:115], v[64:67], 0
    s_waitcnt vmcnt(12)
    v_mfma_f32_32x32x16_bf16 a[224:239], a[4:7], v[68:71], a[224:239]
    s_add_u32 s54, s69, 8400896
    buffer_load_dwordx4 v[64:67], v2, s[44:47], s54 offen sc1
    v_mfma_f32_32x32x16_bf16 a[240:255], a[116:119], v[68:71], a[240:255]
    s_waitcnt vmcnt(12)
    v_mfma_f32_32x32x16_bf16 a[224:239], a[8:11], v[72:75], a[224:239]
    s_add_u32 s54, s69, 8400896
    buffer_load_dwordx4 v[68:71], v2, s[44:47], s54 offen offset:1024 sc1
    v_mfma_f32_32x32x16_bf16 a[240:255], a[120:123], v[72:75], a[240:255]
    s_waitcnt vmcnt(12)
    v_mfma_f32_32x32x16_bf16 a[224:239], a[12:15], v[76:79], a[224:239]
    s_add_u32 s54, s69, 8400896
    buffer_load_dwordx4 v[72:75], v2, s[44:47], s54 offen offset:2048 sc1
    v_mfma_f32_32x32x16_bf16 a[240:255], a[124:127], v[76:79], a[240:255]
    s_waitcnt vmcnt(12)
    v_mfma_f32_32x32x16_bf16 a[224:239], a[16:19], v[80:83], a[224:239]
    s_add_u32 s54, s69, 8400896
    buffer_load_dwordx4 v[76:79], v2, s[44:47], s54 offen offset:3072 sc1
    v_mfma_f32_32x32x16_bf16 a[240:255], a[128:131], v[80:83], a[240:255]
    s_waitcnt vmcnt(12)
    v_mfma_f32_32x32x16_bf16 a[224:239], a[20:23], v[84:87], a[224:239]
    s_add_u32 s54, s69, 8404992
    buffer_load_dwordx4 v[80:83], v2, s[44:47], s54 offen sc1
    v_mfma_f32_32x32x16_bf16 a[240:255], a[132:135], v[84:87], a[240:255]
    s_waitcnt vmcnt(12)
    v_mfma_f32_32x32x16_bf16 a[224:239], a[24:27], v[88:91], a[224:239]
    s_add_u32 s54, s69, 8404992
    buffer_load_dwordx4 v[84:87], v2, s[44:47], s54 offen offset:1024 sc1
    v_mfma_f32_32x32x16_bf16 a[240:255], a[136:139], v[88:91], a[240:255]
    s_waitcnt vmcnt(12)
    v_mfma_f32_32x32x16_bf16 a[224:239], a[28:31], v[92:95], a[224:239]
    s_add_u32 s54, s69, 8404992
    buffer_load_dwordx4 v[88:91], v2, s[44:47], s54 offen offset:2048 sc1
    v_mfma_f32_32x32x16_bf16 a[240:255], a[140:143], v[92:95], a[240:255]
    s_waitcnt vmcnt(12)
    v_mfma_f32_32x32x16_bf16 a[224:239], a[32:35], v[96:99], a[224:239]
    s_add_u32 s54, s69, 8404992
    buffer_load_dwordx4 v[92:95], v2, s[44:47], s54 offen offset:3072 sc1
    v_mfma_f32_32x32x16_bf16 a[240:255], a[144:147], v[96:99], a[240:255]
    s_waitcnt vmcnt(12)
    v_mfma_f32_32x32x16_bf16 a[224:239], a[36:39], v[100:103], a[224:239]
    s_add_u32 s54, s69, 8409088
    buffer_load_dwordx4 v[96:99], v2, s[44:47], s54 offen sc1
    v_mfma_f32_32x32x16_bf16 a[240:255], a[148:151], v[100:103], a[240:255]
    s_waitcnt vmcnt(12)
    v_mfma_f32_32x32x16_bf16 a[224:239], a[40:43], v[104:107], a[224:239]
    s_add_u32 s54, s69, 8409088
    buffer_load_dwordx4 v[100:103], v2, s[44:47], s54 offen offset:1024 sc1
    v_mfma_f32_32x32x16_bf16 a[240:255], a[152:155], v[104:107], a[240:255]
    buffer_load_dword v126, v125, s[44:47], 0 offen sc1
    s_waitcnt vmcnt(13)
    v_mfma_f32_32x32x16_bf16 a[224:239], a[44:47], v[108:111], a[224:239]
    s_add_u32 s54, s69, 8409088
    buffer_load_dwordx4 v[104:107], v2, s[44:47], s54 offen offset:2048 sc1
    v_mfma_f32_32x32x16_bf16 a[240:255], a[156:159], v[108:111], a[240:255]
    s_waitcnt vmcnt(11)
    v_mfma_f32_32x32x16_bf16 a[224:239], a[48:51], v[64:67], a[224:239]
    s_add_u32 s54, s69, 8409088
    buffer_load_dwordx4 v[108:111], v2, s[44:47], s54 offen offset:3072 sc1
    v_mfma_f32_32x32x16_bf16 a[240:255], a[160:163], v[64:67], a[240:255]
    s_waitcnt vmcnt(11)
    v_mfma_f32_32x32x16_bf16 a[224:239], a[52:55], v[68:71], a[224:239]
    s_add_u32 s54, s69, 8413184
    buffer_load_dwordx4 v[64:67], v2, s[44:47], s54 offen sc1
    v_mfma_f32_32x32x16_bf16 a[240:255], a[164:167], v[68:71], a[240:255]
    s_waitcnt vmcnt(11)
    v_mfma_f32_32x32x16_bf16 a[224:239], a[56:59], v[72:75], a[224:239]
    s_add_u32 s54, s69, 8413184
    buffer_load_dwordx4 v[68:71], v2, s[44:47], s54 offen offset:1024 sc1
    v_mfma_f32_32x32x16_bf16 a[240:255], a[168:171], v[72:75], a[240:255]
    s_waitcnt vmcnt(11)
    v_mfma_f32_32x32x16_bf16 a[224:239], a[60:63], v[76:79], a[224:239]
    s_add_u32 s54, s69, 8413184
    buffer_load_dwordx4 v[72:75], v2, s[44:47], s54 offen offset:2048 sc1
    v_mfma_f32_32x32x16_bf16 a[240:255], a[172:175], v[76:79], a[240:255]
    s_waitcnt vmcnt(5)
    v_cmp_ne_u32 vcc, s51, v126
    s_cbranch_vccz L_pcd_83
    s_mov_b32 s53, 0
L_pc_82:
    buffer_load_dword v126, v125, s[44:47], 0 offen sc1
    s_waitcnt vmcnt(0)
    v_cmp_ne_u32 vcc, s51, v126
    s_cbranch_vccz L_pcd_83
    s_add_u32 s53, s53, 1
    s_cmp_lg_u32 s52, 0
    s_cbranch_scc1 L_pcd_83
    s_cmp_lt_u32 s53, 0x8000
    s_cbranch_scc1 L_pc_82
    s_mov_b32 s52, 1
L_pcd_83:
    v_mfma_f32_32x32x16_bf16 a[224:239], a[64:67], v[80:83], a[224:239]
    s_add_u32 s54, s69, 8413184
    buffer_load_dwordx4 v[76:79], v2, s[44:47], s54 offen offset:3072 sc1
    v_mfma_f32_32x32x16_bf16 a[240:255], a[176:179], v[80:83], a[240:255]
    v_mfma_f32_32x32x16_bf16 a[224:239], a[68:71], v[84:87], a[224:239]
    s_add_u32 s54, s69, 8617984
    buffer_load_dwordx4 v[80:83], v2, s[44:47], s54 offen sc1
    v_mfma_f32_32x32x16_bf16 a[240:255], a[180:183], v[84:87], a[240:255]
    v_mfma_f32_32x32x16_bf16 a[224:239], a[72:75], v[88:91], a[224:239]
    s_add_u32 s54, s69, 8617984
    buffer_load_dwordx4 v[84:87], v2, s[44:47], s54 offen offset:1024 sc1
    v_mfma_f32_32x32x16_bf16 a[240:255], a[184:187], v[88:91], a[240:255]
    v_mfma_f32_32x32x16_bf16 a[224:239], a[76:79], v[92:95], a[224:239]
    s_add_u32 s54, s69, 8617984
    buffer_load_dwordx4 v[88:91], v2, s[44:47], s54 offen offset:2048 sc1
    v_mfma_f32_32x32x16_bf16 a[240:255], a[188:191], v[92:95], a[240:255]
    v_mfma_f32_32x32x16_bf16 a[224:239], a[80:83], v[96:99], a[224:239]
    s_add_u32 s54, s69, 8617984
    buffer_load_dwordx4 v[92:95], v2, s[44:47], s54 offen offset:3072 sc1
    v_mfma_f32_32x32x16_bf16 a[240:255], a[192:195], v[96:99], a[240:255]
    v_mfma_f32_32x32x16_bf16 a[224:239], a[84:87], v[100:103], a[224:239]
    s_add_u32 s54, s69, 8622080
    buffer_load_dwordx4 v[96:99], v2, s[44:47], s54 offen sc1
    v_mfma_f32_32x32x16_bf16 a[240:255], a[196:199], v[100:103], a[240:255]
    s_waitcnt vmcnt(10)
    v_mfma_f32_32x32x16_bf16 a[224:239], a[88:91], v[104:107], a[224:239]
    s_add_u32 s54, s69, 8622080
    buffer_load_dwordx4 v[100:103], v2, s[44:47], s54 offen offset:1024 sc1
    v_mfma_f32_32x32x16_bf16 a[240:255], a[200:203], v[104:107], a[240:255]
    s_waitcnt vmcnt(10)
    v_mfma_f32_32x32x16_bf16 a[224:239], a[92:95], v[108:111], a[224:239]
    s_add_u32 s54, s69, 8622080
    buffer_load_dwordx4 v[104:107], v2, s[44:47], s54 offen offset:2048 sc1
    v_mfma_f32_32x32x16_bf16 a[240:255], a[204:207], v[108:111], a[240:255]
    s_waitcnt vmcnt(10)
    v_mfma_f32_32x32x16_bf16 a[224:239], a[96:99], v[64:67], a[224:239]
    s_add_u32 s54, s69, 8622080
    buffer_load_dwordx4 v[108:111], v2, s[44:47], s54 offen offset:3072 sc1
    v_mfma_f32_32x32x16_bf16 a[240:255], a[208:211], v[64:67], a[240:255]
    s_waitcnt vmcnt(10)
    v_mfma_f32_32x32x16_bf16 a[224:239], a[100:103], v[68:71], a[224:239]
    s_add_u32 s54, s69, 8626176
    buffer_load_dwordx4 v[64:67], v2, s[44:47], s54 offen sc1
    v_mfma_f32_32x32x16_bf16 a[240:255], a[212:215], v[68:71], a[240:255]
    s_waitcnt vmcnt(10)
    v_mfma_f32_32x32x16_bf16 a[224:239], a[104:107], v[72:75], a[224:239]
    s_add_u32 s54, s69, 8626176
    buffer_load_dwordx4 v[68:71], v2, s[44:47], s54 offen offset:1024 sc1
    v_mfma_f32_32x32x16_bf16 a[240:255], a[216:219], v[72:75], a[240:255]
    s_waitcnt vmcnt(10)
    v_mfma_f32_32x32x16_bf16 a[224:239], a[108:111], v[76:79], a[224:239]
    s_add_u32 s54, s69, 8626176
    buffer_load_dwordx4 v[72:75], v2, s[44:47], s54 offen offset:2048 sc1
    v_mfma_f32_32x32x16_bf16 a[240:255], a[220:223], v[76:79], a[240:255]
    s_waitcnt vmcnt(10)
    v_mfma_f32_32x32x16_bf16 v[16:31], a[0:3], v[80:83], 0
    s_add_u32 s54, s69, 8626176
    buffer_load_dwordx4 v[76:79], v2, s[44:47], s54 offen offset:3072 sc1
    v_mfma_f32_32x32x16_bf16 v[32:47], a[112:115], v[80:83], 0
    s_waitcnt vmcnt(10)
    v_mfma_f32_32x32x16_bf16 v[16:31], a[4:7], v[84:87], v[16:31]
    s_add_u32 s54, s69, 8630272
    buffer_load_dwordx4 v[80:83], v2, s[44:47], s54 offen sc1
    v_mfma_f32_32x32x16_bf16 v[32:47], a[116:119], v[84:87], v[32:47]
    s_waitcnt vmcnt(10)
    v_mfma_f32_32x32x16_bf16 v[16:31], a[8:11], v[88:91], v[16:31]
    s_add_u32 s54, s69, 8630272
    buffer_load_dwordx4 v[84:87], v2, s[44:47], s54 offen offset:1024 sc1
    v_mfma_f32_32x32x16_bf16 v[32:47], a[120:123], v[88:91], v[32:47]
    ds_write_b128 v115, a[224:227] offset:0
    ds_write_b128 v116, a[228:231] offset:0
    s_waitcnt vmcnt(10)
    v_mfma_f32_32x32x16_bf16 v[16:31], a[12:15], v[92:95], v[16:31]
    s_add_u32 s54, s69, 8630272
    buffer_load_dwordx4 v[88:91], v2, s[44:47], s54 offen offset:2048 sc1
    v_mfma_f32_32x32x16_bf16 v[32:47], a[124:127], v[92:95], v[32:47]
    ds_write_b128 v117, a[232:235] offset:0
    ds_write_b128 v118, a[236:239] offset:0
    s_waitcnt vmcnt(10)
    v_mfma_f32_32x32x16_bf16 v[16:31], a[16:19], v[96:99], v[16:31]
    s_add_u32 s54, s69, 8630272
    buffer_load_dwordx4 v[92:95], v2, s[44:47], s54 offen offset:3072 sc1
    v_mfma_f32_32x32x16_bf16 v[32:47], a[128:131], v[96:99], v[32:47]
    ds_write_b128 v115, a[240:243] offset:128
    ds_write_b128 v116, a[244:247] offset:128
    s_waitcnt vmcnt(10)
    v_mfma_f32_32x32x16_bf16 v[16:31], a[20:23], v[100:103], v[16:31]
    s_add_u32 s54, s69, 8634368
    buffer_load_dwordx4 v[96:99], v2, s[44:47], s54 offen sc1
    v_mfma_f32_32x32x16_bf16 v[32:47], a[132:135], v[100:103], v[32:47]
    ds_write_b128 v117, a[248:251] offset:128
    ds_write_b128 v118, a[252:255] offset:128
    s_waitcnt vmcnt(10)
    v_mfma_f32_32x32x16_bf16 v[16:31], a[24:27], v[104:107], v[16:31]
    s_add_u32 s54, s69, 8634368
    buffer_load_dwordx4 v[100:103], v2, s[44:47], s54 offen offset:1024 sc1
    v_mfma_f32_32x32x16_bf16 v[32:47], a[136:139], v[104:107], v[32:47]
    s_waitcnt vmcnt(10)
    v_mfma_f32_32x32x16_bf16 v[16:31], a[28:31], v[108:111], v[16:31]
    s_add_u32 s54, s69, 8634368
    buffer_load_dwordx4 v[104:107], v2, s[44:47], s54 offen offset:2048 sc1
    v_mfma_f32_32x32x16_bf16 v[32:47], a[140:143], v[108:111], v[32:47]
    s_waitcnt lgkmcnt(0)
    s_barrier
    s_waitcnt vmcnt(10)
    v_mfma_f32_32x32x16_bf16 v[16:31], a[32:35], v[64:67], v[16:31]
    s_add_u32 s54, s69, 8634368
    buffer_load_dwordx4 v[108:111], v2, s[44:47], s54 offen offset:3072 sc1
    v_mfma_f32_32x32x16_bf16 v[32:47], a[144:147], v[64:67], v[32:47]
    ds_read_b128 v[48:51], v113 offset:0
    ds_read_b128 v[52:55], v113 offset:8192
    s_waitcnt lgkmcnt(0)
    v_add_f32 v48, v48, v52
    v_add_f32 v49, v49, v53
    v_add_f32 v50, v50, v54
    v_add_f32 v51, v51, v55
    ds_read_b128 v[52:55], v113 offset:16384
    s_waitcnt vmcnt(10)
    v_mfma_f32_32x32x16_bf16 v[16:31], a[36:39], v[68:71], v[16:31]
    s_add_u32 s54, s69, 8638464
    buffer_load_dwordx4 v[64:67], v2, s[44:47], s54 offen sc1
    v_mfma_f32_32x32x16_bf16 v[32:47], a[148:151], v[68:71], v[32:47]
    s_waitcnt lgkmcnt(0)
    v_add_f32 v48, v48, v52
    v_add_f32 v49, v49, v53
    v_add_f32 v50, v50, v54
    v_add_f32 v51, v51, v55
    ds_read_b128 v[52:55], v113 offset:24576
    s_waitcnt vmcnt(10)
    v_mfma_f32_32x32x16_bf16 v[16:31], a[40:43], v[72:75], v[16:31]
    s_add_u32 s54, s69, 8638464
    buffer_load_dwordx4 v[68:71], v2, s[44:47], s54 offen offset:1024 sc1
    v_mfma_f32_32x32x16_bf16 v[32:47], a[152:155], v[72:75], v[32:47]
    s_waitcnt lgkmcnt(0)
    v_add_f32 v48, v48, v52
    v_add_f32 v49, v49, v53
    v_add_f32 v50, v50, v54
    v_add_f32 v51, v51, v55
    v_lshlrev_b32 v52, 16, v56
    v_and_b32 v53, 0xffff0000, v56
    v_lshlrev_b32 v54, 16, v57
    v_and_b32 v55, 0xffff0000, v57
    v_add_f32 v48, v48, v52
    v_add_f32 v49, v49, v53
    v_add_f32 v50, v50, v54
    v_add_f32 v51, v51, v55
    s_waitcnt vmcnt(10)
    v_mfma_f32_32x32x16_bf16 v[16:31], a[44:47], v[76:79], v[16:31]
    s_add_u32 s54, s69, 8638464
    buffer_load_dwordx4 v[72:75], v2, s[44:47], s54 offen offset:2048 sc1
    v_mfma_f32_32x32x16_bf16 v[32:47], a[156:159], v[76:79], v[32:47]
    v_cvt_pk_bf16_f32 v52, v48, v49
    v_cvt_pk_bf16_f32 v53, v50, v51
    v_lshlrev_b32 v48, 16, v52
    v_and_b32 v49, 0xffff0000, v52
    v_lshlrev_b32 v50, 16, v53
    v_and_b32 v51, 0xffff0000, v53
    s_waitcnt vmcnt(10)
    v_mfma_f32_32x32x16_bf16 v[16:31], a[48:51], v[80:83], v[16:31]
    s_add_u32 s54, s69, 8638464
    buffer_load_dwordx4 v[76:79], v2, s[44:47], s54 offen offset:3072 sc1
    v_mfma_f32_32x32x16_bf16 v[32:47], a[160:163], v[80:83], v[32:47]
    v_lshlrev_b32 v52, 16, v60
    v_and_b32 v53, 0xffff0000, v60
    v_lshlrev_b32 v54, 16, v61
    v_and_b32 v55, 0xffff0000, v61
    v_add_f32 v48, v48, v52
    v_add_f32 v49, v49, v53
    v_add_f32 v50, v50, v54
    v_add_f32 v51, v51, v55
    v_cvt_pk_bf16_f32 v12, v48, v49
    v_cvt_pk_bf16_f32 v13, v50, v51
    s_waitcnt vmcnt(10)
    v_mfma_f32_32x32x16_bf16 v[16:31], a[52:55], v[84:87], v[16:31]
    s_add_u32 s54, s69, 8642560
    buffer_load_dwordx4 v[80:83], v2, s[44:47], s54 offen sc1
    v_mfma_f32_32x32x16_bf16 v[32:47], a[164:167], v[84:87], v[32:47]
    ds_read_b128 v[48:51], v114 offset:0
    ds_read_b128 v[52:55], v114 offset:8192
    s_waitcnt vmcnt(10)
    v_mfma_f32_32x32x16_bf16 v[16:31], a[56:59], v[88:91], v[16:31]
    s_add_u32 s54, s69, 8642560
    buffer_load_dwordx4 v[84:87], v2, s[44:47], s54 offen offset:1024 sc1
    v_mfma_f32_32x32x16_bf16 v[32:47], a[168:171], v[88:91], v[32:47]
    s_waitcnt lgkmcnt(0)
    v_add_f32 v48, v48, v52
    v_add_f32 v49, v49, v53
    v_add_f32 v50, v50, v54
    v_add_f32 v51, v51, v55
    ds_read_b128 v[52:55], v114 offset:16384
    s_waitcnt lgkmcnt(0)
    v_add_f32 v48, v48, v52
    v_add_f32 v49, v49, v53
    v_add_f32 v50, v50, v54
    v_add_f32 v51, v51, v55
    ds_read_b128 v[52:55], v114 offset:24576
    s_waitcnt vmcnt(10)
    v_mfma_f32_32x32x16_bf16 v[16:31], a[60:63], v[92:95], v[16:31]
    s_add_u32 s54, s69, 8642560
    buffer_load_dwordx4 v[88:91], v2, s[44:47], s54 offen offset:2048 sc1
    v_mfma_f32_32x32x16_bf16 v[32:47], a[172:175], v[92:95], v[32:47]
    s_waitcnt lgkmcnt(0)
    v_add_f32 v48, v48, v52
    v_add_f32 v49, v49, v53
    v_add_f32 v50, v50, v54
    v_add_f32 v51, v51, v55
    s_waitcnt vmcnt(10)
    v_mfma_f32_32x32x16_bf16 v[16:31], a[64:67], v[96:99], v[16:31]
    s_add_u32 s54, s69, 8642560
    buffer_load_dwordx4 v[92:95], v2, s[44:47], s54 offen offset:3072 sc1
    v_mfma_f32_32x32x16_bf16 v[32:47], a[176:179], v[96:99], v[32:47]
    v_lshlrev_b32 v52, 16, v58
    v_and_b32 v53, 0xffff0000, v58
    v_lshlrev_b32 v54, 16, v59
    v_and_b32 v55, 0xffff0000, v59
    v_add_f32 v48, v48, v52
    v_add_f32 v49, v49, v53
    v_add_f32 v50, v50, v54
    v_add_f32 v51, v51, v55
    v_cvt_pk_bf16_f32 v52, v48, v49
    v_cvt_pk_bf16_f32 v53, v50, v51
    v_lshlrev_b32 v48, 16, v52
    v_and_b32 v49, 0xffff0000, v52
    v_lshlrev_b32 v50, 16, v53
    v_and_b32 v51, 0xffff0000, v53
    s_waitcnt vmcnt(10)
    v_mfma_f32_32x32x16_bf16 v[16:31], a[68:71], v[100:103], v[16:31]
    v_mfma_f32_32x32x16_bf16 v[32:47], a[180:183], v[100:103], v[32:47]
    v_lshlrev_b32 v52, 16, v62
    v_and_b32 v53, 0xffff0000, v62
    v_lshlrev_b32 v54, 16, v63
    v_and_b32 v55, 0xffff0000, v63
    v_add_f32 v48, v48, v52
    v_add_f32 v49, v49, v53
    v_add_f32 v50, v50, v54
    v_add_f32 v51, v51, v55
    s_waitcnt vmcnt(9)
    v_mfma_f32_32x32x16_bf16 v[16:31], a[72:75], v[104:107], v[16:31]
    v_mfma_f32_32x32x16_bf16 v[32:47], a[184:187], v[104:107], v[32:47]
    v_cvt_pk_bf16_f32 v14, v48, v49
    v_cvt_pk_bf16_f32 v15, v50, v51
    s_mov_b32 s53, 0
    buffer_store_dwordx4 v[12:15], v112, s[8:11], s53 offen sc1
    s_waitcnt vmcnt(9)
    v_mfma_f32_32x32x16_bf16 v[16:31], a[76:79], v[108:111], v[16:31]
    v_mfma_f32_32x32x16_bf16 v[32:47], a[188:191], v[108:111], v[32:47]
    s_waitcnt vmcnt(8)
    v_mfma_f32_32x32x16_bf16 v[16:31], a[80:83], v[64:67], v[16:31]
    v_mfma_f32_32x32x16_bf16 v[32:47], a[192:195], v[64:67], v[32:47]
    s_waitcnt vmcnt(7)
    v_mfma_f32_32x32x16_bf16 v[16:31], a[84:87], v[68:71], v[16:31]
    v_mfma_f32_32x32x16_bf16 v[32:47], a[196:199], v[68:71], v[32:47]
    s_waitcnt vmcnt(6)
    v_mfma_f32_32x32x16_bf16 v[16:31], a[88:91], v[72:75], v[16:31]
    v_mfma_f32_32x32x16_bf16 v[32:47], a[200:203], v[72:75], v[32:47]
    s_mov_b32 s53, 17829888
    buffer_load_dwordx4 v[60:63], v112, s[44:47], s53 offen sc1
    s_waitcnt vmcnt(6)
    v_mfma_f32_32x32x16_bf16 v[16:31], a[92:95], v[76:79], v[16:31]
    v_mfma_f32_32x32x16_bf16 v[32:47], a[204:207], v[76:79], v[32:47]
    s_waitcnt vmcnt(5)
    v_mfma_f32_32x32x16_bf16 v[16:31], a[96:99], v[80:83], v[16:31]
    v_mfma_f32_32x32x16_bf16 v[32:47], a[208:211], v[80:83], v[32:47]
    s_waitcnt vmcnt(4)
    v_mfma_f32_32x32x16_bf16 v[16:31], a[100:103], v[84:87], v[16:31]
    v_mfma_f32_32x32x16_bf16 v[32:47], a[212:215], v[84:87], v[32:47]
    s_waitcnt vmcnt(3)
    v_mfma_f32_32x32x16_bf16 v[16:31], a[104:107], v[88:91], v[16:31]
    v_mfma_f32_32x32x16_bf16 v[32:47], a[216:219], v[88:91], v[32:47]
    s_waitcnt vmcnt(2)
    v_mfma_f32_32x32x16_bf16 v[16:31], a[108:111], v[92:95], v[16:31]
    v_mfma_f32_32x32x16_bf16 v[32:47], a[220:223], v[92:95], v[32:47]
L_ldone_67:
    s_nop 11
    ds_write_b128 v115, v[16:19] offset:32768
    ds_write_b128 v116, v[20:23] offset:32768
    ds_write_b128 v117, v[24:27] offset:32768
    ds_write_b128 v118, v[28:31] offset:32768
    ds_write_b128 v115, v[32:35] offset:32896
    ds_write_b128 v116, v[36:39] offset:32896
    ds_write_b128 v117, v[40:43] offset:32896
    ds_write_b128 v118, v[44:47] offset:32896
    s_waitcnt lgkmcnt(0)
    s_barrier
    ds_read_b128 v[64:67], v113 offset:32768
    ds_read_b128 v[68:71], v114 offset:32768
    ds_read_b128 v[72:75], v113 offset:40960
    ds_read_b128 v[76:79], v114 offset:40960
    ds_read_b128 v[80:83], v113 offset:49152
    ds_read_b128 v[84:87], v114 offset:49152
    ds_read_b128 v[88:91], v113 offset:57344
    ds_read_b128 v[92:95], v114 offset:57344
    v_lshlrev_b32 v96, 16, v56
    v_and_b32 v97, 0xffff0000, v56
    v_lshlrev_b32 v98, 16, v57
    v_and_b32 v99, 0xffff0000, v57
    v_lshlrev_b32 v100, 16, v58
    v_and_b32 v101, 0xffff0000, v58
    v_lshlrev_b32 v102, 16, v59
    v_and_b32 v103, 0xffff0000, v59
    s_waitcnt lgkmcnt(4)
    v_pk_add_f32 v[64:65], v[64:65], v[72:73]
    v_pk_add_f32 v[66:67], v[66:67], v[74:75]
    v_pk_add_f32 v[68:69], v[68:69], v[76:77]
    v_pk_add_f32 v[70:71], v[70:71], v[78:79]
    v_pk_add_f32 v[64:65], v[64:65], v[96:97]
    v_pk_add_f32 v[66:67], v[66:67], v[98:99]
    v_pk_add_f32 v[68:69], v[68:69], v[100:101]
    v_pk_add_f32 v[70:71], v[70:71], v[102:103]
    s_waitcnt lgkmcnt(0)
    v_pk_add_f32 v[80:81], v[80:81], v[88:89]
    v_pk_add_f32 v[82:83], v[82:83], v[90:91]
    v_pk_add_f32 v[84:85], v[84:85], v[92:93]
    v_pk_add_f32 v[86:87], v[86:87], v[94:95]
    v_pk_add_f32 v[64:65], v[64:65], v[80:81]
    v_pk_add_f32 v[66:67], v[66:67], v[82:83]
    v_pk_add_f32 v[68:69], v[68:69], v[84:85]
    v_pk_add_f32 v[70:71], v[70:71], v[86:87]
    v_cvt_pk_bf16_f32 v72, v64, v65
    v_cvt_pk_bf16_f32 v73, v66, v67
    v_cvt_pk_bf16_f32 v74, v68, v69
    v_cvt_pk_bf16_f32 v75, v70, v71
    v_lshlrev_b32 v64, 16, v72
    v_and_b32 v65, 0xffff0000, v72
    v_lshlrev_b32 v66, 16, v73
    v_and_b32 v67, 0xffff0000, v73
    v_lshlrev_b32 v68, 16, v74
    v_and_b32 v69, 0xffff0000, v74
    v_lshlrev_b32 v70, 16, v75
    v_and_b32 v71, 0xffff0000, v75
    s_waitcnt vmcnt(0)
    v_lshlrev_b32 v80, 16, v60
    v_and_b32 v81, 0xffff0000, v60
    v_lshlrev_b32 v82, 16, v61
    v_and_b32 v83, 0xffff0000, v61
    v_lshlrev_b32 v84, 16, v62
    v_and_b32 v85, 0xffff0000, v62
    v_lshlrev_b32 v86, 16, v63
    v_and_b32 v87, 0xffff0000, v63
    v_pk_add_f32 v[64:65], v[64:65], v[80:81]
    v_pk_add_f32 v[66:67], v[66:67], v[82:83]
    v_pk_add_f32 v[68:69], v[68:69], v[84:85]
    v_pk_add_f32 v[70:71], v[70:71], v[86:87]
    v_cvt_pk_bf16_f32 v72, v64, v65
    v_cvt_pk_bf16_f32 v73, v66, v67
    v_cvt_pk_bf16_f32 v74, v68, v69
    v_cvt_pk_bf16_f32 v75, v70, v71
    s_mov_b32 s53, 4096
    buffer_store_dwordx4 v[72:75], v112, s[8:11], s53 offen sc1
    s_branch L_fin
L_code_end:
.section .rodata,"a"
.p2align 6
.amdhsa_kernel interleave_layers__ssm_conv_h3__mixer_channel_mlp__prompt_kernel
  .amdhsa_next_free_vgpr 512
  .amdhsa_next_free_sgpr 102
  .amdhsa_accum_offset 256
  .amdhsa_group_segment_fixed_size 0
  .amdhsa_kernarg_size 112
  .amdhsa_user_sgpr_count 2
  .amdhsa_user_sgpr_kernarg_segment_ptr 1
  .amdhsa_system_sgpr_workgroup_id_x 1
.end_amdhsa_kernel
```
